```python
import torch

def _softmax(x, axis=-1):
    return torch.softmax(x, dim=axis)

def _gelu(x):
    return torch.nn.functional.gelu(x, approximate='tanh')

def _silu(x):
    return torch.nn.functional.silu(x)

def _sigmoid(x):
    return torch.sigmoid(x)

def _layernorm(x, axis=-1, eps=1e-05):
    m = x.mean(dim=axis, keepdim=True)
    v = x.var(dim=axis, keepdim=True, unbiased=False)
    return (x - m) / torch.sqrt(v + eps)

def _scatter_add(tgt, idx, src, axis=0):
    return tgt.clone().index_add_(axis, idx, src)

def _segment_sum(src, seg, n):
    out = torch.zeros((n,) + src.shape[1:], dtype=src.dtype)
    return out.index_add_(0, seg, src)

def _pad(x, pw):
    flat = tuple((v for pair in reversed(pw) for v in pair))
    return torch.nn.functional.pad(x, flat)
kernel_name = 'adaLN_cond__sliding_block_cached__glu_gated_swiglu__prompt'

def setup_inputs():

    _w = lambda a: (lambda t: t.to(torch.bfloat16) if t.is_floating_point() else t)(torch.as_tensor(a))

    def _A_setup():
        B, Sq, D = (1, 2048, 640)
        Hq, Hkv, Sk, Dh = (32, 32, 2048, 192)
        assert Hq % Hkv == 0, (Hq, Hkv)
        return {'x': _w((lambda *s: torch.randn(*s, dtype=torch.bfloat16) * 0.05)(B, Sq, D)), 'k_cache': _w((lambda *s: torch.randn(*s, dtype=torch.bfloat16) * 1.6)(B, Hkv, Sk, Dh)), 'v_cache': _w((lambda *s: torch.randn(*s, dtype=torch.bfloat16) * 0.8)(B, Hkv, Sk, Dh)), 'wq': _w((lambda *s: torch.randn(*s, dtype=torch.bfloat16) * 1.6)(D, Hq * Dh) * D ** (-0.5)), 'wo': _w((lambda *s: torch.randn(*s, dtype=torch.bfloat16) * 0.8)(Hq * Dh, D) * (Hq * Dh) ** (-0.5))}
    _A_in = _A_setup()

    def _B_setup():
        B, S, D, F = (1, 2048, 640, 1536)
        return {'x': _w((lambda *s: torch.randn(*s, dtype=torch.bfloat16) * 0.05)(B, S, D)), 'w1': _w((lambda *s: torch.randn(*s, dtype=torch.bfloat16) * 0.4)(D, F) * (2.0 / D) ** 0.5), 'w3': _w((lambda *s: torch.randn(*s, dtype=torch.bfloat16) * 0.4)(D, F) * (2.0 / D) ** 0.5), 'w2': _w((lambda *s: torch.randn(*s, dtype=torch.bfloat16) * 0.4)(F, D) * (2.0 / F) ** 0.5)}
    _B_in = _B_setup()
    return {'A_x': _A_in['x'], 'A_k_cache': _A_in['k_cache'], 'A_v_cache': _A_in['v_cache'], 'A_wq': _A_in['wq'], 'A_wo': _A_in['wo'], 'B_x': _B_in['x'], 'B_w1': _B_in['w1'], 'B_w3': _B_in['w3'], 'B_w2': _B_in['w2'], 'c': _w((lambda *s: torch.randn(*s, dtype=torch.bfloat16) * 0.2)(1, 640) * 8.0), 'w_mod': _w((lambda *s: torch.randn(*s, dtype=torch.bfloat16) * 0.2)(640, 6 * 640) * 640 ** (-0.5) * 8.0)}

def reference(A_x, A_k_cache, A_v_cache, A_wq, A_wo, B_x, B_w1, B_w3, B_w2, c, w_mod):

    def _A_ref(x, k_cache, v_cache, wq, wo):
        B, Sq, D = x.shape
        Hq, Dh = (32, 192)
        Hkv, Sk = (k_cache.shape[1], k_cache.shape[2])
        W = min(4096, max(256, Sk // 4))
        rep = Hq // Hkv
        q = (lambda x, *d: x.permute(*d))((x @ wq).reshape(B, Sq, Hq, Dh), 0, 2, 1, 3)
        k = (lambda x, n, axis: torch.repeat_interleave(x, n, dim=axis))(k_cache[:, :, Sk - W:, :], rep, axis=1)
        v = (lambda x, n, axis: torch.repeat_interleave(x, n, dim=axis))(v_cache[:, :, Sk - W:, :], rep, axis=1)
        scores = torch.einsum('bhqd,bhkd->bhqk', q, k) * Dh ** (-0.5)
        p = _softmax(scores, axis=-1)
        o = torch.einsum('bhqk,bhkd->bhqd', p, v)
        return (lambda x, *d: x.permute(*d))(o, 0, 2, 1, 3).reshape(B, Sq, Hq * Dh) @ wo

    def _B_ref(x, w1, w3, w2):
        gate = torch.einsum('bsd,df->bsf', x, w1)
        up = torch.einsum('bsd,df->bsf', x, w3)
        h = _silu(gate) * up
        out = torch.einsum('bsf,fd->bsd', h, w2)
        return out
    x = A_x
    mod = (_silu(c) @ w_mod).reshape(c.shape[0], 6, 1, -1)
    sa, ca, ga, sb, cb, gb = (mod[:, 0].clone(), mod[:, 1].clone(), mod[:, 2].clone(), mod[:, 3].clone(), mod[:, 4].clone(), mod[:, 5].clone())
    h = _layernorm(x, axis=-1) * (1 + ca) + sa
    x = x + ga * _A_ref(h, A_k_cache, A_v_cache, A_wq, A_wo)
    h = _layernorm(x, axis=-1) * (1 + cb) + sb
    x = x + gb * _B_ref(h, B_w1, B_w3, B_w2)
    return x
```

```asm
; @launch grid=(256,1,1) block=(256,1,1) lds=163840
.amdgcn_target "amdgcn-amd-amdhsa--gfx950"
.text
.globl adaLN_cond__sliding_block_cached__glu_gated_swiglu__prompt_kernel
.p2align 8
.type adaLN_cond__sliding_block_cached__glu_gated_swiglu__prompt_kernel,@function
adaLN_cond__sliding_block_cached__glu_gated_swiglu__prompt_kernel:
  s_cmp_ge_u32 s2, 256
  s_cbranch_scc1 L_end
  s_getpc_b64 s[96:97]
  v_lshlrev_b32 v2, 6, v0
  v_mov_b32 v3, 0
  v_lshl_add_u64 v[2:3], v[2:3], 0, s[96:97]
  global_load_dword a225, v[2:3], off
  s_load_dwordx8 s[4:11], s[0:1], 0
  s_load_dwordx2 s[12:13], s[0:1], 32
  s_load_dwordx8 s[16:23], s[0:1], 48
  s_load_dwordx4 s[24:27], s[0:1], 80
  s_load_dwordx2 s[28:29], s[0:1], 104
  v_lshrrev_b32 v1, 6, v0
  s_and_b32 s31, s2, 7
  v_readfirstlane_b32 s30, v1
  s_lshr_b32 s35, s2, 3
  s_and_b32 s32, s35, 3
  s_lshr_b32 s33, s2, 5
  s_lshl_b32 s34, s31, 2
  s_add_u32 s34, s34, s32
  v_and_b32 v1, 63, v0
  s_mul_i32 s68, s30, 3072
  s_waitcnt lgkmcnt(0)
  s_add_u32 s92, s28, 60317696
  s_addc_u32 s93, s29, 0
  s_mov_b32 s94, 311296
  s_mov_b32 s95, 0x20000
  s_load_dword s14, s[92:93], 0
  s_add_u32 s88, s28, 60293120
  s_addc_u32 s89, s29, 0
  s_mov_b32 s90, 15360
  s_mov_b32 s91, 0x20000
  s_lshr_b32 s60, s2, 5
  s_lshl_b32 s60, s60, 3
  s_add_u32 s60, s60, s31
  s_lshl_b32 s60, s60, 2
  s_add_u32 s76, s60, s32
  s_cmp_lt_u32 s76, 240
  s_cselect_b32 s63, s76, 0
  s_cselect_b32 s64, 1, 0
  s_lshl_b32 s61, s63, 5
  s_sub_u32 s62, 4915200, s61
  s_mul_i32 s62, s62, s64
  s_add_u32 s40, s24, s61
  s_addc_u32 s41, s25, 0
  s_mov_b32 s42, s62
  s_mov_b32 s43, 0x20000
  s_mov_b32 s56, s22
  s_mov_b32 s57, s23
  s_mov_b32 s58, 1280
  s_mov_b32 s59, 0x20000
  s_lshl_b32 s61, s63, 6
  s_lshl_b32 s62, s64, 6
  s_add_u32 s84, s28, s61
  s_addc_u32 s85, s29, 0
  s_add_u32 s84, s84, 60293120
  s_addc_u32 s85, s85, 0
  s_mov_b32 s86, s62
  s_mov_b32 s87, 0x20000
  v_lshrrev_b32 v2, 1, v0
  v_and_b32 v3, 1, v0
  v_mul_u32_u24 v4, 7680, v2
  v_lshl_add_u32 v4, v3, 4, v4
  v_lshlrev_b32 v5, 1, v2
  buffer_load_ushort v100, v5, s[56:59], 0 offen offset:0
  buffer_load_ushort v101, v5, s[56:59], 0 offen offset:256
  buffer_load_ushort v102, v5, s[56:59], 0 offen offset:512
  buffer_load_ushort v103, v5, s[56:59], 0 offen offset:768
  buffer_load_ushort v104, v5, s[56:59], 0 offen offset:1024
  s_mov_b32 s66, 0
  buffer_load_dwordx4 v[108:111], v4, s[40:43], s66 offen
  s_mov_b32 s66, 983040
  buffer_load_dwordx4 v[112:115], v4, s[40:43], s66 offen
  s_mov_b32 s66, 1966080
  buffer_load_dwordx4 v[116:119], v4, s[40:43], s66 offen
  s_mov_b32 s66, 2949120
  buffer_load_dwordx4 v[120:123], v4, s[40:43], s66 offen
  s_mov_b32 s66, 3932160
  buffer_load_dwordx4 v[124:127], v4, s[40:43], s66 offen
  v_lshrrev_b32 v128, 4, v0
  v_lshlrev_b32 v128, 6, v128
  v_lshl_add_u32 v128, v3, 5, v128
  v_add_u32 v128, 160768, v128
  v_and_b32 v129, 15, v0
  v_lshlrev_b32 v129, 2, v129
  v_add_u32 v130, 160768, v129
  s_lshl_b32 s60, s33, 3
  s_add_u32 s60, s60, s31
  s_lshl_b32 s63, s32, 3
  s_mul_i32 s61, s60, 40960
  s_lshl_b32 s62, s60, 5
  s_add_u32 s62, s62, s63
  s_mul_i32 s62, s62, 1280
  s_add_u32 s36, s4, s62
  s_addc_u32 s37, s5, 0
  s_mov_b32 s38, 10240
  s_mov_b32 s39, 0x20000
  s_add_u32 s48, s28, s61
  s_addc_u32 s49, s29, 0
  s_mov_b32 s50, 40960
  s_mov_b32 s51, 0x20000
  v_and_b32 v24, 7, v0
  v_lshrrev_b32 v25, 3, v0
  v_mul_u32_u24 v26, 1280, v24
  v_mov_b32 v35, 2130706432
  v_cmp_gt_u32 vcc, 128, v0
  v_add_u32 v29, s63, v24
  v_lshlrev_b32 v29, 4, v29
  v_lshl_add_u32 v29, v25, 9, v29
  v_cndmask_b32 v34, v35, v29, vcc
  v_lshl_add_u32 v26, v25, 4, v26
  v_lshlrev_b32 v27, 5, v25
  v_cndmask_b32 v32, v35, v26, vcc
  v_cndmask_b32 v33, v35, v27, vcc
  v_lshrrev_b32 v30, 4, v0
  v_lshlrev_b32 v30, 2, v30
  v_lshl_add_u32 v30, v24, 6, v30
  v_lshlrev_b32 v31, 6, v24
  v_add_u32 v30, 159744, v30
  v_add_u32 v31, 159744, v31
  buffer_load_dwordx4 v[36:39], v26, s[36:39], 0 offen offset:0
  buffer_load_dwordx4 v[40:43], v26, s[36:39], 0 offen offset:512
  buffer_load_dwordx4 v[44:47], v32, s[36:39], 0 offen offset:1024
  s_mul_i32 s60, s34, 384
  s_sub_u32 s61, 7864320, s60
  s_add_u32 s44, s10, s60
  s_addc_u32 s45, s11, 0
  s_mov_b32 s46, s61
  s_mov_b32 s47, 0x20000
  s_mul_i32 s60, s30, 192
  v_add_u32 v164, s60, v1
  v_mul_u32_u24 v165, 2731, v164
  v_lshrrev_b32 v165, 16, v165
  v_mul_u32_u24 v166, 24, v165
  v_sub_u32 v166, v164, v166
  v_lshlrev_b32 v167, 1, v165
  v_and_b32 v167, 4, v167
  v_xor_b32 v167, v166, v167
  v_lshlrev_b32 v167, 4, v167
  v_mul_u32_u24 v168, 12288, v165
  v_add_u32 v168, v167, v168
  v_subrev_u32 v4, 0, v168
  v_add_u32 v164, s60, v1
  v_add_u32 v164, 64, v164
  v_mul_u32_u24 v165, 2731, v164
  v_lshrrev_b32 v165, 16, v165
  v_mul_u32_u24 v166, 24, v165
  v_sub_u32 v166, v164, v166
  v_lshlrev_b32 v167, 1, v165
  v_and_b32 v167, 4, v167
  v_xor_b32 v167, v166, v167
  v_lshlrev_b32 v167, 4, v167
  v_mul_u32_u24 v168, 12288, v165
  v_add_u32 v168, v167, v168
  v_subrev_u32 v5, 1024, v168
  v_add_u32 v164, s60, v1
  v_add_u32 v164, 128, v164
  v_mul_u32_u24 v165, 2731, v164
  v_lshrrev_b32 v165, 16, v165
  v_mul_u32_u24 v166, 24, v165
  v_sub_u32 v166, v164, v166
  v_lshlrev_b32 v167, 1, v165
  v_and_b32 v167, 4, v167
  v_xor_b32 v167, v166, v167
  v_lshlrev_b32 v167, 4, v167
  v_mul_u32_u24 v168, 12288, v165
  v_add_u32 v168, v167, v168
  v_subrev_u32 v6, 2048, v168
  s_mov_b32 s67, 0
  s_add_u32 m0, s68, 0
  s_nop 0
  buffer_load_dwordx4 v4, s[44:47], s67 offen offset:0 lds
  buffer_load_dwordx4 v5, s[44:47], s67 offen offset:1024 lds
  buffer_load_dwordx4 v6, s[44:47], s67 offen offset:2048 lds
  s_mov_b32 s67, 393216
  s_add_u32 m0, s68, 12288
  s_nop 0
  buffer_load_dwordx4 v4, s[44:47], s67 offen offset:0 lds
  buffer_load_dwordx4 v5, s[44:47], s67 offen offset:1024 lds
  buffer_load_dwordx4 v6, s[44:47], s67 offen offset:2048 lds
  s_waitcnt vmcnt(14)
  s_mov_b32 s69, 0xbfb8aa3b
  v_lshlrev_b32 v100, 16, v100
  v_lshlrev_b32 v101, 16, v101
  v_lshlrev_b32 v102, 16, v102
  v_lshlrev_b32 v103, 16, v103
  v_lshlrev_b32 v104, 16, v104
  v_mul_f32 v132, s69, v100
  v_mul_f32 v133, s69, v101
  v_mul_f32 v134, s69, v102
  v_mul_f32 v135, s69, v103
  v_mul_f32 v136, s69, v104
  v_exp_f32 v132, v132
  v_exp_f32 v133, v133
  v_exp_f32 v134, v134
  v_exp_f32 v135, v135
  v_exp_f32 v136, v136
  v_add_f32 v132, 1.0, v132
  v_add_f32 v133, 1.0, v133
  v_add_f32 v134, 1.0, v134
  v_add_f32 v135, 1.0, v135
  v_add_f32 v136, 1.0, v136
  v_rcp_f32 v132, v132
  v_rcp_f32 v133, v133
  v_rcp_f32 v134, v134
  v_rcp_f32 v135, v135
  v_rcp_f32 v136, v136
  v_mul_f32 v100, v100, v132
  v_mul_f32 v101, v101, v133
  v_mul_f32 v102, v102, v134
  v_mul_f32 v103, v103, v135
  v_mul_f32 v104, v104, v136
  v_cvt_pk_bf16_f32 v100, v100, v100
  v_lshlrev_b32 v100, 16, v100
  v_cvt_pk_bf16_f32 v101, v101, v101
  v_lshlrev_b32 v101, 16, v101
  v_cvt_pk_bf16_f32 v102, v102, v102
  v_lshlrev_b32 v102, 16, v102
  v_cvt_pk_bf16_f32 v103, v103, v103
  v_lshlrev_b32 v103, 16, v103
  v_cvt_pk_bf16_f32 v104, v104, v104
  v_lshlrev_b32 v104, 16, v104
  s_mov_b32 s72, 0xffff0000
  v_mov_b32 v140, 0
  v_mov_b32 v141, 0
  v_mov_b32 v142, 0
  v_mov_b32 v143, 0
  v_mov_b32 v144, 0
  v_mov_b32 v145, 0
  v_mov_b32 v146, 0
  v_mov_b32 v147, 0
  s_waitcnt vmcnt(13)
  v_lshlrev_b32 v148, 16, v108
  v_and_b32 v149, s72, v108
  v_fmac_f32 v140, v148, v100
  v_fmac_f32 v141, v149, v100
  v_lshlrev_b32 v148, 16, v109
  v_and_b32 v149, s72, v109
  v_fmac_f32 v142, v148, v100
  v_fmac_f32 v143, v149, v100
  v_lshlrev_b32 v148, 16, v110
  v_and_b32 v149, s72, v110
  v_fmac_f32 v144, v148, v100
  v_fmac_f32 v145, v149, v100
  v_lshlrev_b32 v148, 16, v111
  v_and_b32 v149, s72, v111
  v_fmac_f32 v146, v148, v100
  v_fmac_f32 v147, v149, v100
  s_waitcnt vmcnt(12)
  v_lshlrev_b32 v148, 16, v112
  v_and_b32 v149, s72, v112
  v_fmac_f32 v140, v148, v101
  v_fmac_f32 v141, v149, v101
  v_lshlrev_b32 v148, 16, v113
  v_and_b32 v149, s72, v113
  v_fmac_f32 v142, v148, v101
  v_fmac_f32 v143, v149, v101
  v_lshlrev_b32 v148, 16, v114
  v_and_b32 v149, s72, v114
  v_fmac_f32 v144, v148, v101
  v_fmac_f32 v145, v149, v101
  v_lshlrev_b32 v148, 16, v115
  v_and_b32 v149, s72, v115
  v_fmac_f32 v146, v148, v101
  v_fmac_f32 v147, v149, v101
  s_waitcnt vmcnt(11)
  v_lshlrev_b32 v148, 16, v116
  v_and_b32 v149, s72, v116
  v_fmac_f32 v140, v148, v102
  v_fmac_f32 v141, v149, v102
  v_lshlrev_b32 v148, 16, v117
  v_and_b32 v149, s72, v117
  v_fmac_f32 v142, v148, v102
  v_fmac_f32 v143, v149, v102
  v_lshlrev_b32 v148, 16, v118
  v_and_b32 v149, s72, v118
  v_fmac_f32 v144, v148, v102
  v_fmac_f32 v145, v149, v102
  v_lshlrev_b32 v148, 16, v119
  v_and_b32 v149, s72, v119
  v_fmac_f32 v146, v148, v102
  v_fmac_f32 v147, v149, v102
  s_waitcnt vmcnt(10)
  v_lshlrev_b32 v148, 16, v120
  v_and_b32 v149, s72, v120
  v_fmac_f32 v140, v148, v103
  v_fmac_f32 v141, v149, v103
  v_lshlrev_b32 v148, 16, v121
  v_and_b32 v149, s72, v121
  v_fmac_f32 v142, v148, v103
  v_fmac_f32 v143, v149, v103
  v_lshlrev_b32 v148, 16, v122
  v_and_b32 v149, s72, v122
  v_fmac_f32 v144, v148, v103
  v_fmac_f32 v145, v149, v103
  v_lshlrev_b32 v148, 16, v123
  v_and_b32 v149, s72, v123
  v_fmac_f32 v146, v148, v103
  v_fmac_f32 v147, v149, v103
  s_waitcnt vmcnt(9)
  v_lshlrev_b32 v148, 16, v124
  v_and_b32 v149, s72, v124
  v_fmac_f32 v140, v148, v104
  v_fmac_f32 v141, v149, v104
  v_lshlrev_b32 v148, 16, v125
  v_and_b32 v149, s72, v125
  v_fmac_f32 v142, v148, v104
  v_fmac_f32 v143, v149, v104
  v_lshlrev_b32 v148, 16, v126
  v_and_b32 v149, s72, v126
  v_fmac_f32 v144, v148, v104
  v_fmac_f32 v145, v149, v104
  v_lshlrev_b32 v148, 16, v127
  v_and_b32 v149, s72, v127
  v_fmac_f32 v146, v148, v104
  v_fmac_f32 v147, v149, v104
  v_add_f32_dpp v140, v140, v140 row_ror:8 row_mask:0xf bank_mask:0xf
  v_add_f32_dpp v141, v141, v141 row_ror:8 row_mask:0xf bank_mask:0xf
  v_add_f32_dpp v142, v142, v142 row_ror:8 row_mask:0xf bank_mask:0xf
  v_add_f32_dpp v143, v143, v143 row_ror:8 row_mask:0xf bank_mask:0xf
  v_add_f32_dpp v144, v144, v144 row_ror:8 row_mask:0xf bank_mask:0xf
  v_add_f32_dpp v145, v145, v145 row_ror:8 row_mask:0xf bank_mask:0xf
  v_add_f32_dpp v146, v146, v146 row_ror:8 row_mask:0xf bank_mask:0xf
  v_add_f32_dpp v147, v147, v147 row_ror:8 row_mask:0xf bank_mask:0xf
  v_add_f32_dpp v140, v140, v140 row_ror:4 row_mask:0xf bank_mask:0xf
  v_add_f32_dpp v141, v141, v141 row_ror:4 row_mask:0xf bank_mask:0xf
  v_add_f32_dpp v142, v142, v142 row_ror:4 row_mask:0xf bank_mask:0xf
  v_add_f32_dpp v143, v143, v143 row_ror:4 row_mask:0xf bank_mask:0xf
  v_add_f32_dpp v144, v144, v144 row_ror:4 row_mask:0xf bank_mask:0xf
  v_add_f32_dpp v145, v145, v145 row_ror:4 row_mask:0xf bank_mask:0xf
  v_add_f32_dpp v146, v146, v146 row_ror:4 row_mask:0xf bank_mask:0xf
  v_add_f32_dpp v147, v147, v147 row_ror:4 row_mask:0xf bank_mask:0xf
  v_add_f32_dpp v140, v140, v140 row_ror:2 row_mask:0xf bank_mask:0xf
  v_add_f32_dpp v141, v141, v141 row_ror:2 row_mask:0xf bank_mask:0xf
  v_add_f32_dpp v142, v142, v142 row_ror:2 row_mask:0xf bank_mask:0xf
  v_add_f32_dpp v143, v143, v143 row_ror:2 row_mask:0xf bank_mask:0xf
  v_add_f32_dpp v144, v144, v144 row_ror:2 row_mask:0xf bank_mask:0xf
  v_add_f32_dpp v145, v145, v145 row_ror:2 row_mask:0xf bank_mask:0xf
  v_add_f32_dpp v146, v146, v146 row_ror:2 row_mask:0xf bank_mask:0xf
  v_add_f32_dpp v147, v147, v147 row_ror:2 row_mask:0xf bank_mask:0xf
  ds_write_b128 v128, v[140:143]
  ds_write_b128 v128, v[144:147] offset:16
  s_waitcnt lgkmcnt(0)
  s_barrier
  ds_read_b32 v108, v130 offset:0
  ds_read_b32 v109, v130 offset:64
  ds_read_b32 v110, v130 offset:128
  ds_read_b32 v111, v130 offset:192
  ds_read_b32 v112, v130 offset:256
  ds_read_b32 v113, v130 offset:320
  ds_read_b32 v114, v130 offset:384
  ds_read_b32 v115, v130 offset:448
  s_waitcnt lgkmcnt(0)
  ds_read_b32 v116, v130 offset:512
  ds_read_b32 v117, v130 offset:576
  ds_read_b32 v118, v130 offset:640
  ds_read_b32 v119, v130 offset:704
  ds_read_b32 v120, v130 offset:768
  ds_read_b32 v121, v130 offset:832
  ds_read_b32 v122, v130 offset:896
  ds_read_b32 v123, v130 offset:960
  s_mul_i32 s14, s14, 0x9e3779b1
  s_add_u32 s14, s14, 0x7f4a7c15
  s_waitcnt lgkmcnt(0)
  v_add_f32 v108, v108, v116
  v_add_f32 v109, v109, v117
  v_add_f32 v110, v110, v118
  v_add_f32 v111, v111, v119
  v_add_f32 v112, v112, v120
  v_add_f32 v113, v113, v121
  v_add_f32 v114, v114, v122
  v_add_f32 v115, v115, v123
  v_add_f32 v108, v108, v112
  v_add_f32 v109, v109, v113
  v_add_f32 v110, v110, v114
  v_add_f32 v111, v111, v115
  v_add_f32 v108, v108, v110
  v_add_f32 v109, v109, v111
  v_add_f32 v108, v108, v109
  v_cvt_pk_bf16_f32 v108, v108, v108
  v_lshlrev_b32 v108, 16, v108
  s_mov_b32 s63, 0
  s_sub_u32 s61, s76, 40
  s_cmp_lt_u32 s61, 40
  s_cselect_b32 s63, 1.0, s63
  s_sub_u32 s61, s76, 160
  s_cmp_lt_u32 s61, 40
  s_cselect_b32 s63, 1.0, s63
  v_add_f32 v108, s63, v108
  v_cvt_pk_bf16_f32 v108, v108, v108
  v_lshlrev_b32 v108, 16, v108
  s_cmp_lt_u32 s76, 80
  s_cselect_b32 s61, s76, 0
  s_cselect_b32 s62, 64, 0
  s_lshl_b32 s61, s61, 6
  s_add_u32 s52, s28, s61
  s_addc_u32 s53, s29, 0
  s_add_u32 s52, s52, 60309504
  s_addc_u32 s53, s53, 0
  s_mov_b32 s54, s62
  s_mov_b32 s55, 0x20000
  v_mov_b32_dpp v110, v108 quad_perm:[1,0,3,2] row_mask:0xf bank_mask:0xf
  v_lshrrev_b32 v112, 16, v108
  v_mov_b32 v113, s14
  v_or_b32 v112, v112, v110
  v_mov_b32 v131, 2130706432
  v_and_b32 v114, 0xf1, v0
  v_lshlrev_b32 v115, 2, v0
  v_cmp_eq_u32 vcc, 0, v114
  s_nop 1
  v_cndmask_b32 v115, v131, v115, vcc
  buffer_store_dwordx2 v[112:113], v115, s[52:55], 0 offen sc1
  v_cmp_gt_u32 vcc, 16, v0
  s_nop 1
  v_cndmask_b32 v129, v131, v129, vcc
  buffer_store_dword v108, v129, s[84:87], 0 offen sc1
  s_mov_b32 s67, 786432
  s_add_u32 m0, s68, 24576
  s_nop 0
  buffer_load_dwordx4 v4, s[44:47], s67 offen offset:0 lds
  buffer_load_dwordx4 v5, s[44:47], s67 offen offset:1024 lds
  buffer_load_dwordx4 v6, s[44:47], s67 offen offset:2048 lds
  s_mov_b32 s67, 1179648
  s_add_u32 m0, s68, 36864
  s_nop 0
  buffer_load_dwordx4 v4, s[44:47], s67 offen offset:0 lds
  buffer_load_dwordx4 v5, s[44:47], s67 offen offset:1024 lds
  buffer_load_dwordx4 v6, s[44:47], s67 offen offset:2048 lds
  s_mov_b32 s67, 1572864
  s_add_u32 m0, s68, 49152
  s_nop 0
  buffer_load_dwordx4 v4, s[44:47], s67 offen offset:0 lds
  buffer_load_dwordx4 v5, s[44:47], s67 offen offset:1024 lds
  buffer_load_dwordx4 v6, s[44:47], s67 offen offset:2048 lds
  s_mov_b32 s72, 0xffff0000
  s_waitcnt vmcnt(19)
  v_lshlrev_b32 v92, 16, v36
  v_and_b32 v93, s72, v36
  v_lshlrev_b32 v94, 16, v37
  v_and_b32 v95, s72, v37
  v_lshlrev_b32 v96, 16, v38
  v_and_b32 v97, s72, v38
  v_lshlrev_b32 v98, 16, v39
  v_and_b32 v99, s72, v39
  s_waitcnt vmcnt(18)
  v_lshlrev_b32 v100, 16, v40
  v_and_b32 v101, s72, v40
  v_lshlrev_b32 v102, 16, v41
  v_and_b32 v103, s72, v41
  v_lshlrev_b32 v104, 16, v42
  v_and_b32 v105, s72, v42
  v_lshlrev_b32 v106, 16, v43
  v_and_b32 v107, s72, v43
  s_waitcnt vmcnt(17)
  v_lshlrev_b32 v108, 16, v44
  v_and_b32 v109, s72, v44
  v_lshlrev_b32 v110, 16, v45
  v_and_b32 v111, s72, v45
  v_lshlrev_b32 v112, 16, v46
  v_and_b32 v113, s72, v46
  v_lshlrev_b32 v114, 16, v47
  v_and_b32 v115, s72, v47
  v_add_f32 v72, v92, v93
  v_add_f32 v72, v72, v94
  v_add_f32 v72, v72, v95
  v_add_f32 v72, v72, v96
  v_add_f32 v72, v72, v97
  v_add_f32 v72, v72, v98
  v_add_f32 v72, v72, v99
  v_add_f32 v72, v72, v100
  v_add_f32 v72, v72, v101
  v_add_f32 v72, v72, v102
  v_add_f32 v72, v72, v103
  v_add_f32 v72, v72, v104
  v_add_f32 v72, v72, v105
  v_add_f32 v72, v72, v106
  v_add_f32 v72, v72, v107
  v_add_f32 v72, v72, v108
  v_add_f32 v72, v72, v109
  v_add_f32 v72, v72, v110
  v_add_f32 v72, v72, v111
  v_add_f32 v72, v72, v112
  v_add_f32 v72, v72, v113
  v_add_f32 v72, v72, v114
  v_add_f32 v72, v72, v115
  s_nop 1
  v_add_f32_dpp v72, v72, v72 row_ror:8 row_mask:0xf bank_mask:0xf
  ds_write_b32 v30, v72 offset:0
  s_waitcnt lgkmcnt(0)
  s_barrier
  ds_read_b128 v[76:79], v31 offset:0
  ds_read_b128 v[80:83], v31 offset:16
  ds_read_b128 v[84:87], v31 offset:32
  ds_read_b128 v[88:91], v31 offset:48
  s_waitcnt lgkmcnt(0)
  v_add_f32 v76, v76, v84
  v_add_f32 v77, v77, v85
  v_add_f32 v78, v78, v86
  v_add_f32 v79, v79, v87
  v_add_f32 v80, v80, v88
  v_add_f32 v81, v81, v89
  v_add_f32 v82, v82, v90
  v_add_f32 v83, v83, v91
  v_add_f32 v76, v76, v80
  v_add_f32 v77, v77, v81
  v_add_f32 v78, v78, v82
  v_add_f32 v79, v79, v83
  v_add_f32 v76, v76, v78
  v_add_f32 v77, v77, v79
  v_add_f32 v72, v76, v77
  s_mov_b32 s69, 0x3acccccd
  v_mul_f32 v72, s69, v72
  v_cmp_gt_u32 vcc, 128, v0
  v_sub_f32 v92, v92, v72
  v_sub_f32 v93, v93, v72
  v_sub_f32 v94, v94, v72
  v_sub_f32 v95, v95, v72
  v_sub_f32 v96, v96, v72
  v_sub_f32 v97, v97, v72
  v_sub_f32 v98, v98, v72
  v_sub_f32 v99, v99, v72
  v_sub_f32 v100, v100, v72
  v_sub_f32 v101, v101, v72
  v_sub_f32 v102, v102, v72
  v_sub_f32 v103, v103, v72
  v_sub_f32 v104, v104, v72
  v_sub_f32 v105, v105, v72
  v_sub_f32 v106, v106, v72
  v_sub_f32 v107, v107, v72
  v_sub_f32 v108, v108, v72
  v_sub_f32 v109, v109, v72
  v_sub_f32 v110, v110, v72
  v_sub_f32 v111, v111, v72
  v_sub_f32 v112, v112, v72
  v_sub_f32 v113, v113, v72
  v_sub_f32 v114, v114, v72
  v_sub_f32 v115, v115, v72
  v_cndmask_b32 v108, 0, v108, vcc
  v_cndmask_b32 v109, 0, v109, vcc
  v_cndmask_b32 v110, 0, v110, vcc
  v_cndmask_b32 v111, 0, v111, vcc
  v_cndmask_b32 v112, 0, v112, vcc
  v_cndmask_b32 v113, 0, v113, vcc
  v_cndmask_b32 v114, 0, v114, vcc
  v_cndmask_b32 v115, 0, v115, vcc
  v_mul_f32 v73, v92, v92
  v_fmac_f32 v73, v93, v93
  v_fmac_f32 v73, v94, v94
  v_fmac_f32 v73, v95, v95
  v_fmac_f32 v73, v96, v96
  v_fmac_f32 v73, v97, v97
  v_fmac_f32 v73, v98, v98
  v_fmac_f32 v73, v99, v99
  v_fmac_f32 v73, v100, v100
  v_fmac_f32 v73, v101, v101
  v_fmac_f32 v73, v102, v102
  v_fmac_f32 v73, v103, v103
  v_fmac_f32 v73, v104, v104
  v_fmac_f32 v73, v105, v105
  v_fmac_f32 v73, v106, v106
  v_fmac_f32 v73, v107, v107
  v_fmac_f32 v73, v108, v108
  v_fmac_f32 v73, v109, v109
  v_fmac_f32 v73, v110, v110
  v_fmac_f32 v73, v111, v111
  v_fmac_f32 v73, v112, v112
  v_fmac_f32 v73, v113, v113
  v_fmac_f32 v73, v114, v114
  v_fmac_f32 v73, v115, v115
  s_nop 1
  v_add_f32_dpp v73, v73, v73 row_ror:8 row_mask:0xf bank_mask:0xf
  ds_write_b32 v30, v73 offset:512
  s_waitcnt lgkmcnt(0)
  s_barrier
  ds_read_b128 v[76:79], v31 offset:512
  ds_read_b128 v[80:83], v31 offset:528
  ds_read_b128 v[84:87], v31 offset:544
  ds_read_b128 v[88:91], v31 offset:560
  s_waitcnt lgkmcnt(0)
  v_add_f32 v76, v76, v84
  v_add_f32 v77, v77, v85
  v_add_f32 v78, v78, v86
  v_add_f32 v79, v79, v87
  v_add_f32 v80, v80, v88
  v_add_f32 v81, v81, v89
  v_add_f32 v82, v82, v90
  v_add_f32 v83, v83, v91
  v_add_f32 v76, v76, v80
  v_add_f32 v77, v77, v81
  v_add_f32 v78, v78, v82
  v_add_f32 v79, v79, v83
  v_add_f32 v76, v76, v78
  v_add_f32 v77, v77, v79
  v_add_f32 v73, v76, v77
  s_mov_b32 s73, 0x3727c5ac
  v_mov_b32 v72, s73
  v_fmac_f32 v72, s69, v73
  v_rsq_f32 v72, v72
  s_nop 0
  v_mul_f32 v92, v92, v72
  v_mul_f32 v93, v93, v72
  v_mul_f32 v94, v94, v72
  v_mul_f32 v95, v95, v72
  v_mul_f32 v96, v96, v72
  v_mul_f32 v97, v97, v72
  v_mul_f32 v98, v98, v72
  v_mul_f32 v99, v99, v72
  v_mul_f32 v100, v100, v72
  v_mul_f32 v101, v101, v72
  v_mul_f32 v102, v102, v72
  v_mul_f32 v103, v103, v72
  v_mul_f32 v104, v104, v72
  v_mul_f32 v105, v105, v72
  v_mul_f32 v106, v106, v72
  v_mul_f32 v107, v107, v72
  v_mul_f32 v108, v108, v72
  v_mul_f32 v109, v109, v72
  v_mul_f32 v110, v110, v72
  v_mul_f32 v111, v111, v72
  v_mul_f32 v112, v112, v72
  v_mul_f32 v113, v113, v72
  v_mul_f32 v114, v114, v72
  v_mul_f32 v115, v115, v72
  s_add_u32 s52, s28, 60309504
  s_addc_u32 s53, s29, 0
  s_mov_b32 s54, 5120
  s_mov_b32 s55, 0x20000
  v_lshlrev_b32 v164, 3, v0
  s_cmp_lt_u32 s30, 2
  s_cselect_b32 s64, -1, 0
  s_cselect_b32 s65, -1, 0
  s_mov_b32 s15, 400000
L_spin0:
  s_mov_b32 s66, 0
  buffer_load_dwordx2 v[166:167], v164, s[52:55], s66 offen sc1
  s_mov_b32 s66, 2048
  buffer_load_dwordx2 v[168:169], v164, s[52:55], s66 offen sc1
  s_mov_b32 s66, 4096
  buffer_load_dwordx2 v[170:171], v164, s[52:55], s66 offen sc1
  s_waitcnt vmcnt(0)
  v_cmp_ne_u32 s[62:63], s14, v171
  v_cmp_ne_u32 vcc, s14, v167
  s_and_b64 s[62:63], s[62:63], s[64:65]
  s_or_b64 vcc, vcc, s[62:63]
  v_cmp_ne_u32 s[62:63], s14, v169
  s_or_b64 vcc, vcc, s[62:63]
  s_cbranch_vccz L_done0
  s_sub_u32 s15, s15, 1
  s_cbranch_scc0 L_spin0
L_done0:
  v_lshlrev_b32 v165, 2, v0
  v_add_u32 v165, 147456, v165
  ds_write_b32 v165, v166 offset:0
  ds_write_b32 v165, v168 offset:1024
  ds_write_b32 v165, v170 offset:2048
  v_lshlrev_b32 v165, 4, v25
  v_add_u32 v165, 147456, v165
  s_waitcnt lgkmcnt(0)
  s_barrier
  ds_read_b128 v[168:171], v165 offset:0
  ds_read_b128 v[180:183], v165 offset:1280
  ds_read_b128 v[172:175], v165 offset:512
  ds_read_b128 v[184:187], v165 offset:1792
  ds_read_b128 v[176:179], v165 offset:1024
  ds_read_b128 v[188:191], v165 offset:2304
  s_mov_b32 s72, 0xffff0000
  s_waitcnt lgkmcnt(4)
  v_lshlrev_b32 v140, 16, v168
  v_and_b32 v141, s72, v168
  v_lshlrev_b32 v116, 16, v180
  v_and_b32 v117, s72, v180
  v_lshlrev_b32 v142, 16, v169
  v_and_b32 v143, s72, v169
  v_lshlrev_b32 v118, 16, v181
  v_and_b32 v119, s72, v181
  v_lshlrev_b32 v144, 16, v170
  v_and_b32 v145, s72, v170
  v_lshlrev_b32 v120, 16, v182
  v_and_b32 v121, s72, v182
  v_lshlrev_b32 v146, 16, v171
  v_and_b32 v147, s72, v171
  v_lshlrev_b32 v122, 16, v183
  v_and_b32 v123, s72, v183
  s_waitcnt lgkmcnt(2)
  v_lshlrev_b32 v148, 16, v172
  v_and_b32 v149, s72, v172
  v_lshlrev_b32 v124, 16, v184
  v_and_b32 v125, s72, v184
  v_lshlrev_b32 v150, 16, v173
  v_and_b32 v151, s72, v173
  v_lshlrev_b32 v126, 16, v185
  v_and_b32 v127, s72, v185
  v_lshlrev_b32 v152, 16, v174
  v_and_b32 v153, s72, v174
  v_lshlrev_b32 v128, 16, v186
  v_and_b32 v129, s72, v186
  v_lshlrev_b32 v154, 16, v175
  v_and_b32 v155, s72, v175
  v_lshlrev_b32 v130, 16, v187
  v_and_b32 v131, s72, v187
  s_waitcnt lgkmcnt(0)
  v_lshlrev_b32 v156, 16, v176
  v_and_b32 v157, s72, v176
  v_lshlrev_b32 v132, 16, v188
  v_and_b32 v133, s72, v188
  v_lshlrev_b32 v158, 16, v177
  v_and_b32 v159, s72, v177
  v_lshlrev_b32 v134, 16, v189
  v_and_b32 v135, s72, v189
  v_lshlrev_b32 v160, 16, v178
  v_and_b32 v161, s72, v178
  v_lshlrev_b32 v136, 16, v190
  v_and_b32 v137, s72, v190
  v_lshlrev_b32 v162, 16, v179
  v_and_b32 v163, s72, v179
  v_lshlrev_b32 v138, 16, v191
  v_and_b32 v139, s72, v191
  v_fma_f32 v92, v92, v116, v140
  v_fma_f32 v93, v93, v117, v141
  v_fma_f32 v94, v94, v118, v142
  v_fma_f32 v95, v95, v119, v143
  v_fma_f32 v96, v96, v120, v144
  v_fma_f32 v97, v97, v121, v145
  v_fma_f32 v98, v98, v122, v146
  v_fma_f32 v99, v99, v123, v147
  v_fma_f32 v100, v100, v124, v148
  v_fma_f32 v101, v101, v125, v149
  v_fma_f32 v102, v102, v126, v150
  v_fma_f32 v103, v103, v127, v151
  v_fma_f32 v104, v104, v128, v152
  v_fma_f32 v105, v105, v129, v153
  v_fma_f32 v106, v106, v130, v154
  v_fma_f32 v107, v107, v131, v155
  v_fma_f32 v108, v108, v132, v156
  v_fma_f32 v109, v109, v133, v157
  v_fma_f32 v110, v110, v134, v158
  v_fma_f32 v111, v111, v135, v159
  v_fma_f32 v112, v112, v136, v160
  v_fma_f32 v113, v113, v137, v161
  v_fma_f32 v114, v114, v138, v162
  v_fma_f32 v115, v115, v139, v163
  v_cvt_pk_bf16_f32 v76, v92, v93
  v_cvt_pk_bf16_f32 v77, v94, v95
  v_cvt_pk_bf16_f32 v78, v96, v97
  v_cvt_pk_bf16_f32 v79, v98, v99
  s_mov_b32 s66, 0
  buffer_store_dwordx4 v[76:79], v29, s[48:51], s66 offen sc1
  v_cvt_pk_bf16_f32 v80, v100, v101
  v_cvt_pk_bf16_f32 v81, v102, v103
  v_cvt_pk_bf16_f32 v82, v104, v105
  v_cvt_pk_bf16_f32 v83, v106, v107
  s_mov_b32 s66, 16384
  buffer_store_dwordx4 v[80:83], v29, s[48:51], s66 offen sc1
  v_cvt_pk_bf16_f32 v84, v108, v109
  v_cvt_pk_bf16_f32 v85, v110, v111
  v_cvt_pk_bf16_f32 v86, v112, v113
  v_cvt_pk_bf16_f32 v87, v114, v115
  s_mov_b32 s66, 32768
  buffer_store_dwordx4 v[84:87], v34, s[48:51], s66 offen sc1
  s_waitcnt vmcnt(0)
  s_barrier
  s_cmp_lg_u32 s30, 0
  s_cbranch_scc1 L_nf1
  s_lshl_b32 s60, s33, 5
  s_add_u32 s60, s60, s34
  s_lshl_b32 s60, s60, 2
  s_add_u32 s74, s60, 2048
  v_cmp_eq_u32 vcc, 0, v1
  v_mov_b32 v164, 2130706432
  v_mov_b32 v165, s14
  v_cndmask_b32 v164, v164, v1, vcc
  buffer_store_dword v165, v164, s[92:95], s74 offen sc1
  s_lshl_b32 s74, s2, 2
  s_add_u32 s74, s74, 256
  v_cmp_eq_u32 vcc, 0, v1
  v_mov_b32 v164, 2130706432
  v_mov_b32 v165, s14
  v_cndmask_b32 v164, v164, v1, vcc
  buffer_store_dword v165, v164, s[92:95], s74 offen sc1
L_nf1:
  s_mov_b32 s67, 1966080
  s_add_u32 m0, s68, 61440
  s_nop 0
  buffer_load_dwordx4 v4, s[44:47], s67 offen offset:0 lds
  buffer_load_dwordx4 v5, s[44:47], s67 offen offset:1024 lds
  buffer_load_dwordx4 v6, s[44:47], s67 offen offset:2048 lds
  s_mov_b32 s67, 2359296
  s_add_u32 m0, s68, 73728
  s_nop 0
  buffer_load_dwordx4 v4, s[44:47], s67 offen offset:0 lds
  buffer_load_dwordx4 v5, s[44:47], s67 offen offset:1024 lds
  buffer_load_dwordx4 v6, s[44:47], s67 offen offset:2048 lds
  s_mov_b32 s67, 2752512
  s_add_u32 m0, s68, 86016
  s_nop 0
  buffer_load_dwordx4 v4, s[44:47], s67 offen offset:0 lds
  buffer_load_dwordx4 v5, s[44:47], s67 offen offset:1024 lds
  buffer_load_dwordx4 v6, s[44:47], s67 offen offset:2048 lds
  s_mul_i32 s60, s34, 786432
  s_add_u32 s48, s6, s60
  s_addc_u32 s49, s7, 0
  s_add_u32 s48, s48, 589824
  s_addc_u32 s49, s49, 0
  s_mov_b32 s50, 196608
  s_mov_b32 s51, 0x20000
  s_add_u32 s52, s8, s60
  s_addc_u32 s53, s9, 0
  s_add_u32 s52, s52, 589824
  s_addc_u32 s53, s53, 0
  s_mov_b32 s54, 196608
  s_mov_b32 s55, 0x20000
  s_lshl_b32 s60, s33, 3
  s_lshl_b32 s61, s30, 1
  s_add_u32 s60, s60, s61
  s_mul_i32 s60, s60, 40960
  s_add_u32 s56, s28, s60
  s_addc_u32 s57, s29, 0
  s_mov_b32 s58, 81920
  s_mov_b32 s59, 0x20000
  v_lshlrev_b32 v2, 4, v1
  v_add_u32 v3, 40960, v2
  s_mul_i32 s60, s30, 192
  v_add_u32 v39, s60, v1
  v_mul_u32_u24 v40, 2731, v39
  v_lshrrev_b32 v40, 16, v40
  v_mul_u32_u24 v41, 24, v40
  v_sub_u32 v41, v39, v41
  v_lshrrev_b32 v42, 1, v40
  v_xor_b32 v42, v41, v42
  v_and_b32 v42, 7, v42
  v_and_b32 v43, 24, v41
  v_or_b32 v42, v42, v43
  v_lshlrev_b32 v42, 4, v42
  v_mul_u32_u24 v43, 384, v40
  v_add_u32 v42, v42, v43
  v_subrev_u32 v7, 0, v42
  v_lshlrev_b32 v42, 1, v40
  v_and_b32 v42, 4, v42
  v_xor_b32 v42, v41, v42
  v_lshlrev_b32 v42, 4, v42
  v_mul_u32_u24 v43, 384, v40
  v_add_u32 v43, v42, v43
  v_subrev_u32 v10, 0, v43
  v_add_u32 v39, s60, v1
  v_add_u32 v39, 64, v39
  v_mul_u32_u24 v40, 2731, v39
  v_lshrrev_b32 v40, 16, v40
  v_mul_u32_u24 v41, 24, v40
  v_sub_u32 v41, v39, v41
  v_lshrrev_b32 v42, 1, v40
  v_xor_b32 v42, v41, v42
  v_and_b32 v42, 7, v42
  v_and_b32 v43, 24, v41
  v_or_b32 v42, v42, v43
  v_lshlrev_b32 v42, 4, v42
  v_mul_u32_u24 v43, 384, v40
  v_add_u32 v42, v42, v43
  v_subrev_u32 v8, 1024, v42
  v_lshlrev_b32 v42, 1, v40
  v_and_b32 v42, 4, v42
  v_xor_b32 v42, v41, v42
  v_lshlrev_b32 v42, 4, v42
  v_mul_u32_u24 v43, 384, v40
  v_add_u32 v43, v42, v43
  v_subrev_u32 v11, 1024, v43
  v_add_u32 v39, s60, v1
  v_add_u32 v39, 128, v39
  v_mul_u32_u24 v40, 2731, v39
  v_lshrrev_b32 v40, 16, v40
  v_mul_u32_u24 v41, 24, v40
  v_sub_u32 v41, v39, v41
  v_lshrrev_b32 v42, 1, v40
  v_xor_b32 v42, v41, v42
  v_and_b32 v42, 7, v42
  v_and_b32 v43, 24, v41
  v_or_b32 v42, v42, v43
  v_lshlrev_b32 v42, 4, v42
  v_mul_u32_u24 v43, 384, v40
  v_add_u32 v42, v42, v43
  v_subrev_u32 v9, 2048, v42
  v_lshlrev_b32 v42, 1, v40
  v_and_b32 v42, 4, v42
  v_xor_b32 v42, v41, v42
  v_lshlrev_b32 v42, 4, v42
  v_mul_u32_u24 v43, 384, v40
  v_add_u32 v43, v42, v43
  v_subrev_u32 v12, 2048, v43
  v_lshrrev_b32 v39, 5, v1
  v_bfe_u32 v40, v1, 4, 1
  v_bfe_u32 v41, v1, 2, 2
  v_and_b32 v42, 3, v1
  v_bfe_u32 v43, v1, 3, 1
  v_lshl_add_u32 v44, v39, 3, v41
  v_mul_u32_u24 v44, 384, v44
  v_lshl_add_u32 v44, v40, 5, v44
  v_and_b32 v45, 1, v42
  v_lshl_add_u32 v44, v45, 4, v44
  v_lshrrev_b32 v45, 1, v42
  v_lshl_add_u32 v44, v45, 3, v44
  v_lshl_add_u32 v13, v43, 6, v44
  v_xor_b32 v45, 1, v43
  v_lshl_add_u32 v14, v45, 6, v44
  v_lshl_add_u32 v44, v39, 2, v41
  v_mul_u32_u24 v44, 384, v44
  v_lshl_add_u32 v44, v40, 5, v44
  v_lshl_add_u32 v44, v42, 3, v44
  v_lshl_add_u32 v19, v43, 6, v44
  v_lshl_add_u32 v20, v45, 6, v44
  v_add_u32 v15, 61440, v13
  v_add_u32 v16, 61440, v14
  v_add_u32 v21, 61440, v19
  v_add_u32 v22, 61440, v20
  v_add_u32 v17, 122880, v13
  v_add_u32 v18, 122880, v14
  v_add_u32 v23, 122880, v19
  v_add_u32 v24, 122880, v20
  v_and_b32 v44, 31, v1
  v_lshrrev_b32 v45, 1, v44
  v_mul_u32_u24 v44, 384, v44
  v_add_u32 v46, 0, v39
  v_xor_b32 v46, v46, v45
  v_and_b32 v46, 7, v46
  v_lshl_add_u32 v25, v46, 4, v44
  v_add_u32 v46, 2, v39
  v_xor_b32 v46, v46, v45
  v_and_b32 v46, 7, v46
  v_lshl_add_u32 v26, v46, 4, v44
  v_add_u32 v46, 4, v39
  v_xor_b32 v46, v46, v45
  v_and_b32 v46, 7, v46
  v_lshl_add_u32 v27, v46, 4, v44
  v_add_u32 v46, 6, v39
  v_xor_b32 v46, v46, v45
  v_and_b32 v46, 7, v46
  v_lshl_add_u32 v28, v46, 4, v44
  v_add_u32 v29, 61440, v25
  v_add_u32 v30, 61440, v26
  v_add_u32 v31, 61440, v27
  v_add_u32 v32, 61440, v28
  v_add_u32 v33, 122880, v25
  v_add_u32 v34, 122880, v26
  v_add_u32 v35, 122880, v27
  v_add_u32 v36, 122880, v28
  s_mov_b32 s72, 0x42800000
  v_mov_b32 v44, 0x3dd53b95
  v_mov_b32 v45, 0x3dd53b95
  v_min_u32 v39, 7, v1
  v_lshlrev_b32 v39, 2, v39
  s_lshl_b32 s74, s33, 7
  s_lshl_b32 s60, s30, 5
  s_add_u32 s74, s74, s60
  s_add_u32 s74, s74, 2048
  s_mov_b32 s15, 400000
L_spin3:
  buffer_load_dword v40, v39, s[92:95], s74 offen offset:0 sc1
  s_waitcnt vmcnt(0)
  v_cmp_ne_u32 vcc, s14, v40
  s_cbranch_vccz L_done3
  s_sub_u32 s15, s15, 1
  s_cbranch_scc0 L_spin3
L_done3:
  s_mov_b32 s66, 0
  buffer_load_dwordx4 a[0:3], v2, s[56:59], s66 offen offset:0 sc1
  buffer_load_dwordx4 a[4:7], v3, s[56:59], s66 offen offset:0 sc1
  s_mov_b32 s66, 0
  buffer_load_dwordx4 a[8:11], v2, s[56:59], s66 offen offset:1024 sc1
  buffer_load_dwordx4 a[12:15], v3, s[56:59], s66 offen offset:1024 sc1
  s_mov_b32 s66, 0
  buffer_load_dwordx4 a[16:19], v2, s[56:59], s66 offen offset:2048 sc1
  buffer_load_dwordx4 a[20:23], v3, s[56:59], s66 offen offset:2048 sc1
  s_mov_b32 s66, 0
  buffer_load_dwordx4 a[24:27], v2, s[56:59], s66 offen offset:3072 sc1
  buffer_load_dwordx4 a[28:31], v3, s[56:59], s66 offen offset:3072 sc1
  s_mov_b32 s66, 4096
  buffer_load_dwordx4 a[32:35], v2, s[56:59], s66 offen offset:0 sc1
  buffer_load_dwordx4 a[36:39], v3, s[56:59], s66 offen offset:0 sc1
  s_mov_b32 s66, 4096
  buffer_load_dwordx4 a[40:43], v2, s[56:59], s66 offen offset:1024 sc1
  buffer_load_dwordx4 a[44:47], v3, s[56:59], s66 offen offset:1024 sc1
  s_getpc_b64 s[96:97]
  s_add_u32 s96, s96, 1024
  s_addc_u32 s97, s97, 0
  v_lshlrev_b32 v46, 6, v0
  v_mov_b32 v47, 0
  v_lshl_add_u64 v[46:47], v[46:47], 0, s[96:97]
  global_load_dword a225, v[46:47], off
  s_barrier
  ds_read_b64_tr_b16 a[192:193], v13 offset:0
  ds_read_b64_tr_b16 a[194:195], v13 offset:1536
  ds_read_b64_tr_b16 a[196:197], v14 offset:0
  ds_read_b64_tr_b16 a[198:199], v14 offset:1536
  ds_read_b64_tr_b16 a[200:201], v13 offset:128
  ds_read_b64_tr_b16 a[202:203], v13 offset:1664
  ds_read_b64_tr_b16 a[204:205], v14 offset:128
  ds_read_b64_tr_b16 a[206:207], v14 offset:1664
  ds_read_b64_tr_b16 a[208:209], v13 offset:256
  ds_read_b64_tr_b16 a[210:211], v13 offset:1792
  s_waitcnt vmcnt(11)
  s_waitcnt lgkmcnt(8)
  v_mfma_f32_32x32x16_bf16 v[64:79], a[192:195], a[0:3], 0
  v_mfma_f32_32x32x16_bf16 v[80:95], a[192:195], a[4:7], 0
  ds_read_b64_tr_b16 a[212:213], v14 offset:256
  ds_read_b64_tr_b16 a[214:215], v14 offset:1792
  s_waitcnt lgkmcnt(8)
  v_mfma_f32_32x32x16_bf16 v[96:111], a[196:199], a[0:3], 0
  s_mov_b32 s66, 4096
  buffer_load_dwordx4 a[48:51], v2, s[56:59], s66 offen offset:2048 sc1
  v_mfma_f32_32x32x16_bf16 v[112:127], a[196:199], a[4:7], 0
  ds_read_b64_tr_b16 a[216:217], v13 offset:6144
  ds_read_b64_tr_b16 a[218:219], v13 offset:7680
  s_waitcnt lgkmcnt(8)
  v_mfma_f32_32x32x16_bf16 v[128:143], a[200:203], a[0:3], 0
  buffer_load_dwordx4 a[52:55], v3, s[56:59], s66 offen offset:2048 sc1
  v_mfma_f32_32x32x16_bf16 v[144:159], a[200:203], a[4:7], 0
  ds_read_b64_tr_b16 a[220:221], v14 offset:6144
  ds_read_b64_tr_b16 a[222:223], v14 offset:7680
  s_waitcnt lgkmcnt(8)
  v_mfma_f32_32x32x16_bf16 v[160:175], a[204:207], a[0:3], 0
  s_mov_b32 s66, 4096
  buffer_load_dwordx4 a[56:59], v2, s[56:59], s66 offen offset:3072 sc1
  v_mfma_f32_32x32x16_bf16 v[176:191], a[204:207], a[4:7], 0
  ds_read_b64_tr_b16 a[192:193], v13 offset:6272
  ds_read_b64_tr_b16 a[194:195], v13 offset:7808
  s_waitcnt lgkmcnt(8)
  v_mfma_f32_32x32x16_bf16 v[192:207], a[208:211], a[0:3], 0
  buffer_load_dwordx4 a[60:63], v3, s[56:59], s66 offen offset:3072 sc1
  v_mfma_f32_32x32x16_bf16 v[208:223], a[208:211], a[4:7], 0
  ds_read_b64_tr_b16 a[196:197], v14 offset:6272
  ds_read_b64_tr_b16 a[198:199], v14 offset:7808
  s_waitcnt lgkmcnt(8)
  v_mfma_f32_32x32x16_bf16 v[224:239], a[212:215], a[0:3], 0
  v_mfma_f32_32x32x16_bf16 v[240:255], a[212:215], a[4:7], 0
  ds_read_b64_tr_b16 a[200:201], v13 offset:6400
  ds_read_b64_tr_b16 a[202:203], v13 offset:7936
  s_waitcnt vmcnt(13)
  s_waitcnt lgkmcnt(8)
  v_mfma_f32_32x32x16_bf16 v[64:79], a[216:219], a[8:11], v[64:79]
  v_mfma_f32_32x32x16_bf16 v[80:95], a[216:219], a[12:15], v[80:95]
  ds_read_b64_tr_b16 a[204:205], v14 offset:6400
  ds_read_b64_tr_b16 a[206:207], v14 offset:7936
  s_waitcnt lgkmcnt(8)
  v_mfma_f32_32x32x16_bf16 v[96:111], a[220:223], a[8:11], v[96:111]
  s_mov_b32 s66, 8192
  buffer_load_dwordx4 a[64:67], v2, s[56:59], s66 offen offset:0 sc1
  v_mfma_f32_32x32x16_bf16 v[112:127], a[220:223], a[12:15], v[112:127]
  ds_read_b64_tr_b16 a[208:209], v13 offset:12288
  ds_read_b64_tr_b16 a[210:211], v13 offset:13824
  s_waitcnt lgkmcnt(8)
  v_mfma_f32_32x32x16_bf16 v[128:143], a[192:195], a[8:11], v[128:143]
  buffer_load_dwordx4 a[68:71], v3, s[56:59], s66 offen offset:0 sc1
  v_mfma_f32_32x32x16_bf16 v[144:159], a[192:195], a[12:15], v[144:159]
  ds_read_b64_tr_b16 a[212:213], v14 offset:12288
  ds_read_b64_tr_b16 a[214:215], v14 offset:13824
  s_waitcnt lgkmcnt(8)
  v_mfma_f32_32x32x16_bf16 v[160:175], a[196:199], a[8:11], v[160:175]
  s_mov_b32 s66, 8192
  buffer_load_dwordx4 a[72:75], v2, s[56:59], s66 offen offset:1024 sc1
  v_mfma_f32_32x32x16_bf16 v[176:191], a[196:199], a[12:15], v[176:191]
  ds_read_b64_tr_b16 a[216:217], v13 offset:12416
  ds_read_b64_tr_b16 a[218:219], v13 offset:13952
  s_waitcnt lgkmcnt(8)
  v_mfma_f32_32x32x16_bf16 v[192:207], a[200:203], a[8:11], v[192:207]
  buffer_load_dwordx4 a[76:79], v3, s[56:59], s66 offen offset:1024 sc1
  v_mfma_f32_32x32x16_bf16 v[208:223], a[200:203], a[12:15], v[208:223]
  ds_read_b64_tr_b16 a[220:221], v14 offset:12416
  ds_read_b64_tr_b16 a[222:223], v14 offset:13952
  s_waitcnt lgkmcnt(8)
  v_mfma_f32_32x32x16_bf16 v[224:239], a[204:207], a[8:11], v[224:239]
  v_mfma_f32_32x32x16_bf16 v[240:255], a[204:207], a[12:15], v[240:255]
  ds_read_b64_tr_b16 a[192:193], v13 offset:12544
  ds_read_b64_tr_b16 a[194:195], v13 offset:14080
  s_waitcnt vmcnt(15)
  s_waitcnt lgkmcnt(8)
  v_mfma_f32_32x32x16_bf16 v[64:79], a[208:211], a[16:19], v[64:79]
  v_mfma_f32_32x32x16_bf16 v[80:95], a[208:211], a[20:23], v[80:95]
  ds_read_b64_tr_b16 a[196:197], v14 offset:12544
  ds_read_b64_tr_b16 a[198:199], v14 offset:14080
  s_waitcnt lgkmcnt(8)
  v_mfma_f32_32x32x16_bf16 v[96:111], a[212:215], a[16:19], v[96:111]
  s_mov_b32 s66, 8192
  buffer_load_dwordx4 a[80:83], v2, s[56:59], s66 offen offset:2048 sc1
  v_mfma_f32_32x32x16_bf16 v[112:127], a[212:215], a[20:23], v[112:127]
  ds_read_b64_tr_b16 a[200:201], v13 offset:18432
  ds_read_b64_tr_b16 a[202:203], v13 offset:19968
  s_waitcnt lgkmcnt(8)
  v_mfma_f32_32x32x16_bf16 v[128:143], a[216:219], a[16:19], v[128:143]
  buffer_load_dwordx4 a[84:87], v3, s[56:59], s66 offen offset:2048 sc1
  v_mfma_f32_32x32x16_bf16 v[144:159], a[216:219], a[20:23], v[144:159]
  ds_read_b64_tr_b16 a[204:205], v14 offset:18432
  ds_read_b64_tr_b16 a[206:207], v14 offset:19968
  s_waitcnt lgkmcnt(8)
  v_mfma_f32_32x32x16_bf16 v[160:175], a[220:223], a[16:19], v[160:175]
  s_mov_b32 s66, 8192
  buffer_load_dwordx4 a[88:91], v2, s[56:59], s66 offen offset:3072 sc1
  v_mfma_f32_32x32x16_bf16 v[176:191], a[220:223], a[20:23], v[176:191]
  ds_read_b64_tr_b16 a[208:209], v13 offset:18560
  ds_read_b64_tr_b16 a[210:211], v13 offset:20096
  s_waitcnt lgkmcnt(8)
  v_mfma_f32_32x32x16_bf16 v[192:207], a[192:195], a[16:19], v[192:207]
  buffer_load_dwordx4 a[92:95], v3, s[56:59], s66 offen offset:3072 sc1
  v_mfma_f32_32x32x16_bf16 v[208:223], a[192:195], a[20:23], v[208:223]
  ds_read_b64_tr_b16 a[212:213], v14 offset:18560
  ds_read_b64_tr_b16 a[214:215], v14 offset:20096
  s_waitcnt lgkmcnt(8)
  v_mfma_f32_32x32x16_bf16 v[224:239], a[196:199], a[16:19], v[224:239]
  v_mfma_f32_32x32x16_bf16 v[240:255], a[196:199], a[20:23], v[240:255]
  ds_read_b64_tr_b16 a[216:217], v13 offset:18688
  ds_read_b64_tr_b16 a[218:219], v13 offset:20224
  s_waitcnt vmcnt(17)
  s_waitcnt lgkmcnt(8)
  v_mfma_f32_32x32x16_bf16 v[64:79], a[200:203], a[24:27], v[64:79]
  v_mfma_f32_32x32x16_bf16 v[80:95], a[200:203], a[28:31], v[80:95]
  ds_read_b64_tr_b16 a[220:221], v14 offset:18688
  ds_read_b64_tr_b16 a[222:223], v14 offset:20224
  s_waitcnt lgkmcnt(8)
  v_mfma_f32_32x32x16_bf16 v[96:111], a[204:207], a[24:27], v[96:111]
  s_mov_b32 s66, 12288
  buffer_load_dwordx4 a[96:99], v2, s[56:59], s66 offen offset:0 sc1
  v_mfma_f32_32x32x16_bf16 v[112:127], a[204:207], a[28:31], v[112:127]
  s_barrier
  ds_read_b64_tr_b16 a[192:193], v13 offset:24576
  ds_read_b64_tr_b16 a[194:195], v13 offset:26112
  s_waitcnt lgkmcnt(8)
  v_mfma_f32_32x32x16_bf16 v[128:143], a[208:211], a[24:27], v[128:143]
  buffer_load_dwordx4 a[100:103], v3, s[56:59], s66 offen offset:0 sc1
  v_mfma_f32_32x32x16_bf16 v[144:159], a[208:211], a[28:31], v[144:159]
  ds_read_b64_tr_b16 a[196:197], v14 offset:24576
  ds_read_b64_tr_b16 a[198:199], v14 offset:26112
  s_waitcnt lgkmcnt(8)
  v_mfma_f32_32x32x16_bf16 v[160:175], a[212:215], a[24:27], v[160:175]
  s_mov_b32 s66, 12288
  buffer_load_dwordx4 a[104:107], v2, s[56:59], s66 offen offset:1024 sc1
  v_mfma_f32_32x32x16_bf16 v[176:191], a[212:215], a[28:31], v[176:191]
  ds_read_b64_tr_b16 a[200:201], v13 offset:24704
  ds_read_b64_tr_b16 a[202:203], v13 offset:26240
  s_waitcnt lgkmcnt(8)
  v_mfma_f32_32x32x16_bf16 v[192:207], a[216:219], a[24:27], v[192:207]
  buffer_load_dwordx4 a[108:111], v3, s[56:59], s66 offen offset:1024 sc1
  v_mfma_f32_32x32x16_bf16 v[208:223], a[216:219], a[28:31], v[208:223]
  ds_read_b64_tr_b16 a[204:205], v14 offset:24704
  ds_read_b64_tr_b16 a[206:207], v14 offset:26240
  s_waitcnt lgkmcnt(8)
  v_mfma_f32_32x32x16_bf16 v[224:239], a[220:223], a[24:27], v[224:239]
  v_mfma_f32_32x32x16_bf16 v[240:255], a[220:223], a[28:31], v[240:255]
  ds_read_b64_tr_b16 a[208:209], v13 offset:24832
  ds_read_b64_tr_b16 a[210:211], v13 offset:26368
  s_waitcnt vmcnt(19)
  s_waitcnt lgkmcnt(8)
  v_mfma_f32_32x32x16_bf16 v[64:79], a[192:195], a[32:35], v[64:79]
  v_mfma_f32_32x32x16_bf16 v[80:95], a[192:195], a[36:39], v[80:95]
  ds_read_b64_tr_b16 a[212:213], v14 offset:24832
  ds_read_b64_tr_b16 a[214:215], v14 offset:26368
  s_waitcnt lgkmcnt(8)
  v_mfma_f32_32x32x16_bf16 v[96:111], a[196:199], a[32:35], v[96:111]
  s_mov_b32 s67, 3145728
  s_add_u32 m0, s68, 98304
  s_nop 0
  buffer_load_dwordx4 v4, s[44:47], s67 offen offset:0 lds
  s_mov_b32 s66, 12288
  buffer_load_dwordx4 a[112:115], v2, s[56:59], s66 offen offset:2048 sc1
  v_mfma_f32_32x32x16_bf16 v[112:127], a[196:199], a[36:39], v[112:127]
  ds_read_b64_tr_b16 a[216:217], v13 offset:30720
  ds_read_b64_tr_b16 a[218:219], v13 offset:32256
  buffer_load_dwordx4 v5, s[44:47], s67 offen offset:1024 lds
  s_waitcnt lgkmcnt(8)
  v_mfma_f32_32x32x16_bf16 v[128:143], a[200:203], a[32:35], v[128:143]
  buffer_load_dwordx4 v6, s[44:47], s67 offen offset:2048 lds
  buffer_load_dwordx4 a[116:119], v3, s[56:59], s66 offen offset:2048 sc1
  v_mfma_f32_32x32x16_bf16 v[144:159], a[200:203], a[36:39], v[144:159]
  ds_read_b64_tr_b16 a[220:221], v14 offset:30720
  ds_read_b64_tr_b16 a[222:223], v14 offset:32256
  s_waitcnt lgkmcnt(8)
  v_mfma_f32_32x32x16_bf16 v[160:175], a[204:207], a[32:35], v[160:175]
  s_mov_b32 s67, 3538944
  s_add_u32 m0, s68, 110592
  s_nop 0
  buffer_load_dwordx4 v4, s[44:47], s67 offen offset:0 lds
  v_mfma_f32_32x32x16_bf16 v[176:191], a[204:207], a[36:39], v[176:191]
  ds_read_b64_tr_b16 a[192:193], v13 offset:30848
  ds_read_b64_tr_b16 a[194:195], v13 offset:32384
  buffer_load_dwordx4 v5, s[44:47], s67 offen offset:1024 lds
  s_waitcnt lgkmcnt(8)
  v_mfma_f32_32x32x16_bf16 v[192:207], a[208:211], a[32:35], v[192:207]
  buffer_load_dwordx4 v6, s[44:47], s67 offen offset:2048 lds
  v_mfma_f32_32x32x16_bf16 v[208:223], a[208:211], a[36:39], v[208:223]
  ds_read_b64_tr_b16 a[196:197], v14 offset:30848
  ds_read_b64_tr_b16 a[198:199], v14 offset:32384
  s_waitcnt lgkmcnt(8)
  v_mfma_f32_32x32x16_bf16 v[224:239], a[212:215], a[32:35], v[224:239]
  s_mov_b32 s67, 3932160
  s_add_u32 m0, s68, 122880
  s_nop 0
  buffer_load_dwordx4 v4, s[44:47], s67 offen offset:0 lds
  v_mfma_f32_32x32x16_bf16 v[240:255], a[212:215], a[36:39], v[240:255]
  ds_read_b64_tr_b16 a[200:201], v13 offset:30976
  ds_read_b64_tr_b16 a[202:203], v13 offset:32512
  buffer_load_dwordx4 v5, s[44:47], s67 offen offset:1024 lds
  s_waitcnt vmcnt(27)
  s_waitcnt lgkmcnt(8)
  v_mfma_f32_32x32x16_bf16 v[64:79], a[216:219], a[40:43], v[64:79]
  buffer_load_dwordx4 v6, s[44:47], s67 offen offset:2048 lds
  v_mfma_f32_32x32x16_bf16 v[80:95], a[216:219], a[44:47], v[80:95]
  ds_read_b64_tr_b16 a[204:205], v14 offset:30976
  ds_read_b64_tr_b16 a[206:207], v14 offset:32512
  s_waitcnt lgkmcnt(8)
  v_mfma_f32_32x32x16_bf16 v[96:111], a[220:223], a[40:43], v[96:111]
  s_mov_b32 s67, 4325376
  s_add_u32 m0, s68, 135168
  s_nop 0
  buffer_load_dwordx4 v4, s[44:47], s67 offen offset:0 lds
  s_mov_b32 s66, 12288
  buffer_load_dwordx4 a[120:123], v2, s[56:59], s66 offen offset:3072 sc1
  v_mfma_f32_32x32x16_bf16 v[112:127], a[220:223], a[44:47], v[112:127]
  ds_read_b64_tr_b16 a[208:209], v13 offset:36864
  ds_read_b64_tr_b16 a[210:211], v13 offset:38400
  buffer_load_dwordx4 v5, s[44:47], s67 offen offset:1024 lds
  s_waitcnt lgkmcnt(8)
  v_mfma_f32_32x32x16_bf16 v[128:143], a[192:195], a[40:43], v[128:143]
  buffer_load_dwordx4 v6, s[44:47], s67 offen offset:2048 lds
  buffer_load_dwordx4 a[124:127], v3, s[56:59], s66 offen offset:3072 sc1
  v_mfma_f32_32x32x16_bf16 v[144:159], a[192:195], a[44:47], v[144:159]
  ds_read_b64_tr_b16 a[212:213], v14 offset:36864
  ds_read_b64_tr_b16 a[214:215], v14 offset:38400
  s_waitcnt lgkmcnt(8)
  v_mfma_f32_32x32x16_bf16 v[160:175], a[196:199], a[40:43], v[160:175]
  s_mov_b32 s67, 4718592
  s_add_u32 m0, s68, 147456
  s_nop 0
  buffer_load_dwordx4 v4, s[44:47], s67 offen offset:0 lds
  v_mfma_f32_32x32x16_bf16 v[176:191], a[196:199], a[44:47], v[176:191]
  ds_read_b64_tr_b16 a[216:217], v13 offset:36992
  ds_read_b64_tr_b16 a[218:219], v13 offset:38528
  buffer_load_dwordx4 v5, s[44:47], s67 offen offset:1024 lds
  s_waitcnt lgkmcnt(8)
  v_mfma_f32_32x32x16_bf16 v[192:207], a[200:203], a[40:43], v[192:207]
  buffer_load_dwordx4 v6, s[44:47], s67 offen offset:2048 lds
  v_mfma_f32_32x32x16_bf16 v[208:223], a[200:203], a[44:47], v[208:223]
  ds_read_b64_tr_b16 a[220:221], v14 offset:36992
  ds_read_b64_tr_b16 a[222:223], v14 offset:38528
  s_waitcnt lgkmcnt(8)
  v_mfma_f32_32x32x16_bf16 v[224:239], a[204:207], a[40:43], v[224:239]
  v_mfma_f32_32x32x16_bf16 v[240:255], a[204:207], a[44:47], v[240:255]
  ds_read_b64_tr_b16 a[192:193], v13 offset:37120
  ds_read_b64_tr_b16 a[194:195], v13 offset:38656
  s_waitcnt vmcnt(33)
  s_waitcnt lgkmcnt(8)
  v_mfma_f32_32x32x16_bf16 v[64:79], a[208:211], a[48:51], v[64:79]
  v_mfma_f32_32x32x16_bf16 v[80:95], a[208:211], a[52:55], v[80:95]
  ds_read_b64_tr_b16 a[196:197], v14 offset:37120
  ds_read_b64_tr_b16 a[198:199], v14 offset:38656
  s_waitcnt lgkmcnt(8)
  v_mfma_f32_32x32x16_bf16 v[96:111], a[212:215], a[48:51], v[96:111]
  s_mov_b32 s66, 16384
  buffer_load_dwordx4 a[0:3], v2, s[56:59], s66 offen offset:0 sc1
  v_mfma_f32_32x32x16_bf16 v[112:127], a[212:215], a[52:55], v[112:127]
  ds_read_b64_tr_b16 a[200:201], v13 offset:43008
  ds_read_b64_tr_b16 a[202:203], v13 offset:44544
  s_waitcnt lgkmcnt(8)
  v_mfma_f32_32x32x16_bf16 v[128:143], a[216:219], a[48:51], v[128:143]
  buffer_load_dwordx4 a[4:7], v3, s[56:59], s66 offen offset:0 sc1
  v_mfma_f32_32x32x16_bf16 v[144:159], a[216:219], a[52:55], v[144:159]
  ds_read_b64_tr_b16 a[204:205], v14 offset:43008
  ds_read_b64_tr_b16 a[206:207], v14 offset:44544
  s_waitcnt lgkmcnt(8)
  v_mfma_f32_32x32x16_bf16 v[160:175], a[220:223], a[48:51], v[160:175]
  v_mfma_f32_32x32x16_bf16 v[176:191], a[220:223], a[52:55], v[176:191]
  ds_read_b64_tr_b16 a[208:209], v13 offset:43136
  ds_read_b64_tr_b16 a[210:211], v13 offset:44672
  s_waitcnt lgkmcnt(8)
  v_mfma_f32_32x32x16_bf16 v[192:207], a[192:195], a[48:51], v[192:207]
  v_mfma_f32_32x32x16_bf16 v[208:223], a[192:195], a[52:55], v[208:223]
  ds_read_b64_tr_b16 a[212:213], v14 offset:43136
  ds_read_b64_tr_b16 a[214:215], v14 offset:44672
  s_waitcnt lgkmcnt(8)
  v_mfma_f32_32x32x16_bf16 v[224:239], a[196:199], a[48:51], v[224:239]
  v_mfma_f32_32x32x16_bf16 v[240:255], a[196:199], a[52:55], v[240:255]
  ds_read_b64_tr_b16 a[216:217], v13 offset:43264
  ds_read_b64_tr_b16 a[218:219], v13 offset:44800
  s_waitcnt vmcnt(33)
  s_waitcnt lgkmcnt(8)
  v_mfma_f32_32x32x16_bf16 v[64:79], a[200:203], a[56:59], v[64:79]
  v_mfma_f32_32x32x16_bf16 v[80:95], a[200:203], a[60:63], v[80:95]
  ds_read_b64_tr_b16 a[220:221], v14 offset:43264
  ds_read_b64_tr_b16 a[222:223], v14 offset:44800
  s_waitcnt lgkmcnt(8)
  v_mfma_f32_32x32x16_bf16 v[96:111], a[204:207], a[56:59], v[96:111]
  s_mov_b32 s66, 16384
  buffer_load_dwordx4 a[8:11], v2, s[56:59], s66 offen offset:1024 sc1
  v_mfma_f32_32x32x16_bf16 v[112:127], a[204:207], a[60:63], v[112:127]
  s_barrier
  ds_read_b64_tr_b16 a[192:193], v13 offset:49152
  ds_read_b64_tr_b16 a[194:195], v13 offset:50688
  s_waitcnt lgkmcnt(8)
  v_mfma_f32_32x32x16_bf16 v[128:143], a[208:211], a[56:59], v[128:143]
  s_mov_b32 s67, 5111808
  s_add_u32 m0, s68, 0
  s_nop 0
  buffer_load_dwordx4 v4, s[44:47], s67 offen offset:0 lds
  buffer_load_dwordx4 a[12:15], v3, s[56:59], s66 offen offset:1024 sc1
  v_mfma_f32_32x32x16_bf16 v[144:159], a[208:211], a[60:63], v[144:159]
  ds_read_b64_tr_b16 a[196:197], v14 offset:49152
  ds_read_b64_tr_b16 a[198:199], v14 offset:50688
  buffer_load_dwordx4 v5, s[44:47], s67 offen offset:1024 lds
  s_waitcnt lgkmcnt(8)
  v_mfma_f32_32x32x16_bf16 v[160:175], a[212:215], a[56:59], v[160:175]
  buffer_load_dwordx4 v6, s[44:47], s67 offen offset:2048 lds
  v_mfma_f32_32x32x16_bf16 v[176:191], a[212:215], a[60:63], v[176:191]
  ds_read_b64_tr_b16 a[200:201], v13 offset:49280
  ds_read_b64_tr_b16 a[202:203], v13 offset:50816
  s_mov_b32 s67, 5505024
  s_add_u32 m0, s68, 12288
  s_nop 0
  buffer_load_dwordx4 v4, s[44:47], s67 offen offset:0 lds
  s_waitcnt lgkmcnt(8)
  v_mfma_f32_32x32x16_bf16 v[192:207], a[216:219], a[56:59], v[192:207]
  buffer_load_dwordx4 v5, s[44:47], s67 offen offset:1024 lds
  v_mfma_f32_32x32x16_bf16 v[208:223], a[216:219], a[60:63], v[208:223]
  ds_read_b64_tr_b16 a[204:205], v14 offset:49280
  ds_read_b64_tr_b16 a[206:207], v14 offset:50816
  buffer_load_dwordx4 v6, s[44:47], s67 offen offset:2048 lds
  s_waitcnt lgkmcnt(8)
  v_mfma_f32_32x32x16_bf16 v[224:239], a[220:223], a[56:59], v[224:239]
  v_mfma_f32_32x32x16_bf16 v[240:255], a[220:223], a[60:63], v[240:255]
  ds_read_b64_tr_b16 a[208:209], v13 offset:49408
  ds_read_b64_tr_b16 a[210:211], v13 offset:50944
  s_waitcnt vmcnt(39)
  s_waitcnt lgkmcnt(8)
  v_mfma_f32_32x32x16_bf16 v[64:79], a[192:195], a[64:67], v[64:79]
  v_mfma_f32_32x32x16_bf16 v[80:95], a[192:195], a[68:71], v[80:95]
  ds_read_b64_tr_b16 a[212:213], v14 offset:49408
  ds_read_b64_tr_b16 a[214:215], v14 offset:50944
  s_waitcnt lgkmcnt(8)
  v_mfma_f32_32x32x16_bf16 v[96:111], a[196:199], a[64:67], v[96:111]
  s_mov_b32 s66, 16384
  buffer_load_dwordx4 a[16:19], v2, s[56:59], s66 offen offset:2048 sc1
  v_mfma_f32_32x32x16_bf16 v[112:127], a[196:199], a[68:71], v[112:127]
  ds_read_b64_tr_b16 a[216:217], v13 offset:55296
  ds_read_b64_tr_b16 a[218:219], v13 offset:56832
  s_waitcnt lgkmcnt(8)
  v_mfma_f32_32x32x16_bf16 v[128:143], a[200:203], a[64:67], v[128:143]
  buffer_load_dwordx4 a[20:23], v3, s[56:59], s66 offen offset:2048 sc1
  v_mfma_f32_32x32x16_bf16 v[144:159], a[200:203], a[68:71], v[144:159]
  ds_read_b64_tr_b16 a[220:221], v14 offset:55296
  ds_read_b64_tr_b16 a[222:223], v14 offset:56832
  s_waitcnt lgkmcnt(8)
  v_mfma_f32_32x32x16_bf16 v[160:175], a[204:207], a[64:67], v[160:175]
  v_mfma_f32_32x32x16_bf16 v[176:191], a[204:207], a[68:71], v[176:191]
  ds_read_b64_tr_b16 a[192:193], v13 offset:55424
  ds_read_b64_tr_b16 a[194:195], v13 offset:56960
  s_waitcnt lgkmcnt(8)
  v_mfma_f32_32x32x16_bf16 v[192:207], a[208:211], a[64:67], v[192:207]
  v_mfma_f32_32x32x16_bf16 v[208:223], a[208:211], a[68:71], v[208:223]
  ds_read_b64_tr_b16 a[196:197], v14 offset:55424
  ds_read_b64_tr_b16 a[198:199], v14 offset:56960
  s_waitcnt lgkmcnt(8)
  v_mfma_f32_32x32x16_bf16 v[224:239], a[212:215], a[64:67], v[224:239]
  v_mfma_f32_32x32x16_bf16 v[240:255], a[212:215], a[68:71], v[240:255]
  ds_read_b64_tr_b16 a[200:201], v13 offset:55552
  ds_read_b64_tr_b16 a[202:203], v13 offset:57088
  s_waitcnt vmcnt(39)
  s_waitcnt lgkmcnt(8)
  v_mfma_f32_32x32x16_bf16 v[64:79], a[216:219], a[72:75], v[64:79]
  v_mfma_f32_32x32x16_bf16 v[80:95], a[216:219], a[76:79], v[80:95]
  ds_read_b64_tr_b16 a[204:205], v14 offset:55552
  ds_read_b64_tr_b16 a[206:207], v14 offset:57088
  s_waitcnt lgkmcnt(8)
  v_mfma_f32_32x32x16_bf16 v[96:111], a[220:223], a[72:75], v[96:111]
  s_mov_b32 s66, 16384
  buffer_load_dwordx4 a[24:27], v2, s[56:59], s66 offen offset:3072 sc1
  v_mfma_f32_32x32x16_bf16 v[112:127], a[220:223], a[76:79], v[112:127]
  ds_read_b64_tr_b16 a[208:209], v15 offset:0
  ds_read_b64_tr_b16 a[210:211], v15 offset:1536
  s_waitcnt lgkmcnt(8)
  v_mfma_f32_32x32x16_bf16 v[128:143], a[192:195], a[72:75], v[128:143]
  buffer_load_dwordx4 a[28:31], v3, s[56:59], s66 offen offset:3072 sc1
  v_mfma_f32_32x32x16_bf16 v[144:159], a[192:195], a[76:79], v[144:159]
  ds_read_b64_tr_b16 a[212:213], v16 offset:0
  ds_read_b64_tr_b16 a[214:215], v16 offset:1536
  s_waitcnt lgkmcnt(8)
  v_mfma_f32_32x32x16_bf16 v[160:175], a[196:199], a[72:75], v[160:175]
  v_mfma_f32_32x32x16_bf16 v[176:191], a[196:199], a[76:79], v[176:191]
  ds_read_b64_tr_b16 a[216:217], v15 offset:128
  ds_read_b64_tr_b16 a[218:219], v15 offset:1664
  s_waitcnt lgkmcnt(8)
  v_mfma_f32_32x32x16_bf16 v[192:207], a[200:203], a[72:75], v[192:207]
  v_mfma_f32_32x32x16_bf16 v[208:223], a[200:203], a[76:79], v[208:223]
  ds_read_b64_tr_b16 a[220:221], v16 offset:128
  ds_read_b64_tr_b16 a[222:223], v16 offset:1664
  s_waitcnt lgkmcnt(8)
  v_mfma_f32_32x32x16_bf16 v[224:239], a[204:207], a[72:75], v[224:239]
  v_mfma_f32_32x32x16_bf16 v[240:255], a[204:207], a[76:79], v[240:255]
  ds_read_b64_tr_b16 a[192:193], v15 offset:256
  ds_read_b64_tr_b16 a[194:195], v15 offset:1792
  s_waitcnt vmcnt(39)
  s_waitcnt lgkmcnt(8)
  v_mfma_f32_32x32x16_bf16 v[64:79], a[208:211], a[80:83], v[64:79]
  v_mfma_f32_32x32x16_bf16 v[80:95], a[208:211], a[84:87], v[80:95]
  ds_read_b64_tr_b16 a[196:197], v16 offset:256
  ds_read_b64_tr_b16 a[198:199], v16 offset:1792
  s_waitcnt lgkmcnt(8)
  v_mfma_f32_32x32x16_bf16 v[96:111], a[212:215], a[80:83], v[96:111]
  s_mov_b32 s66, 20480
  buffer_load_dwordx4 a[32:35], v2, s[56:59], s66 offen offset:0 sc1
  v_mfma_f32_32x32x16_bf16 v[112:127], a[212:215], a[84:87], v[112:127]
  ds_read_b64_tr_b16 a[200:201], v15 offset:6144
  ds_read_b64_tr_b16 a[202:203], v15 offset:7680
  s_waitcnt lgkmcnt(8)
  v_mfma_f32_32x32x16_bf16 v[128:143], a[216:219], a[80:83], v[128:143]
  buffer_load_dwordx4 a[36:39], v3, s[56:59], s66 offen offset:0 sc1
  v_mfma_f32_32x32x16_bf16 v[144:159], a[216:219], a[84:87], v[144:159]
  ds_read_b64_tr_b16 a[204:205], v16 offset:6144
  ds_read_b64_tr_b16 a[206:207], v16 offset:7680
  s_waitcnt lgkmcnt(8)
  v_mfma_f32_32x32x16_bf16 v[160:175], a[220:223], a[80:83], v[160:175]
  v_mfma_f32_32x32x16_bf16 v[176:191], a[220:223], a[84:87], v[176:191]
  ds_read_b64_tr_b16 a[208:209], v15 offset:6272
  ds_read_b64_tr_b16 a[210:211], v15 offset:7808
  s_waitcnt lgkmcnt(8)
  v_mfma_f32_32x32x16_bf16 v[192:207], a[192:195], a[80:83], v[192:207]
  v_mfma_f32_32x32x16_bf16 v[208:223], a[192:195], a[84:87], v[208:223]
  ds_read_b64_tr_b16 a[212:213], v16 offset:6272
  ds_read_b64_tr_b16 a[214:215], v16 offset:7808
  s_waitcnt lgkmcnt(8)
  v_mfma_f32_32x32x16_bf16 v[224:239], a[196:199], a[80:83], v[224:239]
  v_mfma_f32_32x32x16_bf16 v[240:255], a[196:199], a[84:87], v[240:255]
  ds_read_b64_tr_b16 a[216:217], v15 offset:6400
  ds_read_b64_tr_b16 a[218:219], v15 offset:7936
  s_waitcnt vmcnt(39)
  s_waitcnt lgkmcnt(8)
  v_mfma_f32_32x32x16_bf16 v[64:79], a[200:203], a[88:91], v[64:79]
  v_mfma_f32_32x32x16_bf16 v[80:95], a[200:203], a[92:95], v[80:95]
  ds_read_b64_tr_b16 a[220:221], v16 offset:6400
  ds_read_b64_tr_b16 a[222:223], v16 offset:7936
  s_waitcnt lgkmcnt(8)
  v_mfma_f32_32x32x16_bf16 v[96:111], a[204:207], a[88:91], v[96:111]
  s_mov_b32 s66, 20480
  buffer_load_dwordx4 a[40:43], v2, s[56:59], s66 offen offset:1024 sc1
  v_mfma_f32_32x32x16_bf16 v[112:127], a[204:207], a[92:95], v[112:127]
  s_barrier
  ds_read_b64_tr_b16 a[192:193], v15 offset:12288
  ds_read_b64_tr_b16 a[194:195], v15 offset:13824
  s_waitcnt lgkmcnt(8)
  v_mfma_f32_32x32x16_bf16 v[128:143], a[208:211], a[88:91], v[128:143]
  s_mov_b32 s67, 5898240
  s_add_u32 m0, s68, 24576
  s_nop 0
  buffer_load_dwordx4 v4, s[44:47], s67 offen offset:0 lds
  buffer_load_dwordx4 a[44:47], v3, s[56:59], s66 offen offset:1024 sc1
  v_mfma_f32_32x32x16_bf16 v[144:159], a[208:211], a[92:95], v[144:159]
  ds_read_b64_tr_b16 a[196:197], v16 offset:12288
  ds_read_b64_tr_b16 a[198:199], v16 offset:13824
  buffer_load_dwordx4 v5, s[44:47], s67 offen offset:1024 lds
  s_waitcnt lgkmcnt(8)
  v_mfma_f32_32x32x16_bf16 v[160:175], a[212:215], a[88:91], v[160:175]
  buffer_load_dwordx4 v6, s[44:47], s67 offen offset:2048 lds
  v_mfma_f32_32x32x16_bf16 v[176:191], a[212:215], a[92:95], v[176:191]
  ds_read_b64_tr_b16 a[200:201], v15 offset:12416
  ds_read_b64_tr_b16 a[202:203], v15 offset:13952
  s_mov_b32 s67, 6291456
  s_add_u32 m0, s68, 36864
  s_nop 0
  buffer_load_dwordx4 v4, s[44:47], s67 offen offset:0 lds
  s_waitcnt lgkmcnt(8)
  v_mfma_f32_32x32x16_bf16 v[192:207], a[216:219], a[88:91], v[192:207]
  buffer_load_dwordx4 v5, s[44:47], s67 offen offset:1024 lds
  v_mfma_f32_32x32x16_bf16 v[208:223], a[216:219], a[92:95], v[208:223]
  ds_read_b64_tr_b16 a[204:205], v16 offset:12416
  ds_read_b64_tr_b16 a[206:207], v16 offset:13952
  buffer_load_dwordx4 v6, s[44:47], s67 offen offset:2048 lds
  s_waitcnt lgkmcnt(8)
  v_mfma_f32_32x32x16_bf16 v[224:239], a[220:223], a[88:91], v[224:239]
  v_mfma_f32_32x32x16_bf16 v[240:255], a[220:223], a[92:95], v[240:255]
  ds_read_b64_tr_b16 a[208:209], v15 offset:12544
  ds_read_b64_tr_b16 a[210:211], v15 offset:14080
  s_waitcnt vmcnt(45)
  s_waitcnt lgkmcnt(8)
  v_mfma_f32_32x32x16_bf16 v[64:79], a[192:195], a[96:99], v[64:79]
  v_mfma_f32_32x32x16_bf16 v[80:95], a[192:195], a[100:103], v[80:95]
  ds_read_b64_tr_b16 a[212:213], v16 offset:12544
  ds_read_b64_tr_b16 a[214:215], v16 offset:14080
  s_waitcnt lgkmcnt(8)
  v_mfma_f32_32x32x16_bf16 v[96:111], a[196:199], a[96:99], v[96:111]
  s_mov_b32 s66, 20480
  buffer_load_dwordx4 a[48:51], v2, s[56:59], s66 offen offset:2048 sc1
  v_mfma_f32_32x32x16_bf16 v[112:127], a[196:199], a[100:103], v[112:127]
  ds_read_b64_tr_b16 a[216:217], v15 offset:18432
  ds_read_b64_tr_b16 a[218:219], v15 offset:19968
  s_waitcnt lgkmcnt(8)
  v_mfma_f32_32x32x16_bf16 v[128:143], a[200:203], a[96:99], v[128:143]
  buffer_load_dwordx4 a[52:55], v3, s[56:59], s66 offen offset:2048 sc1
  v_mfma_f32_32x32x16_bf16 v[144:159], a[200:203], a[100:103], v[144:159]
  ds_read_b64_tr_b16 a[220:221], v16 offset:18432
  ds_read_b64_tr_b16 a[222:223], v16 offset:19968
  s_waitcnt lgkmcnt(8)
  v_mfma_f32_32x32x16_bf16 v[160:175], a[204:207], a[96:99], v[160:175]
  v_mfma_f32_32x32x16_bf16 v[176:191], a[204:207], a[100:103], v[176:191]
  ds_read_b64_tr_b16 a[192:193], v15 offset:18560
  ds_read_b64_tr_b16 a[194:195], v15 offset:20096
  s_waitcnt lgkmcnt(8)
  v_mfma_f32_32x32x16_bf16 v[192:207], a[208:211], a[96:99], v[192:207]
  v_mfma_f32_32x32x16_bf16 v[208:223], a[208:211], a[100:103], v[208:223]
  ds_read_b64_tr_b16 a[196:197], v16 offset:18560
  ds_read_b64_tr_b16 a[198:199], v16 offset:20096
  s_waitcnt lgkmcnt(8)
  v_mfma_f32_32x32x16_bf16 v[224:239], a[212:215], a[96:99], v[224:239]
  v_mfma_f32_32x32x16_bf16 v[240:255], a[212:215], a[100:103], v[240:255]
  ds_read_b64_tr_b16 a[200:201], v15 offset:18688
  ds_read_b64_tr_b16 a[202:203], v15 offset:20224
  s_waitcnt vmcnt(45)
  s_waitcnt lgkmcnt(8)
  v_mfma_f32_32x32x16_bf16 v[64:79], a[216:219], a[104:107], v[64:79]
  v_mfma_f32_32x32x16_bf16 v[80:95], a[216:219], a[108:111], v[80:95]
  ds_read_b64_tr_b16 a[204:205], v16 offset:18688
  ds_read_b64_tr_b16 a[206:207], v16 offset:20224
  s_waitcnt lgkmcnt(8)
  v_mfma_f32_32x32x16_bf16 v[96:111], a[220:223], a[104:107], v[96:111]
  s_mov_b32 s66, 20480
  buffer_load_dwordx4 a[56:59], v2, s[56:59], s66 offen offset:3072 sc1
  v_mfma_f32_32x32x16_bf16 v[112:127], a[220:223], a[108:111], v[112:127]
  ds_read_b64_tr_b16 a[208:209], v15 offset:24576
  ds_read_b64_tr_b16 a[210:211], v15 offset:26112
  s_waitcnt lgkmcnt(8)
  v_mfma_f32_32x32x16_bf16 v[128:143], a[192:195], a[104:107], v[128:143]
  buffer_load_dwordx4 a[60:63], v3, s[56:59], s66 offen offset:3072 sc1
  v_mfma_f32_32x32x16_bf16 v[144:159], a[192:195], a[108:111], v[144:159]
  ds_read_b64_tr_b16 a[212:213], v16 offset:24576
  ds_read_b64_tr_b16 a[214:215], v16 offset:26112
  s_waitcnt lgkmcnt(8)
  v_mfma_f32_32x32x16_bf16 v[160:175], a[196:199], a[104:107], v[160:175]
  v_mfma_f32_32x32x16_bf16 v[176:191], a[196:199], a[108:111], v[176:191]
  ds_read_b64_tr_b16 a[216:217], v15 offset:24704
  ds_read_b64_tr_b16 a[218:219], v15 offset:26240
  s_waitcnt lgkmcnt(8)
  v_mfma_f32_32x32x16_bf16 v[192:207], a[200:203], a[104:107], v[192:207]
  v_mfma_f32_32x32x16_bf16 v[208:223], a[200:203], a[108:111], v[208:223]
  ds_read_b64_tr_b16 a[220:221], v16 offset:24704
  ds_read_b64_tr_b16 a[222:223], v16 offset:26240
  s_waitcnt lgkmcnt(8)
  v_mfma_f32_32x32x16_bf16 v[224:239], a[204:207], a[104:107], v[224:239]
  v_mfma_f32_32x32x16_bf16 v[240:255], a[204:207], a[108:111], v[240:255]
  ds_read_b64_tr_b16 a[192:193], v15 offset:24832
  ds_read_b64_tr_b16 a[194:195], v15 offset:26368
  s_waitcnt vmcnt(42)
  s_waitcnt lgkmcnt(8)
  v_mfma_f32_32x32x16_bf16 v[64:79], a[208:211], a[112:115], v[64:79]
  v_mfma_f32_32x32x16_bf16 v[80:95], a[208:211], a[116:119], v[80:95]
  ds_read_b64_tr_b16 a[196:197], v16 offset:24832
  ds_read_b64_tr_b16 a[198:199], v16 offset:26368
  s_waitcnt lgkmcnt(8)
  v_mfma_f32_32x32x16_bf16 v[96:111], a[212:215], a[112:115], v[96:111]
  s_mov_b32 s66, 24576
  buffer_load_dwordx4 a[64:67], v2, s[56:59], s66 offen offset:0 sc1
  v_mfma_f32_32x32x16_bf16 v[112:127], a[212:215], a[116:119], v[112:127]
  ds_read_b64_tr_b16 a[200:201], v15 offset:30720
  ds_read_b64_tr_b16 a[202:203], v15 offset:32256
  s_waitcnt lgkmcnt(8)
  v_mfma_f32_32x32x16_bf16 v[128:143], a[216:219], a[112:115], v[128:143]
  buffer_load_dwordx4 a[68:71], v3, s[56:59], s66 offen offset:0 sc1
  v_mfma_f32_32x32x16_bf16 v[144:159], a[216:219], a[116:119], v[144:159]
  ds_read_b64_tr_b16 a[204:205], v16 offset:30720
  ds_read_b64_tr_b16 a[206:207], v16 offset:32256
  s_waitcnt lgkmcnt(8)
  v_mfma_f32_32x32x16_bf16 v[160:175], a[220:223], a[112:115], v[160:175]
  v_mfma_f32_32x32x16_bf16 v[176:191], a[220:223], a[116:119], v[176:191]
  ds_read_b64_tr_b16 a[208:209], v15 offset:30848
  ds_read_b64_tr_b16 a[210:211], v15 offset:32384
  s_waitcnt lgkmcnt(8)
  v_mfma_f32_32x32x16_bf16 v[192:207], a[192:195], a[112:115], v[192:207]
  v_mfma_f32_32x32x16_bf16 v[208:223], a[192:195], a[116:119], v[208:223]
  ds_read_b64_tr_b16 a[212:213], v16 offset:30848
  ds_read_b64_tr_b16 a[214:215], v16 offset:32384
  s_waitcnt lgkmcnt(8)
  v_mfma_f32_32x32x16_bf16 v[224:239], a[196:199], a[112:115], v[224:239]
  v_mfma_f32_32x32x16_bf16 v[240:255], a[196:199], a[116:119], v[240:255]
  ds_read_b64_tr_b16 a[216:217], v15 offset:30976
  ds_read_b64_tr_b16 a[218:219], v15 offset:32512
  s_waitcnt vmcnt(33)
  s_waitcnt lgkmcnt(8)
  v_mfma_f32_32x32x16_bf16 v[64:79], a[200:203], a[120:123], v[64:79]
  v_mfma_f32_32x32x16_bf16 v[80:95], a[200:203], a[124:127], v[80:95]
  ds_read_b64_tr_b16 a[220:221], v16 offset:30976
  ds_read_b64_tr_b16 a[222:223], v16 offset:32512
  s_waitcnt lgkmcnt(8)
  v_mfma_f32_32x32x16_bf16 v[96:111], a[204:207], a[120:123], v[96:111]
  s_mov_b32 s66, 24576
  buffer_load_dwordx4 a[72:75], v2, s[56:59], s66 offen offset:1024 sc1
  v_mfma_f32_32x32x16_bf16 v[112:127], a[204:207], a[124:127], v[112:127]
  s_barrier
  ds_read_b64_tr_b16 a[192:193], v15 offset:36864
  ds_read_b64_tr_b16 a[194:195], v15 offset:38400
  s_waitcnt lgkmcnt(8)
  v_mfma_f32_32x32x16_bf16 v[128:143], a[208:211], a[120:123], v[128:143]
  s_mov_b32 s67, 6684672
  s_add_u32 m0, s68, 49152
  s_nop 0
  buffer_load_dwordx4 v4, s[44:47], s67 offen offset:0 lds
  buffer_load_dwordx4 a[76:79], v3, s[56:59], s66 offen offset:1024 sc1
  v_mfma_f32_32x32x16_bf16 v[144:159], a[208:211], a[124:127], v[144:159]
  ds_read_b64_tr_b16 a[196:197], v16 offset:36864
  ds_read_b64_tr_b16 a[198:199], v16 offset:38400
  buffer_load_dwordx4 v5, s[44:47], s67 offen offset:1024 lds
  s_waitcnt lgkmcnt(8)
  v_mfma_f32_32x32x16_bf16 v[160:175], a[212:215], a[120:123], v[160:175]
  buffer_load_dwordx4 v6, s[44:47], s67 offen offset:2048 lds
  v_mfma_f32_32x32x16_bf16 v[176:191], a[212:215], a[124:127], v[176:191]
  ds_read_b64_tr_b16 a[200:201], v15 offset:36992
  ds_read_b64_tr_b16 a[202:203], v15 offset:38528
  s_mov_b32 s67, 7077888
  s_add_u32 m0, s68, 61440
  s_nop 0
  buffer_load_dwordx4 v4, s[44:47], s67 offen offset:0 lds
  s_waitcnt lgkmcnt(8)
  v_mfma_f32_32x32x16_bf16 v[192:207], a[216:219], a[120:123], v[192:207]
  buffer_load_dwordx4 v5, s[44:47], s67 offen offset:1024 lds
  v_mfma_f32_32x32x16_bf16 v[208:223], a[216:219], a[124:127], v[208:223]
  ds_read_b64_tr_b16 a[204:205], v16 offset:36992
  ds_read_b64_tr_b16 a[206:207], v16 offset:38528
  buffer_load_dwordx4 v6, s[44:47], s67 offen offset:2048 lds
  s_waitcnt lgkmcnt(8)
  v_mfma_f32_32x32x16_bf16 v[224:239], a[220:223], a[120:123], v[224:239]
  v_mfma_f32_32x32x16_bf16 v[240:255], a[220:223], a[124:127], v[240:255]
  ds_read_b64_tr_b16 a[208:209], v15 offset:37120
  ds_read_b64_tr_b16 a[210:211], v15 offset:38656
  s_waitcnt vmcnt(36)
  s_waitcnt lgkmcnt(8)
  v_mfma_f32_32x32x16_bf16 v[64:79], a[192:195], a[0:3], v[64:79]
  v_mfma_f32_32x32x16_bf16 v[80:95], a[192:195], a[4:7], v[80:95]
  ds_read_b64_tr_b16 a[212:213], v16 offset:37120
  ds_read_b64_tr_b16 a[214:215], v16 offset:38656
  s_waitcnt lgkmcnt(8)
  v_mfma_f32_32x32x16_bf16 v[96:111], a[196:199], a[0:3], v[96:111]
  s_mov_b32 s66, 24576
  buffer_load_dwordx4 a[80:83], v2, s[56:59], s66 offen offset:2048 sc1
  v_mfma_f32_32x32x16_bf16 v[112:127], a[196:199], a[4:7], v[112:127]
  ds_read_b64_tr_b16 a[216:217], v15 offset:43008
  ds_read_b64_tr_b16 a[218:219], v15 offset:44544
  s_waitcnt lgkmcnt(8)
  v_mfma_f32_32x32x16_bf16 v[128:143], a[200:203], a[0:3], v[128:143]
  buffer_load_dwordx4 a[84:87], v3, s[56:59], s66 offen offset:2048 sc1
  v_mfma_f32_32x32x16_bf16 v[144:159], a[200:203], a[4:7], v[144:159]
  ds_read_b64_tr_b16 a[220:221], v16 offset:43008
  ds_read_b64_tr_b16 a[222:223], v16 offset:44544
  s_waitcnt lgkmcnt(8)
  v_mfma_f32_32x32x16_bf16 v[160:175], a[204:207], a[0:3], v[160:175]
  v_mfma_f32_32x32x16_bf16 v[176:191], a[204:207], a[4:7], v[176:191]
  ds_read_b64_tr_b16 a[192:193], v15 offset:43136
  ds_read_b64_tr_b16 a[194:195], v15 offset:44672
  s_waitcnt lgkmcnt(8)
  v_mfma_f32_32x32x16_bf16 v[192:207], a[208:211], a[0:3], v[192:207]
  v_mfma_f32_32x32x16_bf16 v[208:223], a[208:211], a[4:7], v[208:223]
  ds_read_b64_tr_b16 a[196:197], v16 offset:43136
  ds_read_b64_tr_b16 a[198:199], v16 offset:44672
  s_waitcnt lgkmcnt(8)
  v_mfma_f32_32x32x16_bf16 v[224:239], a[212:215], a[0:3], v[224:239]
  v_mfma_f32_32x32x16_bf16 v[240:255], a[212:215], a[4:7], v[240:255]
  ds_read_b64_tr_b16 a[200:201], v15 offset:43264
  ds_read_b64_tr_b16 a[202:203], v15 offset:44800
  s_waitcnt vmcnt(35)
  s_waitcnt lgkmcnt(8)
  v_mfma_f32_32x32x16_bf16 v[64:79], a[216:219], a[8:11], v[64:79]
  v_mfma_f32_32x32x16_bf16 v[80:95], a[216:219], a[12:15], v[80:95]
  ds_read_b64_tr_b16 a[204:205], v16 offset:43264
  ds_read_b64_tr_b16 a[206:207], v16 offset:44800
  s_waitcnt lgkmcnt(8)
  v_mfma_f32_32x32x16_bf16 v[96:111], a[220:223], a[8:11], v[96:111]
  s_mov_b32 s66, 24576
  buffer_load_dwordx4 a[88:91], v2, s[56:59], s66 offen offset:3072 sc1
  v_mfma_f32_32x32x16_bf16 v[112:127], a[220:223], a[12:15], v[112:127]
  ds_read_b64_tr_b16 a[208:209], v15 offset:49152
  ds_read_b64_tr_b16 a[210:211], v15 offset:50688
  s_waitcnt lgkmcnt(8)
  v_mfma_f32_32x32x16_bf16 v[128:143], a[192:195], a[8:11], v[128:143]
  buffer_load_dwordx4 a[92:95], v3, s[56:59], s66 offen offset:3072 sc1
  v_mfma_f32_32x32x16_bf16 v[144:159], a[192:195], a[12:15], v[144:159]
  ds_read_b64_tr_b16 a[212:213], v16 offset:49152
  ds_read_b64_tr_b16 a[214:215], v16 offset:50688
  s_waitcnt lgkmcnt(8)
  v_mfma_f32_32x32x16_bf16 v[160:175], a[196:199], a[8:11], v[160:175]
  v_mfma_f32_32x32x16_bf16 v[176:191], a[196:199], a[12:15], v[176:191]
  ds_read_b64_tr_b16 a[216:217], v15 offset:49280
  ds_read_b64_tr_b16 a[218:219], v15 offset:50816
  s_waitcnt lgkmcnt(8)
  v_mfma_f32_32x32x16_bf16 v[192:207], a[200:203], a[8:11], v[192:207]
  v_mfma_f32_32x32x16_bf16 v[208:223], a[200:203], a[12:15], v[208:223]
  ds_read_b64_tr_b16 a[220:221], v16 offset:49280
  ds_read_b64_tr_b16 a[222:223], v16 offset:50816
  s_waitcnt lgkmcnt(8)
  v_mfma_f32_32x32x16_bf16 v[224:239], a[204:207], a[8:11], v[224:239]
  v_mfma_f32_32x32x16_bf16 v[240:255], a[204:207], a[12:15], v[240:255]
  ds_read_b64_tr_b16 a[192:193], v15 offset:49408
  ds_read_b64_tr_b16 a[194:195], v15 offset:50944
  s_waitcnt vmcnt(30)
  s_waitcnt lgkmcnt(8)
  v_mfma_f32_32x32x16_bf16 v[64:79], a[208:211], a[16:19], v[64:79]
  v_mfma_f32_32x32x16_bf16 v[80:95], a[208:211], a[20:23], v[80:95]
  ds_read_b64_tr_b16 a[196:197], v16 offset:49408
  ds_read_b64_tr_b16 a[198:199], v16 offset:50944
  s_waitcnt lgkmcnt(8)
  v_mfma_f32_32x32x16_bf16 v[96:111], a[212:215], a[16:19], v[96:111]
  s_mov_b32 s66, 28672
  buffer_load_dwordx4 a[96:99], v2, s[56:59], s66 offen offset:0 sc1
  v_mfma_f32_32x32x16_bf16 v[112:127], a[212:215], a[20:23], v[112:127]
  ds_read_b64_tr_b16 a[200:201], v15 offset:55296
  ds_read_b64_tr_b16 a[202:203], v15 offset:56832
  s_waitcnt lgkmcnt(8)
  v_mfma_f32_32x32x16_bf16 v[128:143], a[216:219], a[16:19], v[128:143]
  buffer_load_dwordx4 a[100:103], v3, s[56:59], s66 offen offset:0 sc1
  v_mfma_f32_32x32x16_bf16 v[144:159], a[216:219], a[20:23], v[144:159]
  ds_read_b64_tr_b16 a[204:205], v16 offset:55296
  ds_read_b64_tr_b16 a[206:207], v16 offset:56832
  s_waitcnt lgkmcnt(8)
  v_mfma_f32_32x32x16_bf16 v[160:175], a[220:223], a[16:19], v[160:175]
  v_mfma_f32_32x32x16_bf16 v[176:191], a[220:223], a[20:23], v[176:191]
  ds_read_b64_tr_b16 a[208:209], v15 offset:55424
  ds_read_b64_tr_b16 a[210:211], v15 offset:56960
  s_waitcnt lgkmcnt(8)
  v_mfma_f32_32x32x16_bf16 v[192:207], a[192:195], a[16:19], v[192:207]
  v_mfma_f32_32x32x16_bf16 v[208:223], a[192:195], a[20:23], v[208:223]
  ds_read_b64_tr_b16 a[212:213], v16 offset:55424
  ds_read_b64_tr_b16 a[214:215], v16 offset:56960
  s_waitcnt lgkmcnt(8)
  v_mfma_f32_32x32x16_bf16 v[224:239], a[196:199], a[16:19], v[224:239]
  v_mfma_f32_32x32x16_bf16 v[240:255], a[196:199], a[20:23], v[240:255]
  ds_read_b64_tr_b16 a[216:217], v15 offset:55552
  ds_read_b64_tr_b16 a[218:219], v15 offset:57088
  s_waitcnt vmcnt(30)
  s_waitcnt lgkmcnt(8)
  v_mfma_f32_32x32x16_bf16 v[64:79], a[200:203], a[24:27], v[64:79]
  v_mfma_f32_32x32x16_bf16 v[80:95], a[200:203], a[28:31], v[80:95]
  ds_read_b64_tr_b16 a[220:221], v16 offset:55552
  ds_read_b64_tr_b16 a[222:223], v16 offset:57088
  s_waitcnt lgkmcnt(8)
  v_mfma_f32_32x32x16_bf16 v[96:111], a[204:207], a[24:27], v[96:111]
  s_mov_b32 s66, 28672
  buffer_load_dwordx4 a[104:107], v2, s[56:59], s66 offen offset:1024 sc1
  v_mfma_f32_32x32x16_bf16 v[112:127], a[204:207], a[28:31], v[112:127]
  s_barrier
  ds_read_b64_tr_b16 a[192:193], v17 offset:0
  ds_read_b64_tr_b16 a[194:195], v17 offset:1536
  s_waitcnt lgkmcnt(8)
  v_mfma_f32_32x32x16_bf16 v[128:143], a[208:211], a[24:27], v[128:143]
  s_mov_b32 s67, 7471104
  s_add_u32 m0, s68, 73728
  s_nop 0
  buffer_load_dwordx4 v4, s[44:47], s67 offen offset:0 lds
  buffer_load_dwordx4 a[108:111], v3, s[56:59], s66 offen offset:1024 sc1
  v_mfma_f32_32x32x16_bf16 v[144:159], a[208:211], a[28:31], v[144:159]
  ds_read_b64_tr_b16 a[196:197], v18 offset:0
  ds_read_b64_tr_b16 a[198:199], v18 offset:1536
  buffer_load_dwordx4 v5, s[44:47], s67 offen offset:1024 lds
  s_waitcnt lgkmcnt(8)
  v_mfma_f32_32x32x16_bf16 v[160:175], a[212:215], a[24:27], v[160:175]
  buffer_load_dwordx4 v6, s[44:47], s67 offen offset:2048 lds
  v_mfma_f32_32x32x16_bf16 v[176:191], a[212:215], a[28:31], v[176:191]
  ds_read_b64_tr_b16 a[200:201], v17 offset:128
  ds_read_b64_tr_b16 a[202:203], v17 offset:1664
  s_mov_b32 s67, 0
  s_add_u32 m0, s68, 86016
  s_nop 0
  buffer_load_dwordx4 v7, s[48:51], s67 offen offset:0 lds
  s_waitcnt lgkmcnt(8)
  v_mfma_f32_32x32x16_bf16 v[192:207], a[216:219], a[24:27], v[192:207]
  buffer_load_dwordx4 v8, s[48:51], s67 offen offset:1024 lds
  v_mfma_f32_32x32x16_bf16 v[208:223], a[216:219], a[28:31], v[208:223]
  ds_read_b64_tr_b16 a[204:205], v18 offset:128
  ds_read_b64_tr_b16 a[206:207], v18 offset:1664
  buffer_load_dwordx4 v9, s[48:51], s67 offen offset:2048 lds
  s_waitcnt lgkmcnt(8)
  v_mfma_f32_32x32x16_bf16 v[224:239], a[220:223], a[24:27], v[224:239]
  v_mfma_f32_32x32x16_bf16 v[240:255], a[220:223], a[28:31], v[240:255]
  ds_read_b64_tr_b16 a[208:209], v17 offset:256
  ds_read_b64_tr_b16 a[210:211], v17 offset:1792
  s_waitcnt vmcnt(36)
  s_waitcnt lgkmcnt(8)
  v_mfma_f32_32x32x16_bf16 v[64:79], a[192:195], a[32:35], v[64:79]
  v_mfma_f32_32x32x16_bf16 v[80:95], a[192:195], a[36:39], v[80:95]
  ds_read_b64_tr_b16 a[212:213], v18 offset:256
  ds_read_b64_tr_b16 a[214:215], v18 offset:1792
  s_waitcnt lgkmcnt(8)
  v_mfma_f32_32x32x16_bf16 v[96:111], a[196:199], a[32:35], v[96:111]
  s_mov_b32 s66, 28672
  buffer_load_dwordx4 a[112:115], v2, s[56:59], s66 offen offset:2048 sc1
  v_mfma_f32_32x32x16_bf16 v[112:127], a[196:199], a[36:39], v[112:127]
  ds_read_b64_tr_b16 a[216:217], v17 offset:6144
  ds_read_b64_tr_b16 a[218:219], v17 offset:7680
  s_waitcnt lgkmcnt(8)
  v_mfma_f32_32x32x16_bf16 v[128:143], a[200:203], a[32:35], v[128:143]
  buffer_load_dwordx4 a[116:119], v3, s[56:59], s66 offen offset:2048 sc1
  v_mfma_f32_32x32x16_bf16 v[144:159], a[200:203], a[36:39], v[144:159]
  ds_read_b64_tr_b16 a[220:221], v18 offset:6144
  ds_read_b64_tr_b16 a[222:223], v18 offset:7680
  s_waitcnt lgkmcnt(8)
  v_mfma_f32_32x32x16_bf16 v[160:175], a[204:207], a[32:35], v[160:175]
  v_mfma_f32_32x32x16_bf16 v[176:191], a[204:207], a[36:39], v[176:191]
  ds_read_b64_tr_b16 a[192:193], v17 offset:6272
  ds_read_b64_tr_b16 a[194:195], v17 offset:7808
  s_waitcnt lgkmcnt(8)
  v_mfma_f32_32x32x16_bf16 v[192:207], a[208:211], a[32:35], v[192:207]
  v_mfma_f32_32x32x16_bf16 v[208:223], a[208:211], a[36:39], v[208:223]
  ds_read_b64_tr_b16 a[196:197], v18 offset:6272
  ds_read_b64_tr_b16 a[198:199], v18 offset:7808
  s_waitcnt lgkmcnt(8)
  v_mfma_f32_32x32x16_bf16 v[224:239], a[212:215], a[32:35], v[224:239]
  v_mfma_f32_32x32x16_bf16 v[240:255], a[212:215], a[36:39], v[240:255]
  ds_read_b64_tr_b16 a[200:201], v17 offset:6400
  ds_read_b64_tr_b16 a[202:203], v17 offset:7936
  s_waitcnt vmcnt(35)
  s_waitcnt lgkmcnt(8)
  v_mfma_f32_32x32x16_bf16 v[64:79], a[216:219], a[40:43], v[64:79]
  v_mfma_f32_32x32x16_bf16 v[80:95], a[216:219], a[44:47], v[80:95]
  ds_read_b64_tr_b16 a[204:205], v18 offset:6400
  ds_read_b64_tr_b16 a[206:207], v18 offset:7936
  s_waitcnt lgkmcnt(8)
  v_mfma_f32_32x32x16_bf16 v[96:111], a[220:223], a[40:43], v[96:111]
  s_mov_b32 s66, 28672
  buffer_load_dwordx4 a[120:123], v2, s[56:59], s66 offen offset:3072 sc1
  v_mfma_f32_32x32x16_bf16 v[112:127], a[220:223], a[44:47], v[112:127]
  ds_read_b64_tr_b16 a[208:209], v17 offset:12288
  ds_read_b64_tr_b16 a[210:211], v17 offset:13824
  s_waitcnt lgkmcnt(8)
  v_mfma_f32_32x32x16_bf16 v[128:143], a[192:195], a[40:43], v[128:143]
  buffer_load_dwordx4 a[124:127], v3, s[56:59], s66 offen offset:3072 sc1
  v_mfma_f32_32x32x16_bf16 v[144:159], a[192:195], a[44:47], v[144:159]
  ds_read_b64_tr_b16 a[212:213], v18 offset:12288
  ds_read_b64_tr_b16 a[214:215], v18 offset:13824
  s_waitcnt lgkmcnt(8)
  v_mfma_f32_32x32x16_bf16 v[160:175], a[196:199], a[40:43], v[160:175]
  v_mfma_f32_32x32x16_bf16 v[176:191], a[196:199], a[44:47], v[176:191]
  ds_read_b64_tr_b16 a[216:217], v17 offset:12416
  ds_read_b64_tr_b16 a[218:219], v17 offset:13952
  s_waitcnt lgkmcnt(8)
  v_mfma_f32_32x32x16_bf16 v[192:207], a[200:203], a[40:43], v[192:207]
  v_mfma_f32_32x32x16_bf16 v[208:223], a[200:203], a[44:47], v[208:223]
  ds_read_b64_tr_b16 a[220:221], v18 offset:12416
  ds_read_b64_tr_b16 a[222:223], v18 offset:13952
  s_waitcnt lgkmcnt(8)
  v_mfma_f32_32x32x16_bf16 v[224:239], a[204:207], a[40:43], v[224:239]
  v_mfma_f32_32x32x16_bf16 v[240:255], a[204:207], a[44:47], v[240:255]
  ds_read_b64_tr_b16 a[192:193], v17 offset:12544
  ds_read_b64_tr_b16 a[194:195], v17 offset:14080
  s_waitcnt vmcnt(30)
  s_waitcnt lgkmcnt(8)
  v_mfma_f32_32x32x16_bf16 v[64:79], a[208:211], a[48:51], v[64:79]
  v_mfma_f32_32x32x16_bf16 v[80:95], a[208:211], a[52:55], v[80:95]
  ds_read_b64_tr_b16 a[196:197], v18 offset:12544
  ds_read_b64_tr_b16 a[198:199], v18 offset:14080
  s_waitcnt lgkmcnt(8)
  v_mfma_f32_32x32x16_bf16 v[96:111], a[212:215], a[48:51], v[96:111]
  s_mov_b32 s66, 32768
  buffer_load_dwordx4 a[0:3], v2, s[56:59], s66 offen offset:0 sc1
  v_mfma_f32_32x32x16_bf16 v[112:127], a[212:215], a[52:55], v[112:127]
  ds_read_b64_tr_b16 a[200:201], v17 offset:18432
  ds_read_b64_tr_b16 a[202:203], v17 offset:19968
  s_waitcnt lgkmcnt(8)
  v_mfma_f32_32x32x16_bf16 v[128:143], a[216:219], a[48:51], v[128:143]
  buffer_load_dwordx4 a[4:7], v3, s[56:59], s66 offen offset:0 sc1
  v_mfma_f32_32x32x16_bf16 v[144:159], a[216:219], a[52:55], v[144:159]
  ds_read_b64_tr_b16 a[204:205], v18 offset:18432
  ds_read_b64_tr_b16 a[206:207], v18 offset:19968
  s_waitcnt lgkmcnt(8)
  v_mfma_f32_32x32x16_bf16 v[160:175], a[220:223], a[48:51], v[160:175]
  v_mfma_f32_32x32x16_bf16 v[176:191], a[220:223], a[52:55], v[176:191]
  ds_read_b64_tr_b16 a[208:209], v17 offset:18560
  ds_read_b64_tr_b16 a[210:211], v17 offset:20096
  s_waitcnt lgkmcnt(8)
  v_mfma_f32_32x32x16_bf16 v[192:207], a[192:195], a[48:51], v[192:207]
  v_mfma_f32_32x32x16_bf16 v[208:223], a[192:195], a[52:55], v[208:223]
  ds_read_b64_tr_b16 a[212:213], v18 offset:18560
  ds_read_b64_tr_b16 a[214:215], v18 offset:20096
  s_waitcnt lgkmcnt(8)
  v_mfma_f32_32x32x16_bf16 v[224:239], a[196:199], a[48:51], v[224:239]
  v_mfma_f32_32x32x16_bf16 v[240:255], a[196:199], a[52:55], v[240:255]
  ds_read_b64_tr_b16 a[216:217], v17 offset:18688
  ds_read_b64_tr_b16 a[218:219], v17 offset:20224
  s_waitcnt vmcnt(30)
  s_waitcnt lgkmcnt(8)
  v_mfma_f32_32x32x16_bf16 v[64:79], a[200:203], a[56:59], v[64:79]
  v_mfma_f32_32x32x16_bf16 v[80:95], a[200:203], a[60:63], v[80:95]
  ds_read_b64_tr_b16 a[220:221], v18 offset:18688
  ds_read_b64_tr_b16 a[222:223], v18 offset:20224
  s_waitcnt lgkmcnt(8)
  v_mfma_f32_32x32x16_bf16 v[96:111], a[204:207], a[56:59], v[96:111]
  s_mov_b32 s66, 32768
  buffer_load_dwordx4 a[8:11], v2, s[56:59], s66 offen offset:1024 sc1
  v_mfma_f32_32x32x16_bf16 v[112:127], a[204:207], a[60:63], v[112:127]
  s_barrier
  ds_read_b64_tr_b16 a[192:193], v17 offset:24576
  ds_read_b64_tr_b16 a[194:195], v17 offset:26112
  s_waitcnt lgkmcnt(8)
  v_mfma_f32_32x32x16_bf16 v[128:143], a[208:211], a[56:59], v[128:143]
  s_mov_b32 s67, 12288
  s_add_u32 m0, s68, 98304
  s_nop 0
  buffer_load_dwordx4 v7, s[48:51], s67 offen offset:0 lds
  buffer_load_dwordx4 a[12:15], v3, s[56:59], s66 offen offset:1024 sc1
  v_mfma_f32_32x32x16_bf16 v[144:159], a[208:211], a[60:63], v[144:159]
  ds_read_b64_tr_b16 a[196:197], v18 offset:24576
  ds_read_b64_tr_b16 a[198:199], v18 offset:26112
  buffer_load_dwordx4 v8, s[48:51], s67 offen offset:1024 lds
  s_waitcnt lgkmcnt(8)
  v_mfma_f32_32x32x16_bf16 v[160:175], a[212:215], a[56:59], v[160:175]
  buffer_load_dwordx4 v9, s[48:51], s67 offen offset:2048 lds
  v_mfma_f32_32x32x16_bf16 v[176:191], a[212:215], a[60:63], v[176:191]
  ds_read_b64_tr_b16 a[200:201], v17 offset:24704
  ds_read_b64_tr_b16 a[202:203], v17 offset:26240
  s_mov_b32 s67, 0
  s_add_u32 m0, s68, 110592
  s_nop 0
  buffer_load_dwordx4 v10, s[52:55], s67 offen offset:0 lds
  s_waitcnt lgkmcnt(8)
  v_mfma_f32_32x32x16_bf16 v[192:207], a[216:219], a[56:59], v[192:207]
  buffer_load_dwordx4 v11, s[52:55], s67 offen offset:1024 lds
  v_mfma_f32_32x32x16_bf16 v[208:223], a[216:219], a[60:63], v[208:223]
  ds_read_b64_tr_b16 a[204:205], v18 offset:24704
  ds_read_b64_tr_b16 a[206:207], v18 offset:26240
  buffer_load_dwordx4 v12, s[52:55], s67 offen offset:2048 lds
  s_waitcnt lgkmcnt(8)
  v_mfma_f32_32x32x16_bf16 v[224:239], a[220:223], a[56:59], v[224:239]
  v_mfma_f32_32x32x16_bf16 v[240:255], a[220:223], a[60:63], v[240:255]
  ds_read_b64_tr_b16 a[208:209], v17 offset:24832
  ds_read_b64_tr_b16 a[210:211], v17 offset:26368
  s_mul_i32 s60, s32, 320
  s_sub_u32 s61, 7864320, s60
  s_add_u32 s44, s12, s60
  s_addc_u32 s45, s13, 0
  s_mov_b32 s46, s61
  s_mov_b32 s47, 0x20000
  s_add_u32 s60, s32, 0
  s_and_b32 s60, s60, 3
  s_lshl_b32 s61, s31, 2
  s_add_u32 s60, s60, s61
  s_mul_i32 s76, s60, 98304
  s_mul_i32 s80, s60, 245760
  s_add_u32 s60, s32, 1
  s_and_b32 s60, s60, 3
  s_lshl_b32 s61, s31, 2
  s_add_u32 s60, s60, s61
  s_mul_i32 s77, s60, 98304
  s_mul_i32 s81, s60, 245760
  s_add_u32 s60, s32, 2
  s_and_b32 s60, s60, 3
  s_lshl_b32 s61, s31, 2
  s_add_u32 s60, s60, s61
  s_mul_i32 s78, s60, 98304
  s_mul_i32 s82, s60, 245760
  s_add_u32 s60, s32, 3
  s_and_b32 s60, s60, 3
  s_lshl_b32 s61, s31, 2
  s_add_u32 s60, s60, s61
  s_mul_i32 s79, s60, 98304
  s_mul_i32 s83, s60, 245760
  s_mul_i32 s60, s30, 192
  v_mov_b32 v43, 2130706432
  s_waitcnt vmcnt(36)
  s_waitcnt lgkmcnt(8)
  v_mfma_f32_32x32x16_bf16 v[64:79], a[192:195], a[64:67], v[64:79]
  v_add_u32 v39, s60, v1
  v_mfma_f32_32x32x16_bf16 v[80:95], a[192:195], a[68:71], v[80:95]
  ds_read_b64_tr_b16 a[212:213], v18 offset:24832
  ds_read_b64_tr_b16 a[214:215], v18 offset:26368
  v_mul_u32_u24 v40, 3277, v39
  s_waitcnt lgkmcnt(8)
  v_mfma_f32_32x32x16_bf16 v[96:111], a[196:199], a[64:67], v[96:111]
  v_lshrrev_b32 v40, 16, v40
  s_mov_b32 s66, 32768
  buffer_load_dwordx4 a[16:19], v2, s[56:59], s66 offen offset:2048 sc1
  v_mfma_f32_32x32x16_bf16 v[112:127], a[196:199], a[68:71], v[112:127]
  ds_read_b64_tr_b16 a[216:217], v17 offset:30720
  ds_read_b64_tr_b16 a[218:219], v17 offset:32256
  v_mul_u32_u24 v41, 20, v40
  s_waitcnt lgkmcnt(8)
  v_mfma_f32_32x32x16_bf16 v[128:143], a[200:203], a[64:67], v[128:143]
  v_sub_u32 v41, v39, v41
  buffer_load_dwordx4 a[20:23], v3, s[56:59], s66 offen offset:2048 sc1
  v_mfma_f32_32x32x16_bf16 v[144:159], a[200:203], a[68:71], v[144:159]
  ds_read_b64_tr_b16 a[220:221], v18 offset:30720
  ds_read_b64_tr_b16 a[222:223], v18 offset:32256
  v_mul_u32_u24 v42, 1280, v40
  s_waitcnt lgkmcnt(8)
  v_mfma_f32_32x32x16_bf16 v[160:175], a[204:207], a[64:67], v[160:175]
  v_lshl_add_u32 v42, v41, 4, v42
  v_mfma_f32_32x32x16_bf16 v[176:191], a[204:207], a[68:71], v[176:191]
  ds_read_b64_tr_b16 a[192:193], v17 offset:30848
  ds_read_b64_tr_b16 a[194:195], v17 offset:32384
  v_subrev_u32 v42, 0, v42
  s_waitcnt lgkmcnt(8)
  v_mfma_f32_32x32x16_bf16 v[192:207], a[208:211], a[64:67], v[192:207]
  v_cmp_gt_u32 vcc, 640, v39
  s_nop 1
  v_mfma_f32_32x32x16_bf16 v[208:223], a[208:211], a[68:71], v[208:223]
  ds_read_b64_tr_b16 a[196:197], v18 offset:30848
  ds_read_b64_tr_b16 a[198:199], v18 offset:32384
  v_cndmask_b32 v4, v43, v42, vcc
  s_waitcnt lgkmcnt(8)
  v_mfma_f32_32x32x16_bf16 v[224:239], a[212:215], a[64:67], v[224:239]
  v_add_u32 v39, s60, v1
  v_mfma_f32_32x32x16_bf16 v[240:255], a[212:215], a[68:71], v[240:255]
  ds_read_b64_tr_b16 a[200:201], v17 offset:30976
  ds_read_b64_tr_b16 a[202:203], v17 offset:32512
  v_add_u32 v39, 64, v39
  s_waitcnt vmcnt(35)
  s_waitcnt lgkmcnt(8)
  v_mfma_f32_32x32x16_bf16 v[64:79], a[216:219], a[72:75], v[64:79]
  v_mul_u32_u24 v40, 3277, v39
  v_mfma_f32_32x32x16_bf16 v[80:95], a[216:219], a[76:79], v[80:95]
  ds_read_b64_tr_b16 a[204:205], v18 offset:30976
  ds_read_b64_tr_b16 a[206:207], v18 offset:32512
  v_lshrrev_b32 v40, 16, v40
  s_waitcnt lgkmcnt(8)
  v_mfma_f32_32x32x16_bf16 v[96:111], a[220:223], a[72:75], v[96:111]
  v_mul_u32_u24 v41, 20, v40
  s_mov_b32 s66, 32768
  buffer_load_dwordx4 a[24:27], v2, s[56:59], s66 offen offset:3072 sc1
  v_mfma_f32_32x32x16_bf16 v[112:127], a[220:223], a[76:79], v[112:127]
  ds_read_b64_tr_b16 a[208:209], v13 offset:0
  ds_read_b64_tr_b16 a[210:211], v13 offset:1536
  v_sub_u32 v41, v39, v41
  v_mul_u32_u24 v42, 1280, v40
  s_waitcnt lgkmcnt(8)
  v_mfma_f32_32x32x16_bf16 v[128:143], a[192:195], a[72:75], v[128:143]
  v_lshl_add_u32 v42, v41, 4, v42
  buffer_load_dwordx4 a[28:31], v3, s[56:59], s66 offen offset:3072 sc1
  v_mfma_f32_32x32x16_bf16 v[144:159], a[192:195], a[76:79], v[144:159]
  ds_read_b64_tr_b16 a[212:213], v14 offset:0
  ds_read_b64_tr_b16 a[214:215], v14 offset:1536
  v_subrev_u32 v42, 1024, v42
  s_waitcnt lgkmcnt(8)
  v_mfma_f32_32x32x16_bf16 v[160:175], a[196:199], a[72:75], v[160:175]
  v_cmp_gt_u32 vcc, 640, v39
  v_mfma_f32_32x32x16_bf16 v[176:191], a[196:199], a[76:79], v[176:191]
  ds_read_b64_tr_b16 a[216:217], v13 offset:128
  ds_read_b64_tr_b16 a[218:219], v13 offset:1664
  s_nop 1
  s_waitcnt lgkmcnt(8)
  v_mfma_f32_32x32x16_bf16 v[192:207], a[200:203], a[72:75], v[192:207]
  v_cndmask_b32 v5, v43, v42, vcc
  v_add_u32 v39, s60, v1
  v_mfma_f32_32x32x16_bf16 v[208:223], a[200:203], a[76:79], v[208:223]
  ds_read_b64_tr_b16 a[220:221], v14 offset:128
  ds_read_b64_tr_b16 a[222:223], v14 offset:1664
  v_add_u32 v39, 128, v39
  s_waitcnt lgkmcnt(8)
  v_mfma_f32_32x32x16_bf16 v[224:239], a[204:207], a[72:75], v[224:239]
  v_mul_u32_u24 v40, 3277, v39
  v_mfma_f32_32x32x16_bf16 v[240:255], a[204:207], a[76:79], v[240:255]
  ds_read_b64_tr_b16 a[192:193], v13 offset:256
  ds_read_b64_tr_b16 a[194:195], v13 offset:1792
  v_lshrrev_b32 v40, 16, v40
  s_waitcnt vmcnt(30)
  s_waitcnt lgkmcnt(8)
  v_mfma_f32_32x32x16_bf16 v[64:79], a[208:211], a[80:83], v[64:79]
  v_mul_u32_u24 v41, 20, v40
  v_mfma_f32_32x32x16_bf16 v[80:95], a[208:211], a[84:87], v[80:95]
  ds_read_b64_tr_b16 a[196:197], v14 offset:256
  ds_read_b64_tr_b16 a[198:199], v14 offset:1792
  v_sub_u32 v41, v39, v41
  s_waitcnt lgkmcnt(8)
  v_mfma_f32_32x32x16_bf16 v[96:111], a[212:215], a[80:83], v[96:111]
  v_mul_u32_u24 v42, 1280, v40
  s_mov_b32 s66, 36864
  buffer_load_dwordx4 a[32:35], v2, s[56:59], s66 offen offset:0 sc1
  v_mfma_f32_32x32x16_bf16 v[112:127], a[212:215], a[84:87], v[112:127]
  ds_read_b64_tr_b16 a[200:201], v13 offset:6144
  ds_read_b64_tr_b16 a[202:203], v13 offset:7680
  v_lshl_add_u32 v42, v41, 4, v42
  s_waitcnt lgkmcnt(8)
  v_mfma_f32_32x32x16_bf16 v[128:143], a[216:219], a[80:83], v[128:143]
  v_subrev_u32 v42, 2048, v42
  buffer_load_dwordx4 a[36:39], v3, s[56:59], s66 offen offset:0 sc1
  v_mfma_f32_32x32x16_bf16 v[144:159], a[216:219], a[84:87], v[144:159]
  ds_read_b64_tr_b16 a[204:205], v14 offset:6144
  ds_read_b64_tr_b16 a[206:207], v14 offset:7680
  v_cmp_gt_u32 vcc, 640, v39
  s_nop 1
  s_waitcnt lgkmcnt(8)
  v_mfma_f32_32x32x16_bf16 v[160:175], a[220:223], a[80:83], v[160:175]
  v_cndmask_b32 v6, v43, v42, vcc
  v_mfma_f32_32x32x16_bf16 v[176:191], a[220:223], a[84:87], v[176:191]
  ds_read_b64_tr_b16 a[208:209], v13 offset:6272
  ds_read_b64_tr_b16 a[210:211], v13 offset:7808
  s_waitcnt lgkmcnt(8)
  v_mfma_f32_32x32x16_bf16 v[192:207], a[192:195], a[80:83], v[192:207]
  v_mfma_f32_32x32x16_bf16 v[208:223], a[192:195], a[84:87], v[208:223]
  ds_read_b64_tr_b16 a[212:213], v14 offset:6272
  ds_read_b64_tr_b16 a[214:215], v14 offset:7808
  s_waitcnt lgkmcnt(8)
  v_mfma_f32_32x32x16_bf16 v[224:239], a[196:199], a[80:83], v[224:239]
  v_mfma_f32_32x32x16_bf16 v[240:255], a[196:199], a[84:87], v[240:255]
  ds_read_b64_tr_b16 a[216:217], v13 offset:6400
  ds_read_b64_tr_b16 a[218:219], v13 offset:7936
  s_waitcnt vmcnt(30)
  s_waitcnt lgkmcnt(8)
  v_mfma_f32_32x32x16_bf16 v[64:79], a[200:203], a[88:91], v[64:79]
  v_mfma_f32_32x32x16_bf16 v[80:95], a[200:203], a[92:95], v[80:95]
  ds_read_b64_tr_b16 a[220:221], v14 offset:6400
  ds_read_b64_tr_b16 a[222:223], v14 offset:7936
  s_waitcnt lgkmcnt(8)
  v_mfma_f32_32x32x16_bf16 v[96:111], a[204:207], a[88:91], v[96:111]
  s_mov_b32 s66, 36864
  buffer_load_dwordx4 a[40:43], v2, s[56:59], s66 offen offset:1024 sc1
  v_mfma_f32_32x32x16_bf16 v[112:127], a[204:207], a[92:95], v[112:127]
  s_barrier
  ds_read_b64_tr_b16 a[192:193], v13 offset:12288
  ds_read_b64_tr_b16 a[194:195], v13 offset:13824
  s_waitcnt lgkmcnt(8)
  v_mfma_f32_32x32x16_bf16 v[128:143], a[208:211], a[88:91], v[128:143]
  s_mov_b32 s67, 24576
  s_add_u32 m0, s68, 122880
  s_nop 0
  buffer_load_dwordx4 v7, s[48:51], s67 offen offset:0 lds
  buffer_load_dwordx4 a[44:47], v3, s[56:59], s66 offen offset:1024 sc1
  v_mfma_f32_32x32x16_bf16 v[144:159], a[208:211], a[92:95], v[144:159]
  ds_read_b64_tr_b16 a[196:197], v14 offset:12288
  ds_read_b64_tr_b16 a[198:199], v14 offset:13824
  buffer_load_dwordx4 v8, s[48:51], s67 offen offset:1024 lds
  s_waitcnt lgkmcnt(8)
  v_mfma_f32_32x32x16_bf16 v[160:175], a[212:215], a[88:91], v[160:175]
  buffer_load_dwordx4 v9, s[48:51], s67 offen offset:2048 lds
  v_mfma_f32_32x32x16_bf16 v[176:191], a[212:215], a[92:95], v[176:191]
  ds_read_b64_tr_b16 a[200:201], v13 offset:12416
  ds_read_b64_tr_b16 a[202:203], v13 offset:13952
  s_mov_b32 s67, 12288
  s_add_u32 m0, s68, 135168
  s_nop 0
  buffer_load_dwordx4 v10, s[52:55], s67 offen offset:0 lds
  s_waitcnt lgkmcnt(8)
  v_mfma_f32_32x32x16_bf16 v[192:207], a[216:219], a[88:91], v[192:207]
  buffer_load_dwordx4 v11, s[52:55], s67 offen offset:1024 lds
  v_mfma_f32_32x32x16_bf16 v[208:223], a[216:219], a[92:95], v[208:223]
  ds_read_b64_tr_b16 a[204:205], v14 offset:12416
  ds_read_b64_tr_b16 a[206:207], v14 offset:13952
  buffer_load_dwordx4 v12, s[52:55], s67 offen offset:2048 lds
  s_waitcnt lgkmcnt(8)
  v_mfma_f32_32x32x16_bf16 v[224:239], a[220:223], a[88:91], v[224:239]
  v_mfma_f32_32x32x16_bf16 v[240:255], a[220:223], a[92:95], v[240:255]
  ds_read_b64_tr_b16 a[208:209], v13 offset:12544
  ds_read_b64_tr_b16 a[210:211], v13 offset:14080
  s_waitcnt vmcnt(36)
  s_waitcnt lgkmcnt(8)
  v_mfma_f32_32x32x16_bf16 v[64:79], a[192:195], a[96:99], v[64:79]
  v_mfma_f32_32x32x16_bf16 v[80:95], a[192:195], a[100:103], v[80:95]
  ds_read_b64_tr_b16 a[212:213], v14 offset:12544
  ds_read_b64_tr_b16 a[214:215], v14 offset:14080
  s_waitcnt lgkmcnt(8)
  v_mfma_f32_32x32x16_bf16 v[96:111], a[196:199], a[96:99], v[96:111]
  s_mov_b32 s66, 36864
  buffer_load_dwordx4 a[48:51], v2, s[56:59], s66 offen offset:2048 sc1
  v_mfma_f32_32x32x16_bf16 v[112:127], a[196:199], a[100:103], v[112:127]
  ds_read_b64_tr_b16 a[216:217], v13 offset:18432
  ds_read_b64_tr_b16 a[218:219], v13 offset:19968
  s_waitcnt lgkmcnt(8)
  v_mfma_f32_32x32x16_bf16 v[128:143], a[200:203], a[96:99], v[128:143]
  buffer_load_dwordx4 a[52:55], v3, s[56:59], s66 offen offset:2048 sc1
  v_mfma_f32_32x32x16_bf16 v[144:159], a[200:203], a[100:103], v[144:159]
  ds_read_b64_tr_b16 a[220:221], v14 offset:18432
  ds_read_b64_tr_b16 a[222:223], v14 offset:19968
  s_waitcnt lgkmcnt(8)
  v_mfma_f32_32x32x16_bf16 v[160:175], a[204:207], a[96:99], v[160:175]
  v_mfma_f32_32x32x16_bf16 v[176:191], a[204:207], a[100:103], v[176:191]
  ds_read_b64_tr_b16 a[192:193], v13 offset:18560
  ds_read_b64_tr_b16 a[194:195], v13 offset:20096
  s_waitcnt lgkmcnt(8)
  v_mfma_f32_32x32x16_bf16 v[192:207], a[208:211], a[96:99], v[192:207]
  v_mfma_f32_32x32x16_bf16 v[208:223], a[208:211], a[100:103], v[208:223]
  ds_read_b64_tr_b16 a[196:197], v14 offset:18560
  ds_read_b64_tr_b16 a[198:199], v14 offset:20096
  s_waitcnt lgkmcnt(8)
  v_mfma_f32_32x32x16_bf16 v[224:239], a[212:215], a[96:99], v[224:239]
  v_mfma_f32_32x32x16_bf16 v[240:255], a[212:215], a[100:103], v[240:255]
  ds_read_b64_tr_b16 a[200:201], v13 offset:18688
  ds_read_b64_tr_b16 a[202:203], v13 offset:20224
  s_waitcnt vmcnt(35)
  s_waitcnt lgkmcnt(8)
  v_mfma_f32_32x32x16_bf16 v[64:79], a[216:219], a[104:107], v[64:79]
  v_mfma_f32_32x32x16_bf16 v[80:95], a[216:219], a[108:111], v[80:95]
  ds_read_b64_tr_b16 a[204:205], v14 offset:18688
  ds_read_b64_tr_b16 a[206:207], v14 offset:20224
  s_waitcnt lgkmcnt(8)
  v_mfma_f32_32x32x16_bf16 v[96:111], a[220:223], a[104:107], v[96:111]
  s_mov_b32 s66, 36864
  buffer_load_dwordx4 a[56:59], v2, s[56:59], s66 offen offset:3072 sc1
  v_mfma_f32_32x32x16_bf16 v[112:127], a[220:223], a[108:111], v[112:127]
  ds_read_b64_tr_b16 a[208:209], v13 offset:24576
  ds_read_b64_tr_b16 a[210:211], v13 offset:26112
  s_waitcnt lgkmcnt(8)
  v_mfma_f32_32x32x16_bf16 v[128:143], a[192:195], a[104:107], v[128:143]
  buffer_load_dwordx4 a[60:63], v3, s[56:59], s66 offen offset:3072 sc1
  v_mfma_f32_32x32x16_bf16 v[144:159], a[192:195], a[108:111], v[144:159]
  ds_read_b64_tr_b16 a[212:213], v14 offset:24576
  ds_read_b64_tr_b16 a[214:215], v14 offset:26112
  s_waitcnt lgkmcnt(8)
  v_mfma_f32_32x32x16_bf16 v[160:175], a[196:199], a[104:107], v[160:175]
  v_mfma_f32_32x32x16_bf16 v[176:191], a[196:199], a[108:111], v[176:191]
  ds_read_b64_tr_b16 a[216:217], v13 offset:24704
  ds_read_b64_tr_b16 a[218:219], v13 offset:26240
  s_waitcnt lgkmcnt(8)
  v_mfma_f32_32x32x16_bf16 v[192:207], a[200:203], a[104:107], v[192:207]
  v_mfma_f32_32x32x16_bf16 v[208:223], a[200:203], a[108:111], v[208:223]
  ds_read_b64_tr_b16 a[220:221], v14 offset:24704
  ds_read_b64_tr_b16 a[222:223], v14 offset:26240
  s_waitcnt lgkmcnt(8)
  v_mfma_f32_32x32x16_bf16 v[224:239], a[204:207], a[104:107], v[224:239]
  v_mfma_f32_32x32x16_bf16 v[240:255], a[204:207], a[108:111], v[240:255]
  ds_read_b64_tr_b16 a[192:193], v13 offset:24832
  ds_read_b64_tr_b16 a[194:195], v13 offset:26368
  s_waitcnt vmcnt(30)
  s_waitcnt lgkmcnt(8)
  v_mfma_f32_32x32x16_bf16 v[64:79], a[208:211], a[112:115], v[64:79]
  v_mfma_f32_32x32x16_bf16 v[80:95], a[208:211], a[116:119], v[80:95]
  ds_read_b64_tr_b16 a[196:197], v14 offset:24832
  ds_read_b64_tr_b16 a[198:199], v14 offset:26368
  s_waitcnt lgkmcnt(8)
  v_mfma_f32_32x32x16_bf16 v[96:111], a[212:215], a[112:115], v[96:111]
  v_mfma_f32_32x32x16_bf16 v[112:127], a[212:215], a[116:119], v[112:127]
  ds_read_b64_tr_b16 a[200:201], v13 offset:30720
  ds_read_b64_tr_b16 a[202:203], v13 offset:32256
  v_lshlrev_b32 v43, 2, v1
  s_mov_b32 s74, 256
  buffer_load_dword v39, v43, s[92:95], s74 offen offset:0 sc1
  buffer_load_dword v40, v43, s[92:95], s74 offen offset:256 sc1
  buffer_load_dword v41, v43, s[92:95], s74 offen offset:512 sc1
  buffer_load_dword v42, v43, s[92:95], s74 offen offset:768 sc1
  s_waitcnt lgkmcnt(8)
  v_mfma_f32_32x32x16_bf16 v[128:143], a[216:219], a[112:115], v[128:143]
  v_mfma_f32_32x32x16_bf16 v[144:159], a[216:219], a[116:119], v[144:159]
  ds_read_b64_tr_b16 a[204:205], v14 offset:30720
  ds_read_b64_tr_b16 a[206:207], v14 offset:32256
  s_waitcnt lgkmcnt(8)
  v_mfma_f32_32x32x16_bf16 v[160:175], a[220:223], a[112:115], v[160:175]
  v_mfma_f32_32x32x16_bf16 v[176:191], a[220:223], a[116:119], v[176:191]
  ds_read_b64_tr_b16 a[208:209], v13 offset:30848
  ds_read_b64_tr_b16 a[210:211], v13 offset:32384
  s_waitcnt lgkmcnt(8)
  v_mfma_f32_32x32x16_bf16 v[192:207], a[192:195], a[112:115], v[192:207]
  v_mfma_f32_32x32x16_bf16 v[208:223], a[192:195], a[116:119], v[208:223]
  ds_read_b64_tr_b16 a[212:213], v14 offset:30848
  ds_read_b64_tr_b16 a[214:215], v14 offset:32384
  s_waitcnt lgkmcnt(8)
  v_mfma_f32_32x32x16_bf16 v[224:239], a[196:199], a[112:115], v[224:239]
  v_mfma_f32_32x32x16_bf16 v[240:255], a[196:199], a[116:119], v[240:255]
  ds_read_b64_tr_b16 a[216:217], v13 offset:30976
  ds_read_b64_tr_b16 a[218:219], v13 offset:32512
  s_waitcnt vmcnt(32)
  s_waitcnt lgkmcnt(8)
  v_mfma_f32_32x32x16_bf16 v[64:79], a[200:203], a[120:123], v[64:79]
  v_mfma_f32_32x32x16_bf16 v[80:95], a[200:203], a[124:127], v[80:95]
  ds_read_b64_tr_b16 a[220:221], v14 offset:30976
  ds_read_b64_tr_b16 a[222:223], v14 offset:32512
  s_waitcnt lgkmcnt(8)
  v_mfma_f32_32x32x16_bf16 v[96:111], a[204:207], a[120:123], v[96:111]
  v_mfma_f32_32x32x16_bf16 v[112:127], a[204:207], a[124:127], v[112:127]
  s_barrier
  ds_read_b64_tr_b16 a[192:193], v13 offset:36864
  ds_read_b64_tr_b16 a[194:195], v13 offset:38400
  s_waitcnt lgkmcnt(8)
  v_mfma_f32_32x32x16_bf16 v[128:143], a[208:211], a[120:123], v[128:143]
  s_mov_b32 s67, 36864
  s_add_u32 m0, s68, 147456
  s_nop 0
  buffer_load_dwordx4 v7, s[48:51], s67 offen offset:0 lds
  v_mfma_f32_32x32x16_bf16 v[144:159], a[208:211], a[124:127], v[144:159]
  ds_read_b64_tr_b16 a[196:197], v14 offset:36864
  ds_read_b64_tr_b16 a[198:199], v14 offset:38400
  buffer_load_dwordx4 v8, s[48:51], s67 offen offset:1024 lds
  s_waitcnt lgkmcnt(8)
  v_mfma_f32_32x32x16_bf16 v[160:175], a[212:215], a[120:123], v[160:175]
  buffer_load_dwordx4 v9, s[48:51], s67 offen offset:2048 lds
  v_mfma_f32_32x32x16_bf16 v[176:191], a[212:215], a[124:127], v[176:191]
  ds_read_b64_tr_b16 a[200:201], v13 offset:36992
  ds_read_b64_tr_b16 a[202:203], v13 offset:38528
  s_mov_b32 s67, 24576
  s_add_u32 m0, s68, 0
  s_nop 0
  buffer_load_dwordx4 v10, s[52:55], s67 offen offset:0 lds
  s_waitcnt lgkmcnt(8)
  v_mfma_f32_32x32x16_bf16 v[192:207], a[216:219], a[120:123], v[192:207]
  buffer_load_dwordx4 v11, s[52:55], s67 offen offset:1024 lds
  v_mfma_f32_32x32x16_bf16 v[208:223], a[216:219], a[124:127], v[208:223]
  ds_read_b64_tr_b16 a[204:205], v14 offset:36992
  ds_read_b64_tr_b16 a[206:207], v14 offset:38528
  buffer_load_dwordx4 v12, s[52:55], s67 offen offset:2048 lds
  s_waitcnt lgkmcnt(8)
  v_mfma_f32_32x32x16_bf16 v[224:239], a[220:223], a[120:123], v[224:239]
  v_mfma_f32_32x32x16_bf16 v[240:255], a[220:223], a[124:127], v[240:255]
  ds_read_b64_tr_b16 a[208:209], v13 offset:37120
  ds_read_b64_tr_b16 a[210:211], v13 offset:38656
  s_waitcnt vmcnt(36)
  s_waitcnt lgkmcnt(8)
  v_mfma_f32_32x32x16_bf16 v[64:79], a[192:195], a[0:3], v[64:79]
  v_mfma_f32_32x32x16_bf16 v[80:95], a[192:195], a[4:7], v[80:95]
  ds_read_b64_tr_b16 a[212:213], v14 offset:37120
  ds_read_b64_tr_b16 a[214:215], v14 offset:38656
  s_waitcnt lgkmcnt(8)
  v_mfma_f32_32x32x16_bf16 v[96:111], a[196:199], a[0:3], v[96:111]
  v_mfma_f32_32x32x16_bf16 v[112:127], a[196:199], a[4:7], v[112:127]
  ds_read_b64_tr_b16 a[216:217], v13 offset:43008
  ds_read_b64_tr_b16 a[218:219], v13 offset:44544
  s_waitcnt lgkmcnt(8)
  v_mfma_f32_32x32x16_bf16 v[128:143], a[200:203], a[0:3], v[128:143]
  v_mfma_f32_32x32x16_bf16 v[144:159], a[200:203], a[4:7], v[144:159]
  ds_read_b64_tr_b16 a[220:221], v14 offset:43008
  ds_read_b64_tr_b16 a[222:223], v14 offset:44544
  s_waitcnt lgkmcnt(8)
  v_mfma_f32_32x32x16_bf16 v[160:175], a[204:207], a[0:3], v[160:175]
  v_mfma_f32_32x32x16_bf16 v[176:191], a[204:207], a[4:7], v[176:191]
  ds_read_b64_tr_b16 a[192:193], v13 offset:43136
  ds_read_b64_tr_b16 a[194:195], v13 offset:44672
  s_waitcnt lgkmcnt(8)
  v_mfma_f32_32x32x16_bf16 v[192:207], a[208:211], a[0:3], v[192:207]
  v_mfma_f32_32x32x16_bf16 v[208:223], a[208:211], a[4:7], v[208:223]
  ds_read_b64_tr_b16 a[196:197], v14 offset:43136
  ds_read_b64_tr_b16 a[198:199], v14 offset:44672
  s_waitcnt lgkmcnt(8)
  v_mfma_f32_32x32x16_bf16 v[224:239], a[212:215], a[0:3], v[224:239]
  v_mfma_f32_32x32x16_bf16 v[240:255], a[212:215], a[4:7], v[240:255]
  ds_read_b64_tr_b16 a[200:201], v13 offset:43264
  ds_read_b64_tr_b16 a[202:203], v13 offset:44800
  s_waitcnt vmcnt(33)
  s_waitcnt lgkmcnt(8)
  v_mfma_f32_32x32x16_bf16 v[64:79], a[216:219], a[8:11], v[64:79]
  v_mfma_f32_32x32x16_bf16 v[80:95], a[216:219], a[12:15], v[80:95]
  ds_read_b64_tr_b16 a[204:205], v14 offset:43264
  ds_read_b64_tr_b16 a[206:207], v14 offset:44800
  s_waitcnt lgkmcnt(8)
  v_mfma_f32_32x32x16_bf16 v[96:111], a[220:223], a[8:11], v[96:111]
  v_mfma_f32_32x32x16_bf16 v[112:127], a[220:223], a[12:15], v[112:127]
  ds_read_b64_tr_b16 a[208:209], v13 offset:49152
  ds_read_b64_tr_b16 a[210:211], v13 offset:50688
  s_waitcnt lgkmcnt(8)
  v_mfma_f32_32x32x16_bf16 v[128:143], a[192:195], a[8:11], v[128:143]
  v_mfma_f32_32x32x16_bf16 v[144:159], a[192:195], a[12:15], v[144:159]
  ds_read_b64_tr_b16 a[212:213], v14 offset:49152
  ds_read_b64_tr_b16 a[214:215], v14 offset:50688
  s_waitcnt lgkmcnt(8)
  v_mfma_f32_32x32x16_bf16 v[160:175], a[196:199], a[8:11], v[160:175]
  v_mfma_f32_32x32x16_bf16 v[176:191], a[196:199], a[12:15], v[176:191]
  ds_read_b64_tr_b16 a[216:217], v13 offset:49280
  ds_read_b64_tr_b16 a[218:219], v13 offset:50816
  s_waitcnt lgkmcnt(8)
  v_mfma_f32_32x32x16_bf16 v[192:207], a[200:203], a[8:11], v[192:207]
  v_mfma_f32_32x32x16_bf16 v[208:223], a[200:203], a[12:15], v[208:223]
  ds_read_b64_tr_b16 a[220:221], v14 offset:49280
  ds_read_b64_tr_b16 a[222:223], v14 offset:50816
  s_waitcnt lgkmcnt(8)
  v_mfma_f32_32x32x16_bf16 v[224:239], a[204:207], a[8:11], v[224:239]
  v_mfma_f32_32x32x16_bf16 v[240:255], a[204:207], a[12:15], v[240:255]
  ds_read_b64_tr_b16 a[192:193], v13 offset:49408
  ds_read_b64_tr_b16 a[194:195], v13 offset:50944
  s_waitcnt vmcnt(26)
  s_waitcnt lgkmcnt(8)
  v_mfma_f32_32x32x16_bf16 v[64:79], a[208:211], a[16:19], v[64:79]
  v_mfma_f32_32x32x16_bf16 v[80:95], a[208:211], a[20:23], v[80:95]
  ds_read_b64_tr_b16 a[196:197], v14 offset:49408
  ds_read_b64_tr_b16 a[198:199], v14 offset:50944
  s_waitcnt lgkmcnt(8)
  v_mfma_f32_32x32x16_bf16 v[96:111], a[212:215], a[16:19], v[96:111]
  v_mfma_f32_32x32x16_bf16 v[112:127], a[212:215], a[20:23], v[112:127]
  ds_read_b64_tr_b16 a[200:201], v13 offset:55296
  ds_read_b64_tr_b16 a[202:203], v13 offset:56832
  s_waitcnt lgkmcnt(8)
  v_mfma_f32_32x32x16_bf16 v[128:143], a[216:219], a[16:19], v[128:143]
  v_mfma_f32_32x32x16_bf16 v[144:159], a[216:219], a[20:23], v[144:159]
  ds_read_b64_tr_b16 a[204:205], v14 offset:55296
  ds_read_b64_tr_b16 a[206:207], v14 offset:56832
  s_waitcnt lgkmcnt(8)
  v_mfma_f32_32x32x16_bf16 v[160:175], a[220:223], a[16:19], v[160:175]
  v_mfma_f32_32x32x16_bf16 v[176:191], a[220:223], a[20:23], v[176:191]
  ds_read_b64_tr_b16 a[208:209], v13 offset:55424
  ds_read_b64_tr_b16 a[210:211], v13 offset:56960
  s_waitcnt vmcnt(6)
  v_cmp_ne_u32 vcc, s14, v39
  v_cmp_ne_u32 s[64:65], s14, v40
  s_nop 0
  s_or_b64 vcc, vcc, s[64:65]
  v_cmp_ne_u32 s[64:65], s14, v41
  s_nop 0
  s_or_b64 vcc, vcc, s[64:65]
  v_cmp_ne_u32 s[64:65], s14, v42
  s_nop 0
  s_or_b64 vcc, vcc, s[64:65]
  s_cbranch_vccz L_done2
  s_mov_b32 s15, 400000
L_spin2:
  buffer_load_dword v39, v43, s[92:95], s74 offen offset:0 sc1
  buffer_load_dword v40, v43, s[92:95], s74 offen offset:256 sc1
  buffer_load_dword v41, v43, s[92:95], s74 offen offset:512 sc1
  buffer_load_dword v42, v43, s[92:95], s74 offen offset:768 sc1
  s_waitcnt vmcnt(0)
  v_cmp_ne_u32 vcc, s14, v39
  v_cmp_ne_u32 s[64:65], s14, v40
  s_nop 0
  s_or_b64 vcc, vcc, s[64:65]
  v_cmp_ne_u32 s[64:65], s14, v41
  s_nop 0
  s_or_b64 vcc, vcc, s[64:65]
  v_cmp_ne_u32 s[64:65], s14, v42
  s_nop 0
  s_or_b64 vcc, vcc, s[64:65]
  s_cbranch_vccz L_done2
  s_sub_u32 s15, s15, 1
  s_cbranch_scc0 L_spin2
L_done2:
  s_lshl_b32 s60, s2, 2
  s_or_b32 s60, s60, s30
  s_cmp_lg_u32 s60, 0
  s_cbranch_scc1 L_nn2
  s_mov_b32 s74, 0
  v_cmp_eq_u32 vcc, 0, v1
  v_mov_b32 v39, 2130706432
  v_mov_b32 v40, s14
  v_cndmask_b32 v39, v39, v1, vcc
  buffer_store_dword v40, v39, s[92:95], s74 offen sc1
L_nn2:
  s_waitcnt lgkmcnt(8)
  v_mfma_f32_32x32x16_bf16 v[192:207], a[192:195], a[16:19], v[192:207]
  v_mfma_f32_32x32x16_bf16 v[208:223], a[192:195], a[20:23], v[208:223]
  ds_read_b64_tr_b16 a[212:213], v14 offset:55424
  ds_read_b64_tr_b16 a[214:215], v14 offset:56960
  s_waitcnt lgkmcnt(8)
  v_mfma_f32_32x32x16_bf16 v[224:239], a[196:199], a[16:19], v[224:239]
  v_mfma_f32_32x32x16_bf16 v[240:255], a[196:199], a[20:23], v[240:255]
  ds_read_b64_tr_b16 a[216:217], v13 offset:55552
  ds_read_b64_tr_b16 a[218:219], v13 offset:57088
  s_waitcnt lgkmcnt(8)
  v_mfma_f32_32x32x16_bf16 v[64:79], a[200:203], a[24:27], v[64:79]
  v_mfma_f32_32x32x16_bf16 v[80:95], a[200:203], a[28:31], v[80:95]
  ds_read_b64_tr_b16 a[220:221], v14 offset:55552
  ds_read_b64_tr_b16 a[222:223], v14 offset:57088
  s_waitcnt lgkmcnt(8)
  v_mfma_f32_32x32x16_bf16 v[96:111], a[204:207], a[24:27], v[96:111]
  v_mfma_f32_32x32x16_bf16 v[112:127], a[204:207], a[28:31], v[112:127]
  s_barrier
  ds_read_b64_tr_b16 a[192:193], v15 offset:0
  ds_read_b64_tr_b16 a[194:195], v15 offset:1536
  s_waitcnt lgkmcnt(8)
  v_mfma_f32_32x32x16_bf16 v[128:143], a[208:211], a[24:27], v[128:143]
  s_mov_b32 s67, 49152
  s_add_u32 m0, s68, 12288
  s_nop 0
  buffer_load_dwordx4 v7, s[48:51], s67 offen offset:0 lds
  v_mfma_f32_32x32x16_bf16 v[144:159], a[208:211], a[28:31], v[144:159]
  ds_read_b64_tr_b16 a[196:197], v15 offset:6144
  ds_read_b64_tr_b16 a[198:199], v15 offset:7680
  buffer_load_dwordx4 v8, s[48:51], s67 offen offset:1024 lds
  s_waitcnt lgkmcnt(8)
  v_mfma_f32_32x32x16_bf16 v[160:175], a[212:215], a[24:27], v[160:175]
  buffer_load_dwordx4 v9, s[48:51], s67 offen offset:2048 lds
  v_mfma_f32_32x32x16_bf16 v[176:191], a[212:215], a[28:31], v[176:191]
  ds_read_b64_tr_b16 a[200:201], v15 offset:12288
  ds_read_b64_tr_b16 a[202:203], v15 offset:13824
  s_mov_b32 s67, 36864
  s_add_u32 m0, s68, 24576
  s_nop 0
  buffer_load_dwordx4 v10, s[52:55], s67 offen offset:0 lds
  s_waitcnt lgkmcnt(8)
  v_mfma_f32_32x32x16_bf16 v[192:207], a[216:219], a[24:27], v[192:207]
  buffer_load_dwordx4 v11, s[52:55], s67 offen offset:1024 lds
  v_mfma_f32_32x32x16_bf16 v[208:223], a[216:219], a[28:31], v[208:223]
  ds_read_b64_tr_b16 a[204:205], v15 offset:18432
  ds_read_b64_tr_b16 a[206:207], v15 offset:19968
  buffer_load_dwordx4 v12, s[52:55], s67 offen offset:2048 lds
  s_waitcnt lgkmcnt(8)
  s_getpc_b64 s[96:97]
  s_add_u32 s96, s96, 1024
  s_addc_u32 s97, s97, 0
  v_lshlrev_b32 v46, 6, v0
  v_mov_b32 v47, 0
  v_lshl_add_u64 v[46:47], v[46:47], 0, s[96:97]
  global_load_dword a225, v[46:47], off
  v_mfma_f32_32x32x16_bf16 v[224:239], a[220:223], a[24:27], v[224:239]
  v_mfma_f32_32x32x16_bf16 v[240:255], a[220:223], a[28:31], v[240:255]
  ds_read_b64_tr_b16 a[208:209], v16 offset:0
  ds_read_b64_tr_b16 a[210:211], v16 offset:1536
  s_waitcnt lgkmcnt(8)
  v_mfma_f32_32x32x16_bf16 v[64:79], a[192:195], a[32:35], v[64:79]
  v_mfma_f32_32x32x16_bf16 v[80:95], a[192:195], a[36:39], v[80:95]
  ds_read_b64_tr_b16 a[212:213], v16 offset:6144
  ds_read_b64_tr_b16 a[214:215], v16 offset:7680
  s_waitcnt lgkmcnt(8)
  v_mfma_f32_32x32x16_bf16 v[64:79], a[196:199], a[40:43], v[64:79]
  v_mfma_f32_32x32x16_bf16 v[80:95], a[196:199], a[44:47], v[80:95]
  ds_read_b64_tr_b16 a[216:217], v16 offset:12288
  ds_read_b64_tr_b16 a[218:219], v16 offset:13824
  s_waitcnt lgkmcnt(8)
  v_mfma_f32_32x32x16_bf16 v[64:79], a[200:203], a[48:51], v[64:79]
  v_mfma_f32_32x32x16_bf16 v[80:95], a[200:203], a[52:55], v[80:95]
  ds_read_b64_tr_b16 a[220:221], v16 offset:18432
  ds_read_b64_tr_b16 a[222:223], v16 offset:19968
  s_waitcnt lgkmcnt(8)
  v_mfma_f32_32x32x16_bf16 v[64:79], a[204:207], a[56:59], v[64:79]
  v_mfma_f32_32x32x16_bf16 v[80:95], a[204:207], a[60:63], v[80:95]
  ds_read_b64_tr_b16 a[192:193], v15 offset:128
  ds_read_b64_tr_b16 a[194:195], v15 offset:1664
  s_waitcnt lgkmcnt(8)
  v_mfma_f32_32x32x16_bf16 v[96:111], a[208:211], a[32:35], v[96:111]
  v_mfma_f32_32x32x16_bf16 v[112:127], a[208:211], a[36:39], v[112:127]
  ds_read_b64_tr_b16 a[196:197], v15 offset:6272
  ds_read_b64_tr_b16 a[198:199], v15 offset:7808
  s_waitcnt lgkmcnt(8)
  v_mfma_f32_32x32x16_bf16 v[96:111], a[212:215], a[40:43], v[96:111]
  v_mfma_f32_32x32x16_bf16 v[112:127], a[212:215], a[44:47], v[112:127]
  ds_read_b64_tr_b16 a[200:201], v15 offset:12416
  ds_read_b64_tr_b16 a[202:203], v15 offset:13952
  v_pk_mul_f32 v[64:65], v[64:65], v[44:45]
  v_pk_mul_f32 v[66:67], v[66:67], v[44:45]
  v_pk_mul_f32 v[68:69], v[68:69], v[44:45]
  v_pk_mul_f32 v[70:71], v[70:71], v[44:45]
  s_waitcnt lgkmcnt(8)
  v_mfma_f32_32x32x16_bf16 v[96:111], a[216:219], a[48:51], v[96:111]
  v_pk_mul_f32 v[72:73], v[72:73], v[44:45]
  v_pk_mul_f32 v[74:75], v[74:75], v[44:45]
  v_pk_mul_f32 v[76:77], v[76:77], v[44:45]
  v_pk_mul_f32 v[78:79], v[78:79], v[44:45]
  v_mfma_f32_32x32x16_bf16 v[112:127], a[216:219], a[52:55], v[112:127]
  ds_read_b64_tr_b16 a[204:205], v15 offset:18560
  ds_read_b64_tr_b16 a[206:207], v15 offset:20096
  v_cvt_pk_bf16_f32 v64, v64, v65
  v_cvt_pk_bf16_f32 v65, v66, v67
  v_cvt_pk_bf16_f32 v66, v68, v69
  v_cvt_pk_bf16_f32 v67, v70, v71
  s_waitcnt lgkmcnt(8)
  v_mfma_f32_32x32x16_bf16 v[96:111], a[220:223], a[56:59], v[96:111]
  v_cvt_pk_bf16_f32 v68, v72, v73
  v_cvt_pk_bf16_f32 v69, v74, v75
  v_cvt_pk_bf16_f32 v70, v76, v77
  v_cvt_pk_bf16_f32 v71, v78, v79
  v_mfma_f32_32x32x16_bf16 v[112:127], a[220:223], a[60:63], v[112:127]
  ds_read_b64_tr_b16 a[208:209], v16 offset:128
  ds_read_b64_tr_b16 a[210:211], v16 offset:1664
  v_pk_mul_f32 v[80:81], v[80:81], v[44:45]
  v_pk_mul_f32 v[82:83], v[82:83], v[44:45]
  v_pk_mul_f32 v[84:85], v[84:85], v[44:45]
  v_pk_mul_f32 v[86:87], v[86:87], v[44:45]
  s_waitcnt lgkmcnt(8)
  v_mfma_f32_32x32x16_bf16 v[128:143], a[192:195], a[32:35], v[128:143]
  v_pk_mul_f32 v[88:89], v[88:89], v[44:45]
  v_pk_mul_f32 v[90:91], v[90:91], v[44:45]
  v_pk_mul_f32 v[92:93], v[92:93], v[44:45]
  v_pk_mul_f32 v[94:95], v[94:95], v[44:45]
  v_mfma_f32_32x32x16_bf16 v[144:159], a[192:195], a[36:39], v[144:159]
  ds_read_b64_tr_b16 a[212:213], v16 offset:6272
  ds_read_b64_tr_b16 a[214:215], v16 offset:7808
  v_cvt_pk_bf16_f32 v72, v80, v81
  v_cvt_pk_bf16_f32 v73, v82, v83
  v_cvt_pk_bf16_f32 v74, v84, v85
  v_cvt_pk_bf16_f32 v75, v86, v87
  s_waitcnt lgkmcnt(8)
  v_mfma_f32_32x32x16_bf16 v[128:143], a[196:199], a[40:43], v[128:143]
  v_cvt_pk_bf16_f32 v76, v88, v89
  v_cvt_pk_bf16_f32 v77, v90, v91
  v_cvt_pk_bf16_f32 v78, v92, v93
  v_cvt_pk_bf16_f32 v79, v94, v95
  v_mfma_f32_32x32x16_bf16 v[144:159], a[196:199], a[44:47], v[144:159]
  ds_read_b64_tr_b16 a[216:217], v16 offset:12416
  ds_read_b64_tr_b16 a[218:219], v16 offset:13952
  v_pk_mul_f32 v[96:97], v[96:97], v[44:45]
  v_pk_mul_f32 v[98:99], v[98:99], v[44:45]
  v_pk_mul_f32 v[100:101], v[100:101], v[44:45]
  v_pk_mul_f32 v[102:103], v[102:103], v[44:45]
  s_waitcnt lgkmcnt(8)
  v_mfma_f32_32x32x16_bf16 v[128:143], a[200:203], a[48:51], v[128:143]
  v_pk_mul_f32 v[104:105], v[104:105], v[44:45]
  v_pk_mul_f32 v[106:107], v[106:107], v[44:45]
  v_pk_mul_f32 v[108:109], v[108:109], v[44:45]
  v_pk_mul_f32 v[110:111], v[110:111], v[44:45]
  v_mfma_f32_32x32x16_bf16 v[144:159], a[200:203], a[52:55], v[144:159]
  ds_read_b64_tr_b16 a[220:221], v16 offset:18560
  ds_read_b64_tr_b16 a[222:223], v16 offset:20096
  v_cvt_pk_bf16_f32 v80, v96, v97
  v_cvt_pk_bf16_f32 v81, v98, v99
  v_cvt_pk_bf16_f32 v82, v100, v101
  v_cvt_pk_bf16_f32 v83, v102, v103
  s_waitcnt lgkmcnt(8)
  v_mfma_f32_32x32x16_bf16 v[128:143], a[204:207], a[56:59], v[128:143]
  v_cvt_pk_bf16_f32 v84, v104, v105
  v_cvt_pk_bf16_f32 v85, v106, v107
  v_cvt_pk_bf16_f32 v86, v108, v109
  v_cvt_pk_bf16_f32 v87, v110, v111
  v_mfma_f32_32x32x16_bf16 v[144:159], a[204:207], a[60:63], v[144:159]
  ds_read_b64_tr_b16 a[192:193], v15 offset:256
  ds_read_b64_tr_b16 a[194:195], v15 offset:1792
  v_pk_mul_f32 v[112:113], v[112:113], v[44:45]
  v_pk_mul_f32 v[114:115], v[114:115], v[44:45]
  v_pk_mul_f32 v[116:117], v[116:117], v[44:45]
  v_pk_mul_f32 v[118:119], v[118:119], v[44:45]
  s_waitcnt lgkmcnt(8)
  v_mfma_f32_32x32x16_bf16 v[160:175], a[208:211], a[32:35], v[160:175]
  v_pk_mul_f32 v[120:121], v[120:121], v[44:45]
  v_pk_mul_f32 v[122:123], v[122:123], v[44:45]
  v_pk_mul_f32 v[124:125], v[124:125], v[44:45]
  v_pk_mul_f32 v[126:127], v[126:127], v[44:45]
  v_mfma_f32_32x32x16_bf16 v[176:191], a[208:211], a[36:39], v[176:191]
  ds_read_b64_tr_b16 a[196:197], v15 offset:6400
  ds_read_b64_tr_b16 a[198:199], v15 offset:7936
  v_cvt_pk_bf16_f32 v88, v112, v113
  v_cvt_pk_bf16_f32 v89, v114, v115
  v_cvt_pk_bf16_f32 v90, v116, v117
  v_cvt_pk_bf16_f32 v91, v118, v119
  s_waitcnt lgkmcnt(8)
  v_mfma_f32_32x32x16_bf16 v[160:175], a[212:215], a[40:43], v[160:175]
  v_cvt_pk_bf16_f32 v92, v120, v121
  v_cvt_pk_bf16_f32 v93, v122, v123
  v_cvt_pk_bf16_f32 v94, v124, v125
  v_cvt_pk_bf16_f32 v95, v126, v127
  v_mfma_f32_32x32x16_bf16 v[176:191], a[212:215], a[44:47], v[176:191]
  ds_read_b64_tr_b16 a[200:201], v15 offset:12544
  ds_read_b64_tr_b16 a[202:203], v15 offset:14080
  v_pk_mul_f32 v[128:129], v[128:129], v[44:45]
  v_pk_mul_f32 v[130:131], v[130:131], v[44:45]
  v_pk_mul_f32 v[132:133], v[132:133], v[44:45]
  v_pk_mul_f32 v[134:135], v[134:135], v[44:45]
  s_waitcnt lgkmcnt(8)
  v_mfma_f32_32x32x16_bf16 v[160:175], a[216:219], a[48:51], v[160:175]
  v_pk_mul_f32 v[136:137], v[136:137], v[44:45]
  v_pk_mul_f32 v[138:139], v[138:139], v[44:45]
  v_pk_mul_f32 v[140:141], v[140:141], v[44:45]
  v_pk_mul_f32 v[142:143], v[142:143], v[44:45]
  v_mfma_f32_32x32x16_bf16 v[176:191], a[216:219], a[52:55], v[176:191]
  ds_read_b64_tr_b16 a[204:205], v15 offset:18688
  ds_read_b64_tr_b16 a[206:207], v15 offset:20224
  v_cvt_pk_bf16_f32 v96, v128, v129
  v_cvt_pk_bf16_f32 v97, v130, v131
  v_cvt_pk_bf16_f32 v98, v132, v133
  v_cvt_pk_bf16_f32 v99, v134, v135
  s_waitcnt lgkmcnt(8)
  v_mfma_f32_32x32x16_bf16 v[160:175], a[220:223], a[56:59], v[160:175]
  v_cvt_pk_bf16_f32 v100, v136, v137
  v_cvt_pk_bf16_f32 v101, v138, v139
  v_cvt_pk_bf16_f32 v102, v140, v141
  v_cvt_pk_bf16_f32 v103, v142, v143
  v_mfma_f32_32x32x16_bf16 v[176:191], a[220:223], a[60:63], v[176:191]
  ds_read_b64_tr_b16 a[208:209], v16 offset:256
  ds_read_b64_tr_b16 a[210:211], v16 offset:1792
  v_pk_mul_f32 v[144:145], v[144:145], v[44:45]
  v_pk_mul_f32 v[146:147], v[146:147], v[44:45]
  v_pk_mul_f32 v[148:149], v[148:149], v[44:45]
  v_pk_mul_f32 v[150:151], v[150:151], v[44:45]
  s_waitcnt lgkmcnt(8)
  v_mfma_f32_32x32x16_bf16 v[192:207], a[192:195], a[32:35], v[192:207]
  v_pk_mul_f32 v[152:153], v[152:153], v[44:45]
  v_pk_mul_f32 v[154:155], v[154:155], v[44:45]
  v_pk_mul_f32 v[156:157], v[156:157], v[44:45]
  v_pk_mul_f32 v[158:159], v[158:159], v[44:45]
  v_mfma_f32_32x32x16_bf16 v[208:223], a[192:195], a[36:39], v[208:223]
  ds_read_b64_tr_b16 a[212:213], v16 offset:6400
  ds_read_b64_tr_b16 a[214:215], v16 offset:7936
  v_cvt_pk_bf16_f32 v104, v144, v145
  v_cvt_pk_bf16_f32 v105, v146, v147
  v_cvt_pk_bf16_f32 v106, v148, v149
  v_cvt_pk_bf16_f32 v107, v150, v151
  s_waitcnt lgkmcnt(8)
  v_mfma_f32_32x32x16_bf16 v[192:207], a[196:199], a[40:43], v[192:207]
  v_cvt_pk_bf16_f32 v108, v152, v153
  v_cvt_pk_bf16_f32 v109, v154, v155
  v_cvt_pk_bf16_f32 v110, v156, v157
  v_cvt_pk_bf16_f32 v111, v158, v159
  v_mfma_f32_32x32x16_bf16 v[208:223], a[196:199], a[44:47], v[208:223]
  ds_read_b64_tr_b16 a[216:217], v16 offset:12544
  ds_read_b64_tr_b16 a[218:219], v16 offset:14080
  v_pk_mul_f32 v[160:161], v[160:161], v[44:45]
  v_pk_mul_f32 v[162:163], v[162:163], v[44:45]
  v_pk_mul_f32 v[164:165], v[164:165], v[44:45]
  v_pk_mul_f32 v[166:167], v[166:167], v[44:45]
  s_waitcnt lgkmcnt(8)
  v_mfma_f32_32x32x16_bf16 v[192:207], a[200:203], a[48:51], v[192:207]
  v_pk_mul_f32 v[168:169], v[168:169], v[44:45]
  v_pk_mul_f32 v[170:171], v[170:171], v[44:45]
  v_pk_mul_f32 v[172:173], v[172:173], v[44:45]
  v_pk_mul_f32 v[174:175], v[174:175], v[44:45]
  v_mfma_f32_32x32x16_bf16 v[208:223], a[200:203], a[52:55], v[208:223]
  ds_read_b64_tr_b16 a[220:221], v16 offset:18688
  ds_read_b64_tr_b16 a[222:223], v16 offset:20224
  v_cvt_pk_bf16_f32 v112, v160, v161
  v_cvt_pk_bf16_f32 v113, v162, v163
  v_cvt_pk_bf16_f32 v114, v164, v165
  v_cvt_pk_bf16_f32 v115, v166, v167
  s_waitcnt lgkmcnt(8)
  v_mfma_f32_32x32x16_bf16 v[192:207], a[204:207], a[56:59], v[192:207]
  v_cvt_pk_bf16_f32 v116, v168, v169
  v_cvt_pk_bf16_f32 v117, v170, v171
  v_cvt_pk_bf16_f32 v118, v172, v173
  v_cvt_pk_bf16_f32 v119, v174, v175
  v_mfma_f32_32x32x16_bf16 v[208:223], a[204:207], a[60:63], v[208:223]
  s_barrier
  ds_read_b128 a[192:195], v29 offset:24576
  v_pk_mul_f32 v[176:177], v[176:177], v[44:45]
  v_pk_mul_f32 v[178:179], v[178:179], v[44:45]
  v_pk_mul_f32 v[180:181], v[180:181], v[44:45]
  v_pk_mul_f32 v[182:183], v[182:183], v[44:45]
  s_waitcnt lgkmcnt(7)
  v_mfma_f32_32x32x16_bf16 v[224:239], a[208:211], a[32:35], v[224:239]
  s_mov_b32 s67, 61440
  s_add_u32 m0, s68, 36864
  s_nop 0
  buffer_load_dwordx4 v7, s[48:51], s67 offen offset:0 lds
  v_pk_mul_f32 v[184:185], v[184:185], v[44:45]
  v_pk_mul_f32 v[186:187], v[186:187], v[44:45]
  v_pk_mul_f32 v[188:189], v[188:189], v[44:45]
  v_pk_mul_f32 v[190:191], v[190:191], v[44:45]
  v_mfma_f32_32x32x16_bf16 v[240:255], a[208:211], a[36:39], v[240:255]
  ds_read_b128 a[196:199], v30 offset:24576
  buffer_load_dwordx4 v8, s[48:51], s67 offen offset:1024 lds
  v_cvt_pk_bf16_f32 v120, v176, v177
  v_cvt_pk_bf16_f32 v121, v178, v179
  v_cvt_pk_bf16_f32 v122, v180, v181
  v_cvt_pk_bf16_f32 v123, v182, v183
  s_waitcnt lgkmcnt(6)
  v_mfma_f32_32x32x16_bf16 v[224:239], a[212:215], a[40:43], v[224:239]
  buffer_load_dwordx4 v9, s[48:51], s67 offen offset:2048 lds
  v_cvt_pk_bf16_f32 v124, v184, v185
  v_cvt_pk_bf16_f32 v125, v186, v187
  v_cvt_pk_bf16_f32 v126, v188, v189
  v_cvt_pk_bf16_f32 v127, v190, v191
  v_mfma_f32_32x32x16_bf16 v[240:255], a[212:215], a[44:47], v[240:255]
  ds_read_b128 a[200:203], v31 offset:24576
  s_mov_b32 s67, 49152
  s_add_u32 m0, s68, 49152
  s_nop 0
  buffer_load_dwordx4 v10, s[52:55], s67 offen offset:0 lds
  v_pk_mul_f32 v[192:193], v[192:193], v[44:45]
  v_pk_mul_f32 v[194:195], v[194:195], v[44:45]
  v_pk_mul_f32 v[196:197], v[196:197], v[44:45]
  v_pk_mul_f32 v[198:199], v[198:199], v[44:45]
  s_waitcnt lgkmcnt(5)
  v_mfma_f32_32x32x16_bf16 v[224:239], a[216:219], a[48:51], v[224:239]
  buffer_load_dwordx4 v11, s[52:55], s67 offen offset:1024 lds
  v_pk_mul_f32 v[200:201], v[200:201], v[44:45]
  v_pk_mul_f32 v[202:203], v[202:203], v[44:45]
  v_pk_mul_f32 v[204:205], v[204:205], v[44:45]
  v_pk_mul_f32 v[206:207], v[206:207], v[44:45]
  v_mfma_f32_32x32x16_bf16 v[240:255], a[216:219], a[52:55], v[240:255]
  ds_read_b128 a[204:207], v32 offset:24576
  buffer_load_dwordx4 v12, s[52:55], s67 offen offset:2048 lds
  v_cvt_pk_bf16_f32 v128, v192, v193
  v_cvt_pk_bf16_f32 v129, v194, v195
  v_cvt_pk_bf16_f32 v130, v196, v197
  v_cvt_pk_bf16_f32 v131, v198, v199
  s_waitcnt lgkmcnt(4)
  v_mfma_f32_32x32x16_bf16 v[224:239], a[220:223], a[56:59], v[224:239]
  v_cvt_pk_bf16_f32 v132, v200, v201
  v_cvt_pk_bf16_f32 v133, v202, v203
  v_cvt_pk_bf16_f32 v134, v204, v205
  v_cvt_pk_bf16_f32 v135, v206, v207
  v_mfma_f32_32x32x16_bf16 v[240:255], a[220:223], a[60:63], v[240:255]
  ds_read_b128 a[208:211], v29 offset:24704
  v_pk_mul_f32 v[208:209], v[208:209], v[44:45]
  v_pk_mul_f32 v[210:211], v[210:211], v[44:45]
  v_pk_mul_f32 v[212:213], v[212:213], v[44:45]
  v_pk_mul_f32 v[214:215], v[214:215], v[44:45]
  s_waitcnt lgkmcnt(4)
  v_mfma_f32_32x32x16_bf16 v[160:175], a[192:195], v[64:67], 0
  v_pk_mul_f32 v[216:217], v[216:217], v[44:45]
  v_pk_mul_f32 v[218:219], v[218:219], v[44:45]
  v_pk_mul_f32 v[220:221], v[220:221], v[44:45]
  v_pk_mul_f32 v[222:223], v[222:223], v[44:45]
  v_mfma_f32_32x32x16_bf16 v[176:191], a[192:195], v[72:75], 0
  ds_read_b128 a[212:215], v30 offset:24704
  v_cvt_pk_bf16_f32 v136, v208, v209
  v_cvt_pk_bf16_f32 v137, v210, v211
  v_cvt_pk_bf16_f32 v138, v212, v213
  v_cvt_pk_bf16_f32 v139, v214, v215
  s_waitcnt lgkmcnt(4)
  v_mfma_f32_32x32x16_bf16 v[160:175], a[196:199], v[68:71], v[160:175]
  v_cvt_pk_bf16_f32 v140, v216, v217
  v_cvt_pk_bf16_f32 v141, v218, v219
  v_cvt_pk_bf16_f32 v142, v220, v221
  v_cvt_pk_bf16_f32 v143, v222, v223
  v_mfma_f32_32x32x16_bf16 v[176:191], a[196:199], v[76:79], v[176:191]
  ds_read_b128 a[216:219], v31 offset:24704
  v_pk_mul_f32 v[224:225], v[224:225], v[44:45]
  v_pk_mul_f32 v[226:227], v[226:227], v[44:45]
  s_waitcnt lgkmcnt(4)
  v_mfma_f32_32x32x16_bf16 v[160:175], a[200:203], v[80:83], v[160:175]
  v_pk_mul_f32 v[228:229], v[228:229], v[44:45]
  v_pk_mul_f32 v[230:231], v[230:231], v[44:45]
  v_pk_mul_f32 v[232:233], v[232:233], v[44:45]
  v_mfma_f32_32x32x16_bf16 v[176:191], a[200:203], v[88:91], v[176:191]
  ds_read_b128 a[220:223], v32 offset:24704
  v_pk_mul_f32 v[234:235], v[234:235], v[44:45]
  v_pk_mul_f32 v[236:237], v[236:237], v[44:45]
  s_waitcnt lgkmcnt(4)
  v_mfma_f32_32x32x16_bf16 v[160:175], a[204:207], v[84:87], v[160:175]
  v_pk_mul_f32 v[238:239], v[238:239], v[44:45]
  v_cvt_pk_bf16_f32 v144, v224, v225
  v_mfma_f32_32x32x16_bf16 v[176:191], a[204:207], v[92:95], v[176:191]
  ds_read_b128 a[192:195], v29 offset:24832
  v_cvt_pk_bf16_f32 v145, v226, v227
  v_cvt_pk_bf16_f32 v146, v228, v229
  s_waitcnt lgkmcnt(4)
  v_mfma_f32_32x32x16_bf16 v[160:175], a[208:211], v[96:99], v[160:175]
  v_cvt_pk_bf16_f32 v147, v230, v231
  v_cvt_pk_bf16_f32 v148, v232, v233
  v_cvt_pk_bf16_f32 v149, v234, v235
  v_mfma_f32_32x32x16_bf16 v[176:191], a[208:211], v[104:107], v[176:191]
  ds_read_b128 a[196:199], v30 offset:24832
  v_cvt_pk_bf16_f32 v150, v236, v237
  v_cvt_pk_bf16_f32 v151, v238, v239
  s_waitcnt lgkmcnt(4)
  v_mfma_f32_32x32x16_bf16 v[160:175], a[212:215], v[100:103], v[160:175]
  v_pk_mul_f32 v[240:241], v[240:241], v[44:45]
  v_pk_mul_f32 v[242:243], v[242:243], v[44:45]
  v_mfma_f32_32x32x16_bf16 v[176:191], a[212:215], v[108:111], v[176:191]
  ds_read_b128 a[200:203], v31 offset:24832
  v_pk_mul_f32 v[244:245], v[244:245], v[44:45]
  v_pk_mul_f32 v[246:247], v[246:247], v[44:45]
  v_pk_mul_f32 v[248:249], v[248:249], v[44:45]
  s_waitcnt lgkmcnt(4)
  v_mfma_f32_32x32x16_bf16 v[160:175], a[216:219], v[112:115], v[160:175]
  v_pk_mul_f32 v[250:251], v[250:251], v[44:45]
  v_pk_mul_f32 v[252:253], v[252:253], v[44:45]
  v_mfma_f32_32x32x16_bf16 v[176:191], a[216:219], v[120:123], v[176:191]
  ds_read_b128 a[204:207], v32 offset:24832
  v_pk_mul_f32 v[254:255], v[254:255], v[44:45]
  v_cvt_pk_bf16_f32 v152, v240, v241
  s_waitcnt lgkmcnt(4)
  v_mfma_f32_32x32x16_bf16 v[160:175], a[220:223], v[116:119], v[160:175]
  v_cvt_pk_bf16_f32 v153, v242, v243
  v_cvt_pk_bf16_f32 v154, v244, v245
  v_mfma_f32_32x32x16_bf16 v[176:191], a[220:223], v[124:127], v[176:191]
  s_barrier
  ds_read_b128 a[208:211], v29 offset:36864
  v_cvt_pk_bf16_f32 v155, v246, v247
  v_cvt_pk_bf16_f32 v156, v248, v249
  v_cvt_pk_bf16_f32 v157, v250, v251
  s_waitcnt lgkmcnt(4)
  v_mfma_f32_32x32x16_bf16 v[160:175], a[192:195], v[128:131], v[160:175]
  s_mov_b32 s67, 73728
  s_add_u32 m0, s68, 61440
  s_nop 0
  buffer_load_dwordx4 v7, s[48:51], s67 offen offset:0 lds
  v_cvt_pk_bf16_f32 v158, v252, v253
  v_cvt_pk_bf16_f32 v159, v254, v255
  v_mfma_f32_32x32x16_bf16 v[176:191], a[192:195], v[136:139], v[176:191]
  ds_read_b128 a[212:215], v30 offset:36864
  buffer_load_dwordx4 v8, s[48:51], s67 offen offset:1024 lds
  s_waitcnt lgkmcnt(4)
  v_mfma_f32_32x32x16_bf16 v[160:175], a[196:199], v[132:135], v[160:175]
  buffer_load_dwordx4 v9, s[48:51], s67 offen offset:2048 lds
  v_mfma_f32_32x32x16_bf16 v[176:191], a[196:199], v[140:143], v[176:191]
  ds_read_b128 a[216:219], v31 offset:36864
  s_mov_b32 s67, 61440
  s_add_u32 m0, s68, 73728
  s_nop 0
  buffer_load_dwordx4 v10, s[52:55], s67 offen offset:0 lds
  s_waitcnt lgkmcnt(4)
  v_mfma_f32_32x32x16_bf16 v[160:175], a[200:203], v[144:147], v[160:175]
  buffer_load_dwordx4 v11, s[52:55], s67 offen offset:1024 lds
  v_mfma_f32_32x32x16_bf16 v[176:191], a[200:203], v[152:155], v[176:191]
  ds_read_b128 a[220:223], v32 offset:36864
  buffer_load_dwordx4 v12, s[52:55], s67 offen offset:2048 lds
  s_waitcnt lgkmcnt(4)
  v_mfma_f32_32x32x16_bf16 v[160:175], a[204:207], v[148:151], v[160:175]
  v_mfma_f32_32x32x16_bf16 v[176:191], a[204:207], v[156:159], v[176:191]
  ds_read_b128 a[192:195], v29 offset:36992
  s_nop 9
  v_max3_f32 v39, v160, v161, v162
  v_max3_f32 v40, v176, v177, v178
  v_max3_f32 v39, v39, v163, v164
  v_max3_f32 v40, v40, v179, v180
  v_max3_f32 v39, v39, v165, v166
  v_max3_f32 v40, v40, v181, v182
  v_max3_f32 v39, v39, v167, v168
  v_max3_f32 v40, v40, v183, v184
  v_max3_f32 v39, v39, v169, v170
  v_max3_f32 v40, v40, v185, v186
  v_max3_f32 v39, v39, v171, v172
  v_max3_f32 v40, v40, v187, v188
  v_max3_f32 v39, v39, v173, v174
  v_max3_f32 v40, v40, v189, v190
  v_max_f32 v39, v39, v175
  v_max_f32 v40, v40, v191
  v_mov_b32 v41, v39
  v_mov_b32 v42, v40
  s_nop 0
  v_permlane32_swap_b32 v41, v39
  v_permlane32_swap_b32 v42, v40
  v_max_f32 v39, v39, v41
  v_max_f32 v40, v40, v42
  v_sub_f32 v224, 0, v39
  v_sub_f32 v240, 0, v40
  v_mov_b32 v225, v224
  v_mov_b32 v241, v240
  v_mov_b32 v226, v224
  v_mov_b32 v242, v240
  v_mov_b32 v227, v224
  v_mov_b32 v243, v240
  v_mov_b32 v228, v224
  v_mov_b32 v244, v240
  v_mov_b32 v229, v224
  v_mov_b32 v245, v240
  v_mov_b32 v230, v224
  v_mov_b32 v246, v240
  v_mov_b32 v231, v224
  v_mov_b32 v247, v240
  v_mov_b32 v232, v224
  v_mov_b32 v248, v240
  v_mov_b32 v233, v224
  v_mov_b32 v249, v240
  v_mov_b32 v234, v224
  v_mov_b32 v250, v240
  v_mov_b32 v235, v224
  v_mov_b32 v251, v240
  v_mov_b32 v236, v224
  v_mov_b32 v252, v240
  v_mov_b32 v237, v224
  v_mov_b32 v253, v240
  v_mov_b32 v238, v224
  v_mov_b32 v254, v240
  v_mov_b32 v239, v224
  v_mov_b32 v255, v240
  v_add_f32 v160, v160, v224
  v_add_f32 v176, v176, v240
  v_add_f32 v161, v161, v224
  v_add_f32 v177, v177, v240
  v_add_f32 v162, v162, v224
  v_add_f32 v178, v178, v240
  v_add_f32 v163, v163, v224
  v_add_f32 v179, v179, v240
  v_add_f32 v164, v164, v224
  v_add_f32 v180, v180, v240
  v_add_f32 v165, v165, v224
  v_add_f32 v181, v181, v240
  v_add_f32 v166, v166, v224
  v_add_f32 v182, v182, v240
  v_add_f32 v167, v167, v224
  v_add_f32 v183, v183, v240
  v_add_f32 v168, v168, v224
  v_add_f32 v184, v184, v240
  v_add_f32 v169, v169, v224
  v_add_f32 v185, v185, v240
  v_add_f32 v170, v170, v224
  v_add_f32 v186, v186, v240
  v_add_f32 v171, v171, v224
  v_add_f32 v187, v187, v240
  v_add_f32 v172, v172, v224
  v_add_f32 v188, v188, v240
  v_add_f32 v173, v173, v224
  v_add_f32 v189, v189, v240
  v_add_f32 v174, v174, v224
  v_add_f32 v190, v190, v240
  v_add_f32 v175, v175, v224
  v_add_f32 v191, v191, v240
  s_waitcnt lgkmcnt(4)
  v_mfma_f32_32x32x16_bf16 v[192:207], a[208:211], v[64:67], v[224:239]
  v_exp_f32 v160, v160
  v_exp_f32 v161, v161
  v_mfma_f32_32x32x16_bf16 v[208:223], a[208:211], v[72:75], v[240:255]
  ds_read_b128 a[196:199], v30 offset:36992
  v_mov_b32 v37, v160
  v_exp_f32 v162, v162
  s_waitcnt lgkmcnt(4)
  v_mfma_f32_32x32x16_bf16 v[192:207], a[212:215], v[68:71], v[192:207]
  v_add_f32 v37, v37, v161
  v_cvt_pk_bf16_f32 v48, v160, v161
  v_exp_f32 v163, v163
  v_mfma_f32_32x32x16_bf16 v[208:223], a[212:215], v[76:79], v[208:223]
  ds_read_b128 a[200:203], v31 offset:36992
  v_add_f32 v37, v37, v162
  v_exp_f32 v164, v164
  s_waitcnt lgkmcnt(4)
  v_mfma_f32_32x32x16_bf16 v[192:207], a[216:219], v[80:83], v[192:207]
  v_add_f32 v37, v37, v163
  v_cvt_pk_bf16_f32 v49, v162, v163
  v_mfma_f32_32x32x16_bf16 v[208:223], a[216:219], v[88:91], v[208:223]
  ds_read_b128 a[204:207], v32 offset:36992
  v_exp_f32 v165, v165
  v_add_f32 v37, v37, v164
  v_exp_f32 v166, v166
  s_waitcnt lgkmcnt(4)
  v_mfma_f32_32x32x16_bf16 v[192:207], a[220:223], v[84:87], v[192:207]
  v_add_f32 v37, v37, v165
  v_cvt_pk_bf16_f32 v50, v164, v165
  v_mfma_f32_32x32x16_bf16 v[208:223], a[220:223], v[92:95], v[208:223]
  ds_read_b128 a[208:211], v29 offset:37120
  v_exp_f32 v167, v167
  v_add_f32 v37, v37, v166
  s_waitcnt lgkmcnt(4)
  v_mfma_f32_32x32x16_bf16 v[192:207], a[192:195], v[96:99], v[192:207]
  v_exp_f32 v176, v176
  v_add_f32 v37, v37, v167
  v_cvt_pk_bf16_f32 v51, v166, v167
  v_mfma_f32_32x32x16_bf16 v[208:223], a[192:195], v[104:107], v[208:223]
  ds_read_b128 a[212:215], v30 offset:37120
  v_exp_f32 v177, v177
  v_mov_b32 v38, v176
  s_waitcnt lgkmcnt(4)
  v_mfma_f32_32x32x16_bf16 v[192:207], a[196:199], v[100:103], v[192:207]
  v_exp_f32 v178, v178
  v_add_f32 v38, v38, v177
  v_cvt_pk_bf16_f32 v52, v176, v177
  v_mfma_f32_32x32x16_bf16 v[208:223], a[196:199], v[108:111], v[208:223]
  ds_read_b128 a[216:219], v31 offset:37120
  v_exp_f32 v179, v179
  v_add_f32 v38, v38, v178
  s_waitcnt lgkmcnt(4)
  v_mfma_f32_32x32x16_bf16 v[192:207], a[200:203], v[112:115], v[192:207]
  v_exp_f32 v180, v180
  v_add_f32 v38, v38, v179
  v_cvt_pk_bf16_f32 v53, v178, v179
  v_mfma_f32_32x32x16_bf16 v[208:223], a[200:203], v[120:123], v[208:223]
  ds_read_b128 a[220:223], v32 offset:37120
  v_exp_f32 v181, v181
  v_add_f32 v38, v38, v180
  s_waitcnt lgkmcnt(4)
  v_mfma_f32_32x32x16_bf16 v[192:207], a[204:207], v[116:119], v[192:207]
  v_exp_f32 v182, v182
  v_add_f32 v38, v38, v181
  v_mfma_f32_32x32x16_bf16 v[208:223], a[204:207], v[124:127], v[208:223]
  ds_read_b64_tr_b16 a[192:193], v21 offset:49152
  ds_read_b64_tr_b16 a[194:195], v21 offset:52224
  v_cvt_pk_bf16_f32 v54, v180, v181
  v_exp_f32 v183, v183
  v_add_f32 v38, v38, v182
  s_waitcnt lgkmcnt(5)
  v_mfma_f32_32x32x16_bf16 v[192:207], a[208:211], v[128:131], v[192:207]
  v_add_f32 v38, v38, v183
  v_cvt_pk_bf16_f32 v55, v182, v183
  v_mfma_f32_32x32x16_bf16 v[208:223], a[208:211], v[136:139], v[208:223]
  ds_read_b64_tr_b16 a[196:197], v22 offset:49152
  ds_read_b64_tr_b16 a[198:199], v22 offset:52224
  v_exp_f32 v168, v168
  v_exp_f32 v169, v169
  s_waitcnt lgkmcnt(6)
  v_mfma_f32_32x32x16_bf16 v[192:207], a[212:215], v[132:135], v[192:207]
  v_add_f32 v37, v37, v168
  v_exp_f32 v170, v170
  v_add_f32 v37, v37, v169
  v_mfma_f32_32x32x16_bf16 v[208:223], a[212:215], v[140:143], v[208:223]
  ds_read_b64_tr_b16 a[200:201], v21 offset:49280
  ds_read_b64_tr_b16 a[202:203], v21 offset:52352
  v_cvt_pk_bf16_f32 v56, v168, v169
  v_exp_f32 v171, v171
  s_waitcnt lgkmcnt(7)
  v_mfma_f32_32x32x16_bf16 v[192:207], a[216:219], v[144:147], v[192:207]
  v_add_f32 v37, v37, v170
  v_exp_f32 v172, v172
  v_mfma_f32_32x32x16_bf16 v[208:223], a[216:219], v[152:155], v[208:223]
  ds_read_b64_tr_b16 a[204:205], v22 offset:49280
  ds_read_b64_tr_b16 a[206:207], v22 offset:52352
  v_add_f32 v37, v37, v171
  v_cvt_pk_bf16_f32 v57, v170, v171
  v_exp_f32 v173, v173
  s_waitcnt lgkmcnt(8)
  v_mfma_f32_32x32x16_bf16 v[192:207], a[220:223], v[148:151], v[192:207]
  v_add_f32 v37, v37, v172
  v_exp_f32 v174, v174
  v_mfma_f32_32x32x16_bf16 v[208:223], a[220:223], v[156:159], v[208:223]
  ds_read_b64_tr_b16 a[208:209], v21 offset:49408
  ds_read_b64_tr_b16 a[210:211], v21 offset:52480
  s_waitcnt lgkmcnt(8)
  v_mfma_f32_32x32x16_bf16 a[0:15], a[192:195], v[48:51], 0
  v_add_f32 v37, v37, v173
  v_cvt_pk_bf16_f32 v58, v172, v173
  v_exp_f32 v175, v175
  v_mfma_f32_32x32x16_bf16 a[16:31], a[192:195], v[52:55], 0
  ds_read_b64_tr_b16 a[212:213], v22 offset:49408
  ds_read_b64_tr_b16 a[214:215], v22 offset:52480
  v_add_f32 v37, v37, v174
  v_exp_f32 v184, v184
  s_waitcnt lgkmcnt(8)
  v_mfma_f32_32x32x16_bf16 a[32:47], a[196:199], v[48:51], 0
  v_add_f32 v37, v37, v175
  v_cvt_pk_bf16_f32 v59, v174, v175
  v_mfma_f32_32x32x16_bf16 a[48:63], a[196:199], v[52:55], 0
  ds_read_b64_tr_b16 a[216:217], v21 offset:55296
  ds_read_b64_tr_b16 a[218:219], v21 offset:58368
  v_exp_f32 v185, v185
  v_add_f32 v38, v38, v184
  s_waitcnt lgkmcnt(8)
  v_mfma_f32_32x32x16_bf16 a[64:79], a[200:203], v[48:51], 0
  v_exp_f32 v186, v186
  v_add_f32 v38, v38, v185
  v_cvt_pk_bf16_f32 v60, v184, v185
  v_mfma_f32_32x32x16_bf16 a[80:95], a[200:203], v[52:55], 0
  ds_read_b64_tr_b16 a[220:221], v22 offset:55296
  ds_read_b64_tr_b16 a[222:223], v22 offset:58368
  v_exp_f32 v187, v187
  v_add_f32 v38, v38, v186
  s_waitcnt lgkmcnt(8)
  v_mfma_f32_32x32x16_bf16 a[96:111], a[204:207], v[48:51], 0
  v_exp_f32 v188, v188
  v_add_f32 v38, v38, v187
  v_mfma_f32_32x32x16_bf16 a[112:127], a[204:207], v[52:55], 0
  ds_read_b64_tr_b16 a[192:193], v21 offset:55424
  ds_read_b64_tr_b16 a[194:195], v21 offset:58496
  v_cvt_pk_bf16_f32 v61, v186, v187
  v_exp_f32 v189, v189
  s_waitcnt lgkmcnt(8)
  v_mfma_f32_32x32x16_bf16 a[128:143], a[208:211], v[48:51], 0
  v_add_f32 v38, v38, v188
  v_exp_f32 v190, v190
  v_add_f32 v38, v38, v189
  v_mfma_f32_32x32x16_bf16 a[144:159], a[208:211], v[52:55], 0
  ds_read_b64_tr_b16 a[196:197], v22 offset:55424
  ds_read_b64_tr_b16 a[198:199], v22 offset:58496
  v_cvt_pk_bf16_f32 v62, v188, v189
  v_exp_f32 v191, v191
  s_waitcnt lgkmcnt(8)
  v_mfma_f32_32x32x16_bf16 a[160:175], a[212:215], v[48:51], 0
  v_add_f32 v38, v38, v190
  v_add_f32 v38, v38, v191
  v_cvt_pk_bf16_f32 v63, v190, v191
  v_mfma_f32_32x32x16_bf16 a[176:191], a[212:215], v[52:55], 0
  ds_read_b64_tr_b16 a[200:201], v21 offset:55552
  ds_read_b64_tr_b16 a[202:203], v21 offset:58624
  s_waitcnt lgkmcnt(8)
  v_mfma_f32_32x32x16_bf16 a[0:15], a[216:219], v[56:59], a[0:15]
  v_max3_f32 v39, v192, v193, v194
  v_mfma_f32_32x32x16_bf16 a[16:31], a[216:219], v[60:63], a[16:31]
  ds_read_b64_tr_b16 a[204:205], v22 offset:55552
  ds_read_b64_tr_b16 a[206:207], v22 offset:58624
  v_max3_f32 v40, v208, v209, v210
  v_max3_f32 v39, v39, v195, v196
  s_waitcnt lgkmcnt(8)
  v_mfma_f32_32x32x16_bf16 a[32:47], a[220:223], v[56:59], a[32:47]
  v_max3_f32 v40, v40, v211, v212
  v_mfma_f32_32x32x16_bf16 a[48:63], a[220:223], v[60:63], a[48:63]
  s_barrier
  ds_read_b128 a[208:211], v33 offset:0
  v_max3_f32 v39, v39, v197, v198
  v_max3_f32 v40, v40, v213, v214
  s_waitcnt lgkmcnt(7)
  v_mfma_f32_32x32x16_bf16 a[64:79], a[192:195], v[56:59], a[64:79]
  s_mov_b32 s67, 86016
  s_add_u32 m0, s68, 86016
  s_nop 0
  buffer_load_dwordx4 v7, s[48:51], s67 offen offset:0 lds
  v_max3_f32 v39, v39, v199, v200
  v_mfma_f32_32x32x16_bf16 a[80:95], a[192:195], v[60:63], a[80:95]
  ds_read_b128 a[212:215], v34 offset:0
  buffer_load_dwordx4 v8, s[48:51], s67 offen offset:1024 lds
  v_max3_f32 v40, v40, v215, v216
  v_max3_f32 v39, v39, v201, v202
  s_waitcnt lgkmcnt(6)
  v_mfma_f32_32x32x16_bf16 a[96:111], a[196:199], v[56:59], a[96:111]
  buffer_load_dwordx4 v9, s[48:51], s67 offen offset:2048 lds
  v_max3_f32 v40, v40, v217, v218
  v_mfma_f32_32x32x16_bf16 a[112:127], a[196:199], v[60:63], a[112:127]
  ds_read_b128 a[216:219], v35 offset:0
  v_max3_f32 v39, v39, v203, v204
  v_max3_f32 v40, v40, v219, v220
  s_waitcnt lgkmcnt(5)
  v_mfma_f32_32x32x16_bf16 a[128:143], a[200:203], v[56:59], a[128:143]
  v_max3_f32 v39, v39, v205, v206
  v_mfma_f32_32x32x16_bf16 a[144:159], a[200:203], v[60:63], a[144:159]
  ds_read_b128 a[220:223], v36 offset:0
  v_max3_f32 v40, v40, v221, v222
  v_max_f32 v39, v39, v207
  s_waitcnt lgkmcnt(4)
  v_mfma_f32_32x32x16_bf16 a[160:175], a[204:207], v[56:59], a[160:175]
  v_max_f32 v40, v40, v223
  v_mfma_f32_32x32x16_bf16 a[176:191], a[204:207], v[60:63], a[176:191]
  ds_read_b128 a[192:195], v33 offset:128
  v_max_f32 v41, v39, v40
  v_cmp_lt_f32 vcc, s72, v41
  s_cbranch_vccz L_ok0
  s_call_b64 s[70:71], L_rescale1
L_ok0:
  s_waitcnt lgkmcnt(4)
  v_mfma_f32_32x32x16_bf16 v[160:175], a[208:211], v[64:67], v[224:239]
  v_exp_f32 v192, v192
  v_exp_f32 v193, v193
  v_mfma_f32_32x32x16_bf16 v[176:191], a[208:211], v[72:75], v[240:255]
  ds_read_b128 a[196:199], v34 offset:128
  v_add_f32 v37, v37, v192
  v_exp_f32 v194, v194
  s_waitcnt lgkmcnt(4)
  v_mfma_f32_32x32x16_bf16 v[160:175], a[212:215], v[68:71], v[160:175]
  v_add_f32 v37, v37, v193
  v_cvt_pk_bf16_f32 v48, v192, v193
  v_exp_f32 v195, v195
  v_mfma_f32_32x32x16_bf16 v[176:191], a[212:215], v[76:79], v[176:191]
  ds_read_b128 a[200:203], v35 offset:128
  v_add_f32 v37, v37, v194
  v_exp_f32 v196, v196
  s_waitcnt lgkmcnt(4)
  v_mfma_f32_32x32x16_bf16 v[160:175], a[216:219], v[80:83], v[160:175]
  v_add_f32 v37, v37, v195
  v_cvt_pk_bf16_f32 v49, v194, v195
  v_mfma_f32_32x32x16_bf16 v[176:191], a[216:219], v[88:91], v[176:191]
  ds_read_b128 a[204:207], v36 offset:128
  v_exp_f32 v197, v197
  v_add_f32 v37, v37, v196
  v_exp_f32 v198, v198
  s_waitcnt lgkmcnt(4)
  v_mfma_f32_32x32x16_bf16 v[160:175], a[220:223], v[84:87], v[160:175]
  v_add_f32 v37, v37, v197
  v_cvt_pk_bf16_f32 v50, v196, v197
  v_mfma_f32_32x32x16_bf16 v[176:191], a[220:223], v[92:95], v[176:191]
  ds_read_b128 a[208:211], v33 offset:256
  v_exp_f32 v199, v199
  v_add_f32 v37, v37, v198
  s_waitcnt lgkmcnt(4)
  v_mfma_f32_32x32x16_bf16 v[160:175], a[192:195], v[96:99], v[160:175]
  v_exp_f32 v208, v208
  v_add_f32 v37, v37, v199
  v_cvt_pk_bf16_f32 v51, v198, v199
  v_mfma_f32_32x32x16_bf16 v[176:191], a[192:195], v[104:107], v[176:191]
  ds_read_b128 a[212:215], v34 offset:256
  v_exp_f32 v209, v209
  v_add_f32 v38, v38, v208
  s_waitcnt lgkmcnt(4)
  v_mfma_f32_32x32x16_bf16 v[160:175], a[196:199], v[100:103], v[160:175]
  v_exp_f32 v210, v210
  v_add_f32 v38, v38, v209
  v_cvt_pk_bf16_f32 v52, v208, v209
  v_mfma_f32_32x32x16_bf16 v[176:191], a[196:199], v[108:111], v[176:191]
  ds_read_b128 a[216:219], v35 offset:256
  v_exp_f32 v211, v211
  v_add_f32 v38, v38, v210
  s_waitcnt lgkmcnt(4)
  v_mfma_f32_32x32x16_bf16 v[160:175], a[200:203], v[112:115], v[160:175]
  v_exp_f32 v212, v212
  v_add_f32 v38, v38, v211
  v_cvt_pk_bf16_f32 v53, v210, v211
  v_mfma_f32_32x32x16_bf16 v[176:191], a[200:203], v[120:123], v[176:191]
  ds_read_b128 a[220:223], v36 offset:256
  v_exp_f32 v213, v213
  v_add_f32 v38, v38, v212
  s_waitcnt lgkmcnt(4)
  v_mfma_f32_32x32x16_bf16 v[160:175], a[204:207], v[116:119], v[160:175]
  v_exp_f32 v214, v214
  v_add_f32 v38, v38, v213
  v_mfma_f32_32x32x16_bf16 v[176:191], a[204:207], v[124:127], v[176:191]
  ds_read_b64_tr_b16 a[192:193], v23 offset:12288
  ds_read_b64_tr_b16 a[194:195], v23 offset:15360
  v_cvt_pk_bf16_f32 v54, v212, v213
  v_exp_f32 v215, v215
  v_add_f32 v38, v38, v214
  s_waitcnt lgkmcnt(5)
  v_mfma_f32_32x32x16_bf16 v[160:175], a[208:211], v[128:131], v[160:175]
  v_add_f32 v38, v38, v215
  v_cvt_pk_bf16_f32 v55, v214, v215
  v_mfma_f32_32x32x16_bf16 v[176:191], a[208:211], v[136:139], v[176:191]
  ds_read_b64_tr_b16 a[196:197], v24 offset:12288
  ds_read_b64_tr_b16 a[198:199], v24 offset:15360
  v_exp_f32 v200, v200
  v_exp_f32 v201, v201
  s_waitcnt lgkmcnt(6)
  v_mfma_f32_32x32x16_bf16 v[160:175], a[212:215], v[132:135], v[160:175]
  v_add_f32 v37, v37, v200
  v_exp_f32 v202, v202
  v_add_f32 v37, v37, v201
  v_mfma_f32_32x32x16_bf16 v[176:191], a[212:215], v[140:143], v[176:191]
  ds_read_b64_tr_b16 a[200:201], v23 offset:12416
  ds_read_b64_tr_b16 a[202:203], v23 offset:15488
  v_cvt_pk_bf16_f32 v56, v200, v201
  v_exp_f32 v203, v203
  s_waitcnt lgkmcnt(7)
  v_mfma_f32_32x32x16_bf16 v[160:175], a[216:219], v[144:147], v[160:175]
  v_add_f32 v37, v37, v202
  v_exp_f32 v204, v204
  v_mfma_f32_32x32x16_bf16 v[176:191], a[216:219], v[152:155], v[176:191]
  ds_read_b64_tr_b16 a[204:205], v24 offset:12416
  ds_read_b64_tr_b16 a[206:207], v24 offset:15488
  v_add_f32 v37, v37, v203
  v_cvt_pk_bf16_f32 v57, v202, v203
  v_exp_f32 v205, v205
  s_waitcnt lgkmcnt(8)
  v_mfma_f32_32x32x16_bf16 v[160:175], a[220:223], v[148:151], v[160:175]
  v_add_f32 v37, v37, v204
  v_exp_f32 v206, v206
  v_mfma_f32_32x32x16_bf16 v[176:191], a[220:223], v[156:159], v[176:191]
  ds_read_b64_tr_b16 a[208:209], v23 offset:12544
  ds_read_b64_tr_b16 a[210:211], v23 offset:15616
  s_waitcnt lgkmcnt(8)
  v_mfma_f32_32x32x16_bf16 a[0:15], a[192:195], v[48:51], a[0:15]
  v_add_f32 v37, v37, v205
  v_cvt_pk_bf16_f32 v58, v204, v205
  v_exp_f32 v207, v207
  v_mfma_f32_32x32x16_bf16 a[16:31], a[192:195], v[52:55], a[16:31]
  ds_read_b64_tr_b16 a[212:213], v24 offset:12544
  ds_read_b64_tr_b16 a[214:215], v24 offset:15616
  v_add_f32 v37, v37, v206
  v_exp_f32 v216, v216
  s_waitcnt lgkmcnt(8)
  v_mfma_f32_32x32x16_bf16 a[32:47], a[196:199], v[48:51], a[32:47]
  v_add_f32 v37, v37, v207
  v_cvt_pk_bf16_f32 v59, v206, v207
  v_mfma_f32_32x32x16_bf16 a[48:63], a[196:199], v[52:55], a[48:63]
  ds_read_b64_tr_b16 a[216:217], v23 offset:18432
  ds_read_b64_tr_b16 a[218:219], v23 offset:21504
  v_exp_f32 v217, v217
  v_add_f32 v38, v38, v216
  s_waitcnt lgkmcnt(8)
  v_mfma_f32_32x32x16_bf16 a[64:79], a[200:203], v[48:51], a[64:79]
  v_exp_f32 v218, v218
  v_add_f32 v38, v38, v217
  v_cvt_pk_bf16_f32 v60, v216, v217
  v_mfma_f32_32x32x16_bf16 a[80:95], a[200:203], v[52:55], a[80:95]
  ds_read_b64_tr_b16 a[220:221], v24 offset:18432
  ds_read_b64_tr_b16 a[222:223], v24 offset:21504
  v_exp_f32 v219, v219
  v_add_f32 v38, v38, v218
  s_waitcnt lgkmcnt(8)
  v_mfma_f32_32x32x16_bf16 a[96:111], a[204:207], v[48:51], a[96:111]
  v_exp_f32 v220, v220
  v_add_f32 v38, v38, v219
  v_mfma_f32_32x32x16_bf16 a[112:127], a[204:207], v[52:55], a[112:127]
  ds_read_b64_tr_b16 a[192:193], v23 offset:18560
  ds_read_b64_tr_b16 a[194:195], v23 offset:21632
  v_cvt_pk_bf16_f32 v61, v218, v219
  v_exp_f32 v221, v221
  s_waitcnt lgkmcnt(8)
  v_mfma_f32_32x32x16_bf16 a[128:143], a[208:211], v[48:51], a[128:143]
  v_add_f32 v38, v38, v220
  v_exp_f32 v222, v222
  v_add_f32 v38, v38, v221
  v_mfma_f32_32x32x16_bf16 a[144:159], a[208:211], v[52:55], a[144:159]
  ds_read_b64_tr_b16 a[196:197], v24 offset:18560
  ds_read_b64_tr_b16 a[198:199], v24 offset:21632
  v_cvt_pk_bf16_f32 v62, v220, v221
  v_exp_f32 v223, v223
  s_waitcnt lgkmcnt(8)
  v_mfma_f32_32x32x16_bf16 a[160:175], a[212:215], v[48:51], a[160:175]
  v_add_f32 v38, v38, v222
  v_add_f32 v38, v38, v223
  v_cvt_pk_bf16_f32 v63, v222, v223
  v_mfma_f32_32x32x16_bf16 a[176:191], a[212:215], v[52:55], a[176:191]
  ds_read_b64_tr_b16 a[200:201], v23 offset:18688
  ds_read_b64_tr_b16 a[202:203], v23 offset:21760
  s_waitcnt lgkmcnt(8)
  v_mfma_f32_32x32x16_bf16 a[0:15], a[216:219], v[56:59], a[0:15]
  v_max3_f32 v39, v160, v161, v162
  v_mfma_f32_32x32x16_bf16 a[16:31], a[216:219], v[60:63], a[16:31]
  ds_read_b64_tr_b16 a[204:205], v24 offset:18688
  ds_read_b64_tr_b16 a[206:207], v24 offset:21760
  v_max3_f32 v40, v176, v177, v178
  v_max3_f32 v39, v39, v163, v164
  s_waitcnt lgkmcnt(8)
  v_mfma_f32_32x32x16_bf16 a[32:47], a[220:223], v[56:59], a[32:47]
  v_max3_f32 v40, v40, v179, v180
  v_mfma_f32_32x32x16_bf16 a[48:63], a[220:223], v[60:63], a[48:63]
  s_waitcnt vmcnt(22)
  s_barrier
  ds_read_b128 a[208:211], v33 offset:24576
  v_max3_f32 v39, v39, v165, v166
  v_max3_f32 v40, v40, v181, v182
  s_waitcnt lgkmcnt(7)
  v_mfma_f32_32x32x16_bf16 a[64:79], a[192:195], v[56:59], a[64:79]
  s_mov_b32 s67, 73728
  s_add_u32 m0, s68, 98304
  s_nop 0
  buffer_load_dwordx4 v10, s[52:55], s67 offen offset:0 lds
  v_max3_f32 v39, v39, v167, v168
  v_mfma_f32_32x32x16_bf16 a[80:95], a[192:195], v[60:63], a[80:95]
  ds_read_b128 a[212:215], v34 offset:24576
  buffer_load_dwordx4 v11, s[52:55], s67 offen offset:1024 lds
  v_max3_f32 v40, v40, v183, v184
  v_max3_f32 v39, v39, v169, v170
  s_waitcnt lgkmcnt(6)
  v_mfma_f32_32x32x16_bf16 a[96:111], a[196:199], v[56:59], a[96:111]
  buffer_load_dwordx4 v12, s[52:55], s67 offen offset:2048 lds
  v_max3_f32 v40, v40, v185, v186
  v_mfma_f32_32x32x16_bf16 a[112:127], a[196:199], v[60:63], a[112:127]
  ds_read_b128 a[216:219], v35 offset:24576
  s_mov_b32 s67, 98304
  s_add_u32 m0, s68, 110592
  s_nop 0
  buffer_load_dwordx4 v7, s[48:51], s67 offen offset:0 lds
  v_max3_f32 v39, v39, v171, v172
  v_max3_f32 v40, v40, v187, v188
  s_waitcnt lgkmcnt(5)
  v_mfma_f32_32x32x16_bf16 a[128:143], a[200:203], v[56:59], a[128:143]
  buffer_load_dwordx4 v8, s[48:51], s67 offen offset:1024 lds
  v_max3_f32 v39, v39, v173, v174
  v_mfma_f32_32x32x16_bf16 a[144:159], a[200:203], v[60:63], a[144:159]
  ds_read_b128 a[220:223], v36 offset:24576
  buffer_load_dwordx4 v9, s[48:51], s67 offen offset:2048 lds
  v_max3_f32 v40, v40, v189, v190
  v_max_f32 v39, v39, v175
  s_waitcnt lgkmcnt(4)
  v_mfma_f32_32x32x16_bf16 a[160:175], a[204:207], v[56:59], a[160:175]
  v_max_f32 v40, v40, v191
  v_mfma_f32_32x32x16_bf16 a[176:191], a[204:207], v[60:63], a[176:191]
  ds_read_b128 a[192:195], v33 offset:24704
  v_max_f32 v41, v39, v40
  v_cmp_lt_f32 vcc, s72, v41
  s_cbranch_vccz L_ok1
  s_call_b64 s[70:71], L_rescale0
L_ok1:
  s_waitcnt lgkmcnt(4)
  v_mfma_f32_32x32x16_bf16 v[192:207], a[208:211], v[64:67], v[224:239]
  v_exp_f32 v160, v160
  v_exp_f32 v161, v161
  v_mfma_f32_32x32x16_bf16 v[208:223], a[208:211], v[72:75], v[240:255]
  ds_read_b128 a[196:199], v34 offset:24704
  v_add_f32 v37, v37, v160
  v_exp_f32 v162, v162
  s_waitcnt lgkmcnt(4)
  v_mfma_f32_32x32x16_bf16 v[192:207], a[212:215], v[68:71], v[192:207]
  v_add_f32 v37, v37, v161
  v_cvt_pk_bf16_f32 v48, v160, v161
  v_exp_f32 v163, v163
  v_mfma_f32_32x32x16_bf16 v[208:223], a[212:215], v[76:79], v[208:223]
  ds_read_b128 a[200:203], v35 offset:24704
  v_add_f32 v37, v37, v162
  v_exp_f32 v164, v164
  s_waitcnt lgkmcnt(4)
  v_mfma_f32_32x32x16_bf16 v[192:207], a[216:219], v[80:83], v[192:207]
  v_add_f32 v37, v37, v163
  v_cvt_pk_bf16_f32 v49, v162, v163
  v_mfma_f32_32x32x16_bf16 v[208:223], a[216:219], v[88:91], v[208:223]
  ds_read_b128 a[204:207], v36 offset:24704
  v_exp_f32 v165, v165
  v_add_f32 v37, v37, v164
  v_exp_f32 v166, v166
  s_waitcnt lgkmcnt(4)
  v_mfma_f32_32x32x16_bf16 v[192:207], a[220:223], v[84:87], v[192:207]
  v_add_f32 v37, v37, v165
  v_cvt_pk_bf16_f32 v50, v164, v165
  v_mfma_f32_32x32x16_bf16 v[208:223], a[220:223], v[92:95], v[208:223]
  ds_read_b128 a[208:211], v33 offset:24832
  v_exp_f32 v167, v167
  v_add_f32 v37, v37, v166
  s_waitcnt lgkmcnt(4)
  v_mfma_f32_32x32x16_bf16 v[192:207], a[192:195], v[96:99], v[192:207]
  v_exp_f32 v176, v176
  v_add_f32 v37, v37, v167
  v_cvt_pk_bf16_f32 v51, v166, v167
  v_mfma_f32_32x32x16_bf16 v[208:223], a[192:195], v[104:107], v[208:223]
  ds_read_b128 a[212:215], v34 offset:24832
  v_exp_f32 v177, v177
  v_add_f32 v38, v38, v176
  s_waitcnt lgkmcnt(4)
  v_mfma_f32_32x32x16_bf16 v[192:207], a[196:199], v[100:103], v[192:207]
  v_exp_f32 v178, v178
  v_add_f32 v38, v38, v177
  v_cvt_pk_bf16_f32 v52, v176, v177
  v_mfma_f32_32x32x16_bf16 v[208:223], a[196:199], v[108:111], v[208:223]
  ds_read_b128 a[216:219], v35 offset:24832
  v_exp_f32 v179, v179
  v_add_f32 v38, v38, v178
  s_waitcnt lgkmcnt(4)
  v_mfma_f32_32x32x16_bf16 v[192:207], a[200:203], v[112:115], v[192:207]
  v_exp_f32 v180, v180
  v_add_f32 v38, v38, v179
  v_cvt_pk_bf16_f32 v53, v178, v179
  v_mfma_f32_32x32x16_bf16 v[208:223], a[200:203], v[120:123], v[208:223]
  ds_read_b128 a[220:223], v36 offset:24832
  v_exp_f32 v181, v181
  v_add_f32 v38, v38, v180
  s_waitcnt lgkmcnt(4)
  v_mfma_f32_32x32x16_bf16 v[192:207], a[204:207], v[116:119], v[192:207]
  v_exp_f32 v182, v182
  v_add_f32 v38, v38, v181
  v_mfma_f32_32x32x16_bf16 v[208:223], a[204:207], v[124:127], v[208:223]
  ds_read_b64_tr_b16 a[192:193], v19 offset:0
  ds_read_b64_tr_b16 a[194:195], v19 offset:3072
  v_cvt_pk_bf16_f32 v54, v180, v181
  v_exp_f32 v183, v183
  v_add_f32 v38, v38, v182
  s_waitcnt lgkmcnt(5)
  v_mfma_f32_32x32x16_bf16 v[192:207], a[208:211], v[128:131], v[192:207]
  v_add_f32 v38, v38, v183
  v_cvt_pk_bf16_f32 v55, v182, v183
  v_mfma_f32_32x32x16_bf16 v[208:223], a[208:211], v[136:139], v[208:223]
  ds_read_b64_tr_b16 a[196:197], v20 offset:0
  ds_read_b64_tr_b16 a[198:199], v20 offset:3072
  v_exp_f32 v168, v168
  v_exp_f32 v169, v169
  s_waitcnt lgkmcnt(6)
  v_mfma_f32_32x32x16_bf16 v[192:207], a[212:215], v[132:135], v[192:207]
  v_add_f32 v37, v37, v168
  v_exp_f32 v170, v170
  v_add_f32 v37, v37, v169
  v_mfma_f32_32x32x16_bf16 v[208:223], a[212:215], v[140:143], v[208:223]
  ds_read_b64_tr_b16 a[200:201], v19 offset:128
  ds_read_b64_tr_b16 a[202:203], v19 offset:3200
  v_cvt_pk_bf16_f32 v56, v168, v169
  v_exp_f32 v171, v171
  s_waitcnt lgkmcnt(7)
  v_mfma_f32_32x32x16_bf16 v[192:207], a[216:219], v[144:147], v[192:207]
  v_add_f32 v37, v37, v170
  v_exp_f32 v172, v172
  v_mfma_f32_32x32x16_bf16 v[208:223], a[216:219], v[152:155], v[208:223]
  ds_read_b64_tr_b16 a[204:205], v20 offset:128
  ds_read_b64_tr_b16 a[206:207], v20 offset:3200
  v_add_f32 v37, v37, v171
  v_cvt_pk_bf16_f32 v57, v170, v171
  v_exp_f32 v173, v173
  s_waitcnt lgkmcnt(8)
  v_mfma_f32_32x32x16_bf16 v[192:207], a[220:223], v[148:151], v[192:207]
  v_add_f32 v37, v37, v172
  v_exp_f32 v174, v174
  v_mfma_f32_32x32x16_bf16 v[208:223], a[220:223], v[156:159], v[208:223]
  ds_read_b64_tr_b16 a[208:209], v19 offset:256
  ds_read_b64_tr_b16 a[210:211], v19 offset:3328
  s_waitcnt lgkmcnt(8)
  v_mfma_f32_32x32x16_bf16 a[0:15], a[192:195], v[48:51], a[0:15]
  v_add_f32 v37, v37, v173
  v_cvt_pk_bf16_f32 v58, v172, v173
  v_exp_f32 v175, v175
  v_mfma_f32_32x32x16_bf16 a[16:31], a[192:195], v[52:55], a[16:31]
  ds_read_b64_tr_b16 a[212:213], v20 offset:256
  ds_read_b64_tr_b16 a[214:215], v20 offset:3328
  v_add_f32 v37, v37, v174
  v_exp_f32 v184, v184
  s_waitcnt lgkmcnt(8)
  v_mfma_f32_32x32x16_bf16 a[32:47], a[196:199], v[48:51], a[32:47]
  v_add_f32 v37, v37, v175
  v_cvt_pk_bf16_f32 v59, v174, v175
  v_mfma_f32_32x32x16_bf16 a[48:63], a[196:199], v[52:55], a[48:63]
  ds_read_b64_tr_b16 a[216:217], v19 offset:6144
  ds_read_b64_tr_b16 a[218:219], v19 offset:9216
  v_exp_f32 v185, v185
  v_add_f32 v38, v38, v184
  s_waitcnt lgkmcnt(8)
  v_mfma_f32_32x32x16_bf16 a[64:79], a[200:203], v[48:51], a[64:79]
  v_exp_f32 v186, v186
  v_add_f32 v38, v38, v185
  v_cvt_pk_bf16_f32 v60, v184, v185
  v_mfma_f32_32x32x16_bf16 a[80:95], a[200:203], v[52:55], a[80:95]
  ds_read_b64_tr_b16 a[220:221], v20 offset:6144
  ds_read_b64_tr_b16 a[222:223], v20 offset:9216
  v_exp_f32 v187, v187
  v_add_f32 v38, v38, v186
  s_waitcnt lgkmcnt(8)
  v_mfma_f32_32x32x16_bf16 a[96:111], a[204:207], v[48:51], a[96:111]
  v_exp_f32 v188, v188
  v_add_f32 v38, v38, v187
  v_mfma_f32_32x32x16_bf16 a[112:127], a[204:207], v[52:55], a[112:127]
  ds_read_b64_tr_b16 a[192:193], v19 offset:6272
  ds_read_b64_tr_b16 a[194:195], v19 offset:9344
  v_cvt_pk_bf16_f32 v61, v186, v187
  v_exp_f32 v189, v189
  s_waitcnt lgkmcnt(8)
  v_mfma_f32_32x32x16_bf16 a[128:143], a[208:211], v[48:51], a[128:143]
  v_add_f32 v38, v38, v188
  v_exp_f32 v190, v190
  v_add_f32 v38, v38, v189
  v_mfma_f32_32x32x16_bf16 a[144:159], a[208:211], v[52:55], a[144:159]
  ds_read_b64_tr_b16 a[196:197], v20 offset:6272
  ds_read_b64_tr_b16 a[198:199], v20 offset:9344
  v_cvt_pk_bf16_f32 v62, v188, v189
  v_exp_f32 v191, v191
  s_waitcnt lgkmcnt(8)
  v_mfma_f32_32x32x16_bf16 a[160:175], a[212:215], v[48:51], a[160:175]
  v_add_f32 v38, v38, v190
  v_add_f32 v38, v38, v191
  v_cvt_pk_bf16_f32 v63, v190, v191
  v_mfma_f32_32x32x16_bf16 a[176:191], a[212:215], v[52:55], a[176:191]
  ds_read_b64_tr_b16 a[200:201], v19 offset:6400
  ds_read_b64_tr_b16 a[202:203], v19 offset:9472
  s_waitcnt lgkmcnt(8)
  v_mfma_f32_32x32x16_bf16 a[0:15], a[216:219], v[56:59], a[0:15]
  v_max3_f32 v39, v192, v193, v194
  v_mfma_f32_32x32x16_bf16 a[16:31], a[216:219], v[60:63], a[16:31]
  ds_read_b64_tr_b16 a[204:205], v20 offset:6400
  ds_read_b64_tr_b16 a[206:207], v20 offset:9472
  v_max3_f32 v40, v208, v209, v210
  v_max3_f32 v39, v39, v195, v196
  s_waitcnt lgkmcnt(8)
  v_mfma_f32_32x32x16_bf16 a[32:47], a[220:223], v[56:59], a[32:47]
  v_max3_f32 v40, v40, v211, v212
  s_mul_i32 s60, s2, 30720
  s_mul_i32 s61, s30, 7680
  s_add_u32 s60, s60, s61
  s_add_u32 s40, s12, s60
  s_addc_u32 s41, s13, 0
  s_mov_b32 s42, 7680
  s_mov_b32 s43, 0x20000
  v_mfma_f32_32x32x16_bf16 a[48:63], a[220:223], v[60:63], a[48:63]
  s_waitcnt vmcnt(22)
  s_barrier
  ds_read_b128 a[208:211], v25 offset:12288
  v_max3_f32 v39, v39, v197, v198
  v_max3_f32 v40, v40, v213, v214
  s_waitcnt lgkmcnt(7)
  v_mfma_f32_32x32x16_bf16 a[64:79], a[192:195], v[56:59], a[64:79]
  s_mov_b32 s67, 86016
  s_add_u32 m0, s68, 122880
  s_nop 0
  buffer_load_dwordx4 v10, s[52:55], s67 offen offset:0 lds
  v_max3_f32 v39, v39, v199, v200
  v_mfma_f32_32x32x16_bf16 a[80:95], a[192:195], v[60:63], a[80:95]
  ds_read_b128 a[212:215], v26 offset:12288
  buffer_load_dwordx4 v11, s[52:55], s67 offen offset:1024 lds
  v_max3_f32 v40, v40, v215, v216
  v_max3_f32 v39, v39, v201, v202
  v_lshlrev_b32 v47, 6, v1
  s_mov_b32 s66, 0
  buffer_load_dword a224, v47, s[40:43], s66 offen
  s_waitcnt lgkmcnt(6)
  v_mfma_f32_32x32x16_bf16 a[96:111], a[196:199], v[56:59], a[96:111]
  buffer_load_dwordx4 v12, s[52:55], s67 offen offset:2048 lds
  v_max3_f32 v40, v40, v217, v218
  v_mfma_f32_32x32x16_bf16 a[112:127], a[196:199], v[60:63], a[112:127]
  ds_read_b128 a[216:219], v27 offset:12288
  s_mov_b32 s67, 110592
  s_add_u32 m0, s68, 135168
  s_nop 0
  buffer_load_dwordx4 v7, s[48:51], s67 offen offset:0 lds
  v_max3_f32 v39, v39, v203, v204
  v_max3_f32 v40, v40, v219, v220
  s_waitcnt lgkmcnt(5)
  v_mfma_f32_32x32x16_bf16 a[128:143], a[200:203], v[56:59], a[128:143]
  buffer_load_dwordx4 v8, s[48:51], s67 offen offset:1024 lds
  v_max3_f32 v39, v39, v205, v206
  v_lshlrev_b32 v47, 6, v1
  s_mov_b32 s66, 4096
  buffer_load_dword a224, v47, s[40:43], s66 offen
  v_mfma_f32_32x32x16_bf16 a[144:159], a[200:203], v[60:63], a[144:159]
  ds_read_b128 a[220:223], v28 offset:12288
  buffer_load_dwordx4 v9, s[48:51], s67 offen offset:2048 lds
  v_max3_f32 v40, v40, v221, v222
  v_max_f32 v39, v39, v207
  s_waitcnt lgkmcnt(4)
  v_mfma_f32_32x32x16_bf16 a[160:175], a[204:207], v[56:59], a[160:175]
  v_max_f32 v40, v40, v223
  v_mfma_f32_32x32x16_bf16 a[176:191], a[204:207], v[60:63], a[176:191]
  ds_read_b128 a[192:195], v25 offset:12416
  v_max_f32 v41, v39, v40
  v_cmp_lt_f32 vcc, s72, v41
  s_cbranch_vccz L_ok2
  s_call_b64 s[70:71], L_rescale1
L_ok2:
  s_waitcnt lgkmcnt(4)
  v_mfma_f32_32x32x16_bf16 v[160:175], a[208:211], v[64:67], v[224:239]
  v_exp_f32 v192, v192
  v_exp_f32 v193, v193
  v_mfma_f32_32x32x16_bf16 v[176:191], a[208:211], v[72:75], v[240:255]
  ds_read_b128 a[196:199], v26 offset:12416
  v_add_f32 v37, v37, v192
  v_exp_f32 v194, v194
  s_waitcnt lgkmcnt(4)
  v_mfma_f32_32x32x16_bf16 v[160:175], a[212:215], v[68:71], v[160:175]
  v_add_f32 v37, v37, v193
  v_cvt_pk_bf16_f32 v48, v192, v193
  v_exp_f32 v195, v195
  v_mfma_f32_32x32x16_bf16 v[176:191], a[212:215], v[76:79], v[176:191]
  ds_read_b128 a[200:203], v27 offset:12416
  v_add_f32 v37, v37, v194
  v_exp_f32 v196, v196
  s_waitcnt lgkmcnt(4)
  v_mfma_f32_32x32x16_bf16 v[160:175], a[216:219], v[80:83], v[160:175]
  v_add_f32 v37, v37, v195
  v_cvt_pk_bf16_f32 v49, v194, v195
  v_mfma_f32_32x32x16_bf16 v[176:191], a[216:219], v[88:91], v[176:191]
  ds_read_b128 a[204:207], v28 offset:12416
  v_exp_f32 v197, v197
  v_add_f32 v37, v37, v196
  v_exp_f32 v198, v198
  s_waitcnt lgkmcnt(4)
  v_mfma_f32_32x32x16_bf16 v[160:175], a[220:223], v[84:87], v[160:175]
  v_add_f32 v37, v37, v197
  v_cvt_pk_bf16_f32 v50, v196, v197
  v_mfma_f32_32x32x16_bf16 v[176:191], a[220:223], v[92:95], v[176:191]
  ds_read_b128 a[208:211], v25 offset:12544
  v_exp_f32 v199, v199
  v_add_f32 v37, v37, v198
  s_waitcnt lgkmcnt(4)
  v_mfma_f32_32x32x16_bf16 v[160:175], a[192:195], v[96:99], v[160:175]
  v_exp_f32 v208, v208
  v_add_f32 v37, v37, v199
  v_cvt_pk_bf16_f32 v51, v198, v199
  v_mfma_f32_32x32x16_bf16 v[176:191], a[192:195], v[104:107], v[176:191]
  ds_read_b128 a[212:215], v26 offset:12544
  v_exp_f32 v209, v209
  v_add_f32 v38, v38, v208
  s_waitcnt lgkmcnt(4)
  v_mfma_f32_32x32x16_bf16 v[160:175], a[196:199], v[100:103], v[160:175]
  v_exp_f32 v210, v210
  v_add_f32 v38, v38, v209
  v_cvt_pk_bf16_f32 v52, v208, v209
  v_mfma_f32_32x32x16_bf16 v[176:191], a[196:199], v[108:111], v[176:191]
  ds_read_b128 a[216:219], v27 offset:12544
  v_exp_f32 v211, v211
  v_add_f32 v38, v38, v210
  s_waitcnt lgkmcnt(4)
  v_mfma_f32_32x32x16_bf16 v[160:175], a[200:203], v[112:115], v[160:175]
  v_exp_f32 v212, v212
  v_add_f32 v38, v38, v211
  v_cvt_pk_bf16_f32 v53, v210, v211
  v_mfma_f32_32x32x16_bf16 v[176:191], a[200:203], v[120:123], v[176:191]
  ds_read_b128 a[220:223], v28 offset:12544
  v_exp_f32 v213, v213
  v_add_f32 v38, v38, v212
  s_waitcnt lgkmcnt(4)
  v_mfma_f32_32x32x16_bf16 v[160:175], a[204:207], v[116:119], v[160:175]
  v_exp_f32 v214, v214
  v_add_f32 v38, v38, v213
  v_mfma_f32_32x32x16_bf16 v[176:191], a[204:207], v[124:127], v[176:191]
  ds_read_b64_tr_b16 a[192:193], v19 offset:24576
  ds_read_b64_tr_b16 a[194:195], v19 offset:27648
  v_cvt_pk_bf16_f32 v54, v212, v213
  v_exp_f32 v215, v215
  v_add_f32 v38, v38, v214
  s_waitcnt lgkmcnt(5)
  v_mfma_f32_32x32x16_bf16 v[160:175], a[208:211], v[128:131], v[160:175]
  v_add_f32 v38, v38, v215
  v_cvt_pk_bf16_f32 v55, v214, v215
  v_mfma_f32_32x32x16_bf16 v[176:191], a[208:211], v[136:139], v[176:191]
  ds_read_b64_tr_b16 a[196:197], v20 offset:24576
  ds_read_b64_tr_b16 a[198:199], v20 offset:27648
  v_exp_f32 v200, v200
  v_exp_f32 v201, v201
  s_waitcnt lgkmcnt(6)
  v_mfma_f32_32x32x16_bf16 v[160:175], a[212:215], v[132:135], v[160:175]
  v_add_f32 v37, v37, v200
  v_exp_f32 v202, v202
  v_add_f32 v37, v37, v201
  v_mfma_f32_32x32x16_bf16 v[176:191], a[212:215], v[140:143], v[176:191]
  ds_read_b64_tr_b16 a[200:201], v19 offset:24704
  ds_read_b64_tr_b16 a[202:203], v19 offset:27776
  v_cvt_pk_bf16_f32 v56, v200, v201
  v_exp_f32 v203, v203
  s_waitcnt lgkmcnt(7)
  v_mfma_f32_32x32x16_bf16 v[160:175], a[216:219], v[144:147], v[160:175]
  v_add_f32 v37, v37, v202
  v_exp_f32 v204, v204
  v_mfma_f32_32x32x16_bf16 v[176:191], a[216:219], v[152:155], v[176:191]
  ds_read_b64_tr_b16 a[204:205], v20 offset:24704
  ds_read_b64_tr_b16 a[206:207], v20 offset:27776
  v_add_f32 v37, v37, v203
  v_cvt_pk_bf16_f32 v57, v202, v203
  v_exp_f32 v205, v205
  s_waitcnt lgkmcnt(8)
  v_mfma_f32_32x32x16_bf16 v[160:175], a[220:223], v[148:151], v[160:175]
  v_add_f32 v37, v37, v204
  v_exp_f32 v206, v206
  v_mfma_f32_32x32x16_bf16 v[176:191], a[220:223], v[156:159], v[176:191]
  ds_read_b64_tr_b16 a[208:209], v19 offset:24832
  ds_read_b64_tr_b16 a[210:211], v19 offset:27904
  s_waitcnt lgkmcnt(8)
  v_mfma_f32_32x32x16_bf16 a[0:15], a[192:195], v[48:51], a[0:15]
  v_add_f32 v37, v37, v205
  v_cvt_pk_bf16_f32 v58, v204, v205
  v_exp_f32 v207, v207
  v_mfma_f32_32x32x16_bf16 a[16:31], a[192:195], v[52:55], a[16:31]
  ds_read_b64_tr_b16 a[212:213], v20 offset:24832
  ds_read_b64_tr_b16 a[214:215], v20 offset:27904
  v_add_f32 v37, v37, v206
  v_exp_f32 v216, v216
  s_waitcnt lgkmcnt(8)
  v_mfma_f32_32x32x16_bf16 a[32:47], a[196:199], v[48:51], a[32:47]
  v_add_f32 v37, v37, v207
  v_cvt_pk_bf16_f32 v59, v206, v207
  v_mfma_f32_32x32x16_bf16 a[48:63], a[196:199], v[52:55], a[48:63]
  ds_read_b64_tr_b16 a[216:217], v19 offset:30720
  ds_read_b64_tr_b16 a[218:219], v19 offset:33792
  v_exp_f32 v217, v217
  v_add_f32 v38, v38, v216
  s_waitcnt lgkmcnt(8)
  v_mfma_f32_32x32x16_bf16 a[64:79], a[200:203], v[48:51], a[64:79]
  v_exp_f32 v218, v218
  v_add_f32 v38, v38, v217
  v_cvt_pk_bf16_f32 v60, v216, v217
  v_mfma_f32_32x32x16_bf16 a[80:95], a[200:203], v[52:55], a[80:95]
  ds_read_b64_tr_b16 a[220:221], v20 offset:30720
  ds_read_b64_tr_b16 a[222:223], v20 offset:33792
  v_exp_f32 v219, v219
  v_add_f32 v38, v38, v218
  s_waitcnt lgkmcnt(8)
  v_mfma_f32_32x32x16_bf16 a[96:111], a[204:207], v[48:51], a[96:111]
  v_exp_f32 v220, v220
  v_add_f32 v38, v38, v219
  v_mfma_f32_32x32x16_bf16 a[112:127], a[204:207], v[52:55], a[112:127]
  ds_read_b64_tr_b16 a[192:193], v19 offset:30848
  ds_read_b64_tr_b16 a[194:195], v19 offset:33920
  v_cvt_pk_bf16_f32 v61, v218, v219
  v_exp_f32 v221, v221
  s_waitcnt lgkmcnt(8)
  v_mfma_f32_32x32x16_bf16 a[128:143], a[208:211], v[48:51], a[128:143]
  v_add_f32 v38, v38, v220
  v_exp_f32 v222, v222
  v_add_f32 v38, v38, v221
  v_mfma_f32_32x32x16_bf16 a[144:159], a[208:211], v[52:55], a[144:159]
  ds_read_b64_tr_b16 a[196:197], v20 offset:30848
  ds_read_b64_tr_b16 a[198:199], v20 offset:33920
  v_cvt_pk_bf16_f32 v62, v220, v221
  v_exp_f32 v223, v223
  s_waitcnt lgkmcnt(8)
  v_mfma_f32_32x32x16_bf16 a[160:175], a[212:215], v[48:51], a[160:175]
  v_add_f32 v38, v38, v222
  v_add_f32 v38, v38, v223
  v_cvt_pk_bf16_f32 v63, v222, v223
  v_mfma_f32_32x32x16_bf16 a[176:191], a[212:215], v[52:55], a[176:191]
  ds_read_b64_tr_b16 a[200:201], v19 offset:30976
  ds_read_b64_tr_b16 a[202:203], v19 offset:34048
  s_waitcnt lgkmcnt(8)
  v_mfma_f32_32x32x16_bf16 a[0:15], a[216:219], v[56:59], a[0:15]
  v_max3_f32 v39, v160, v161, v162
  v_mfma_f32_32x32x16_bf16 a[16:31], a[216:219], v[60:63], a[16:31]
  ds_read_b64_tr_b16 a[204:205], v20 offset:30976
  ds_read_b64_tr_b16 a[206:207], v20 offset:34048
  v_max3_f32 v40, v176, v177, v178
  v_max3_f32 v39, v39, v163, v164
  s_waitcnt lgkmcnt(8)
  v_mfma_f32_32x32x16_bf16 a[32:47], a[220:223], v[56:59], a[32:47]
  v_max3_f32 v40, v40, v179, v180
  s_mul_i32 s60, s2, 7680
  s_cmp_eq_u32 s30, 0
  s_cselect_b32 s61, 7680, 0
  s_add_u32 s40, s16, s60
  s_addc_u32 s41, s17, 0
  s_mov_b32 s42, s61
  s_mov_b32 s43, 0x20000
  v_mfma_f32_32x32x16_bf16 a[48:63], a[220:223], v[60:63], a[48:63]
  s_waitcnt vmcnt(23)
  s_barrier
  ds_read_b128 a[208:211], v25 offset:36864
  v_max3_f32 v39, v39, v165, v166
  v_max3_f32 v40, v40, v181, v182
  s_waitcnt lgkmcnt(7)
  v_mfma_f32_32x32x16_bf16 a[64:79], a[192:195], v[56:59], a[64:79]
  s_mov_b32 s67, 98304
  s_add_u32 m0, s68, 147456
  s_nop 0
  buffer_load_dwordx4 v10, s[52:55], s67 offen offset:0 lds
  v_max3_f32 v39, v39, v167, v168
  v_mfma_f32_32x32x16_bf16 a[80:95], a[192:195], v[60:63], a[80:95]
  ds_read_b128 a[212:215], v26 offset:36864
  buffer_load_dwordx4 v11, s[52:55], s67 offen offset:1024 lds
  v_max3_f32 v40, v40, v183, v184
  v_max3_f32 v39, v39, v169, v170
  v_lshlrev_b32 v47, 6, v1
  s_mov_b32 s66, 0
  buffer_load_dword a224, v47, s[40:43], s66 offen
  s_waitcnt lgkmcnt(6)
  s_getpc_b64 s[96:97]
  s_add_u32 s96, s96, 1024
  s_addc_u32 s97, s97, 0
  v_lshlrev_b32 v46, 6, v0
  v_mov_b32 v47, 0
  v_lshl_add_u64 v[46:47], v[46:47], 0, s[96:97]
  global_load_dword a225, v[46:47], off
  v_mfma_f32_32x32x16_bf16 a[96:111], a[196:199], v[56:59], a[96:111]
  buffer_load_dwordx4 v12, s[52:55], s67 offen offset:2048 lds
  v_max3_f32 v40, v40, v185, v186
  v_mfma_f32_32x32x16_bf16 a[112:127], a[196:199], v[60:63], a[112:127]
  ds_read_b128 a[216:219], v27 offset:36864
  s_mov_b32 s67, 122880
  s_add_u32 m0, s68, 0
  s_nop 0
  buffer_load_dwordx4 v7, s[48:51], s67 offen offset:0 lds
  v_max3_f32 v39, v39, v171, v172
  v_max3_f32 v40, v40, v187, v188
  s_waitcnt lgkmcnt(5)
  v_mfma_f32_32x32x16_bf16 a[128:143], a[200:203], v[56:59], a[128:143]
  buffer_load_dwordx4 v8, s[48:51], s67 offen offset:1024 lds
  v_max3_f32 v39, v39, v173, v174
  v_lshlrev_b32 v47, 6, v1
  s_mov_b32 s66, 4096
  buffer_load_dword a224, v47, s[40:43], s66 offen
  v_mfma_f32_32x32x16_bf16 a[144:159], a[200:203], v[60:63], a[144:159]
  ds_read_b128 a[220:223], v28 offset:36864
  buffer_load_dwordx4 v9, s[48:51], s67 offen offset:2048 lds
  v_max3_f32 v40, v40, v189, v190
  v_max_f32 v39, v39, v175
  s_waitcnt lgkmcnt(4)
  v_mfma_f32_32x32x16_bf16 a[160:175], a[204:207], v[56:59], a[160:175]
  v_max_f32 v40, v40, v191
  v_mfma_f32_32x32x16_bf16 a[176:191], a[204:207], v[60:63], a[176:191]
  ds_read_b128 a[192:195], v25 offset:36992
  v_max_f32 v41, v39, v40
  v_cmp_lt_f32 vcc, s72, v41
  s_cbranch_vccz L_ok3
  s_call_b64 s[70:71], L_rescale0
L_ok3:
  s_waitcnt lgkmcnt(4)
  v_mfma_f32_32x32x16_bf16 v[192:207], a[208:211], v[64:67], v[224:239]
  v_exp_f32 v160, v160
  v_exp_f32 v161, v161
  v_mfma_f32_32x32x16_bf16 v[208:223], a[208:211], v[72:75], v[240:255]
  ds_read_b128 a[196:199], v26 offset:36992
  v_add_f32 v37, v37, v160
  v_exp_f32 v162, v162
  s_waitcnt lgkmcnt(4)
  v_mfma_f32_32x32x16_bf16 v[192:207], a[212:215], v[68:71], v[192:207]
  v_add_f32 v37, v37, v161
  v_cvt_pk_bf16_f32 v48, v160, v161
  v_exp_f32 v163, v163
  v_mfma_f32_32x32x16_bf16 v[208:223], a[212:215], v[76:79], v[208:223]
  ds_read_b128 a[200:203], v27 offset:36992
  v_add_f32 v37, v37, v162
  v_exp_f32 v164, v164
  s_waitcnt lgkmcnt(4)
  v_mfma_f32_32x32x16_bf16 v[192:207], a[216:219], v[80:83], v[192:207]
  v_add_f32 v37, v37, v163
  v_cvt_pk_bf16_f32 v49, v162, v163
  v_mfma_f32_32x32x16_bf16 v[208:223], a[216:219], v[88:91], v[208:223]
  ds_read_b128 a[204:207], v28 offset:36992
  v_exp_f32 v165, v165
  v_add_f32 v37, v37, v164
  v_exp_f32 v166, v166
  s_waitcnt lgkmcnt(4)
  v_mfma_f32_32x32x16_bf16 v[192:207], a[220:223], v[84:87], v[192:207]
  v_add_f32 v37, v37, v165
  v_cvt_pk_bf16_f32 v50, v164, v165
  v_mfma_f32_32x32x16_bf16 v[208:223], a[220:223], v[92:95], v[208:223]
  ds_read_b128 a[208:211], v25 offset:37120
  v_exp_f32 v167, v167
  v_add_f32 v37, v37, v166
  s_waitcnt lgkmcnt(4)
  v_mfma_f32_32x32x16_bf16 v[192:207], a[192:195], v[96:99], v[192:207]
  v_exp_f32 v176, v176
  v_add_f32 v37, v37, v167
  v_cvt_pk_bf16_f32 v51, v166, v167
  v_mfma_f32_32x32x16_bf16 v[208:223], a[192:195], v[104:107], v[208:223]
  ds_read_b128 a[212:215], v26 offset:37120
  v_exp_f32 v177, v177
  v_add_f32 v38, v38, v176
  s_waitcnt lgkmcnt(4)
  v_mfma_f32_32x32x16_bf16 v[192:207], a[196:199], v[100:103], v[192:207]
  v_exp_f32 v178, v178
  v_add_f32 v38, v38, v177
  v_cvt_pk_bf16_f32 v52, v176, v177
  v_mfma_f32_32x32x16_bf16 v[208:223], a[196:199], v[108:111], v[208:223]
  ds_read_b128 a[216:219], v27 offset:37120
  v_exp_f32 v179, v179
  v_add_f32 v38, v38, v178
  s_waitcnt lgkmcnt(4)
  v_mfma_f32_32x32x16_bf16 v[192:207], a[200:203], v[112:115], v[192:207]
  v_exp_f32 v180, v180
  v_add_f32 v38, v38, v179
  v_cvt_pk_bf16_f32 v53, v178, v179
  v_mfma_f32_32x32x16_bf16 v[208:223], a[200:203], v[120:123], v[208:223]
  ds_read_b128 a[220:223], v28 offset:37120
  v_exp_f32 v181, v181
  v_add_f32 v38, v38, v180
  s_waitcnt lgkmcnt(4)
  v_mfma_f32_32x32x16_bf16 v[192:207], a[204:207], v[116:119], v[192:207]
  v_exp_f32 v182, v182
  v_add_f32 v38, v38, v181
  v_mfma_f32_32x32x16_bf16 v[208:223], a[204:207], v[124:127], v[208:223]
  ds_read_b64_tr_b16 a[192:193], v19 offset:49152
  ds_read_b64_tr_b16 a[194:195], v19 offset:52224
  v_cvt_pk_bf16_f32 v54, v180, v181
  v_exp_f32 v183, v183
  v_add_f32 v38, v38, v182
  s_waitcnt lgkmcnt(5)
  v_mfma_f32_32x32x16_bf16 v[192:207], a[208:211], v[128:131], v[192:207]
  v_add_f32 v38, v38, v183
  v_cvt_pk_bf16_f32 v55, v182, v183
  v_mfma_f32_32x32x16_bf16 v[208:223], a[208:211], v[136:139], v[208:223]
  ds_read_b64_tr_b16 a[196:197], v20 offset:49152
  ds_read_b64_tr_b16 a[198:199], v20 offset:52224
  v_exp_f32 v168, v168
  v_exp_f32 v169, v169
  s_waitcnt lgkmcnt(6)
  v_mfma_f32_32x32x16_bf16 v[192:207], a[212:215], v[132:135], v[192:207]
  v_add_f32 v37, v37, v168
  v_exp_f32 v170, v170
  v_add_f32 v37, v37, v169
  v_mfma_f32_32x32x16_bf16 v[208:223], a[212:215], v[140:143], v[208:223]
  ds_read_b64_tr_b16 a[200:201], v19 offset:49280
  ds_read_b64_tr_b16 a[202:203], v19 offset:52352
  v_cvt_pk_bf16_f32 v56, v168, v169
  v_exp_f32 v171, v171
  s_waitcnt lgkmcnt(7)
  v_mfma_f32_32x32x16_bf16 v[192:207], a[216:219], v[144:147], v[192:207]
  v_add_f32 v37, v37, v170
  v_exp_f32 v172, v172
  v_mfma_f32_32x32x16_bf16 v[208:223], a[216:219], v[152:155], v[208:223]
  ds_read_b64_tr_b16 a[204:205], v20 offset:49280
  ds_read_b64_tr_b16 a[206:207], v20 offset:52352
  v_add_f32 v37, v37, v171
  v_cvt_pk_bf16_f32 v57, v170, v171
  v_exp_f32 v173, v173
  s_waitcnt lgkmcnt(8)
  v_mfma_f32_32x32x16_bf16 v[192:207], a[220:223], v[148:151], v[192:207]
  v_add_f32 v37, v37, v172
  v_exp_f32 v174, v174
  v_mfma_f32_32x32x16_bf16 v[208:223], a[220:223], v[156:159], v[208:223]
  ds_read_b64_tr_b16 a[208:209], v19 offset:49408
  ds_read_b64_tr_b16 a[210:211], v19 offset:52480
  s_waitcnt lgkmcnt(8)
  v_mfma_f32_32x32x16_bf16 a[0:15], a[192:195], v[48:51], a[0:15]
  v_add_f32 v37, v37, v173
  v_cvt_pk_bf16_f32 v58, v172, v173
  v_exp_f32 v175, v175
  v_mfma_f32_32x32x16_bf16 a[16:31], a[192:195], v[52:55], a[16:31]
  ds_read_b64_tr_b16 a[212:213], v20 offset:49408
  ds_read_b64_tr_b16 a[214:215], v20 offset:52480
  v_add_f32 v37, v37, v174
  v_exp_f32 v184, v184
  s_waitcnt lgkmcnt(8)
  v_mfma_f32_32x32x16_bf16 a[32:47], a[196:199], v[48:51], a[32:47]
  v_add_f32 v37, v37, v175
  v_cvt_pk_bf16_f32 v59, v174, v175
  v_mfma_f32_32x32x16_bf16 a[48:63], a[196:199], v[52:55], a[48:63]
  ds_read_b64_tr_b16 a[216:217], v19 offset:55296
  ds_read_b64_tr_b16 a[218:219], v19 offset:58368
  v_exp_f32 v185, v185
  v_add_f32 v38, v38, v184
  s_waitcnt lgkmcnt(8)
  v_mfma_f32_32x32x16_bf16 a[64:79], a[200:203], v[48:51], a[64:79]
  v_exp_f32 v186, v186
  v_add_f32 v38, v38, v185
  v_cvt_pk_bf16_f32 v60, v184, v185
  v_mfma_f32_32x32x16_bf16 a[80:95], a[200:203], v[52:55], a[80:95]
  ds_read_b64_tr_b16 a[220:221], v20 offset:55296
  ds_read_b64_tr_b16 a[222:223], v20 offset:58368
  v_exp_f32 v187, v187
  v_add_f32 v38, v38, v186
  s_waitcnt lgkmcnt(8)
  v_mfma_f32_32x32x16_bf16 a[96:111], a[204:207], v[48:51], a[96:111]
  v_exp_f32 v188, v188
  v_add_f32 v38, v38, v187
  v_mfma_f32_32x32x16_bf16 a[112:127], a[204:207], v[52:55], a[112:127]
  ds_read_b64_tr_b16 a[192:193], v19 offset:55424
  ds_read_b64_tr_b16 a[194:195], v19 offset:58496
  v_cvt_pk_bf16_f32 v61, v186, v187
  v_exp_f32 v189, v189
  s_waitcnt lgkmcnt(8)
  v_mfma_f32_32x32x16_bf16 a[128:143], a[208:211], v[48:51], a[128:143]
  v_add_f32 v38, v38, v188
  v_exp_f32 v190, v190
  v_add_f32 v38, v38, v189
  v_mfma_f32_32x32x16_bf16 a[144:159], a[208:211], v[52:55], a[144:159]
  ds_read_b64_tr_b16 a[196:197], v20 offset:55424
  ds_read_b64_tr_b16 a[198:199], v20 offset:58496
  v_cvt_pk_bf16_f32 v62, v188, v189
  v_exp_f32 v191, v191
  s_waitcnt lgkmcnt(8)
  v_mfma_f32_32x32x16_bf16 a[160:175], a[212:215], v[48:51], a[160:175]
  v_add_f32 v38, v38, v190
  v_add_f32 v38, v38, v191
  v_cvt_pk_bf16_f32 v63, v190, v191
  v_mfma_f32_32x32x16_bf16 a[176:191], a[212:215], v[52:55], a[176:191]
  ds_read_b64_tr_b16 a[200:201], v19 offset:55552
  ds_read_b64_tr_b16 a[202:203], v19 offset:58624
  s_waitcnt lgkmcnt(8)
  v_mfma_f32_32x32x16_bf16 a[0:15], a[216:219], v[56:59], a[0:15]
  v_max3_f32 v39, v192, v193, v194
  v_mfma_f32_32x32x16_bf16 a[16:31], a[216:219], v[60:63], a[16:31]
  ds_read_b64_tr_b16 a[204:205], v20 offset:55552
  ds_read_b64_tr_b16 a[206:207], v20 offset:58624
  v_max3_f32 v40, v208, v209, v210
  v_max3_f32 v39, v39, v195, v196
  s_waitcnt lgkmcnt(8)
  v_mfma_f32_32x32x16_bf16 a[32:47], a[220:223], v[56:59], a[32:47]
  v_max3_f32 v40, v40, v211, v212
  s_mul_i32 s60, s2, 7680
  s_cmp_eq_u32 s30, 1
  s_cselect_b32 s61, 7680, 0
  s_add_u32 s40, s18, s60
  s_addc_u32 s41, s19, 0
  s_mov_b32 s42, s61
  s_mov_b32 s43, 0x20000
  v_mfma_f32_32x32x16_bf16 a[48:63], a[220:223], v[60:63], a[48:63]
  s_waitcnt vmcnt(26)
  s_barrier
  ds_read_b128 a[208:211], v29 offset:0
  v_max3_f32 v39, v39, v197, v198
  v_max3_f32 v40, v40, v213, v214
  s_waitcnt lgkmcnt(7)
  v_mfma_f32_32x32x16_bf16 a[64:79], a[192:195], v[56:59], a[64:79]
  s_mov_b32 s67, 110592
  s_add_u32 m0, s68, 12288
  s_nop 0
  buffer_load_dwordx4 v10, s[52:55], s67 offen offset:0 lds
  v_max3_f32 v39, v39, v199, v200
  v_mfma_f32_32x32x16_bf16 a[80:95], a[192:195], v[60:63], a[80:95]
  ds_read_b128 a[212:215], v30 offset:0
  buffer_load_dwordx4 v11, s[52:55], s67 offen offset:1024 lds
  v_max3_f32 v40, v40, v215, v216
  v_max3_f32 v39, v39, v201, v202
  v_lshlrev_b32 v47, 6, v1
  s_mov_b32 s66, 0
  buffer_load_dword a224, v47, s[40:43], s66 offen
  s_waitcnt lgkmcnt(6)
  v_mfma_f32_32x32x16_bf16 a[96:111], a[196:199], v[56:59], a[96:111]
  buffer_load_dwordx4 v12, s[52:55], s67 offen offset:2048 lds
  v_max3_f32 v40, v40, v217, v218
  v_mfma_f32_32x32x16_bf16 a[112:127], a[196:199], v[60:63], a[112:127]
  ds_read_b128 a[216:219], v31 offset:0
  s_mov_b32 s67, 135168
  s_add_u32 m0, s68, 24576
  s_nop 0
  buffer_load_dwordx4 v7, s[48:51], s67 offen offset:0 lds
  v_max3_f32 v39, v39, v203, v204
  v_max3_f32 v40, v40, v219, v220
  s_waitcnt lgkmcnt(5)
  v_mfma_f32_32x32x16_bf16 a[128:143], a[200:203], v[56:59], a[128:143]
  buffer_load_dwordx4 v8, s[48:51], s67 offen offset:1024 lds
  v_max3_f32 v39, v39, v205, v206
  v_lshlrev_b32 v47, 6, v1
  s_mov_b32 s66, 4096
  buffer_load_dword a224, v47, s[40:43], s66 offen
  v_mfma_f32_32x32x16_bf16 a[144:159], a[200:203], v[60:63], a[144:159]
  ds_read_b128 a[220:223], v32 offset:0
  buffer_load_dwordx4 v9, s[48:51], s67 offen offset:2048 lds
  v_max3_f32 v40, v40, v221, v222
  v_max_f32 v39, v39, v207
  s_waitcnt lgkmcnt(4)
  v_mfma_f32_32x32x16_bf16 a[160:175], a[204:207], v[56:59], a[160:175]
  v_max_f32 v40, v40, v223
  v_mfma_f32_32x32x16_bf16 a[176:191], a[204:207], v[60:63], a[176:191]
  ds_read_b128 a[192:195], v29 offset:128
  v_max_f32 v41, v39, v40
  v_cmp_lt_f32 vcc, s72, v41
  s_cbranch_vccz L_ok4
  s_call_b64 s[70:71], L_rescale1
L_ok4:
  s_waitcnt lgkmcnt(4)
  v_mfma_f32_32x32x16_bf16 v[160:175], a[208:211], v[64:67], v[224:239]
  v_exp_f32 v192, v192
  v_exp_f32 v193, v193
  v_mfma_f32_32x32x16_bf16 v[176:191], a[208:211], v[72:75], v[240:255]
  ds_read_b128 a[196:199], v30 offset:128
  v_add_f32 v37, v37, v192
  v_exp_f32 v194, v194
  s_waitcnt lgkmcnt(4)
  v_mfma_f32_32x32x16_bf16 v[160:175], a[212:215], v[68:71], v[160:175]
  v_add_f32 v37, v37, v193
  v_cvt_pk_bf16_f32 v48, v192, v193
  v_exp_f32 v195, v195
  v_mfma_f32_32x32x16_bf16 v[176:191], a[212:215], v[76:79], v[176:191]
  ds_read_b128 a[200:203], v31 offset:128
  v_add_f32 v37, v37, v194
  v_exp_f32 v196, v196
  s_waitcnt lgkmcnt(4)
  v_mfma_f32_32x32x16_bf16 v[160:175], a[216:219], v[80:83], v[160:175]
  v_add_f32 v37, v37, v195
  v_cvt_pk_bf16_f32 v49, v194, v195
  v_mfma_f32_32x32x16_bf16 v[176:191], a[216:219], v[88:91], v[176:191]
  ds_read_b128 a[204:207], v32 offset:128
  v_exp_f32 v197, v197
  v_add_f32 v37, v37, v196
  v_exp_f32 v198, v198
  s_waitcnt lgkmcnt(4)
  v_mfma_f32_32x32x16_bf16 v[160:175], a[220:223], v[84:87], v[160:175]
  v_add_f32 v37, v37, v197
  v_cvt_pk_bf16_f32 v50, v196, v197
  v_mfma_f32_32x32x16_bf16 v[176:191], a[220:223], v[92:95], v[176:191]
  ds_read_b128 a[208:211], v29 offset:256
  v_exp_f32 v199, v199
  v_add_f32 v37, v37, v198
  s_waitcnt lgkmcnt(4)
  v_mfma_f32_32x32x16_bf16 v[160:175], a[192:195], v[96:99], v[160:175]
  v_exp_f32 v208, v208
  v_add_f32 v37, v37, v199
  v_cvt_pk_bf16_f32 v51, v198, v199
  v_mfma_f32_32x32x16_bf16 v[176:191], a[192:195], v[104:107], v[176:191]
  ds_read_b128 a[212:215], v30 offset:256
  v_exp_f32 v209, v209
  v_add_f32 v38, v38, v208
  s_waitcnt lgkmcnt(4)
  v_mfma_f32_32x32x16_bf16 v[160:175], a[196:199], v[100:103], v[160:175]
  v_exp_f32 v210, v210
  v_add_f32 v38, v38, v209
  v_cvt_pk_bf16_f32 v52, v208, v209
  v_mfma_f32_32x32x16_bf16 v[176:191], a[196:199], v[108:111], v[176:191]
  ds_read_b128 a[216:219], v31 offset:256
  v_exp_f32 v211, v211
  v_add_f32 v38, v38, v210
  s_waitcnt lgkmcnt(4)
  v_mfma_f32_32x32x16_bf16 v[160:175], a[200:203], v[112:115], v[160:175]
  v_exp_f32 v212, v212
  v_add_f32 v38, v38, v211
  v_cvt_pk_bf16_f32 v53, v210, v211
  v_mfma_f32_32x32x16_bf16 v[176:191], a[200:203], v[120:123], v[176:191]
  ds_read_b128 a[220:223], v32 offset:256
  v_exp_f32 v213, v213
  v_add_f32 v38, v38, v212
  s_waitcnt lgkmcnt(4)
  v_mfma_f32_32x32x16_bf16 v[160:175], a[204:207], v[116:119], v[160:175]
  v_exp_f32 v214, v214
  v_add_f32 v38, v38, v213
  v_mfma_f32_32x32x16_bf16 v[176:191], a[204:207], v[124:127], v[176:191]
  ds_read_b64_tr_b16 a[192:193], v21 offset:12288
  ds_read_b64_tr_b16 a[194:195], v21 offset:15360
  v_cvt_pk_bf16_f32 v54, v212, v213
  v_exp_f32 v215, v215
  v_add_f32 v38, v38, v214
  s_waitcnt lgkmcnt(5)
  v_mfma_f32_32x32x16_bf16 v[160:175], a[208:211], v[128:131], v[160:175]
  v_add_f32 v38, v38, v215
  v_cvt_pk_bf16_f32 v55, v214, v215
  v_mfma_f32_32x32x16_bf16 v[176:191], a[208:211], v[136:139], v[176:191]
  ds_read_b64_tr_b16 a[196:197], v22 offset:12288
  ds_read_b64_tr_b16 a[198:199], v22 offset:15360
  v_exp_f32 v200, v200
  v_exp_f32 v201, v201
  s_waitcnt lgkmcnt(6)
  v_mfma_f32_32x32x16_bf16 v[160:175], a[212:215], v[132:135], v[160:175]
  v_add_f32 v37, v37, v200
  v_exp_f32 v202, v202
  v_add_f32 v37, v37, v201
  v_mfma_f32_32x32x16_bf16 v[176:191], a[212:215], v[140:143], v[176:191]
  ds_read_b64_tr_b16 a[200:201], v21 offset:12416
  ds_read_b64_tr_b16 a[202:203], v21 offset:15488
  v_cvt_pk_bf16_f32 v56, v200, v201
  v_exp_f32 v203, v203
  s_waitcnt lgkmcnt(7)
  v_mfma_f32_32x32x16_bf16 v[160:175], a[216:219], v[144:147], v[160:175]
  v_add_f32 v37, v37, v202
  v_exp_f32 v204, v204
  v_mfma_f32_32x32x16_bf16 v[176:191], a[216:219], v[152:155], v[176:191]
  ds_read_b64_tr_b16 a[204:205], v22 offset:12416
  ds_read_b64_tr_b16 a[206:207], v22 offset:15488
  v_add_f32 v37, v37, v203
  v_cvt_pk_bf16_f32 v57, v202, v203
  v_exp_f32 v205, v205
  s_waitcnt lgkmcnt(8)
  v_mfma_f32_32x32x16_bf16 v[160:175], a[220:223], v[148:151], v[160:175]
  v_add_f32 v37, v37, v204
  v_exp_f32 v206, v206
  v_mfma_f32_32x32x16_bf16 v[176:191], a[220:223], v[156:159], v[176:191]
  ds_read_b64_tr_b16 a[208:209], v21 offset:12544
  ds_read_b64_tr_b16 a[210:211], v21 offset:15616
  s_waitcnt lgkmcnt(8)
  v_mfma_f32_32x32x16_bf16 a[0:15], a[192:195], v[48:51], a[0:15]
  v_add_f32 v37, v37, v205
  v_cvt_pk_bf16_f32 v58, v204, v205
  v_exp_f32 v207, v207
  v_mfma_f32_32x32x16_bf16 a[16:31], a[192:195], v[52:55], a[16:31]
  ds_read_b64_tr_b16 a[212:213], v22 offset:12544
  ds_read_b64_tr_b16 a[214:215], v22 offset:15616
  v_add_f32 v37, v37, v206
  v_exp_f32 v216, v216
  s_waitcnt lgkmcnt(8)
  v_mfma_f32_32x32x16_bf16 a[32:47], a[196:199], v[48:51], a[32:47]
  v_add_f32 v37, v37, v207
  v_cvt_pk_bf16_f32 v59, v206, v207
  v_mfma_f32_32x32x16_bf16 a[48:63], a[196:199], v[52:55], a[48:63]
  ds_read_b64_tr_b16 a[216:217], v21 offset:18432
  ds_read_b64_tr_b16 a[218:219], v21 offset:21504
  v_exp_f32 v217, v217
  v_add_f32 v38, v38, v216
  s_waitcnt lgkmcnt(8)
  v_mfma_f32_32x32x16_bf16 a[64:79], a[200:203], v[48:51], a[64:79]
  v_exp_f32 v218, v218
  v_add_f32 v38, v38, v217
  v_cvt_pk_bf16_f32 v60, v216, v217
  v_mfma_f32_32x32x16_bf16 a[80:95], a[200:203], v[52:55], a[80:95]
  ds_read_b64_tr_b16 a[220:221], v22 offset:18432
  ds_read_b64_tr_b16 a[222:223], v22 offset:21504
  v_exp_f32 v219, v219
  v_add_f32 v38, v38, v218
  s_waitcnt lgkmcnt(8)
  v_mfma_f32_32x32x16_bf16 a[96:111], a[204:207], v[48:51], a[96:111]
  v_exp_f32 v220, v220
  v_add_f32 v38, v38, v219
  v_mfma_f32_32x32x16_bf16 a[112:127], a[204:207], v[52:55], a[112:127]
  ds_read_b64_tr_b16 a[192:193], v21 offset:18560
  ds_read_b64_tr_b16 a[194:195], v21 offset:21632
  v_cvt_pk_bf16_f32 v61, v218, v219
  v_exp_f32 v221, v221
  s_waitcnt lgkmcnt(8)
  v_mfma_f32_32x32x16_bf16 a[128:143], a[208:211], v[48:51], a[128:143]
  v_add_f32 v38, v38, v220
  v_exp_f32 v222, v222
  v_add_f32 v38, v38, v221
  v_mfma_f32_32x32x16_bf16 a[144:159], a[208:211], v[52:55], a[144:159]
  ds_read_b64_tr_b16 a[196:197], v22 offset:18560
  ds_read_b64_tr_b16 a[198:199], v22 offset:21632
  v_cvt_pk_bf16_f32 v62, v220, v221
  v_exp_f32 v223, v223
  s_waitcnt lgkmcnt(8)
  v_mfma_f32_32x32x16_bf16 a[160:175], a[212:215], v[48:51], a[160:175]
  v_add_f32 v38, v38, v222
  v_add_f32 v38, v38, v223
  v_cvt_pk_bf16_f32 v63, v222, v223
  v_mfma_f32_32x32x16_bf16 a[176:191], a[212:215], v[52:55], a[176:191]
  ds_read_b64_tr_b16 a[200:201], v21 offset:18688
  ds_read_b64_tr_b16 a[202:203], v21 offset:21760
  s_waitcnt lgkmcnt(8)
  v_mfma_f32_32x32x16_bf16 a[0:15], a[216:219], v[56:59], a[0:15]
  v_max3_f32 v39, v160, v161, v162
  v_mfma_f32_32x32x16_bf16 a[16:31], a[216:219], v[60:63], a[16:31]
  ds_read_b64_tr_b16 a[204:205], v22 offset:18688
  ds_read_b64_tr_b16 a[206:207], v22 offset:21760
  v_max3_f32 v40, v176, v177, v178
  v_max3_f32 v39, v39, v163, v164
  s_waitcnt lgkmcnt(8)
  v_mfma_f32_32x32x16_bf16 a[32:47], a[220:223], v[56:59], a[32:47]
  v_max3_f32 v40, v40, v179, v180
  s_mul_i32 s60, s2, 7680
  s_cmp_eq_u32 s30, 2
  s_cselect_b32 s61, 7680, 0
  s_add_u32 s40, s20, s60
  s_addc_u32 s41, s21, 0
  s_mov_b32 s42, s61
  s_mov_b32 s43, 0x20000
  v_mfma_f32_32x32x16_bf16 a[48:63], a[220:223], v[60:63], a[48:63]
  s_waitcnt vmcnt(28)
  s_barrier
  ds_read_b128 a[208:211], v29 offset:24576
  v_max3_f32 v39, v39, v165, v166
  v_max3_f32 v40, v40, v181, v182
  s_waitcnt lgkmcnt(7)
  v_mfma_f32_32x32x16_bf16 a[64:79], a[192:195], v[56:59], a[64:79]
  s_mov_b32 s67, 122880
  s_add_u32 m0, s68, 36864
  s_nop 0
  buffer_load_dwordx4 v10, s[52:55], s67 offen offset:0 lds
  v_max3_f32 v39, v39, v167, v168
  v_mfma_f32_32x32x16_bf16 a[80:95], a[192:195], v[60:63], a[80:95]
  ds_read_b128 a[212:215], v30 offset:24576
  buffer_load_dwordx4 v11, s[52:55], s67 offen offset:1024 lds
  v_max3_f32 v40, v40, v183, v184
  v_max3_f32 v39, v39, v169, v170
  v_lshlrev_b32 v47, 6, v1
  s_mov_b32 s66, 0
  buffer_load_dword a224, v47, s[40:43], s66 offen
  s_waitcnt lgkmcnt(6)
  v_mfma_f32_32x32x16_bf16 a[96:111], a[196:199], v[56:59], a[96:111]
  buffer_load_dwordx4 v12, s[52:55], s67 offen offset:2048 lds
  v_max3_f32 v40, v40, v185, v186
  v_mfma_f32_32x32x16_bf16 a[112:127], a[196:199], v[60:63], a[112:127]
  ds_read_b128 a[216:219], v31 offset:24576
  s_mov_b32 s67, 147456
  s_add_u32 m0, s68, 49152
  s_nop 0
  buffer_load_dwordx4 v7, s[48:51], s67 offen offset:0 lds
  v_max3_f32 v39, v39, v171, v172
  v_max3_f32 v40, v40, v187, v188
  s_waitcnt lgkmcnt(5)
  v_mfma_f32_32x32x16_bf16 a[128:143], a[200:203], v[56:59], a[128:143]
  buffer_load_dwordx4 v8, s[48:51], s67 offen offset:1024 lds
  v_max3_f32 v39, v39, v173, v174
  v_lshlrev_b32 v47, 6, v1
  s_mov_b32 s66, 4096
  buffer_load_dword a224, v47, s[40:43], s66 offen
  v_mfma_f32_32x32x16_bf16 a[144:159], a[200:203], v[60:63], a[144:159]
  ds_read_b128 a[220:223], v32 offset:24576
  buffer_load_dwordx4 v9, s[48:51], s67 offen offset:2048 lds
  v_max3_f32 v40, v40, v189, v190
  v_max_f32 v39, v39, v175
  s_waitcnt lgkmcnt(4)
  v_mfma_f32_32x32x16_bf16 a[160:175], a[204:207], v[56:59], a[160:175]
  v_max_f32 v40, v40, v191
  v_mfma_f32_32x32x16_bf16 a[176:191], a[204:207], v[60:63], a[176:191]
  ds_read_b128 a[192:195], v29 offset:24704
  v_max_f32 v41, v39, v40
  v_cmp_lt_f32 vcc, s72, v41
  s_cbranch_vccz L_ok5
  s_call_b64 s[70:71], L_rescale0
L_ok5:
  s_waitcnt lgkmcnt(4)
  v_mfma_f32_32x32x16_bf16 v[192:207], a[208:211], v[64:67], v[224:239]
  v_exp_f32 v160, v160
  v_exp_f32 v161, v161
  v_mfma_f32_32x32x16_bf16 v[208:223], a[208:211], v[72:75], v[240:255]
  ds_read_b128 a[196:199], v30 offset:24704
  v_add_f32 v37, v37, v160
  v_exp_f32 v162, v162
  s_waitcnt lgkmcnt(4)
  v_mfma_f32_32x32x16_bf16 v[192:207], a[212:215], v[68:71], v[192:207]
  v_add_f32 v37, v37, v161
  v_cvt_pk_bf16_f32 v48, v160, v161
  v_exp_f32 v163, v163
  v_mfma_f32_32x32x16_bf16 v[208:223], a[212:215], v[76:79], v[208:223]
  ds_read_b128 a[200:203], v31 offset:24704
  v_add_f32 v37, v37, v162
  v_exp_f32 v164, v164
  s_waitcnt lgkmcnt(4)
  v_mfma_f32_32x32x16_bf16 v[192:207], a[216:219], v[80:83], v[192:207]
  v_add_f32 v37, v37, v163
  v_cvt_pk_bf16_f32 v49, v162, v163
  v_mfma_f32_32x32x16_bf16 v[208:223], a[216:219], v[88:91], v[208:223]
  ds_read_b128 a[204:207], v32 offset:24704
  v_exp_f32 v165, v165
  v_add_f32 v37, v37, v164
  v_exp_f32 v166, v166
  s_waitcnt lgkmcnt(4)
  v_mfma_f32_32x32x16_bf16 v[192:207], a[220:223], v[84:87], v[192:207]
  v_add_f32 v37, v37, v165
  v_cvt_pk_bf16_f32 v50, v164, v165
  v_mfma_f32_32x32x16_bf16 v[208:223], a[220:223], v[92:95], v[208:223]
  ds_read_b128 a[208:211], v29 offset:24832
  v_exp_f32 v167, v167
  v_add_f32 v37, v37, v166
  s_waitcnt lgkmcnt(4)
  v_mfma_f32_32x32x16_bf16 v[192:207], a[192:195], v[96:99], v[192:207]
  v_exp_f32 v176, v176
  v_add_f32 v37, v37, v167
  v_cvt_pk_bf16_f32 v51, v166, v167
  v_mfma_f32_32x32x16_bf16 v[208:223], a[192:195], v[104:107], v[208:223]
  ds_read_b128 a[212:215], v30 offset:24832
  v_exp_f32 v177, v177
  v_add_f32 v38, v38, v176
  s_waitcnt lgkmcnt(4)
  v_mfma_f32_32x32x16_bf16 v[192:207], a[196:199], v[100:103], v[192:207]
  v_exp_f32 v178, v178
  v_add_f32 v38, v38, v177
  v_cvt_pk_bf16_f32 v52, v176, v177
  v_mfma_f32_32x32x16_bf16 v[208:223], a[196:199], v[108:111], v[208:223]
  ds_read_b128 a[216:219], v31 offset:24832
  v_exp_f32 v179, v179
  v_add_f32 v38, v38, v178
  s_waitcnt lgkmcnt(4)
  v_mfma_f32_32x32x16_bf16 v[192:207], a[200:203], v[112:115], v[192:207]
  v_exp_f32 v180, v180
  v_add_f32 v38, v38, v179
  v_cvt_pk_bf16_f32 v53, v178, v179
  v_mfma_f32_32x32x16_bf16 v[208:223], a[200:203], v[120:123], v[208:223]
  ds_read_b128 a[220:223], v32 offset:24832
  v_exp_f32 v181, v181
  v_add_f32 v38, v38, v180
  s_waitcnt lgkmcnt(4)
  v_mfma_f32_32x32x16_bf16 v[192:207], a[204:207], v[116:119], v[192:207]
  v_exp_f32 v182, v182
  v_add_f32 v38, v38, v181
  v_mfma_f32_32x32x16_bf16 v[208:223], a[204:207], v[124:127], v[208:223]
  ds_read_b64_tr_b16 a[192:193], v21 offset:36864
  ds_read_b64_tr_b16 a[194:195], v21 offset:39936
  v_cvt_pk_bf16_f32 v54, v180, v181
  v_exp_f32 v183, v183
  v_add_f32 v38, v38, v182
  s_waitcnt lgkmcnt(5)
  v_mfma_f32_32x32x16_bf16 v[192:207], a[208:211], v[128:131], v[192:207]
  v_add_f32 v38, v38, v183
  v_cvt_pk_bf16_f32 v55, v182, v183
  v_mfma_f32_32x32x16_bf16 v[208:223], a[208:211], v[136:139], v[208:223]
  ds_read_b64_tr_b16 a[196:197], v22 offset:36864
  ds_read_b64_tr_b16 a[198:199], v22 offset:39936
  v_exp_f32 v168, v168
  v_exp_f32 v169, v169
  s_waitcnt lgkmcnt(6)
  v_mfma_f32_32x32x16_bf16 v[192:207], a[212:215], v[132:135], v[192:207]
  v_add_f32 v37, v37, v168
  v_exp_f32 v170, v170
  v_add_f32 v37, v37, v169
  v_mfma_f32_32x32x16_bf16 v[208:223], a[212:215], v[140:143], v[208:223]
  ds_read_b64_tr_b16 a[200:201], v21 offset:36992
  ds_read_b64_tr_b16 a[202:203], v21 offset:40064
  v_cvt_pk_bf16_f32 v56, v168, v169
  v_exp_f32 v171, v171
  s_waitcnt lgkmcnt(7)
  v_mfma_f32_32x32x16_bf16 v[192:207], a[216:219], v[144:147], v[192:207]
  v_add_f32 v37, v37, v170
  v_exp_f32 v172, v172
  v_mfma_f32_32x32x16_bf16 v[208:223], a[216:219], v[152:155], v[208:223]
  ds_read_b64_tr_b16 a[204:205], v22 offset:36992
  ds_read_b64_tr_b16 a[206:207], v22 offset:40064
  v_add_f32 v37, v37, v171
  v_cvt_pk_bf16_f32 v57, v170, v171
  v_exp_f32 v173, v173
  s_waitcnt lgkmcnt(8)
  v_mfma_f32_32x32x16_bf16 v[192:207], a[220:223], v[148:151], v[192:207]
  v_add_f32 v37, v37, v172
  v_exp_f32 v174, v174
  v_mfma_f32_32x32x16_bf16 v[208:223], a[220:223], v[156:159], v[208:223]
  ds_read_b64_tr_b16 a[208:209], v21 offset:37120
  ds_read_b64_tr_b16 a[210:211], v21 offset:40192
  s_waitcnt lgkmcnt(8)
  v_mfma_f32_32x32x16_bf16 a[0:15], a[192:195], v[48:51], a[0:15]
  v_add_f32 v37, v37, v173
  v_cvt_pk_bf16_f32 v58, v172, v173
  v_exp_f32 v175, v175
  v_mfma_f32_32x32x16_bf16 a[16:31], a[192:195], v[52:55], a[16:31]
  ds_read_b64_tr_b16 a[212:213], v22 offset:37120
  ds_read_b64_tr_b16 a[214:215], v22 offset:40192
  v_add_f32 v37, v37, v174
  v_exp_f32 v184, v184
  s_waitcnt lgkmcnt(8)
  v_mfma_f32_32x32x16_bf16 a[32:47], a[196:199], v[48:51], a[32:47]
  v_add_f32 v37, v37, v175
  v_cvt_pk_bf16_f32 v59, v174, v175
  v_mfma_f32_32x32x16_bf16 a[48:63], a[196:199], v[52:55], a[48:63]
  ds_read_b64_tr_b16 a[216:217], v21 offset:43008
  ds_read_b64_tr_b16 a[218:219], v21 offset:46080
  v_exp_f32 v185, v185
  v_add_f32 v38, v38, v184
  s_waitcnt lgkmcnt(8)
  v_mfma_f32_32x32x16_bf16 a[64:79], a[200:203], v[48:51], a[64:79]
  v_exp_f32 v186, v186
  v_add_f32 v38, v38, v185
  v_cvt_pk_bf16_f32 v60, v184, v185
  v_mfma_f32_32x32x16_bf16 a[80:95], a[200:203], v[52:55], a[80:95]
  ds_read_b64_tr_b16 a[220:221], v22 offset:43008
  ds_read_b64_tr_b16 a[222:223], v22 offset:46080
  v_exp_f32 v187, v187
  v_add_f32 v38, v38, v186
  s_waitcnt lgkmcnt(8)
  v_mfma_f32_32x32x16_bf16 a[96:111], a[204:207], v[48:51], a[96:111]
  v_exp_f32 v188, v188
  v_add_f32 v38, v38, v187
  v_mfma_f32_32x32x16_bf16 a[112:127], a[204:207], v[52:55], a[112:127]
  ds_read_b64_tr_b16 a[192:193], v21 offset:43136
  ds_read_b64_tr_b16 a[194:195], v21 offset:46208
  v_cvt_pk_bf16_f32 v61, v186, v187
  v_exp_f32 v189, v189
  s_waitcnt lgkmcnt(8)
  v_mfma_f32_32x32x16_bf16 a[128:143], a[208:211], v[48:51], a[128:143]
  v_add_f32 v38, v38, v188
  v_exp_f32 v190, v190
  v_add_f32 v38, v38, v189
  v_mfma_f32_32x32x16_bf16 a[144:159], a[208:211], v[52:55], a[144:159]
  ds_read_b64_tr_b16 a[196:197], v22 offset:43136
  ds_read_b64_tr_b16 a[198:199], v22 offset:46208
  v_cvt_pk_bf16_f32 v62, v188, v189
  v_exp_f32 v191, v191
  s_waitcnt lgkmcnt(8)
  v_mfma_f32_32x32x16_bf16 a[160:175], a[212:215], v[48:51], a[160:175]
  v_add_f32 v38, v38, v190
  v_add_f32 v38, v38, v191
  v_cvt_pk_bf16_f32 v63, v190, v191
  v_mfma_f32_32x32x16_bf16 a[176:191], a[212:215], v[52:55], a[176:191]
  ds_read_b64_tr_b16 a[200:201], v21 offset:43264
  ds_read_b64_tr_b16 a[202:203], v21 offset:46336
  s_waitcnt lgkmcnt(8)
  v_mfma_f32_32x32x16_bf16 a[0:15], a[216:219], v[56:59], a[0:15]
  v_max3_f32 v39, v192, v193, v194
  v_mfma_f32_32x32x16_bf16 a[16:31], a[216:219], v[60:63], a[16:31]
  ds_read_b64_tr_b16 a[204:205], v22 offset:43264
  ds_read_b64_tr_b16 a[206:207], v22 offset:46336
  v_max3_f32 v40, v208, v209, v210
  v_max3_f32 v39, v39, v195, v196
  s_waitcnt lgkmcnt(8)
  v_mfma_f32_32x32x16_bf16 a[32:47], a[220:223], v[56:59], a[32:47]
  v_max3_f32 v40, v40, v211, v212
  v_mfma_f32_32x32x16_bf16 a[48:63], a[220:223], v[60:63], a[48:63]
  s_waitcnt vmcnt(29)
  s_barrier
  ds_read_b128 a[208:211], v29 offset:49152
  v_max3_f32 v39, v39, v197, v198
  v_max3_f32 v40, v40, v213, v214
  s_waitcnt lgkmcnt(7)
  v_mfma_f32_32x32x16_bf16 a[64:79], a[192:195], v[56:59], a[64:79]
  s_mov_b32 s67, 135168
  s_add_u32 m0, s68, 61440
  s_nop 0
  buffer_load_dwordx4 v10, s[52:55], s67 offen offset:0 lds
  v_max3_f32 v39, v39, v199, v200
  v_mfma_f32_32x32x16_bf16 a[80:95], a[192:195], v[60:63], a[80:95]
  ds_read_b128 a[212:215], v30 offset:49152
  buffer_load_dwordx4 v11, s[52:55], s67 offen offset:1024 lds
  v_max3_f32 v40, v40, v215, v216
  v_max3_f32 v39, v39, v201, v202
  s_waitcnt lgkmcnt(6)
  v_mfma_f32_32x32x16_bf16 a[96:111], a[196:199], v[56:59], a[96:111]
  buffer_load_dwordx4 v12, s[52:55], s67 offen offset:2048 lds
  v_max3_f32 v40, v40, v217, v218
  v_mfma_f32_32x32x16_bf16 a[112:127], a[196:199], v[60:63], a[112:127]
  ds_read_b128 a[216:219], v31 offset:49152
  s_mov_b32 s67, 159744
  s_add_u32 m0, s68, 73728
  s_nop 0
  buffer_load_dwordx4 v7, s[48:51], s67 offen offset:0 lds
  v_max3_f32 v39, v39, v203, v204
  v_max3_f32 v40, v40, v219, v220
  s_waitcnt lgkmcnt(5)
  v_mfma_f32_32x32x16_bf16 a[128:143], a[200:203], v[56:59], a[128:143]
  buffer_load_dwordx4 v8, s[48:51], s67 offen offset:1024 lds
  v_max3_f32 v39, v39, v205, v206
  v_mfma_f32_32x32x16_bf16 a[144:159], a[200:203], v[60:63], a[144:159]
  ds_read_b128 a[220:223], v32 offset:49152
  buffer_load_dwordx4 v9, s[48:51], s67 offen offset:2048 lds
  v_max3_f32 v40, v40, v221, v222
  v_max_f32 v39, v39, v207
  s_waitcnt lgkmcnt(4)
  v_mfma_f32_32x32x16_bf16 a[160:175], a[204:207], v[56:59], a[160:175]
  v_max_f32 v40, v40, v223
  v_mfma_f32_32x32x16_bf16 a[176:191], a[204:207], v[60:63], a[176:191]
  ds_read_b128 a[192:195], v29 offset:49280
  v_max_f32 v41, v39, v40
  v_cmp_lt_f32 vcc, s72, v41
  s_cbranch_vccz L_ok6
  s_call_b64 s[70:71], L_rescale1
L_ok6:
  s_waitcnt lgkmcnt(4)
  v_mfma_f32_32x32x16_bf16 v[160:175], a[208:211], v[64:67], v[224:239]
  v_exp_f32 v192, v192
  v_exp_f32 v193, v193
  v_mfma_f32_32x32x16_bf16 v[176:191], a[208:211], v[72:75], v[240:255]
  ds_read_b128 a[196:199], v30 offset:49280
  v_add_f32 v37, v37, v192
  v_exp_f32 v194, v194
  s_waitcnt lgkmcnt(4)
  v_mfma_f32_32x32x16_bf16 v[160:175], a[212:215], v[68:71], v[160:175]
  v_add_f32 v37, v37, v193
  v_cvt_pk_bf16_f32 v48, v192, v193
  v_exp_f32 v195, v195
  v_mfma_f32_32x32x16_bf16 v[176:191], a[212:215], v[76:79], v[176:191]
  ds_read_b128 a[200:203], v31 offset:49280
  v_add_f32 v37, v37, v194
  v_exp_f32 v196, v196
  s_waitcnt lgkmcnt(4)
  v_mfma_f32_32x32x16_bf16 v[160:175], a[216:219], v[80:83], v[160:175]
  v_add_f32 v37, v37, v195
  v_cvt_pk_bf16_f32 v49, v194, v195
  v_mfma_f32_32x32x16_bf16 v[176:191], a[216:219], v[88:91], v[176:191]
  ds_read_b128 a[204:207], v32 offset:49280
  v_exp_f32 v197, v197
  v_add_f32 v37, v37, v196
  v_exp_f32 v198, v198
  s_waitcnt lgkmcnt(4)
  v_mfma_f32_32x32x16_bf16 v[160:175], a[220:223], v[84:87], v[160:175]
  v_add_f32 v37, v37, v197
  v_cvt_pk_bf16_f32 v50, v196, v197
  v_mfma_f32_32x32x16_bf16 v[176:191], a[220:223], v[92:95], v[176:191]
  ds_read_b128 a[208:211], v29 offset:49408
  v_exp_f32 v199, v199
  v_add_f32 v37, v37, v198
  s_waitcnt lgkmcnt(4)
  v_mfma_f32_32x32x16_bf16 v[160:175], a[192:195], v[96:99], v[160:175]
  v_exp_f32 v208, v208
  v_add_f32 v37, v37, v199
  v_cvt_pk_bf16_f32 v51, v198, v199
  v_mfma_f32_32x32x16_bf16 v[176:191], a[192:195], v[104:107], v[176:191]
  ds_read_b128 a[212:215], v30 offset:49408
  v_exp_f32 v209, v209
  v_add_f32 v38, v38, v208
  s_waitcnt lgkmcnt(4)
  v_mfma_f32_32x32x16_bf16 v[160:175], a[196:199], v[100:103], v[160:175]
  v_exp_f32 v210, v210
  v_add_f32 v38, v38, v209
  v_cvt_pk_bf16_f32 v52, v208, v209
  v_mfma_f32_32x32x16_bf16 v[176:191], a[196:199], v[108:111], v[176:191]
  ds_read_b128 a[216:219], v31 offset:49408
  v_exp_f32 v211, v211
  v_add_f32 v38, v38, v210
  s_waitcnt lgkmcnt(4)
  v_mfma_f32_32x32x16_bf16 v[160:175], a[200:203], v[112:115], v[160:175]
  v_exp_f32 v212, v212
  v_add_f32 v38, v38, v211
  v_cvt_pk_bf16_f32 v53, v210, v211
  v_mfma_f32_32x32x16_bf16 v[176:191], a[200:203], v[120:123], v[176:191]
  ds_read_b128 a[220:223], v32 offset:49408
  v_exp_f32 v213, v213
  v_add_f32 v38, v38, v212
  s_waitcnt lgkmcnt(4)
  v_mfma_f32_32x32x16_bf16 v[160:175], a[204:207], v[116:119], v[160:175]
  v_exp_f32 v214, v214
  v_add_f32 v38, v38, v213
  v_mfma_f32_32x32x16_bf16 v[176:191], a[204:207], v[124:127], v[176:191]
  ds_read_b64_tr_b16 a[192:193], v23 offset:0
  ds_read_b64_tr_b16 a[194:195], v23 offset:3072
  v_cvt_pk_bf16_f32 v54, v212, v213
  v_exp_f32 v215, v215
  v_add_f32 v38, v38, v214
  s_waitcnt lgkmcnt(5)
  v_mfma_f32_32x32x16_bf16 v[160:175], a[208:211], v[128:131], v[160:175]
  v_add_f32 v38, v38, v215
  v_cvt_pk_bf16_f32 v55, v214, v215
  v_mfma_f32_32x32x16_bf16 v[176:191], a[208:211], v[136:139], v[176:191]
  ds_read_b64_tr_b16 a[196:197], v24 offset:0
  ds_read_b64_tr_b16 a[198:199], v24 offset:3072
  v_exp_f32 v200, v200
  v_exp_f32 v201, v201
  s_waitcnt lgkmcnt(6)
  v_mfma_f32_32x32x16_bf16 v[160:175], a[212:215], v[132:135], v[160:175]
  v_add_f32 v37, v37, v200
  v_exp_f32 v202, v202
  v_add_f32 v37, v37, v201
  v_mfma_f32_32x32x16_bf16 v[176:191], a[212:215], v[140:143], v[176:191]
  ds_read_b64_tr_b16 a[200:201], v23 offset:128
  ds_read_b64_tr_b16 a[202:203], v23 offset:3200
  v_cvt_pk_bf16_f32 v56, v200, v201
  v_exp_f32 v203, v203
  s_waitcnt lgkmcnt(7)
  v_mfma_f32_32x32x16_bf16 v[160:175], a[216:219], v[144:147], v[160:175]
  v_add_f32 v37, v37, v202
  v_exp_f32 v204, v204
  v_mfma_f32_32x32x16_bf16 v[176:191], a[216:219], v[152:155], v[176:191]
  ds_read_b64_tr_b16 a[204:205], v24 offset:128
  ds_read_b64_tr_b16 a[206:207], v24 offset:3200
  v_add_f32 v37, v37, v203
  v_cvt_pk_bf16_f32 v57, v202, v203
  v_exp_f32 v205, v205
  s_waitcnt lgkmcnt(8)
  v_mfma_f32_32x32x16_bf16 v[160:175], a[220:223], v[148:151], v[160:175]
  v_add_f32 v37, v37, v204
  v_exp_f32 v206, v206
  v_mfma_f32_32x32x16_bf16 v[176:191], a[220:223], v[156:159], v[176:191]
  ds_read_b64_tr_b16 a[208:209], v23 offset:256
  ds_read_b64_tr_b16 a[210:211], v23 offset:3328
  s_waitcnt lgkmcnt(8)
  v_mfma_f32_32x32x16_bf16 a[0:15], a[192:195], v[48:51], a[0:15]
  v_add_f32 v37, v37, v205
  v_cvt_pk_bf16_f32 v58, v204, v205
  v_exp_f32 v207, v207
  v_mfma_f32_32x32x16_bf16 a[16:31], a[192:195], v[52:55], a[16:31]
  ds_read_b64_tr_b16 a[212:213], v24 offset:256
  ds_read_b64_tr_b16 a[214:215], v24 offset:3328
  v_add_f32 v37, v37, v206
  v_exp_f32 v216, v216
  s_waitcnt lgkmcnt(8)
  v_mfma_f32_32x32x16_bf16 a[32:47], a[196:199], v[48:51], a[32:47]
  v_add_f32 v37, v37, v207
  v_cvt_pk_bf16_f32 v59, v206, v207
  v_mfma_f32_32x32x16_bf16 a[48:63], a[196:199], v[52:55], a[48:63]
  ds_read_b64_tr_b16 a[216:217], v23 offset:6144
  ds_read_b64_tr_b16 a[218:219], v23 offset:9216
  v_exp_f32 v217, v217
  v_add_f32 v38, v38, v216
  s_waitcnt lgkmcnt(8)
  v_mfma_f32_32x32x16_bf16 a[64:79], a[200:203], v[48:51], a[64:79]
  v_exp_f32 v218, v218
  v_add_f32 v38, v38, v217
  v_cvt_pk_bf16_f32 v60, v216, v217
  v_mfma_f32_32x32x16_bf16 a[80:95], a[200:203], v[52:55], a[80:95]
  ds_read_b64_tr_b16 a[220:221], v24 offset:6144
  ds_read_b64_tr_b16 a[222:223], v24 offset:9216
  v_exp_f32 v219, v219
  v_add_f32 v38, v38, v218
  s_waitcnt lgkmcnt(8)
  v_mfma_f32_32x32x16_bf16 a[96:111], a[204:207], v[48:51], a[96:111]
  v_exp_f32 v220, v220
  v_add_f32 v38, v38, v219
  v_mfma_f32_32x32x16_bf16 a[112:127], a[204:207], v[52:55], a[112:127]
  ds_read_b64_tr_b16 a[192:193], v23 offset:6272
  ds_read_b64_tr_b16 a[194:195], v23 offset:9344
  v_cvt_pk_bf16_f32 v61, v218, v219
  v_exp_f32 v221, v221
  s_waitcnt lgkmcnt(8)
  v_mfma_f32_32x32x16_bf16 a[128:143], a[208:211], v[48:51], a[128:143]
  v_add_f32 v38, v38, v220
  v_exp_f32 v222, v222
  v_add_f32 v38, v38, v221
  v_mfma_f32_32x32x16_bf16 a[144:159], a[208:211], v[52:55], a[144:159]
  ds_read_b64_tr_b16 a[196:197], v24 offset:6272
  ds_read_b64_tr_b16 a[198:199], v24 offset:9344
  v_cvt_pk_bf16_f32 v62, v220, v221
  v_exp_f32 v223, v223
  s_waitcnt lgkmcnt(8)
  v_mfma_f32_32x32x16_bf16 a[160:175], a[212:215], v[48:51], a[160:175]
  v_add_f32 v38, v38, v222
  v_add_f32 v38, v38, v223
  v_cvt_pk_bf16_f32 v63, v222, v223
  v_mfma_f32_32x32x16_bf16 a[176:191], a[212:215], v[52:55], a[176:191]
  ds_read_b64_tr_b16 a[200:201], v23 offset:6400
  ds_read_b64_tr_b16 a[202:203], v23 offset:9472
  s_waitcnt lgkmcnt(8)
  v_mfma_f32_32x32x16_bf16 a[0:15], a[216:219], v[56:59], a[0:15]
  v_max3_f32 v39, v160, v161, v162
  v_mfma_f32_32x32x16_bf16 a[16:31], a[216:219], v[60:63], a[16:31]
  ds_read_b64_tr_b16 a[204:205], v24 offset:6400
  ds_read_b64_tr_b16 a[206:207], v24 offset:9472
  v_max3_f32 v40, v176, v177, v178
  v_max3_f32 v39, v39, v163, v164
  s_waitcnt lgkmcnt(8)
  v_mfma_f32_32x32x16_bf16 a[32:47], a[220:223], v[56:59], a[32:47]
  v_max3_f32 v40, v40, v179, v180
  v_mfma_f32_32x32x16_bf16 a[48:63], a[220:223], v[60:63], a[48:63]
  s_waitcnt vmcnt(26)
  s_barrier
  ds_read_b128 a[208:211], v33 offset:12288
  v_max3_f32 v39, v39, v165, v166
  v_max3_f32 v40, v40, v181, v182
  s_waitcnt lgkmcnt(7)
  v_mfma_f32_32x32x16_bf16 a[64:79], a[192:195], v[56:59], a[64:79]
  s_mov_b32 s67, 147456
  s_add_u32 m0, s68, 86016
  s_nop 0
  buffer_load_dwordx4 v10, s[52:55], s67 offen offset:0 lds
  v_max3_f32 v39, v39, v167, v168
  v_mfma_f32_32x32x16_bf16 a[80:95], a[192:195], v[60:63], a[80:95]
  ds_read_b128 a[212:215], v34 offset:12288
  buffer_load_dwordx4 v11, s[52:55], s67 offen offset:1024 lds
  v_max3_f32 v40, v40, v183, v184
  v_max3_f32 v39, v39, v169, v170
  s_waitcnt lgkmcnt(6)
  v_mfma_f32_32x32x16_bf16 a[96:111], a[196:199], v[56:59], a[96:111]
  buffer_load_dwordx4 v12, s[52:55], s67 offen offset:2048 lds
  v_max3_f32 v40, v40, v185, v186
  v_mfma_f32_32x32x16_bf16 a[112:127], a[196:199], v[60:63], a[112:127]
  ds_read_b128 a[216:219], v35 offset:12288
  s_mov_b32 s67, 172032
  s_add_u32 m0, s68, 98304
  s_nop 0
  buffer_load_dwordx4 v7, s[48:51], s67 offen offset:0 lds
  v_max3_f32 v39, v39, v171, v172
  v_max3_f32 v40, v40, v187, v188
  s_waitcnt lgkmcnt(5)
  v_mfma_f32_32x32x16_bf16 a[128:143], a[200:203], v[56:59], a[128:143]
  buffer_load_dwordx4 v8, s[48:51], s67 offen offset:1024 lds
  v_max3_f32 v39, v39, v173, v174
  v_mfma_f32_32x32x16_bf16 a[144:159], a[200:203], v[60:63], a[144:159]
  ds_read_b128 a[220:223], v36 offset:12288
  buffer_load_dwordx4 v9, s[48:51], s67 offen offset:2048 lds
  v_max3_f32 v40, v40, v189, v190
  v_max_f32 v39, v39, v175
  s_waitcnt lgkmcnt(4)
  v_mfma_f32_32x32x16_bf16 a[160:175], a[204:207], v[56:59], a[160:175]
  v_max_f32 v40, v40, v191
  v_mfma_f32_32x32x16_bf16 a[176:191], a[204:207], v[60:63], a[176:191]
  ds_read_b128 a[192:195], v33 offset:12416
  v_max_f32 v41, v39, v40
  v_cmp_lt_f32 vcc, s72, v41
  s_cbranch_vccz L_ok7
  s_call_b64 s[70:71], L_rescale0
L_ok7:
  s_waitcnt lgkmcnt(4)
  v_mfma_f32_32x32x16_bf16 v[192:207], a[208:211], v[64:67], v[224:239]
  v_exp_f32 v160, v160
  v_exp_f32 v161, v161
  v_mfma_f32_32x32x16_bf16 v[208:223], a[208:211], v[72:75], v[240:255]
  ds_read_b128 a[196:199], v34 offset:12416
  v_add_f32 v37, v37, v160
  v_exp_f32 v162, v162
  s_waitcnt lgkmcnt(4)
  v_mfma_f32_32x32x16_bf16 v[192:207], a[212:215], v[68:71], v[192:207]
  v_add_f32 v37, v37, v161
  v_cvt_pk_bf16_f32 v48, v160, v161
  v_exp_f32 v163, v163
  v_mfma_f32_32x32x16_bf16 v[208:223], a[212:215], v[76:79], v[208:223]
  ds_read_b128 a[200:203], v35 offset:12416
  v_add_f32 v37, v37, v162
  v_exp_f32 v164, v164
  s_waitcnt lgkmcnt(4)
  v_mfma_f32_32x32x16_bf16 v[192:207], a[216:219], v[80:83], v[192:207]
  v_add_f32 v37, v37, v163
  v_cvt_pk_bf16_f32 v49, v162, v163
  v_mfma_f32_32x32x16_bf16 v[208:223], a[216:219], v[88:91], v[208:223]
  ds_read_b128 a[204:207], v36 offset:12416
  v_exp_f32 v165, v165
  v_add_f32 v37, v37, v164
  v_exp_f32 v166, v166
  s_waitcnt lgkmcnt(4)
  v_mfma_f32_32x32x16_bf16 v[192:207], a[220:223], v[84:87], v[192:207]
  v_add_f32 v37, v37, v165
  v_cvt_pk_bf16_f32 v50, v164, v165
  v_mfma_f32_32x32x16_bf16 v[208:223], a[220:223], v[92:95], v[208:223]
  ds_read_b128 a[208:211], v33 offset:12544
  v_exp_f32 v167, v167
  v_add_f32 v37, v37, v166
  s_waitcnt lgkmcnt(4)
  v_mfma_f32_32x32x16_bf16 v[192:207], a[192:195], v[96:99], v[192:207]
  v_exp_f32 v176, v176
  v_add_f32 v37, v37, v167
  v_cvt_pk_bf16_f32 v51, v166, v167
  v_mfma_f32_32x32x16_bf16 v[208:223], a[192:195], v[104:107], v[208:223]
  ds_read_b128 a[212:215], v34 offset:12544
  v_exp_f32 v177, v177
  v_add_f32 v38, v38, v176
  s_waitcnt lgkmcnt(4)
  v_mfma_f32_32x32x16_bf16 v[192:207], a[196:199], v[100:103], v[192:207]
  v_exp_f32 v178, v178
  v_add_f32 v38, v38, v177
  v_cvt_pk_bf16_f32 v52, v176, v177
  v_mfma_f32_32x32x16_bf16 v[208:223], a[196:199], v[108:111], v[208:223]
  ds_read_b128 a[216:219], v35 offset:12544
  v_exp_f32 v179, v179
  v_add_f32 v38, v38, v178
  s_waitcnt lgkmcnt(4)
  v_mfma_f32_32x32x16_bf16 v[192:207], a[200:203], v[112:115], v[192:207]
  v_exp_f32 v180, v180
  v_add_f32 v38, v38, v179
  v_cvt_pk_bf16_f32 v53, v178, v179
  v_mfma_f32_32x32x16_bf16 v[208:223], a[200:203], v[120:123], v[208:223]
  ds_read_b128 a[220:223], v36 offset:12544
  v_exp_f32 v181, v181
  v_add_f32 v38, v38, v180
  s_waitcnt lgkmcnt(4)
  v_mfma_f32_32x32x16_bf16 v[192:207], a[204:207], v[116:119], v[192:207]
  v_exp_f32 v182, v182
  v_add_f32 v38, v38, v181
  v_mfma_f32_32x32x16_bf16 v[208:223], a[204:207], v[124:127], v[208:223]
  ds_read_b64_tr_b16 a[192:193], v23 offset:24576
  ds_read_b64_tr_b16 a[194:195], v23 offset:27648
  v_cvt_pk_bf16_f32 v54, v180, v181
  v_exp_f32 v183, v183
  v_add_f32 v38, v38, v182
  s_waitcnt lgkmcnt(5)
  v_mfma_f32_32x32x16_bf16 v[192:207], a[208:211], v[128:131], v[192:207]
  v_add_f32 v38, v38, v183
  v_cvt_pk_bf16_f32 v55, v182, v183
  v_mfma_f32_32x32x16_bf16 v[208:223], a[208:211], v[136:139], v[208:223]
  ds_read_b64_tr_b16 a[196:197], v24 offset:24576
  ds_read_b64_tr_b16 a[198:199], v24 offset:27648
  v_exp_f32 v168, v168
  v_exp_f32 v169, v169
  s_waitcnt lgkmcnt(6)
  v_mfma_f32_32x32x16_bf16 v[192:207], a[212:215], v[132:135], v[192:207]
  v_add_f32 v37, v37, v168
  v_exp_f32 v170, v170
  v_add_f32 v37, v37, v169
  v_mfma_f32_32x32x16_bf16 v[208:223], a[212:215], v[140:143], v[208:223]
  ds_read_b64_tr_b16 a[200:201], v23 offset:24704
  ds_read_b64_tr_b16 a[202:203], v23 offset:27776
  v_cvt_pk_bf16_f32 v56, v168, v169
  v_exp_f32 v171, v171
  s_waitcnt lgkmcnt(7)
  v_mfma_f32_32x32x16_bf16 v[192:207], a[216:219], v[144:147], v[192:207]
  v_add_f32 v37, v37, v170
  v_exp_f32 v172, v172
  v_mfma_f32_32x32x16_bf16 v[208:223], a[216:219], v[152:155], v[208:223]
  ds_read_b64_tr_b16 a[204:205], v24 offset:24704
  ds_read_b64_tr_b16 a[206:207], v24 offset:27776
  v_add_f32 v37, v37, v171
  v_cvt_pk_bf16_f32 v57, v170, v171
  v_exp_f32 v173, v173
  s_waitcnt lgkmcnt(8)
  v_mfma_f32_32x32x16_bf16 v[192:207], a[220:223], v[148:151], v[192:207]
  v_add_f32 v37, v37, v172
  v_exp_f32 v174, v174
  v_mfma_f32_32x32x16_bf16 v[208:223], a[220:223], v[156:159], v[208:223]
  ds_read_b64_tr_b16 a[208:209], v23 offset:24832
  ds_read_b64_tr_b16 a[210:211], v23 offset:27904
  s_waitcnt lgkmcnt(8)
  v_mfma_f32_32x32x16_bf16 a[0:15], a[192:195], v[48:51], a[0:15]
  v_add_f32 v37, v37, v173
  v_cvt_pk_bf16_f32 v58, v172, v173
  v_exp_f32 v175, v175
  v_mfma_f32_32x32x16_bf16 a[16:31], a[192:195], v[52:55], a[16:31]
  ds_read_b64_tr_b16 a[212:213], v24 offset:24832
  ds_read_b64_tr_b16 a[214:215], v24 offset:27904
  v_add_f32 v37, v37, v174
  v_exp_f32 v184, v184
  s_waitcnt lgkmcnt(8)
  v_mfma_f32_32x32x16_bf16 a[32:47], a[196:199], v[48:51], a[32:47]
  v_add_f32 v37, v37, v175
  v_cvt_pk_bf16_f32 v59, v174, v175
  v_mfma_f32_32x32x16_bf16 a[48:63], a[196:199], v[52:55], a[48:63]
  ds_read_b64_tr_b16 a[216:217], v23 offset:30720
  ds_read_b64_tr_b16 a[218:219], v23 offset:33792
  v_exp_f32 v185, v185
  v_add_f32 v38, v38, v184
  s_waitcnt lgkmcnt(8)
  v_mfma_f32_32x32x16_bf16 a[64:79], a[200:203], v[48:51], a[64:79]
  v_exp_f32 v186, v186
  v_add_f32 v38, v38, v185
  v_cvt_pk_bf16_f32 v60, v184, v185
  v_mfma_f32_32x32x16_bf16 a[80:95], a[200:203], v[52:55], a[80:95]
  ds_read_b64_tr_b16 a[220:221], v24 offset:30720
  ds_read_b64_tr_b16 a[222:223], v24 offset:33792
  v_exp_f32 v187, v187
  v_add_f32 v38, v38, v186
  s_waitcnt lgkmcnt(8)
  v_mfma_f32_32x32x16_bf16 a[96:111], a[204:207], v[48:51], a[96:111]
  v_exp_f32 v188, v188
  v_add_f32 v38, v38, v187
  v_mfma_f32_32x32x16_bf16 a[112:127], a[204:207], v[52:55], a[112:127]
  ds_read_b64_tr_b16 a[192:193], v23 offset:30848
  ds_read_b64_tr_b16 a[194:195], v23 offset:33920
  v_cvt_pk_bf16_f32 v61, v186, v187
  v_exp_f32 v189, v189
  s_waitcnt lgkmcnt(8)
  v_mfma_f32_32x32x16_bf16 a[128:143], a[208:211], v[48:51], a[128:143]
  v_add_f32 v38, v38, v188
  v_exp_f32 v190, v190
  v_add_f32 v38, v38, v189
  v_mfma_f32_32x32x16_bf16 a[144:159], a[208:211], v[52:55], a[144:159]
  ds_read_b64_tr_b16 a[196:197], v24 offset:30848
  ds_read_b64_tr_b16 a[198:199], v24 offset:33920
  v_cvt_pk_bf16_f32 v62, v188, v189
  v_exp_f32 v191, v191
  s_waitcnt lgkmcnt(8)
  v_mfma_f32_32x32x16_bf16 a[160:175], a[212:215], v[48:51], a[160:175]
  v_add_f32 v38, v38, v190
  v_add_f32 v38, v38, v191
  v_cvt_pk_bf16_f32 v63, v190, v191
  v_mfma_f32_32x32x16_bf16 a[176:191], a[212:215], v[52:55], a[176:191]
  ds_read_b64_tr_b16 a[200:201], v23 offset:30976
  ds_read_b64_tr_b16 a[202:203], v23 offset:34048
  s_waitcnt lgkmcnt(8)
  v_mfma_f32_32x32x16_bf16 a[0:15], a[216:219], v[56:59], a[0:15]
  v_max3_f32 v39, v192, v193, v194
  v_mfma_f32_32x32x16_bf16 a[16:31], a[216:219], v[60:63], a[16:31]
  ds_read_b64_tr_b16 a[204:205], v24 offset:30976
  ds_read_b64_tr_b16 a[206:207], v24 offset:34048
  v_max3_f32 v40, v208, v209, v210
  v_max3_f32 v39, v39, v195, v196
  s_waitcnt lgkmcnt(8)
  v_mfma_f32_32x32x16_bf16 a[32:47], a[220:223], v[56:59], a[32:47]
  v_max3_f32 v40, v40, v211, v212
  v_mfma_f32_32x32x16_bf16 a[48:63], a[220:223], v[60:63], a[48:63]
  s_waitcnt vmcnt(24)
  s_barrier
  ds_read_b128 a[208:211], v25 offset:0
  v_max3_f32 v39, v39, v197, v198
  v_max3_f32 v40, v40, v213, v214
  s_waitcnt lgkmcnt(7)
  v_mfma_f32_32x32x16_bf16 a[64:79], a[192:195], v[56:59], a[64:79]
  s_mov_b32 s67, 159744
  s_add_u32 m0, s68, 110592
  s_nop 0
  buffer_load_dwordx4 v10, s[52:55], s67 offen offset:0 lds
  v_max3_f32 v39, v39, v199, v200
  v_mfma_f32_32x32x16_bf16 a[80:95], a[192:195], v[60:63], a[80:95]
  ds_read_b128 a[212:215], v26 offset:0
  buffer_load_dwordx4 v11, s[52:55], s67 offen offset:1024 lds
  v_max3_f32 v40, v40, v215, v216
  v_max3_f32 v39, v39, v201, v202
  s_waitcnt lgkmcnt(6)
  v_mfma_f32_32x32x16_bf16 a[96:111], a[196:199], v[56:59], a[96:111]
  buffer_load_dwordx4 v12, s[52:55], s67 offen offset:2048 lds
  v_max3_f32 v40, v40, v217, v218
  v_mfma_f32_32x32x16_bf16 a[112:127], a[196:199], v[60:63], a[112:127]
  ds_read_b128 a[216:219], v27 offset:0
  s_mov_b32 s67, 184320
  s_add_u32 m0, s68, 122880
  s_nop 0
  buffer_load_dwordx4 v7, s[48:51], s67 offen offset:0 lds
  v_max3_f32 v39, v39, v203, v204
  v_max3_f32 v40, v40, v219, v220
  s_waitcnt lgkmcnt(5)
  v_mfma_f32_32x32x16_bf16 a[128:143], a[200:203], v[56:59], a[128:143]
  buffer_load_dwordx4 v8, s[48:51], s67 offen offset:1024 lds
  v_max3_f32 v39, v39, v205, v206
  v_mfma_f32_32x32x16_bf16 a[144:159], a[200:203], v[60:63], a[144:159]
  ds_read_b128 a[220:223], v28 offset:0
  buffer_load_dwordx4 v9, s[48:51], s67 offen offset:2048 lds
  v_max3_f32 v40, v40, v221, v222
  v_max_f32 v39, v39, v207
  s_waitcnt lgkmcnt(4)
  v_mfma_f32_32x32x16_bf16 a[160:175], a[204:207], v[56:59], a[160:175]
  v_max_f32 v40, v40, v223
  v_mfma_f32_32x32x16_bf16 a[176:191], a[204:207], v[60:63], a[176:191]
  ds_read_b128 a[192:195], v25 offset:128
  v_max_f32 v41, v39, v40
  v_cmp_lt_f32 vcc, s72, v41
  s_cbranch_vccz L_ok8
  s_call_b64 s[70:71], L_rescale1
L_ok8:
  s_waitcnt lgkmcnt(4)
  v_mfma_f32_32x32x16_bf16 v[160:175], a[208:211], v[64:67], v[224:239]
  v_exp_f32 v192, v192
  v_exp_f32 v193, v193
  v_mfma_f32_32x32x16_bf16 v[176:191], a[208:211], v[72:75], v[240:255]
  ds_read_b128 a[196:199], v26 offset:128
  v_add_f32 v37, v37, v192
  v_exp_f32 v194, v194
  s_waitcnt lgkmcnt(4)
  v_mfma_f32_32x32x16_bf16 v[160:175], a[212:215], v[68:71], v[160:175]
  v_add_f32 v37, v37, v193
  v_cvt_pk_bf16_f32 v48, v192, v193
  v_exp_f32 v195, v195
  v_mfma_f32_32x32x16_bf16 v[176:191], a[212:215], v[76:79], v[176:191]
  ds_read_b128 a[200:203], v27 offset:128
  v_add_f32 v37, v37, v194
  v_exp_f32 v196, v196
  s_waitcnt lgkmcnt(4)
  v_mfma_f32_32x32x16_bf16 v[160:175], a[216:219], v[80:83], v[160:175]
  v_add_f32 v37, v37, v195
  v_cvt_pk_bf16_f32 v49, v194, v195
  v_mfma_f32_32x32x16_bf16 v[176:191], a[216:219], v[88:91], v[176:191]
  ds_read_b128 a[204:207], v28 offset:128
  v_exp_f32 v197, v197
  v_add_f32 v37, v37, v196
  v_exp_f32 v198, v198
  s_waitcnt lgkmcnt(4)
  v_mfma_f32_32x32x16_bf16 v[160:175], a[220:223], v[84:87], v[160:175]
  v_add_f32 v37, v37, v197
  v_cvt_pk_bf16_f32 v50, v196, v197
  v_mfma_f32_32x32x16_bf16 v[176:191], a[220:223], v[92:95], v[176:191]
  ds_read_b128 a[208:211], v25 offset:256
  v_exp_f32 v199, v199
  v_add_f32 v37, v37, v198
  s_waitcnt lgkmcnt(4)
  v_mfma_f32_32x32x16_bf16 v[160:175], a[192:195], v[96:99], v[160:175]
  v_exp_f32 v208, v208
  v_add_f32 v37, v37, v199
  v_cvt_pk_bf16_f32 v51, v198, v199
  v_mfma_f32_32x32x16_bf16 v[176:191], a[192:195], v[104:107], v[176:191]
  ds_read_b128 a[212:215], v26 offset:256
  v_exp_f32 v209, v209
  v_add_f32 v38, v38, v208
  s_waitcnt lgkmcnt(4)
  v_mfma_f32_32x32x16_bf16 v[160:175], a[196:199], v[100:103], v[160:175]
  v_exp_f32 v210, v210
  v_add_f32 v38, v38, v209
  v_cvt_pk_bf16_f32 v52, v208, v209
  v_mfma_f32_32x32x16_bf16 v[176:191], a[196:199], v[108:111], v[176:191]
  ds_read_b128 a[216:219], v27 offset:256
  v_exp_f32 v211, v211
  v_add_f32 v38, v38, v210
  s_waitcnt lgkmcnt(4)
  v_mfma_f32_32x32x16_bf16 v[160:175], a[200:203], v[112:115], v[160:175]
  v_exp_f32 v212, v212
  v_add_f32 v38, v38, v211
  v_cvt_pk_bf16_f32 v53, v210, v211
  v_mfma_f32_32x32x16_bf16 v[176:191], a[200:203], v[120:123], v[176:191]
  ds_read_b128 a[220:223], v28 offset:256
  v_exp_f32 v213, v213
  v_add_f32 v38, v38, v212
  s_waitcnt lgkmcnt(4)
  v_mfma_f32_32x32x16_bf16 v[160:175], a[204:207], v[116:119], v[160:175]
  v_exp_f32 v214, v214
  v_add_f32 v38, v38, v213
  v_mfma_f32_32x32x16_bf16 v[176:191], a[204:207], v[124:127], v[176:191]
  ds_read_b64_tr_b16 a[192:193], v19 offset:12288
  ds_read_b64_tr_b16 a[194:195], v19 offset:15360
  v_cvt_pk_bf16_f32 v54, v212, v213
  v_exp_f32 v215, v215
  v_add_f32 v38, v38, v214
  s_waitcnt lgkmcnt(5)
  v_mfma_f32_32x32x16_bf16 v[160:175], a[208:211], v[128:131], v[160:175]
  v_add_f32 v38, v38, v215
  v_cvt_pk_bf16_f32 v55, v214, v215
  v_mfma_f32_32x32x16_bf16 v[176:191], a[208:211], v[136:139], v[176:191]
  ds_read_b64_tr_b16 a[196:197], v20 offset:12288
  ds_read_b64_tr_b16 a[198:199], v20 offset:15360
  v_exp_f32 v200, v200
  v_exp_f32 v201, v201
  s_waitcnt lgkmcnt(6)
  v_mfma_f32_32x32x16_bf16 v[160:175], a[212:215], v[132:135], v[160:175]
  v_add_f32 v37, v37, v200
  v_exp_f32 v202, v202
  v_add_f32 v37, v37, v201
  v_mfma_f32_32x32x16_bf16 v[176:191], a[212:215], v[140:143], v[176:191]
  ds_read_b64_tr_b16 a[200:201], v19 offset:12416
  ds_read_b64_tr_b16 a[202:203], v19 offset:15488
  v_cvt_pk_bf16_f32 v56, v200, v201
  v_exp_f32 v203, v203
  s_waitcnt lgkmcnt(7)
  v_mfma_f32_32x32x16_bf16 v[160:175], a[216:219], v[144:147], v[160:175]
  v_add_f32 v37, v37, v202
  v_exp_f32 v204, v204
  v_mfma_f32_32x32x16_bf16 v[176:191], a[216:219], v[152:155], v[176:191]
  ds_read_b64_tr_b16 a[204:205], v20 offset:12416
  ds_read_b64_tr_b16 a[206:207], v20 offset:15488
  v_add_f32 v37, v37, v203
  v_cvt_pk_bf16_f32 v57, v202, v203
  v_exp_f32 v205, v205
  s_waitcnt lgkmcnt(8)
  v_mfma_f32_32x32x16_bf16 v[160:175], a[220:223], v[148:151], v[160:175]
  v_add_f32 v37, v37, v204
  v_exp_f32 v206, v206
  v_mfma_f32_32x32x16_bf16 v[176:191], a[220:223], v[156:159], v[176:191]
  ds_read_b64_tr_b16 a[208:209], v19 offset:12544
  ds_read_b64_tr_b16 a[210:211], v19 offset:15616
  s_waitcnt lgkmcnt(8)
  v_mfma_f32_32x32x16_bf16 a[0:15], a[192:195], v[48:51], a[0:15]
  v_add_f32 v37, v37, v205
  v_cvt_pk_bf16_f32 v58, v204, v205
  v_exp_f32 v207, v207
  v_mfma_f32_32x32x16_bf16 a[16:31], a[192:195], v[52:55], a[16:31]
  ds_read_b64_tr_b16 a[212:213], v20 offset:12544
  ds_read_b64_tr_b16 a[214:215], v20 offset:15616
  v_add_f32 v37, v37, v206
  v_exp_f32 v216, v216
  s_waitcnt lgkmcnt(8)
  v_mfma_f32_32x32x16_bf16 a[32:47], a[196:199], v[48:51], a[32:47]
  v_add_f32 v37, v37, v207
  v_cvt_pk_bf16_f32 v59, v206, v207
  v_mfma_f32_32x32x16_bf16 a[48:63], a[196:199], v[52:55], a[48:63]
  ds_read_b64_tr_b16 a[216:217], v19 offset:18432
  ds_read_b64_tr_b16 a[218:219], v19 offset:21504
  v_exp_f32 v217, v217
  v_add_f32 v38, v38, v216
  s_waitcnt lgkmcnt(8)
  v_mfma_f32_32x32x16_bf16 a[64:79], a[200:203], v[48:51], a[64:79]
  v_exp_f32 v218, v218
  v_add_f32 v38, v38, v217
  v_cvt_pk_bf16_f32 v60, v216, v217
  v_mfma_f32_32x32x16_bf16 a[80:95], a[200:203], v[52:55], a[80:95]
  ds_read_b64_tr_b16 a[220:221], v20 offset:18432
  ds_read_b64_tr_b16 a[222:223], v20 offset:21504
  v_exp_f32 v219, v219
  v_add_f32 v38, v38, v218
  s_waitcnt lgkmcnt(8)
  v_mfma_f32_32x32x16_bf16 a[96:111], a[204:207], v[48:51], a[96:111]
  v_exp_f32 v220, v220
  v_add_f32 v38, v38, v219
  v_mfma_f32_32x32x16_bf16 a[112:127], a[204:207], v[52:55], a[112:127]
  ds_read_b64_tr_b16 a[192:193], v19 offset:18560
  ds_read_b64_tr_b16 a[194:195], v19 offset:21632
  v_cvt_pk_bf16_f32 v61, v218, v219
  v_exp_f32 v221, v221
  s_waitcnt lgkmcnt(8)
  v_mfma_f32_32x32x16_bf16 a[128:143], a[208:211], v[48:51], a[128:143]
  v_add_f32 v38, v38, v220
  v_exp_f32 v222, v222
  v_add_f32 v38, v38, v221
  v_mfma_f32_32x32x16_bf16 a[144:159], a[208:211], v[52:55], a[144:159]
  ds_read_b64_tr_b16 a[196:197], v20 offset:18560
  ds_read_b64_tr_b16 a[198:199], v20 offset:21632
  v_cvt_pk_bf16_f32 v62, v220, v221
  v_exp_f32 v223, v223
  s_waitcnt lgkmcnt(8)
  v_mfma_f32_32x32x16_bf16 a[160:175], a[212:215], v[48:51], a[160:175]
  v_add_f32 v38, v38, v222
  v_add_f32 v38, v38, v223
  v_cvt_pk_bf16_f32 v63, v222, v223
  v_mfma_f32_32x32x16_bf16 a[176:191], a[212:215], v[52:55], a[176:191]
  ds_read_b64_tr_b16 a[200:201], v19 offset:18688
  ds_read_b64_tr_b16 a[202:203], v19 offset:21760
  s_waitcnt lgkmcnt(8)
  v_mfma_f32_32x32x16_bf16 a[0:15], a[216:219], v[56:59], a[0:15]
  v_max3_f32 v39, v160, v161, v162
  v_mfma_f32_32x32x16_bf16 a[16:31], a[216:219], v[60:63], a[16:31]
  ds_read_b64_tr_b16 a[204:205], v20 offset:18688
  ds_read_b64_tr_b16 a[206:207], v20 offset:21760
  v_max3_f32 v40, v176, v177, v178
  v_max3_f32 v39, v39, v163, v164
  s_waitcnt lgkmcnt(8)
  v_mfma_f32_32x32x16_bf16 a[32:47], a[220:223], v[56:59], a[32:47]
  v_max3_f32 v40, v40, v179, v180
  v_mfma_f32_32x32x16_bf16 a[48:63], a[220:223], v[60:63], a[48:63]
  s_waitcnt vmcnt(22)
  s_barrier
  ds_read_b128 a[208:211], v25 offset:24576
  v_max3_f32 v39, v39, v165, v166
  v_max3_f32 v40, v40, v181, v182
  s_waitcnt lgkmcnt(7)
  v_mfma_f32_32x32x16_bf16 a[64:79], a[192:195], v[56:59], a[64:79]
  s_mov_b32 s67, 172032
  s_add_u32 m0, s68, 135168
  s_nop 0
  buffer_load_dwordx4 v10, s[52:55], s67 offen offset:0 lds
  v_max3_f32 v39, v39, v167, v168
  v_mfma_f32_32x32x16_bf16 a[80:95], a[192:195], v[60:63], a[80:95]
  ds_read_b128 a[212:215], v26 offset:24576
  buffer_load_dwordx4 v11, s[52:55], s67 offen offset:1024 lds
  v_max3_f32 v40, v40, v183, v184
  v_max3_f32 v39, v39, v169, v170
  s_waitcnt lgkmcnt(6)
  v_mfma_f32_32x32x16_bf16 a[96:111], a[196:199], v[56:59], a[96:111]
  buffer_load_dwordx4 v12, s[52:55], s67 offen offset:2048 lds
  v_max3_f32 v40, v40, v185, v186
  s_getpc_b64 s[96:97]
  s_add_u32 s96, s96, 1024
  s_addc_u32 s97, s97, 0
  v_lshlrev_b32 v46, 6, v0
  v_mov_b32 v47, 0
  v_lshl_add_u64 v[46:47], v[46:47], 0, s[96:97]
  global_load_dword a225, v[46:47], off
  v_mfma_f32_32x32x16_bf16 a[112:127], a[196:199], v[60:63], a[112:127]
  ds_read_b128 a[216:219], v27 offset:24576
  s_mov_b32 s67, 184320
  s_add_u32 m0, s68, 147456
  s_nop 0
  buffer_load_dwordx4 v10, s[52:55], s67 offen offset:0 lds
  v_max3_f32 v39, v39, v171, v172
  v_max3_f32 v40, v40, v187, v188
  s_waitcnt lgkmcnt(5)
  v_mfma_f32_32x32x16_bf16 a[128:143], a[200:203], v[56:59], a[128:143]
  buffer_load_dwordx4 v11, s[52:55], s67 offen offset:1024 lds
  v_max3_f32 v39, v39, v173, v174
  v_mfma_f32_32x32x16_bf16 a[144:159], a[200:203], v[60:63], a[144:159]
  ds_read_b128 a[220:223], v28 offset:24576
  buffer_load_dwordx4 v12, s[52:55], s67 offen offset:2048 lds
  v_max3_f32 v40, v40, v189, v190
  v_max_f32 v39, v39, v175
  s_waitcnt lgkmcnt(4)
  v_mfma_f32_32x32x16_bf16 a[160:175], a[204:207], v[56:59], a[160:175]
  v_max_f32 v40, v40, v191
  v_mfma_f32_32x32x16_bf16 a[176:191], a[204:207], v[60:63], a[176:191]
  ds_read_b128 a[192:195], v25 offset:24704
  v_max_f32 v41, v39, v40
  v_cmp_lt_f32 vcc, s72, v41
  s_cbranch_vccz L_ok9
  s_call_b64 s[70:71], L_rescale0
L_ok9:
  s_waitcnt lgkmcnt(4)
  v_mfma_f32_32x32x16_bf16 v[192:207], a[208:211], v[64:67], v[224:239]
  v_exp_f32 v160, v160
  v_exp_f32 v161, v161
  v_mfma_f32_32x32x16_bf16 v[208:223], a[208:211], v[72:75], v[240:255]
  ds_read_b128 a[196:199], v26 offset:24704
  v_add_f32 v37, v37, v160
  v_exp_f32 v162, v162
  s_waitcnt lgkmcnt(4)
  v_mfma_f32_32x32x16_bf16 v[192:207], a[212:215], v[68:71], v[192:207]
  v_add_f32 v37, v37, v161
  v_cvt_pk_bf16_f32 v48, v160, v161
  v_exp_f32 v163, v163
  v_mfma_f32_32x32x16_bf16 v[208:223], a[212:215], v[76:79], v[208:223]
  ds_read_b128 a[200:203], v27 offset:24704
  v_add_f32 v37, v37, v162
  v_exp_f32 v164, v164
  s_waitcnt lgkmcnt(4)
  v_mfma_f32_32x32x16_bf16 v[192:207], a[216:219], v[80:83], v[192:207]
  v_add_f32 v37, v37, v163
  v_cvt_pk_bf16_f32 v49, v162, v163
  v_mfma_f32_32x32x16_bf16 v[208:223], a[216:219], v[88:91], v[208:223]
  ds_read_b128 a[204:207], v28 offset:24704
  v_exp_f32 v165, v165
  v_add_f32 v37, v37, v164
  v_exp_f32 v166, v166
  s_waitcnt lgkmcnt(4)
  v_mfma_f32_32x32x16_bf16 v[192:207], a[220:223], v[84:87], v[192:207]
  v_add_f32 v37, v37, v165
  v_cvt_pk_bf16_f32 v50, v164, v165
  v_mfma_f32_32x32x16_bf16 v[208:223], a[220:223], v[92:95], v[208:223]
  ds_read_b128 a[208:211], v25 offset:24832
  v_exp_f32 v167, v167
  v_add_f32 v37, v37, v166
  s_waitcnt lgkmcnt(4)
  v_mfma_f32_32x32x16_bf16 v[192:207], a[192:195], v[96:99], v[192:207]
  v_exp_f32 v176, v176
  v_add_f32 v37, v37, v167
  v_cvt_pk_bf16_f32 v51, v166, v167
  v_mfma_f32_32x32x16_bf16 v[208:223], a[192:195], v[104:107], v[208:223]
  ds_read_b128 a[212:215], v26 offset:24832
  v_exp_f32 v177, v177
  v_add_f32 v38, v38, v176
  s_waitcnt lgkmcnt(4)
  v_mfma_f32_32x32x16_bf16 v[192:207], a[196:199], v[100:103], v[192:207]
  v_exp_f32 v178, v178
  v_add_f32 v38, v38, v177
  v_cvt_pk_bf16_f32 v52, v176, v177
  v_mfma_f32_32x32x16_bf16 v[208:223], a[196:199], v[108:111], v[208:223]
  ds_read_b128 a[216:219], v27 offset:24832
  v_exp_f32 v179, v179
  v_add_f32 v38, v38, v178
  s_waitcnt lgkmcnt(4)
  v_mfma_f32_32x32x16_bf16 v[192:207], a[200:203], v[112:115], v[192:207]
  v_exp_f32 v180, v180
  v_add_f32 v38, v38, v179
  v_cvt_pk_bf16_f32 v53, v178, v179
  v_mfma_f32_32x32x16_bf16 v[208:223], a[200:203], v[120:123], v[208:223]
  ds_read_b128 a[220:223], v28 offset:24832
  v_exp_f32 v181, v181
  v_add_f32 v38, v38, v180
  s_waitcnt lgkmcnt(4)
  v_mfma_f32_32x32x16_bf16 v[192:207], a[204:207], v[116:119], v[192:207]
  v_exp_f32 v182, v182
  v_add_f32 v38, v38, v181
  v_mfma_f32_32x32x16_bf16 v[208:223], a[204:207], v[124:127], v[208:223]
  ds_read_b64_tr_b16 a[192:193], v19 offset:36864
  ds_read_b64_tr_b16 a[194:195], v19 offset:39936
  v_cvt_pk_bf16_f32 v54, v180, v181
  v_exp_f32 v183, v183
  v_add_f32 v38, v38, v182
  s_waitcnt lgkmcnt(5)
  v_mfma_f32_32x32x16_bf16 v[192:207], a[208:211], v[128:131], v[192:207]
  v_add_f32 v38, v38, v183
  v_cvt_pk_bf16_f32 v55, v182, v183
  v_mfma_f32_32x32x16_bf16 v[208:223], a[208:211], v[136:139], v[208:223]
  ds_read_b64_tr_b16 a[196:197], v20 offset:36864
  ds_read_b64_tr_b16 a[198:199], v20 offset:39936
  v_exp_f32 v168, v168
  v_exp_f32 v169, v169
  s_waitcnt lgkmcnt(6)
  v_mfma_f32_32x32x16_bf16 v[192:207], a[212:215], v[132:135], v[192:207]
  v_add_f32 v37, v37, v168
  v_exp_f32 v170, v170
  v_add_f32 v37, v37, v169
  v_mfma_f32_32x32x16_bf16 v[208:223], a[212:215], v[140:143], v[208:223]
  ds_read_b64_tr_b16 a[200:201], v19 offset:36992
  ds_read_b64_tr_b16 a[202:203], v19 offset:40064
  v_cvt_pk_bf16_f32 v56, v168, v169
  v_exp_f32 v171, v171
  s_waitcnt lgkmcnt(7)
  v_mfma_f32_32x32x16_bf16 v[192:207], a[216:219], v[144:147], v[192:207]
  v_add_f32 v37, v37, v170
  v_exp_f32 v172, v172
  v_mfma_f32_32x32x16_bf16 v[208:223], a[216:219], v[152:155], v[208:223]
  ds_read_b64_tr_b16 a[204:205], v20 offset:36992
  ds_read_b64_tr_b16 a[206:207], v20 offset:40064
  v_add_f32 v37, v37, v171
  v_cvt_pk_bf16_f32 v57, v170, v171
  v_exp_f32 v173, v173
  s_waitcnt lgkmcnt(8)
  v_mfma_f32_32x32x16_bf16 v[192:207], a[220:223], v[148:151], v[192:207]
  v_add_f32 v37, v37, v172
  v_exp_f32 v174, v174
  v_mfma_f32_32x32x16_bf16 v[208:223], a[220:223], v[156:159], v[208:223]
  ds_read_b64_tr_b16 a[208:209], v19 offset:37120
  ds_read_b64_tr_b16 a[210:211], v19 offset:40192
  s_waitcnt lgkmcnt(8)
  v_mfma_f32_32x32x16_bf16 a[0:15], a[192:195], v[48:51], a[0:15]
  v_add_f32 v37, v37, v173
  v_cvt_pk_bf16_f32 v58, v172, v173
  v_exp_f32 v175, v175
  v_mfma_f32_32x32x16_bf16 a[16:31], a[192:195], v[52:55], a[16:31]
  ds_read_b64_tr_b16 a[212:213], v20 offset:37120
  ds_read_b64_tr_b16 a[214:215], v20 offset:40192
  v_add_f32 v37, v37, v174
  v_exp_f32 v184, v184
  s_waitcnt lgkmcnt(8)
  v_mfma_f32_32x32x16_bf16 a[32:47], a[196:199], v[48:51], a[32:47]
  v_add_f32 v37, v37, v175
  v_cvt_pk_bf16_f32 v59, v174, v175
  v_mfma_f32_32x32x16_bf16 a[48:63], a[196:199], v[52:55], a[48:63]
  ds_read_b64_tr_b16 a[216:217], v19 offset:43008
  ds_read_b64_tr_b16 a[218:219], v19 offset:46080
  v_exp_f32 v185, v185
  v_add_f32 v38, v38, v184
  s_waitcnt lgkmcnt(8)
  v_mfma_f32_32x32x16_bf16 a[64:79], a[200:203], v[48:51], a[64:79]
  v_exp_f32 v186, v186
  v_add_f32 v38, v38, v185
  v_cvt_pk_bf16_f32 v60, v184, v185
  v_mfma_f32_32x32x16_bf16 a[80:95], a[200:203], v[52:55], a[80:95]
  ds_read_b64_tr_b16 a[220:221], v20 offset:43008
  ds_read_b64_tr_b16 a[222:223], v20 offset:46080
  v_exp_f32 v187, v187
  v_add_f32 v38, v38, v186
  s_waitcnt lgkmcnt(8)
  v_mfma_f32_32x32x16_bf16 a[96:111], a[204:207], v[48:51], a[96:111]
  v_exp_f32 v188, v188
  v_add_f32 v38, v38, v187
  v_mfma_f32_32x32x16_bf16 a[112:127], a[204:207], v[52:55], a[112:127]
  ds_read_b64_tr_b16 a[192:193], v19 offset:43136
  ds_read_b64_tr_b16 a[194:195], v19 offset:46208
  v_cvt_pk_bf16_f32 v61, v186, v187
  v_exp_f32 v189, v189
  s_waitcnt lgkmcnt(8)
  v_mfma_f32_32x32x16_bf16 a[128:143], a[208:211], v[48:51], a[128:143]
  v_add_f32 v38, v38, v188
  v_exp_f32 v190, v190
  v_add_f32 v38, v38, v189
  v_mfma_f32_32x32x16_bf16 a[144:159], a[208:211], v[52:55], a[144:159]
  ds_read_b64_tr_b16 a[196:197], v20 offset:43136
  ds_read_b64_tr_b16 a[198:199], v20 offset:46208
  v_cvt_pk_bf16_f32 v62, v188, v189
  v_exp_f32 v191, v191
  s_waitcnt lgkmcnt(8)
  v_mfma_f32_32x32x16_bf16 a[160:175], a[212:215], v[48:51], a[160:175]
  v_add_f32 v38, v38, v190
  v_add_f32 v38, v38, v191
  v_cvt_pk_bf16_f32 v63, v190, v191
  v_mfma_f32_32x32x16_bf16 a[176:191], a[212:215], v[52:55], a[176:191]
  ds_read_b64_tr_b16 a[200:201], v19 offset:43264
  ds_read_b64_tr_b16 a[202:203], v19 offset:46336
  s_waitcnt lgkmcnt(8)
  v_mfma_f32_32x32x16_bf16 a[0:15], a[216:219], v[56:59], a[0:15]
  v_max3_f32 v39, v192, v193, v194
  v_mfma_f32_32x32x16_bf16 a[16:31], a[216:219], v[60:63], a[16:31]
  ds_read_b64_tr_b16 a[204:205], v20 offset:43264
  ds_read_b64_tr_b16 a[206:207], v20 offset:46336
  v_max3_f32 v40, v208, v209, v210
  v_max3_f32 v39, v39, v195, v196
  s_waitcnt lgkmcnt(8)
  v_mfma_f32_32x32x16_bf16 a[32:47], a[220:223], v[56:59], a[32:47]
  v_max3_f32 v40, v40, v211, v212
  v_mfma_f32_32x32x16_bf16 a[48:63], a[220:223], v[60:63], a[48:63]
  s_waitcnt vmcnt(22)
  s_barrier
  ds_read_b128 a[208:211], v25 offset:49152
  v_max3_f32 v39, v39, v197, v198
  v_max3_f32 v40, v40, v213, v214
  s_waitcnt lgkmcnt(7)
  v_mfma_f32_32x32x16_bf16 a[64:79], a[192:195], v[56:59], a[64:79]
  s_add_u32 s67, s80, 0
  s_add_u32 m0, s68, 0
  s_nop 0
  buffer_load_dwordx4 v4, s[44:47], s67 offen offset:0 lds
  v_max3_f32 v39, v39, v199, v200
  v_mfma_f32_32x32x16_bf16 a[80:95], a[192:195], v[60:63], a[80:95]
  ds_read_b128 a[212:215], v26 offset:49152
  buffer_load_dwordx4 v5, s[44:47], s67 offen offset:1024 lds
  v_max3_f32 v40, v40, v215, v216
  v_max3_f32 v39, v39, v201, v202
  s_waitcnt lgkmcnt(6)
  v_mfma_f32_32x32x16_bf16 a[96:111], a[196:199], v[56:59], a[96:111]
  buffer_load_dwordx4 v6, s[44:47], s67 offen offset:2048 lds
  v_max3_f32 v40, v40, v217, v218
  v_mfma_f32_32x32x16_bf16 a[112:127], a[196:199], v[60:63], a[112:127]
  ds_read_b128 a[216:219], v27 offset:49152
  s_add_u32 s67, s80, 40960
  s_add_u32 m0, s68, 12288
  s_nop 0
  buffer_load_dwordx4 v4, s[44:47], s67 offen offset:0 lds
  v_max3_f32 v39, v39, v203, v204
  v_max3_f32 v40, v40, v219, v220
  s_waitcnt lgkmcnt(5)
  v_mfma_f32_32x32x16_bf16 a[128:143], a[200:203], v[56:59], a[128:143]
  buffer_load_dwordx4 v5, s[44:47], s67 offen offset:1024 lds
  v_max3_f32 v39, v39, v205, v206
  v_mfma_f32_32x32x16_bf16 a[144:159], a[200:203], v[60:63], a[144:159]
  ds_read_b128 a[220:223], v28 offset:49152
  buffer_load_dwordx4 v6, s[44:47], s67 offen offset:2048 lds
  v_max3_f32 v40, v40, v221, v222
  v_max_f32 v39, v39, v207
  s_waitcnt lgkmcnt(4)
  v_mfma_f32_32x32x16_bf16 a[160:175], a[204:207], v[56:59], a[160:175]
  v_max_f32 v40, v40, v223
  v_mfma_f32_32x32x16_bf16 a[176:191], a[204:207], v[60:63], a[176:191]
  ds_read_b128 a[192:195], v25 offset:49280
  v_max_f32 v41, v39, v40
  v_cmp_lt_f32 vcc, s72, v41
  s_cbranch_vccz L_ok10
  s_call_b64 s[70:71], L_rescale1
L_ok10:
  s_waitcnt lgkmcnt(4)
  v_mfma_f32_32x32x16_bf16 v[160:175], a[208:211], v[64:67], v[224:239]
  v_exp_f32 v192, v192
  v_exp_f32 v193, v193
  v_mfma_f32_32x32x16_bf16 v[176:191], a[208:211], v[72:75], v[240:255]
  ds_read_b128 a[196:199], v26 offset:49280
  v_add_f32 v37, v37, v192
  v_exp_f32 v194, v194
  s_waitcnt lgkmcnt(4)
  v_mfma_f32_32x32x16_bf16 v[160:175], a[212:215], v[68:71], v[160:175]
  v_add_f32 v37, v37, v193
  v_cvt_pk_bf16_f32 v48, v192, v193
  v_exp_f32 v195, v195
  v_mfma_f32_32x32x16_bf16 v[176:191], a[212:215], v[76:79], v[176:191]
  ds_read_b128 a[200:203], v27 offset:49280
  v_add_f32 v37, v37, v194
  v_exp_f32 v196, v196
  s_waitcnt lgkmcnt(4)
  v_mfma_f32_32x32x16_bf16 v[160:175], a[216:219], v[80:83], v[160:175]
  v_add_f32 v37, v37, v195
  v_cvt_pk_bf16_f32 v49, v194, v195
  v_mfma_f32_32x32x16_bf16 v[176:191], a[216:219], v[88:91], v[176:191]
  ds_read_b128 a[204:207], v28 offset:49280
  v_exp_f32 v197, v197
  v_add_f32 v37, v37, v196
  v_exp_f32 v198, v198
  s_waitcnt lgkmcnt(4)
  v_mfma_f32_32x32x16_bf16 v[160:175], a[220:223], v[84:87], v[160:175]
  v_add_f32 v37, v37, v197
  v_cvt_pk_bf16_f32 v50, v196, v197
  v_mfma_f32_32x32x16_bf16 v[176:191], a[220:223], v[92:95], v[176:191]
  ds_read_b128 a[208:211], v25 offset:49408
  v_exp_f32 v199, v199
  v_add_f32 v37, v37, v198
  s_waitcnt lgkmcnt(4)
  v_mfma_f32_32x32x16_bf16 v[160:175], a[192:195], v[96:99], v[160:175]
  v_exp_f32 v208, v208
  v_add_f32 v37, v37, v199
  v_cvt_pk_bf16_f32 v51, v198, v199
  v_mfma_f32_32x32x16_bf16 v[176:191], a[192:195], v[104:107], v[176:191]
  ds_read_b128 a[212:215], v26 offset:49408
  v_exp_f32 v209, v209
  v_add_f32 v38, v38, v208
  s_waitcnt lgkmcnt(4)
  v_mfma_f32_32x32x16_bf16 v[160:175], a[196:199], v[100:103], v[160:175]
  v_exp_f32 v210, v210
  v_add_f32 v38, v38, v209
  v_cvt_pk_bf16_f32 v52, v208, v209
  v_mfma_f32_32x32x16_bf16 v[176:191], a[196:199], v[108:111], v[176:191]
  ds_read_b128 a[216:219], v27 offset:49408
  v_exp_f32 v211, v211
  v_add_f32 v38, v38, v210
  s_waitcnt lgkmcnt(4)
  v_mfma_f32_32x32x16_bf16 v[160:175], a[200:203], v[112:115], v[160:175]
  v_exp_f32 v212, v212
  v_add_f32 v38, v38, v211
  v_cvt_pk_bf16_f32 v53, v210, v211
  v_mfma_f32_32x32x16_bf16 v[176:191], a[200:203], v[120:123], v[176:191]
  ds_read_b128 a[220:223], v28 offset:49408
  v_exp_f32 v213, v213
  v_add_f32 v38, v38, v212
  s_waitcnt lgkmcnt(4)
  v_mfma_f32_32x32x16_bf16 v[160:175], a[204:207], v[116:119], v[160:175]
  v_exp_f32 v214, v214
  v_add_f32 v38, v38, v213
  v_mfma_f32_32x32x16_bf16 v[176:191], a[204:207], v[124:127], v[176:191]
  ds_read_b64_tr_b16 a[192:193], v21 offset:0
  ds_read_b64_tr_b16 a[194:195], v21 offset:3072
  v_cvt_pk_bf16_f32 v54, v212, v213
  v_exp_f32 v215, v215
  v_add_f32 v38, v38, v214
  s_waitcnt lgkmcnt(5)
  v_mfma_f32_32x32x16_bf16 v[160:175], a[208:211], v[128:131], v[160:175]
  v_add_f32 v38, v38, v215
  v_cvt_pk_bf16_f32 v55, v214, v215
  v_mfma_f32_32x32x16_bf16 v[176:191], a[208:211], v[136:139], v[176:191]
  ds_read_b64_tr_b16 a[196:197], v22 offset:0
  ds_read_b64_tr_b16 a[198:199], v22 offset:3072
  v_exp_f32 v200, v200
  v_exp_f32 v201, v201
  s_waitcnt lgkmcnt(6)
  v_mfma_f32_32x32x16_bf16 v[160:175], a[212:215], v[132:135], v[160:175]
  v_add_f32 v37, v37, v200
  v_exp_f32 v202, v202
  v_add_f32 v37, v37, v201
  v_mfma_f32_32x32x16_bf16 v[176:191], a[212:215], v[140:143], v[176:191]
  ds_read_b64_tr_b16 a[200:201], v21 offset:128
  ds_read_b64_tr_b16 a[202:203], v21 offset:3200
  v_cvt_pk_bf16_f32 v56, v200, v201
  v_exp_f32 v203, v203
  s_waitcnt lgkmcnt(7)
  v_mfma_f32_32x32x16_bf16 v[160:175], a[216:219], v[144:147], v[160:175]
  v_add_f32 v37, v37, v202
  v_exp_f32 v204, v204
  v_mfma_f32_32x32x16_bf16 v[176:191], a[216:219], v[152:155], v[176:191]
  ds_read_b64_tr_b16 a[204:205], v22 offset:128
  ds_read_b64_tr_b16 a[206:207], v22 offset:3200
  v_add_f32 v37, v37, v203
  v_cvt_pk_bf16_f32 v57, v202, v203
  v_exp_f32 v205, v205
  s_waitcnt lgkmcnt(8)
  v_mfma_f32_32x32x16_bf16 v[160:175], a[220:223], v[148:151], v[160:175]
  v_add_f32 v37, v37, v204
  v_exp_f32 v206, v206
  v_mfma_f32_32x32x16_bf16 v[176:191], a[220:223], v[156:159], v[176:191]
  ds_read_b64_tr_b16 a[208:209], v21 offset:256
  ds_read_b64_tr_b16 a[210:211], v21 offset:3328
  s_waitcnt lgkmcnt(8)
  v_mfma_f32_32x32x16_bf16 a[0:15], a[192:195], v[48:51], a[0:15]
  v_add_f32 v37, v37, v205
  v_cvt_pk_bf16_f32 v58, v204, v205
  v_exp_f32 v207, v207
  v_mfma_f32_32x32x16_bf16 a[16:31], a[192:195], v[52:55], a[16:31]
  ds_read_b64_tr_b16 a[212:213], v22 offset:256
  ds_read_b64_tr_b16 a[214:215], v22 offset:3328
  v_add_f32 v37, v37, v206
  v_exp_f32 v216, v216
  s_waitcnt lgkmcnt(8)
  v_mfma_f32_32x32x16_bf16 a[32:47], a[196:199], v[48:51], a[32:47]
  v_add_f32 v37, v37, v207
  v_cvt_pk_bf16_f32 v59, v206, v207
  v_mfma_f32_32x32x16_bf16 a[48:63], a[196:199], v[52:55], a[48:63]
  ds_read_b64_tr_b16 a[216:217], v21 offset:6144
  ds_read_b64_tr_b16 a[218:219], v21 offset:9216
  v_exp_f32 v217, v217
  v_add_f32 v38, v38, v216
  s_waitcnt lgkmcnt(8)
  v_mfma_f32_32x32x16_bf16 a[64:79], a[200:203], v[48:51], a[64:79]
  v_exp_f32 v218, v218
  v_add_f32 v38, v38, v217
  v_cvt_pk_bf16_f32 v60, v216, v217
  v_mfma_f32_32x32x16_bf16 a[80:95], a[200:203], v[52:55], a[80:95]
  ds_read_b64_tr_b16 a[220:221], v22 offset:6144
  ds_read_b64_tr_b16 a[222:223], v22 offset:9216
  v_exp_f32 v219, v219
  v_add_f32 v38, v38, v218
  s_waitcnt lgkmcnt(8)
  v_mfma_f32_32x32x16_bf16 a[96:111], a[204:207], v[48:51], a[96:111]
  v_exp_f32 v220, v220
  v_add_f32 v38, v38, v219
  v_mfma_f32_32x32x16_bf16 a[112:127], a[204:207], v[52:55], a[112:127]
  ds_read_b64_tr_b16 a[192:193], v21 offset:6272
  ds_read_b64_tr_b16 a[194:195], v21 offset:9344
  v_cvt_pk_bf16_f32 v61, v218, v219
  v_exp_f32 v221, v221
  s_waitcnt lgkmcnt(8)
  v_mfma_f32_32x32x16_bf16 a[128:143], a[208:211], v[48:51], a[128:143]
  v_add_f32 v38, v38, v220
  v_exp_f32 v222, v222
  v_add_f32 v38, v38, v221
  v_mfma_f32_32x32x16_bf16 a[144:159], a[208:211], v[52:55], a[144:159]
  ds_read_b64_tr_b16 a[196:197], v22 offset:6272
  ds_read_b64_tr_b16 a[198:199], v22 offset:9344
  v_cvt_pk_bf16_f32 v62, v220, v221
  v_exp_f32 v223, v223
  s_waitcnt lgkmcnt(8)
  v_mfma_f32_32x32x16_bf16 a[160:175], a[212:215], v[48:51], a[160:175]
  v_add_f32 v38, v38, v222
  v_add_f32 v38, v38, v223
  v_cvt_pk_bf16_f32 v63, v222, v223
  v_mfma_f32_32x32x16_bf16 a[176:191], a[212:215], v[52:55], a[176:191]
  ds_read_b64_tr_b16 a[200:201], v21 offset:6400
  ds_read_b64_tr_b16 a[202:203], v21 offset:9472
  s_waitcnt lgkmcnt(8)
  v_mfma_f32_32x32x16_bf16 a[0:15], a[216:219], v[56:59], a[0:15]
  v_max3_f32 v39, v160, v161, v162
  v_mfma_f32_32x32x16_bf16 a[16:31], a[216:219], v[60:63], a[16:31]
  ds_read_b64_tr_b16 a[204:205], v22 offset:6400
  ds_read_b64_tr_b16 a[206:207], v22 offset:9472
  v_max3_f32 v40, v176, v177, v178
  v_max3_f32 v39, v39, v163, v164
  s_waitcnt lgkmcnt(8)
  v_mfma_f32_32x32x16_bf16 a[32:47], a[220:223], v[56:59], a[32:47]
  v_max3_f32 v40, v40, v179, v180
  v_mfma_f32_32x32x16_bf16 a[48:63], a[220:223], v[60:63], a[48:63]
  s_waitcnt vmcnt(22)
  s_barrier
  ds_read_b128 a[208:211], v29 offset:12288
  v_max3_f32 v39, v39, v165, v166
  v_max3_f32 v40, v40, v181, v182
  s_waitcnt lgkmcnt(7)
  v_mfma_f32_32x32x16_bf16 a[64:79], a[192:195], v[56:59], a[64:79]
  s_add_u32 s67, s80, 81920
  s_add_u32 m0, s68, 24576
  s_nop 0
  buffer_load_dwordx4 v4, s[44:47], s67 offen offset:0 lds
  v_max3_f32 v39, v39, v167, v168
  v_mfma_f32_32x32x16_bf16 a[80:95], a[192:195], v[60:63], a[80:95]
  ds_read_b128 a[212:215], v30 offset:12288
  buffer_load_dwordx4 v5, s[44:47], s67 offen offset:1024 lds
  v_max3_f32 v40, v40, v183, v184
  v_max3_f32 v39, v39, v169, v170
  s_waitcnt lgkmcnt(6)
  v_mfma_f32_32x32x16_bf16 a[96:111], a[196:199], v[56:59], a[96:111]
  buffer_load_dwordx4 v6, s[44:47], s67 offen offset:2048 lds
  v_max3_f32 v40, v40, v185, v186
  v_mfma_f32_32x32x16_bf16 a[112:127], a[196:199], v[60:63], a[112:127]
  ds_read_b128 a[216:219], v31 offset:12288
  s_add_u32 s67, s80, 122880
  s_add_u32 m0, s68, 36864
  s_nop 0
  buffer_load_dwordx4 v4, s[44:47], s67 offen offset:0 lds
  v_max3_f32 v39, v39, v171, v172
  v_max3_f32 v40, v40, v187, v188
  s_waitcnt lgkmcnt(5)
  v_mfma_f32_32x32x16_bf16 a[128:143], a[200:203], v[56:59], a[128:143]
  buffer_load_dwordx4 v5, s[44:47], s67 offen offset:1024 lds
  v_max3_f32 v39, v39, v173, v174
  v_mfma_f32_32x32x16_bf16 a[144:159], a[200:203], v[60:63], a[144:159]
  ds_read_b128 a[220:223], v32 offset:12288
  buffer_load_dwordx4 v6, s[44:47], s67 offen offset:2048 lds
  v_max3_f32 v40, v40, v189, v190
  v_max_f32 v39, v39, v175
  s_waitcnt lgkmcnt(4)
  v_mfma_f32_32x32x16_bf16 a[160:175], a[204:207], v[56:59], a[160:175]
  v_max_f32 v40, v40, v191
  v_mfma_f32_32x32x16_bf16 a[176:191], a[204:207], v[60:63], a[176:191]
  ds_read_b128 a[192:195], v29 offset:12416
  v_max_f32 v41, v39, v40
  v_cmp_lt_f32 vcc, s72, v41
  s_cbranch_vccz L_ok11
  s_call_b64 s[70:71], L_rescale0
L_ok11:
  s_waitcnt lgkmcnt(4)
  v_mfma_f32_32x32x16_bf16 v[192:207], a[208:211], v[64:67], v[224:239]
  v_exp_f32 v160, v160
  v_exp_f32 v161, v161
  v_mfma_f32_32x32x16_bf16 v[208:223], a[208:211], v[72:75], v[240:255]
  ds_read_b128 a[196:199], v30 offset:12416
  v_add_f32 v37, v37, v160
  v_exp_f32 v162, v162
  s_waitcnt lgkmcnt(4)
  v_mfma_f32_32x32x16_bf16 v[192:207], a[212:215], v[68:71], v[192:207]
  v_add_f32 v37, v37, v161
  v_cvt_pk_bf16_f32 v48, v160, v161
  v_exp_f32 v163, v163
  v_mfma_f32_32x32x16_bf16 v[208:223], a[212:215], v[76:79], v[208:223]
  ds_read_b128 a[200:203], v31 offset:12416
  v_add_f32 v37, v37, v162
  v_exp_f32 v164, v164
  s_waitcnt lgkmcnt(4)
  v_mfma_f32_32x32x16_bf16 v[192:207], a[216:219], v[80:83], v[192:207]
  v_add_f32 v37, v37, v163
  v_cvt_pk_bf16_f32 v49, v162, v163
  v_mfma_f32_32x32x16_bf16 v[208:223], a[216:219], v[88:91], v[208:223]
  ds_read_b128 a[204:207], v32 offset:12416
  v_exp_f32 v165, v165
  v_add_f32 v37, v37, v164
  v_exp_f32 v166, v166
  s_waitcnt lgkmcnt(4)
  v_mfma_f32_32x32x16_bf16 v[192:207], a[220:223], v[84:87], v[192:207]
  v_add_f32 v37, v37, v165
  v_cvt_pk_bf16_f32 v50, v164, v165
  v_mfma_f32_32x32x16_bf16 v[208:223], a[220:223], v[92:95], v[208:223]
  ds_read_b128 a[208:211], v29 offset:12544
  v_exp_f32 v167, v167
  v_add_f32 v37, v37, v166
  s_waitcnt lgkmcnt(4)
  v_mfma_f32_32x32x16_bf16 v[192:207], a[192:195], v[96:99], v[192:207]
  v_exp_f32 v176, v176
  v_add_f32 v37, v37, v167
  v_cvt_pk_bf16_f32 v51, v166, v167
  v_mfma_f32_32x32x16_bf16 v[208:223], a[192:195], v[104:107], v[208:223]
  ds_read_b128 a[212:215], v30 offset:12544
  v_exp_f32 v177, v177
  v_add_f32 v38, v38, v176
  s_waitcnt lgkmcnt(4)
  v_mfma_f32_32x32x16_bf16 v[192:207], a[196:199], v[100:103], v[192:207]
  v_exp_f32 v178, v178
  v_add_f32 v38, v38, v177
  v_cvt_pk_bf16_f32 v52, v176, v177
  v_mfma_f32_32x32x16_bf16 v[208:223], a[196:199], v[108:111], v[208:223]
  ds_read_b128 a[216:219], v31 offset:12544
  v_exp_f32 v179, v179
  v_add_f32 v38, v38, v178
  s_waitcnt lgkmcnt(4)
  v_mfma_f32_32x32x16_bf16 v[192:207], a[200:203], v[112:115], v[192:207]
  v_exp_f32 v180, v180
  v_add_f32 v38, v38, v179
  v_cvt_pk_bf16_f32 v53, v178, v179
  v_mfma_f32_32x32x16_bf16 v[208:223], a[200:203], v[120:123], v[208:223]
  ds_read_b128 a[220:223], v32 offset:12544
  v_exp_f32 v181, v181
  v_add_f32 v38, v38, v180
  s_waitcnt lgkmcnt(4)
  v_mfma_f32_32x32x16_bf16 v[192:207], a[204:207], v[116:119], v[192:207]
  v_exp_f32 v182, v182
  v_add_f32 v38, v38, v181
  v_mfma_f32_32x32x16_bf16 v[208:223], a[204:207], v[124:127], v[208:223]
  ds_read_b64_tr_b16 a[192:193], v21 offset:24576
  ds_read_b64_tr_b16 a[194:195], v21 offset:27648
  v_cvt_pk_bf16_f32 v54, v180, v181
  v_exp_f32 v183, v183
  v_add_f32 v38, v38, v182
  s_waitcnt lgkmcnt(5)
  v_mfma_f32_32x32x16_bf16 v[192:207], a[208:211], v[128:131], v[192:207]
  v_add_f32 v38, v38, v183
  v_cvt_pk_bf16_f32 v55, v182, v183
  v_mfma_f32_32x32x16_bf16 v[208:223], a[208:211], v[136:139], v[208:223]
  ds_read_b64_tr_b16 a[196:197], v22 offset:24576
  ds_read_b64_tr_b16 a[198:199], v22 offset:27648
  v_exp_f32 v168, v168
  v_exp_f32 v169, v169
  s_waitcnt lgkmcnt(6)
  v_mfma_f32_32x32x16_bf16 v[192:207], a[212:215], v[132:135], v[192:207]
  v_add_f32 v37, v37, v168
  v_exp_f32 v170, v170
  v_add_f32 v37, v37, v169
  v_mfma_f32_32x32x16_bf16 v[208:223], a[212:215], v[140:143], v[208:223]
  ds_read_b64_tr_b16 a[200:201], v21 offset:24704
  ds_read_b64_tr_b16 a[202:203], v21 offset:27776
  v_cvt_pk_bf16_f32 v56, v168, v169
  v_exp_f32 v171, v171
  s_waitcnt lgkmcnt(7)
  v_mfma_f32_32x32x16_bf16 v[192:207], a[216:219], v[144:147], v[192:207]
  v_add_f32 v37, v37, v170
  v_exp_f32 v172, v172
  v_mfma_f32_32x32x16_bf16 v[208:223], a[216:219], v[152:155], v[208:223]
  ds_read_b64_tr_b16 a[204:205], v22 offset:24704
  ds_read_b64_tr_b16 a[206:207], v22 offset:27776
  v_add_f32 v37, v37, v171
  v_cvt_pk_bf16_f32 v57, v170, v171
  v_exp_f32 v173, v173
  s_waitcnt lgkmcnt(8)
  v_mfma_f32_32x32x16_bf16 v[192:207], a[220:223], v[148:151], v[192:207]
  v_add_f32 v37, v37, v172
  v_exp_f32 v174, v174
  v_mfma_f32_32x32x16_bf16 v[208:223], a[220:223], v[156:159], v[208:223]
  ds_read_b64_tr_b16 a[208:209], v21 offset:24832
  ds_read_b64_tr_b16 a[210:211], v21 offset:27904
  s_waitcnt lgkmcnt(8)
  v_mfma_f32_32x32x16_bf16 a[0:15], a[192:195], v[48:51], a[0:15]
  v_add_f32 v37, v37, v173
  v_cvt_pk_bf16_f32 v58, v172, v173
  v_exp_f32 v175, v175
  v_mfma_f32_32x32x16_bf16 a[16:31], a[192:195], v[52:55], a[16:31]
  ds_read_b64_tr_b16 a[212:213], v22 offset:24832
  ds_read_b64_tr_b16 a[214:215], v22 offset:27904
  v_add_f32 v37, v37, v174
  v_exp_f32 v184, v184
  s_waitcnt lgkmcnt(8)
  v_mfma_f32_32x32x16_bf16 a[32:47], a[196:199], v[48:51], a[32:47]
  v_add_f32 v37, v37, v175
  v_cvt_pk_bf16_f32 v59, v174, v175
  v_mfma_f32_32x32x16_bf16 a[48:63], a[196:199], v[52:55], a[48:63]
  ds_read_b64_tr_b16 a[216:217], v21 offset:30720
  ds_read_b64_tr_b16 a[218:219], v21 offset:33792
  v_exp_f32 v185, v185
  v_add_f32 v38, v38, v184
  s_waitcnt lgkmcnt(8)
  v_mfma_f32_32x32x16_bf16 a[64:79], a[200:203], v[48:51], a[64:79]
  v_exp_f32 v186, v186
  v_add_f32 v38, v38, v185
  v_cvt_pk_bf16_f32 v60, v184, v185
  v_mfma_f32_32x32x16_bf16 a[80:95], a[200:203], v[52:55], a[80:95]
  ds_read_b64_tr_b16 a[220:221], v22 offset:30720
  ds_read_b64_tr_b16 a[222:223], v22 offset:33792
  v_exp_f32 v187, v187
  v_add_f32 v38, v38, v186
  s_waitcnt lgkmcnt(8)
  v_mfma_f32_32x32x16_bf16 a[96:111], a[204:207], v[48:51], a[96:111]
  v_exp_f32 v188, v188
  v_add_f32 v38, v38, v187
  v_mfma_f32_32x32x16_bf16 a[112:127], a[204:207], v[52:55], a[112:127]
  ds_read_b64_tr_b16 a[192:193], v21 offset:30848
  ds_read_b64_tr_b16 a[194:195], v21 offset:33920
  v_cvt_pk_bf16_f32 v61, v186, v187
  v_exp_f32 v189, v189
  s_waitcnt lgkmcnt(8)
  v_mfma_f32_32x32x16_bf16 a[128:143], a[208:211], v[48:51], a[128:143]
  v_add_f32 v38, v38, v188
  v_exp_f32 v190, v190
  v_add_f32 v38, v38, v189
  v_mfma_f32_32x32x16_bf16 a[144:159], a[208:211], v[52:55], a[144:159]
  ds_read_b64_tr_b16 a[196:197], v22 offset:30848
  ds_read_b64_tr_b16 a[198:199], v22 offset:33920
  v_cvt_pk_bf16_f32 v62, v188, v189
  v_exp_f32 v191, v191
  s_waitcnt lgkmcnt(8)
  v_mfma_f32_32x32x16_bf16 a[160:175], a[212:215], v[48:51], a[160:175]
  v_add_f32 v38, v38, v190
  v_add_f32 v38, v38, v191
  v_cvt_pk_bf16_f32 v63, v190, v191
  v_mfma_f32_32x32x16_bf16 a[176:191], a[212:215], v[52:55], a[176:191]
  ds_read_b64_tr_b16 a[200:201], v21 offset:30976
  ds_read_b64_tr_b16 a[202:203], v21 offset:34048
  s_waitcnt lgkmcnt(8)
  v_mfma_f32_32x32x16_bf16 a[0:15], a[216:219], v[56:59], a[0:15]
  v_max3_f32 v39, v192, v193, v194
  v_mfma_f32_32x32x16_bf16 a[16:31], a[216:219], v[60:63], a[16:31]
  ds_read_b64_tr_b16 a[204:205], v22 offset:30976
  ds_read_b64_tr_b16 a[206:207], v22 offset:34048
  v_max3_f32 v40, v208, v209, v210
  v_max3_f32 v39, v39, v195, v196
  s_waitcnt lgkmcnt(8)
  v_mfma_f32_32x32x16_bf16 a[32:47], a[220:223], v[56:59], a[32:47]
  v_max3_f32 v40, v40, v211, v212
  v_mfma_f32_32x32x16_bf16 a[48:63], a[220:223], v[60:63], a[48:63]
  s_waitcnt vmcnt(22)
  s_barrier
  ds_read_b128 a[208:211], v29 offset:36864
  v_max3_f32 v39, v39, v197, v198
  v_max3_f32 v40, v40, v213, v214
  s_waitcnt lgkmcnt(7)
  v_mfma_f32_32x32x16_bf16 a[64:79], a[192:195], v[56:59], a[64:79]
  s_add_u32 s67, s80, 163840
  s_add_u32 m0, s68, 49152
  s_nop 0
  buffer_load_dwordx4 v4, s[44:47], s67 offen offset:0 lds
  v_max3_f32 v39, v39, v199, v200
  v_mfma_f32_32x32x16_bf16 a[80:95], a[192:195], v[60:63], a[80:95]
  ds_read_b128 a[212:215], v30 offset:36864
  buffer_load_dwordx4 v5, s[44:47], s67 offen offset:1024 lds
  v_max3_f32 v40, v40, v215, v216
  v_max3_f32 v39, v39, v201, v202
  s_waitcnt lgkmcnt(6)
  v_mfma_f32_32x32x16_bf16 a[96:111], a[196:199], v[56:59], a[96:111]
  buffer_load_dwordx4 v6, s[44:47], s67 offen offset:2048 lds
  v_max3_f32 v40, v40, v217, v218
  v_mfma_f32_32x32x16_bf16 a[112:127], a[196:199], v[60:63], a[112:127]
  ds_read_b128 a[216:219], v31 offset:36864
  s_add_u32 s67, s80, 204800
  s_add_u32 m0, s68, 61440
  s_nop 0
  buffer_load_dwordx4 v4, s[44:47], s67 offen offset:0 lds
  v_max3_f32 v39, v39, v203, v204
  v_max3_f32 v40, v40, v219, v220
  s_waitcnt lgkmcnt(5)
  v_mfma_f32_32x32x16_bf16 a[128:143], a[200:203], v[56:59], a[128:143]
  buffer_load_dwordx4 v5, s[44:47], s67 offen offset:1024 lds
  v_max3_f32 v39, v39, v205, v206
  v_mfma_f32_32x32x16_bf16 a[144:159], a[200:203], v[60:63], a[144:159]
  ds_read_b128 a[220:223], v32 offset:36864
  buffer_load_dwordx4 v6, s[44:47], s67 offen offset:2048 lds
  v_max3_f32 v40, v40, v221, v222
  v_max_f32 v39, v39, v207
  s_waitcnt lgkmcnt(4)
  v_mfma_f32_32x32x16_bf16 a[160:175], a[204:207], v[56:59], a[160:175]
  v_max_f32 v40, v40, v223
  v_mfma_f32_32x32x16_bf16 a[176:191], a[204:207], v[60:63], a[176:191]
  ds_read_b128 a[192:195], v29 offset:36992
  v_max_f32 v41, v39, v40
  v_cmp_lt_f32 vcc, s72, v41
  s_cbranch_vccz L_ok12
  s_call_b64 s[70:71], L_rescale1
L_ok12:
  s_waitcnt lgkmcnt(4)
  v_mfma_f32_32x32x16_bf16 v[160:175], a[208:211], v[64:67], v[224:239]
  v_exp_f32 v192, v192
  v_exp_f32 v193, v193
  v_mfma_f32_32x32x16_bf16 v[176:191], a[208:211], v[72:75], v[240:255]
  ds_read_b128 a[196:199], v30 offset:36992
  v_add_f32 v37, v37, v192
  v_exp_f32 v194, v194
  s_waitcnt lgkmcnt(4)
  v_mfma_f32_32x32x16_bf16 v[160:175], a[212:215], v[68:71], v[160:175]
  v_add_f32 v37, v37, v193
  v_cvt_pk_bf16_f32 v48, v192, v193
  v_exp_f32 v195, v195
  v_mfma_f32_32x32x16_bf16 v[176:191], a[212:215], v[76:79], v[176:191]
  ds_read_b128 a[200:203], v31 offset:36992
  v_add_f32 v37, v37, v194
  v_exp_f32 v196, v196
  s_waitcnt lgkmcnt(4)
  v_mfma_f32_32x32x16_bf16 v[160:175], a[216:219], v[80:83], v[160:175]
  v_add_f32 v37, v37, v195
  v_cvt_pk_bf16_f32 v49, v194, v195
  v_mfma_f32_32x32x16_bf16 v[176:191], a[216:219], v[88:91], v[176:191]
  ds_read_b128 a[204:207], v32 offset:36992
  v_exp_f32 v197, v197
  v_add_f32 v37, v37, v196
  v_exp_f32 v198, v198
  s_waitcnt lgkmcnt(4)
  v_mfma_f32_32x32x16_bf16 v[160:175], a[220:223], v[84:87], v[160:175]
  v_add_f32 v37, v37, v197
  v_cvt_pk_bf16_f32 v50, v196, v197
  v_mfma_f32_32x32x16_bf16 v[176:191], a[220:223], v[92:95], v[176:191]
  ds_read_b128 a[208:211], v29 offset:37120
  v_exp_f32 v199, v199
  v_add_f32 v37, v37, v198
  s_waitcnt lgkmcnt(4)
  v_mfma_f32_32x32x16_bf16 v[160:175], a[192:195], v[96:99], v[160:175]
  v_exp_f32 v208, v208
  v_add_f32 v37, v37, v199
  v_cvt_pk_bf16_f32 v51, v198, v199
  v_mfma_f32_32x32x16_bf16 v[176:191], a[192:195], v[104:107], v[176:191]
  ds_read_b128 a[212:215], v30 offset:37120
  v_exp_f32 v209, v209
  v_add_f32 v38, v38, v208
  s_waitcnt lgkmcnt(4)
  v_mfma_f32_32x32x16_bf16 v[160:175], a[196:199], v[100:103], v[160:175]
  v_exp_f32 v210, v210
  v_add_f32 v38, v38, v209
  v_cvt_pk_bf16_f32 v52, v208, v209
  v_mfma_f32_32x32x16_bf16 v[176:191], a[196:199], v[108:111], v[176:191]
  ds_read_b128 a[216:219], v31 offset:37120
  v_exp_f32 v211, v211
  v_add_f32 v38, v38, v210
  s_waitcnt lgkmcnt(4)
  v_mfma_f32_32x32x16_bf16 v[160:175], a[200:203], v[112:115], v[160:175]
  v_exp_f32 v212, v212
  v_add_f32 v38, v38, v211
  v_cvt_pk_bf16_f32 v53, v210, v211
  v_mfma_f32_32x32x16_bf16 v[176:191], a[200:203], v[120:123], v[176:191]
  ds_read_b128 a[220:223], v32 offset:37120
  v_exp_f32 v213, v213
  v_add_f32 v38, v38, v212
  s_waitcnt lgkmcnt(4)
  v_mfma_f32_32x32x16_bf16 v[160:175], a[204:207], v[116:119], v[160:175]
  v_exp_f32 v214, v214
  v_add_f32 v38, v38, v213
  v_mfma_f32_32x32x16_bf16 v[176:191], a[204:207], v[124:127], v[176:191]
  ds_read_b64_tr_b16 a[192:193], v21 offset:49152
  ds_read_b64_tr_b16 a[194:195], v21 offset:52224
  v_cvt_pk_bf16_f32 v54, v212, v213
  v_exp_f32 v215, v215
  v_add_f32 v38, v38, v214
  s_waitcnt lgkmcnt(5)
  v_mfma_f32_32x32x16_bf16 v[160:175], a[208:211], v[128:131], v[160:175]
  v_add_f32 v38, v38, v215
  v_cvt_pk_bf16_f32 v55, v214, v215
  v_mfma_f32_32x32x16_bf16 v[176:191], a[208:211], v[136:139], v[176:191]
  ds_read_b64_tr_b16 a[196:197], v22 offset:49152
  ds_read_b64_tr_b16 a[198:199], v22 offset:52224
  v_exp_f32 v200, v200
  v_exp_f32 v201, v201
  s_waitcnt lgkmcnt(6)
  v_mfma_f32_32x32x16_bf16 v[160:175], a[212:215], v[132:135], v[160:175]
  v_add_f32 v37, v37, v200
  v_exp_f32 v202, v202
  v_add_f32 v37, v37, v201
  v_mfma_f32_32x32x16_bf16 v[176:191], a[212:215], v[140:143], v[176:191]
  ds_read_b64_tr_b16 a[200:201], v21 offset:49280
  ds_read_b64_tr_b16 a[202:203], v21 offset:52352
  v_cvt_pk_bf16_f32 v56, v200, v201
  v_exp_f32 v203, v203
  s_waitcnt lgkmcnt(7)
  v_mfma_f32_32x32x16_bf16 v[160:175], a[216:219], v[144:147], v[160:175]
  v_add_f32 v37, v37, v202
  v_exp_f32 v204, v204
  v_mfma_f32_32x32x16_bf16 v[176:191], a[216:219], v[152:155], v[176:191]
  ds_read_b64_tr_b16 a[204:205], v22 offset:49280
  ds_read_b64_tr_b16 a[206:207], v22 offset:52352
  v_add_f32 v37, v37, v203
  v_cvt_pk_bf16_f32 v57, v202, v203
  v_exp_f32 v205, v205
  s_waitcnt lgkmcnt(8)
  v_mfma_f32_32x32x16_bf16 v[160:175], a[220:223], v[148:151], v[160:175]
  v_add_f32 v37, v37, v204
  v_exp_f32 v206, v206
  v_mfma_f32_32x32x16_bf16 v[176:191], a[220:223], v[156:159], v[176:191]
  ds_read_b64_tr_b16 a[208:209], v21 offset:49408
  ds_read_b64_tr_b16 a[210:211], v21 offset:52480
  s_waitcnt lgkmcnt(8)
  v_mfma_f32_32x32x16_bf16 a[0:15], a[192:195], v[48:51], a[0:15]
  v_add_f32 v37, v37, v205
  v_cvt_pk_bf16_f32 v58, v204, v205
  v_exp_f32 v207, v207
  v_mfma_f32_32x32x16_bf16 a[16:31], a[192:195], v[52:55], a[16:31]
  ds_read_b64_tr_b16 a[212:213], v22 offset:49408
  ds_read_b64_tr_b16 a[214:215], v22 offset:52480
  v_add_f32 v37, v37, v206
  v_exp_f32 v216, v216
  s_waitcnt lgkmcnt(8)
  v_mfma_f32_32x32x16_bf16 a[32:47], a[196:199], v[48:51], a[32:47]
  v_add_f32 v37, v37, v207
  v_cvt_pk_bf16_f32 v59, v206, v207
  v_mfma_f32_32x32x16_bf16 a[48:63], a[196:199], v[52:55], a[48:63]
  ds_read_b64_tr_b16 a[216:217], v21 offset:55296
  ds_read_b64_tr_b16 a[218:219], v21 offset:58368
  v_exp_f32 v217, v217
  v_add_f32 v38, v38, v216
  s_waitcnt lgkmcnt(8)
  v_mfma_f32_32x32x16_bf16 a[64:79], a[200:203], v[48:51], a[64:79]
  v_exp_f32 v218, v218
  v_add_f32 v38, v38, v217
  v_cvt_pk_bf16_f32 v60, v216, v217
  v_mfma_f32_32x32x16_bf16 a[80:95], a[200:203], v[52:55], a[80:95]
  ds_read_b64_tr_b16 a[220:221], v22 offset:55296
  ds_read_b64_tr_b16 a[222:223], v22 offset:58368
  v_exp_f32 v219, v219
  v_add_f32 v38, v38, v218
  s_waitcnt lgkmcnt(8)
  v_mfma_f32_32x32x16_bf16 a[96:111], a[204:207], v[48:51], a[96:111]
  v_exp_f32 v220, v220
  v_add_f32 v38, v38, v219
  v_mfma_f32_32x32x16_bf16 a[112:127], a[204:207], v[52:55], a[112:127]
  ds_read_b64_tr_b16 a[192:193], v21 offset:55424
  ds_read_b64_tr_b16 a[194:195], v21 offset:58496
  v_cvt_pk_bf16_f32 v61, v218, v219
  v_exp_f32 v221, v221
  s_waitcnt lgkmcnt(8)
  v_mfma_f32_32x32x16_bf16 a[128:143], a[208:211], v[48:51], a[128:143]
  v_add_f32 v38, v38, v220
  v_exp_f32 v222, v222
  v_add_f32 v38, v38, v221
  v_mfma_f32_32x32x16_bf16 a[144:159], a[208:211], v[52:55], a[144:159]
  ds_read_b64_tr_b16 a[196:197], v22 offset:55424
  ds_read_b64_tr_b16 a[198:199], v22 offset:58496
  v_cvt_pk_bf16_f32 v62, v220, v221
  v_exp_f32 v223, v223
  s_waitcnt lgkmcnt(8)
  v_mfma_f32_32x32x16_bf16 a[160:175], a[212:215], v[48:51], a[160:175]
  v_add_f32 v38, v38, v222
  v_add_f32 v38, v38, v223
  v_cvt_pk_bf16_f32 v63, v222, v223
  v_mfma_f32_32x32x16_bf16 a[176:191], a[212:215], v[52:55], a[176:191]
  ds_read_b64_tr_b16 a[200:201], v21 offset:55552
  ds_read_b64_tr_b16 a[202:203], v21 offset:58624
  s_waitcnt lgkmcnt(8)
  v_mfma_f32_32x32x16_bf16 a[0:15], a[216:219], v[56:59], a[0:15]
  v_max3_f32 v39, v160, v161, v162
  v_mfma_f32_32x32x16_bf16 a[16:31], a[216:219], v[60:63], a[16:31]
  ds_read_b64_tr_b16 a[204:205], v22 offset:55552
  ds_read_b64_tr_b16 a[206:207], v22 offset:58624
  v_max3_f32 v40, v176, v177, v178
  v_max3_f32 v39, v39, v163, v164
  s_waitcnt lgkmcnt(8)
  v_mfma_f32_32x32x16_bf16 a[32:47], a[220:223], v[56:59], a[32:47]
  v_max3_f32 v40, v40, v179, v180
  v_mfma_f32_32x32x16_bf16 a[48:63], a[220:223], v[60:63], a[48:63]
  s_waitcnt vmcnt(22)
  s_barrier
  ds_read_b128 a[208:211], v33 offset:0
  v_max3_f32 v39, v39, v165, v166
  v_max3_f32 v40, v40, v181, v182
  s_waitcnt lgkmcnt(7)
  v_mfma_f32_32x32x16_bf16 a[64:79], a[192:195], v[56:59], a[64:79]
  s_add_u32 s67, s81, 0
  s_add_u32 m0, s68, 73728
  s_nop 0
  buffer_load_dwordx4 v4, s[44:47], s67 offen offset:0 lds
  v_max3_f32 v39, v39, v167, v168
  v_mfma_f32_32x32x16_bf16 a[80:95], a[192:195], v[60:63], a[80:95]
  ds_read_b128 a[212:215], v34 offset:0
  buffer_load_dwordx4 v5, s[44:47], s67 offen offset:1024 lds
  v_max3_f32 v40, v40, v183, v184
  v_max3_f32 v39, v39, v169, v170
  s_waitcnt lgkmcnt(6)
  v_mfma_f32_32x32x16_bf16 a[96:111], a[196:199], v[56:59], a[96:111]
  buffer_load_dwordx4 v6, s[44:47], s67 offen offset:2048 lds
  v_max3_f32 v40, v40, v185, v186
  v_mfma_f32_32x32x16_bf16 a[112:127], a[196:199], v[60:63], a[112:127]
  ds_read_b128 a[216:219], v35 offset:0
  s_add_u32 s67, s82, 0
  s_add_u32 m0, s68, 86016
  s_nop 0
  buffer_load_dwordx4 v4, s[44:47], s67 offen offset:0 lds
  v_max3_f32 v39, v39, v171, v172
  v_max3_f32 v40, v40, v187, v188
  s_waitcnt lgkmcnt(5)
  v_mfma_f32_32x32x16_bf16 a[128:143], a[200:203], v[56:59], a[128:143]
  buffer_load_dwordx4 v5, s[44:47], s67 offen offset:1024 lds
  v_max3_f32 v39, v39, v173, v174
  v_mfma_f32_32x32x16_bf16 a[144:159], a[200:203], v[60:63], a[144:159]
  ds_read_b128 a[220:223], v36 offset:0
  buffer_load_dwordx4 v6, s[44:47], s67 offen offset:2048 lds
  v_max3_f32 v40, v40, v189, v190
  v_max_f32 v39, v39, v175
  s_waitcnt lgkmcnt(4)
  v_mfma_f32_32x32x16_bf16 a[160:175], a[204:207], v[56:59], a[160:175]
  v_max_f32 v40, v40, v191
  v_mfma_f32_32x32x16_bf16 a[176:191], a[204:207], v[60:63], a[176:191]
  ds_read_b128 a[192:195], v33 offset:128
  v_max_f32 v41, v39, v40
  v_cmp_lt_f32 vcc, s72, v41
  s_cbranch_vccz L_ok13
  s_call_b64 s[70:71], L_rescale0
L_ok13:
  s_waitcnt lgkmcnt(4)
  v_mfma_f32_32x32x16_bf16 v[192:207], a[208:211], v[64:67], v[224:239]
  v_exp_f32 v160, v160
  v_exp_f32 v161, v161
  v_mfma_f32_32x32x16_bf16 v[208:223], a[208:211], v[72:75], v[240:255]
  ds_read_b128 a[196:199], v34 offset:128
  v_add_f32 v37, v37, v160
  v_exp_f32 v162, v162
  s_waitcnt lgkmcnt(4)
  v_mfma_f32_32x32x16_bf16 v[192:207], a[212:215], v[68:71], v[192:207]
  v_add_f32 v37, v37, v161
  v_cvt_pk_bf16_f32 v48, v160, v161
  v_exp_f32 v163, v163
  v_mfma_f32_32x32x16_bf16 v[208:223], a[212:215], v[76:79], v[208:223]
  ds_read_b128 a[200:203], v35 offset:128
  v_add_f32 v37, v37, v162
  v_exp_f32 v164, v164
  s_waitcnt lgkmcnt(4)
  v_mfma_f32_32x32x16_bf16 v[192:207], a[216:219], v[80:83], v[192:207]
  v_add_f32 v37, v37, v163
  v_cvt_pk_bf16_f32 v49, v162, v163
  v_mfma_f32_32x32x16_bf16 v[208:223], a[216:219], v[88:91], v[208:223]
  ds_read_b128 a[204:207], v36 offset:128
  v_exp_f32 v165, v165
  v_add_f32 v37, v37, v164
  v_exp_f32 v166, v166
  s_waitcnt lgkmcnt(4)
  v_mfma_f32_32x32x16_bf16 v[192:207], a[220:223], v[84:87], v[192:207]
  v_add_f32 v37, v37, v165
  v_cvt_pk_bf16_f32 v50, v164, v165
  v_mfma_f32_32x32x16_bf16 v[208:223], a[220:223], v[92:95], v[208:223]
  ds_read_b128 a[208:211], v33 offset:256
  v_exp_f32 v167, v167
  v_add_f32 v37, v37, v166
  s_waitcnt lgkmcnt(4)
  v_mfma_f32_32x32x16_bf16 v[192:207], a[192:195], v[96:99], v[192:207]
  v_exp_f32 v176, v176
  v_add_f32 v37, v37, v167
  v_cvt_pk_bf16_f32 v51, v166, v167
  v_mfma_f32_32x32x16_bf16 v[208:223], a[192:195], v[104:107], v[208:223]
  ds_read_b128 a[212:215], v34 offset:256
  v_exp_f32 v177, v177
  v_add_f32 v38, v38, v176
  s_waitcnt lgkmcnt(4)
  v_mfma_f32_32x32x16_bf16 v[192:207], a[196:199], v[100:103], v[192:207]
  v_exp_f32 v178, v178
  v_add_f32 v38, v38, v177
  v_cvt_pk_bf16_f32 v52, v176, v177
  v_mfma_f32_32x32x16_bf16 v[208:223], a[196:199], v[108:111], v[208:223]
  ds_read_b128 a[216:219], v35 offset:256
  v_exp_f32 v179, v179
  v_add_f32 v38, v38, v178
  s_waitcnt lgkmcnt(4)
  v_mfma_f32_32x32x16_bf16 v[192:207], a[200:203], v[112:115], v[192:207]
  v_exp_f32 v180, v180
  v_add_f32 v38, v38, v179
  v_cvt_pk_bf16_f32 v53, v178, v179
  v_mfma_f32_32x32x16_bf16 v[208:223], a[200:203], v[120:123], v[208:223]
  ds_read_b128 a[220:223], v36 offset:256
  v_exp_f32 v181, v181
  v_add_f32 v38, v38, v180
  s_waitcnt lgkmcnt(4)
  v_mfma_f32_32x32x16_bf16 v[192:207], a[204:207], v[116:119], v[192:207]
  v_exp_f32 v182, v182
  v_add_f32 v38, v38, v181
  v_mfma_f32_32x32x16_bf16 v[208:223], a[204:207], v[124:127], v[208:223]
  ds_read_b64_tr_b16 a[192:193], v23 offset:12288
  ds_read_b64_tr_b16 a[194:195], v23 offset:15360
  v_cvt_pk_bf16_f32 v54, v180, v181
  v_exp_f32 v183, v183
  v_add_f32 v38, v38, v182
  s_waitcnt lgkmcnt(5)
  v_mfma_f32_32x32x16_bf16 v[192:207], a[208:211], v[128:131], v[192:207]
  v_add_f32 v38, v38, v183
  v_cvt_pk_bf16_f32 v55, v182, v183
  v_mfma_f32_32x32x16_bf16 v[208:223], a[208:211], v[136:139], v[208:223]
  ds_read_b64_tr_b16 a[196:197], v24 offset:12288
  ds_read_b64_tr_b16 a[198:199], v24 offset:15360
  v_exp_f32 v168, v168
  v_exp_f32 v169, v169
  s_waitcnt lgkmcnt(6)
  v_mfma_f32_32x32x16_bf16 v[192:207], a[212:215], v[132:135], v[192:207]
  v_add_f32 v37, v37, v168
  v_exp_f32 v170, v170
  v_add_f32 v37, v37, v169
  v_mfma_f32_32x32x16_bf16 v[208:223], a[212:215], v[140:143], v[208:223]
  ds_read_b64_tr_b16 a[200:201], v23 offset:12416
  ds_read_b64_tr_b16 a[202:203], v23 offset:15488
  v_cvt_pk_bf16_f32 v56, v168, v169
  v_exp_f32 v171, v171
  s_waitcnt lgkmcnt(7)
  v_mfma_f32_32x32x16_bf16 v[192:207], a[216:219], v[144:147], v[192:207]
  v_add_f32 v37, v37, v170
  v_exp_f32 v172, v172
  v_mfma_f32_32x32x16_bf16 v[208:223], a[216:219], v[152:155], v[208:223]
  ds_read_b64_tr_b16 a[204:205], v24 offset:12416
  ds_read_b64_tr_b16 a[206:207], v24 offset:15488
  v_add_f32 v37, v37, v171
  v_cvt_pk_bf16_f32 v57, v170, v171
  v_exp_f32 v173, v173
  s_waitcnt lgkmcnt(8)
  v_mfma_f32_32x32x16_bf16 v[192:207], a[220:223], v[148:151], v[192:207]
  v_add_f32 v37, v37, v172
  v_exp_f32 v174, v174
  v_mfma_f32_32x32x16_bf16 v[208:223], a[220:223], v[156:159], v[208:223]
  ds_read_b64_tr_b16 a[208:209], v23 offset:12544
  ds_read_b64_tr_b16 a[210:211], v23 offset:15616
  s_waitcnt lgkmcnt(8)
  v_mfma_f32_32x32x16_bf16 a[0:15], a[192:195], v[48:51], a[0:15]
  v_add_f32 v37, v37, v173
  v_cvt_pk_bf16_f32 v58, v172, v173
  v_exp_f32 v175, v175
  v_mfma_f32_32x32x16_bf16 a[16:31], a[192:195], v[52:55], a[16:31]
  ds_read_b64_tr_b16 a[212:213], v24 offset:12544
  ds_read_b64_tr_b16 a[214:215], v24 offset:15616
  v_add_f32 v37, v37, v174
  v_exp_f32 v184, v184
  s_waitcnt lgkmcnt(8)
  v_mfma_f32_32x32x16_bf16 a[32:47], a[196:199], v[48:51], a[32:47]
  v_add_f32 v37, v37, v175
  v_cvt_pk_bf16_f32 v59, v174, v175
  v_mfma_f32_32x32x16_bf16 a[48:63], a[196:199], v[52:55], a[48:63]
  ds_read_b64_tr_b16 a[216:217], v23 offset:18432
  ds_read_b64_tr_b16 a[218:219], v23 offset:21504
  v_exp_f32 v185, v185
  v_add_f32 v38, v38, v184
  s_waitcnt lgkmcnt(8)
  v_mfma_f32_32x32x16_bf16 a[64:79], a[200:203], v[48:51], a[64:79]
  v_exp_f32 v186, v186
  v_add_f32 v38, v38, v185
  v_cvt_pk_bf16_f32 v60, v184, v185
  v_mfma_f32_32x32x16_bf16 a[80:95], a[200:203], v[52:55], a[80:95]
  ds_read_b64_tr_b16 a[220:221], v24 offset:18432
  ds_read_b64_tr_b16 a[222:223], v24 offset:21504
  v_exp_f32 v187, v187
  v_add_f32 v38, v38, v186
  s_waitcnt lgkmcnt(8)
  v_mfma_f32_32x32x16_bf16 a[96:111], a[204:207], v[48:51], a[96:111]
  v_exp_f32 v188, v188
  v_add_f32 v38, v38, v187
  v_mfma_f32_32x32x16_bf16 a[112:127], a[204:207], v[52:55], a[112:127]
  ds_read_b64_tr_b16 a[192:193], v23 offset:18560
  ds_read_b64_tr_b16 a[194:195], v23 offset:21632
  v_cvt_pk_bf16_f32 v61, v186, v187
  v_exp_f32 v189, v189
  s_waitcnt lgkmcnt(8)
  v_mfma_f32_32x32x16_bf16 a[128:143], a[208:211], v[48:51], a[128:143]
  v_add_f32 v38, v38, v188
  v_exp_f32 v190, v190
  v_add_f32 v38, v38, v189
  v_mfma_f32_32x32x16_bf16 a[144:159], a[208:211], v[52:55], a[144:159]
  ds_read_b64_tr_b16 a[196:197], v24 offset:18560
  ds_read_b64_tr_b16 a[198:199], v24 offset:21632
  v_cvt_pk_bf16_f32 v62, v188, v189
  v_exp_f32 v191, v191
  s_waitcnt lgkmcnt(8)
  v_mfma_f32_32x32x16_bf16 a[160:175], a[212:215], v[48:51], a[160:175]
  v_add_f32 v38, v38, v190
  v_add_f32 v38, v38, v191
  v_cvt_pk_bf16_f32 v63, v190, v191
  v_mfma_f32_32x32x16_bf16 a[176:191], a[212:215], v[52:55], a[176:191]
  ds_read_b64_tr_b16 a[200:201], v23 offset:18688
  ds_read_b64_tr_b16 a[202:203], v23 offset:21760
  s_waitcnt lgkmcnt(8)
  v_mfma_f32_32x32x16_bf16 a[0:15], a[216:219], v[56:59], a[0:15]
  v_max3_f32 v39, v192, v193, v194
  v_mfma_f32_32x32x16_bf16 a[16:31], a[216:219], v[60:63], a[16:31]
  ds_read_b64_tr_b16 a[204:205], v24 offset:18688
  ds_read_b64_tr_b16 a[206:207], v24 offset:21760
  v_max3_f32 v40, v208, v209, v210
  v_max3_f32 v39, v39, v195, v196
  s_waitcnt lgkmcnt(8)
  v_mfma_f32_32x32x16_bf16 a[32:47], a[220:223], v[56:59], a[32:47]
  v_max3_f32 v40, v40, v211, v212
  v_mfma_f32_32x32x16_bf16 a[48:63], a[220:223], v[60:63], a[48:63]
  s_waitcnt vmcnt(24)
  s_barrier
  ds_read_b64_tr_b16 a[208:209], v23 offset:24576
  ds_read_b64_tr_b16 a[210:211], v23 offset:27648
  v_max3_f32 v39, v39, v197, v198
  v_max3_f32 v40, v40, v213, v214
  s_waitcnt lgkmcnt(8)
  v_mfma_f32_32x32x16_bf16 a[64:79], a[192:195], v[56:59], a[64:79]
  s_add_u32 s67, s83, 0
  s_add_u32 m0, s68, 98304
  s_nop 0
  buffer_load_dwordx4 v4, s[44:47], s67 offen offset:0 lds
  v_max3_f32 v39, v39, v199, v200
  v_mfma_f32_32x32x16_bf16 a[80:95], a[192:195], v[60:63], a[80:95]
  ds_read_b64_tr_b16 a[212:213], v24 offset:24576
  ds_read_b64_tr_b16 a[214:215], v24 offset:27648
  buffer_load_dwordx4 v5, s[44:47], s67 offen offset:1024 lds
  v_max3_f32 v40, v40, v215, v216
  v_max3_f32 v39, v39, v201, v202
  s_waitcnt lgkmcnt(8)
  v_mfma_f32_32x32x16_bf16 a[96:111], a[196:199], v[56:59], a[96:111]
  buffer_load_dwordx4 v6, s[44:47], s67 offen offset:2048 lds
  v_max3_f32 v40, v40, v217, v218
  v_mfma_f32_32x32x16_bf16 a[112:127], a[196:199], v[60:63], a[112:127]
  ds_read_b64_tr_b16 a[216:217], v23 offset:24704
  ds_read_b64_tr_b16 a[218:219], v23 offset:27776
  s_add_u32 s67, s81, 40960
  s_add_u32 m0, s68, 110592
  s_nop 0
  buffer_load_dwordx4 v4, s[44:47], s67 offen offset:0 lds
  v_max3_f32 v39, v39, v203, v204
  v_max3_f32 v40, v40, v219, v220
  s_waitcnt lgkmcnt(8)
  v_mfma_f32_32x32x16_bf16 a[128:143], a[200:203], v[56:59], a[128:143]
  buffer_load_dwordx4 v5, s[44:47], s67 offen offset:1024 lds
  v_max3_f32 v39, v39, v205, v206
  v_mfma_f32_32x32x16_bf16 a[144:159], a[200:203], v[60:63], a[144:159]
  ds_read_b64_tr_b16 a[220:221], v24 offset:24704
  ds_read_b64_tr_b16 a[222:223], v24 offset:27776
  buffer_load_dwordx4 v6, s[44:47], s67 offen offset:2048 lds
  v_max3_f32 v40, v40, v221, v222
  v_max_f32 v39, v39, v207
  s_waitcnt lgkmcnt(8)
  v_mfma_f32_32x32x16_bf16 a[160:175], a[204:207], v[56:59], a[160:175]
  v_max_f32 v40, v40, v223
  v_mfma_f32_32x32x16_bf16 a[176:191], a[204:207], v[60:63], a[176:191]
  ds_read_b64_tr_b16 a[192:193], v23 offset:24832
  ds_read_b64_tr_b16 a[194:195], v23 offset:27904
  v_max_f32 v41, v39, v40
  v_cmp_lt_f32 vcc, s72, v41
  s_cbranch_vccz L_ok14
  s_call_b64 s[70:71], L_rescale1
L_ok14:
  v_exp_f32 v192, v192
  v_exp_f32 v193, v193
  v_add_f32 v37, v37, v192
  v_exp_f32 v194, v194
  v_add_f32 v37, v37, v193
  v_cvt_pk_bf16_f32 v48, v192, v193
  v_exp_f32 v195, v195
  v_add_f32 v37, v37, v194
  v_exp_f32 v196, v196
  v_add_f32 v37, v37, v195
  v_cvt_pk_bf16_f32 v49, v194, v195
  v_exp_f32 v197, v197
  v_add_f32 v37, v37, v196
  v_exp_f32 v198, v198
  v_add_f32 v37, v37, v197
  v_cvt_pk_bf16_f32 v50, v196, v197
  v_exp_f32 v199, v199
  v_add_f32 v37, v37, v198
  v_exp_f32 v208, v208
  v_add_f32 v37, v37, v199
  v_cvt_pk_bf16_f32 v51, v198, v199
  v_exp_f32 v209, v209
  v_add_f32 v38, v38, v208
  v_exp_f32 v210, v210
  v_add_f32 v38, v38, v209
  v_cvt_pk_bf16_f32 v52, v208, v209
  v_exp_f32 v211, v211
  v_add_f32 v38, v38, v210
  v_exp_f32 v212, v212
  v_add_f32 v38, v38, v211
  v_cvt_pk_bf16_f32 v53, v210, v211
  v_exp_f32 v213, v213
  v_add_f32 v38, v38, v212
  v_exp_f32 v214, v214
  v_add_f32 v38, v38, v213
  v_cvt_pk_bf16_f32 v54, v212, v213
  v_exp_f32 v215, v215
  v_add_f32 v38, v38, v214
  v_add_f32 v38, v38, v215
  v_cvt_pk_bf16_f32 v55, v214, v215
  s_waitcnt lgkmcnt(8)
  v_mfma_f32_32x32x16_bf16 a[0:15], a[208:211], v[48:51], a[0:15]
  v_exp_f32 v200, v200
  v_exp_f32 v201, v201
  v_add_f32 v37, v37, v200
  s_lshl_b32 s60, s33, 5
  s_add_u32 s60, s60, s34
  s_lshl_b32 s60, s60, 2
  s_add_u32 s60, s60, s30
  s_mul_i32 s60, s60, 24576
  s_add_u32 s84, s28, s60
  s_addc_u32 s85, s29, 0
  s_add_u32 s84, s84, 14155776
  s_addc_u32 s85, s85, 0
  s_mov_b32 s86, 24576
  s_mov_b32 s87, 0x20000
  v_mfma_f32_32x32x16_bf16 a[16:31], a[208:211], v[52:55], a[16:31]
  ds_read_b64_tr_b16 a[196:197], v24 offset:24832
  ds_read_b64_tr_b16 a[198:199], v24 offset:27904
  v_exp_f32 v202, v202
  v_add_f32 v37, v37, v201
  v_cvt_pk_bf16_f32 v56, v200, v201
  v_exp_f32 v203, v203
  s_waitcnt lgkmcnt(8)
  v_mfma_f32_32x32x16_bf16 a[32:47], a[212:215], v[48:51], a[32:47]
  v_add_f32 v37, v37, v202
  v_exp_f32 v204, v204
  v_add_f32 v37, v37, v203
  v_mfma_f32_32x32x16_bf16 a[48:63], a[212:215], v[52:55], a[48:63]
  ds_read_b64_tr_b16 a[200:201], v23 offset:30720
  ds_read_b64_tr_b16 a[202:203], v23 offset:33792
  v_cvt_pk_bf16_f32 v57, v202, v203
  v_exp_f32 v205, v205
  v_add_f32 v37, v37, v204
  v_exp_f32 v206, v206
  s_waitcnt lgkmcnt(8)
  v_mfma_f32_32x32x16_bf16 a[64:79], a[216:219], v[48:51], a[64:79]
  v_add_f32 v37, v37, v205
  v_cvt_pk_bf16_f32 v58, v204, v205
  v_exp_f32 v207, v207
  v_mfma_f32_32x32x16_bf16 a[80:95], a[216:219], v[52:55], a[80:95]
  ds_read_b64_tr_b16 a[204:205], v24 offset:30720
  ds_read_b64_tr_b16 a[206:207], v24 offset:33792
  v_add_f32 v37, v37, v206
  v_exp_f32 v216, v216
  v_add_f32 v37, v37, v207
  v_cvt_pk_bf16_f32 v59, v206, v207
  s_waitcnt lgkmcnt(8)
  v_mfma_f32_32x32x16_bf16 a[96:111], a[220:223], v[48:51], a[96:111]
  v_exp_f32 v217, v217
  v_add_f32 v38, v38, v216
  v_exp_f32 v218, v218
  v_add_f32 v38, v38, v217
  v_mfma_f32_32x32x16_bf16 a[112:127], a[220:223], v[52:55], a[112:127]
  ds_read_b64_tr_b16 a[208:209], v23 offset:30848
  ds_read_b64_tr_b16 a[210:211], v23 offset:33920
  v_cvt_pk_bf16_f32 v60, v216, v217
  v_exp_f32 v219, v219
  v_add_f32 v38, v38, v218
  s_waitcnt lgkmcnt(8)
  v_mfma_f32_32x32x16_bf16 a[128:143], a[192:195], v[48:51], a[128:143]
  v_exp_f32 v220, v220
  v_add_f32 v38, v38, v219
  v_cvt_pk_bf16_f32 v61, v218, v219
  v_exp_f32 v221, v221
  v_mfma_f32_32x32x16_bf16 a[144:159], a[192:195], v[52:55], a[144:159]
  ds_read_b64_tr_b16 a[212:213], v24 offset:30848
  ds_read_b64_tr_b16 a[214:215], v24 offset:33920
  v_add_f32 v38, v38, v220
  v_exp_f32 v222, v222
  v_add_f32 v38, v38, v221
  v_cvt_pk_bf16_f32 v62, v220, v221
  s_waitcnt lgkmcnt(8)
  v_mfma_f32_32x32x16_bf16 a[160:175], a[196:199], v[48:51], a[160:175]
  v_exp_f32 v223, v223
  v_add_f32 v38, v38, v222
  v_add_f32 v38, v38, v223
  v_cvt_pk_bf16_f32 v63, v222, v223
  v_mfma_f32_32x32x16_bf16 a[176:191], a[196:199], v[52:55], a[176:191]
  ds_read_b64_tr_b16 a[216:217], v23 offset:30976
  ds_read_b64_tr_b16 a[218:219], v23 offset:34048
  s_waitcnt lgkmcnt(8)
  v_mfma_f32_32x32x16_bf16 a[0:15], a[200:203], v[56:59], a[0:15]
  v_mov_b32 v39, v37
  v_mov_b32 v40, v38
  s_nop 1
  v_permlane32_swap_b32 v39, v37
  v_mfma_f32_32x32x16_bf16 a[16:31], a[200:203], v[60:63], a[16:31]
  ds_read_b64_tr_b16 a[220:221], v24 offset:30976
  ds_read_b64_tr_b16 a[222:223], v24 offset:34048
  v_permlane32_swap_b32 v40, v38
  v_add_f32 v37, v37, v39
  v_add_f32 v38, v38, v40
  v_rcp_f32 v48, v37
  s_waitcnt lgkmcnt(8)
  v_mfma_f32_32x32x16_bf16 a[32:47], a[204:207], v[56:59], a[32:47]
  v_rcp_f32 v50, v38
  s_nop 0
  v_mov_b32 v49, v48
  v_mov_b32 v51, v50
  v_mfma_f32_32x32x16_bf16 a[48:63], a[204:207], v[60:63], a[48:63]
  s_waitcnt lgkmcnt(6)
  v_mfma_f32_32x32x16_bf16 a[64:79], a[208:211], v[56:59], a[64:79]
  v_accvgpr_read_b32 v80, a0
  v_accvgpr_read_b32 v81, a1
  v_accvgpr_read_b32 v82, a2
  v_accvgpr_read_b32 v83, a3
  v_accvgpr_read_b32 v84, a4
  v_accvgpr_read_b32 v85, a5
  v_accvgpr_read_b32 v86, a6
  v_accvgpr_read_b32 v87, a7
  v_accvgpr_read_b32 v88, a8
  v_accvgpr_read_b32 v89, a9
  v_accvgpr_read_b32 v90, a10
  v_mfma_f32_32x32x16_bf16 a[80:95], a[208:211], v[60:63], a[80:95]
  v_accvgpr_read_b32 v91, a11
  v_accvgpr_read_b32 v92, a12
  v_accvgpr_read_b32 v93, a13
  v_accvgpr_read_b32 v94, a14
  v_accvgpr_read_b32 v95, a15
  v_pk_mul_f32 v[80:81], v[80:81], v[48:49]
  v_pk_mul_f32 v[82:83], v[82:83], v[48:49]
  v_pk_mul_f32 v[84:85], v[84:85], v[48:49]
  v_pk_mul_f32 v[86:87], v[86:87], v[48:49]
  v_pk_mul_f32 v[88:89], v[88:89], v[48:49]
  s_waitcnt lgkmcnt(4)
  v_mfma_f32_32x32x16_bf16 a[96:111], a[212:215], v[56:59], a[96:111]
  v_pk_mul_f32 v[90:91], v[90:91], v[48:49]
  v_pk_mul_f32 v[92:93], v[92:93], v[48:49]
  v_pk_mul_f32 v[94:95], v[94:95], v[48:49]
  v_cvt_pk_bf16_f32 v64, v80, v81
  v_cvt_pk_bf16_f32 v65, v82, v83
  v_cvt_pk_bf16_f32 v66, v84, v85
  v_cvt_pk_bf16_f32 v67, v86, v87
  v_cvt_pk_bf16_f32 v68, v88, v89
  v_cvt_pk_bf16_f32 v69, v90, v91
  v_cvt_pk_bf16_f32 v70, v92, v93
  v_cvt_pk_bf16_f32 v71, v94, v95
  v_mfma_f32_32x32x16_bf16 a[112:127], a[212:215], v[60:63], a[112:127]
  s_mov_b32 s66, 0
  buffer_store_dwordx4 v[64:67], v2, s[84:87], s66 offen offset:0 sc1
  s_mov_b32 s66, 0
  buffer_store_dwordx4 v[68:71], v2, s[84:87], s66 offen offset:1024 sc1
  v_accvgpr_write_b32 a0, v64
  v_accvgpr_write_b32 a1, v65
  v_accvgpr_write_b32 a2, v66
  v_accvgpr_write_b32 a3, v67
  v_accvgpr_write_b32 a4, v68
  v_accvgpr_write_b32 a5, v69
  v_accvgpr_write_b32 a6, v70
  v_accvgpr_write_b32 a7, v71
  s_waitcnt lgkmcnt(2)
  v_mfma_f32_32x32x16_bf16 a[128:143], a[216:219], v[56:59], a[128:143]
  v_accvgpr_read_b32 v80, a16
  v_accvgpr_read_b32 v81, a17
  v_accvgpr_read_b32 v82, a18
  v_accvgpr_read_b32 v83, a19
  v_accvgpr_read_b32 v84, a20
  v_accvgpr_read_b32 v85, a21
  v_accvgpr_read_b32 v86, a22
  v_accvgpr_read_b32 v87, a23
  v_accvgpr_read_b32 v88, a24
  v_accvgpr_read_b32 v89, a25
  v_accvgpr_read_b32 v90, a26
  v_mfma_f32_32x32x16_bf16 a[144:159], a[216:219], v[60:63], a[144:159]
  v_accvgpr_read_b32 v91, a27
  v_accvgpr_read_b32 v92, a28
  v_accvgpr_read_b32 v93, a29
  v_accvgpr_read_b32 v94, a30
  v_accvgpr_read_b32 v95, a31
  v_pk_mul_f32 v[80:81], v[80:81], v[50:51]
  v_pk_mul_f32 v[82:83], v[82:83], v[50:51]
  v_pk_mul_f32 v[84:85], v[84:85], v[50:51]
  v_pk_mul_f32 v[86:87], v[86:87], v[50:51]
  v_pk_mul_f32 v[88:89], v[88:89], v[50:51]
  s_waitcnt lgkmcnt(0)
  s_getpc_b64 s[96:97]
  s_add_u32 s96, s96, 1024
  s_addc_u32 s97, s97, 0
  v_lshlrev_b32 v46, 6, v0
  v_mov_b32 v47, 0
  v_lshl_add_u64 v[46:47], v[46:47], 0, s[96:97]
  global_load_dword a225, v[46:47], off
  v_mfma_f32_32x32x16_bf16 a[160:175], a[220:223], v[56:59], a[160:175]
  v_pk_mul_f32 v[90:91], v[90:91], v[50:51]
  v_pk_mul_f32 v[92:93], v[92:93], v[50:51]
  v_pk_mul_f32 v[94:95], v[94:95], v[50:51]
  v_cvt_pk_bf16_f32 v72, v80, v81
  v_cvt_pk_bf16_f32 v73, v82, v83
  v_cvt_pk_bf16_f32 v74, v84, v85
  v_cvt_pk_bf16_f32 v75, v86, v87
  v_cvt_pk_bf16_f32 v76, v88, v89
  v_cvt_pk_bf16_f32 v77, v90, v91
  v_cvt_pk_bf16_f32 v78, v92, v93
  v_cvt_pk_bf16_f32 v79, v94, v95
  v_mfma_f32_32x32x16_bf16 a[176:191], a[220:223], v[60:63], a[176:191]
  s_mov_b32 s66, 12288
  buffer_store_dwordx4 v[72:75], v2, s[84:87], s66 offen offset:0 sc1
  s_mov_b32 s66, 12288
  buffer_store_dwordx4 v[76:79], v2, s[84:87], s66 offen offset:1024 sc1
  v_accvgpr_write_b32 a16, v72
  v_accvgpr_write_b32 a17, v73
  v_accvgpr_write_b32 a18, v74
  v_accvgpr_write_b32 a19, v75
  v_accvgpr_write_b32 a20, v76
  v_accvgpr_write_b32 a21, v77
  v_accvgpr_write_b32 a22, v78
  v_accvgpr_write_b32 a23, v79
  s_lshl_b32 s60, s33, 7
  s_add_u32 s60, s60, s30
  s_mul_i32 s60, s60, 24576
  s_mul_i32 s62, s30, 24576
  s_sub_u32 s61, 3145728, s62
  s_add_u32 s56, s28, s60
  s_addc_u32 s57, s29, 0
  s_add_u32 s56, s56, 14155776
  s_addc_u32 s57, s57, 0
  s_mov_b32 s58, s61
  s_mov_b32 s59, 0x20000
  v_lshrrev_b32 v44, 5, v1
  v_bfe_u32 v45, v1, 4, 1
  v_bfe_u32 v46, v1, 2, 2
  v_and_b32 v47, 3, v1
  v_lshl_add_u32 v44, v44, 2, v46
  v_mul_u32_u24 v44, 320, v44
  v_lshl_add_u32 v44, v45, 5, v44
  v_lshl_add_u32 v13, v47, 3, v44
  v_add_u32 v14, 61440, v13
  v_add_u32 v15, 122880, v13
  s_mul_i32 s60, s31, 2621440
  s_lshl_b32 s61, s33, 3
  s_lshl_b32 s62, s30, 1
  s_add_u32 s61, s61, s62
  s_mul_i32 s61, s61, 40960
  s_add_u32 s60, s60, s61
  s_mul_i32 s61, s32, 10240
  s_add_u32 s60, s60, s61
  s_add_u32 s52, s28, s60
  s_addc_u32 s53, s29, 0
  s_add_u32 s52, s52, 39321600
  s_addc_u32 s53, s53, 0
  s_mov_b32 s54, 51200
  s_mov_b32 s55, 0x20000
  s_lshl_b32 s60, s33, 3
  s_add_u32 s60, s60, s31
  s_lshl_b32 s60, s60, 2
  s_add_u32 s60, s60, s30
  s_mul_i32 s60, s60, 512
  s_add_u32 s75, s60, 16384
  s_mul_i32 s61, s32, 128
  s_add_u32 s100, s75, s61
  v_min_u32 v42, 3, v1
  v_lshlrev_b32 v42, 7, v42
  v_cmp_eq_u32 vcc, 0, v1
  v_mov_b32 v40, 2130706432
  v_mov_b32 v41, s14
  v_cndmask_b32 v40, v40, v1, vcc
  s_waitcnt vmcnt(29)
  s_barrier
  ds_read_b64_tr_b16 a[192:193], v13 offset:0
  ds_read_b64_tr_b16 a[194:195], v13 offset:2560
  ds_read_b64_tr_b16 a[196:197], v13 offset:64
  ds_read_b64_tr_b16 a[198:199], v13 offset:2624
  ds_read_b64_tr_b16 a[200:201], v13 offset:128
  ds_read_b64_tr_b16 a[202:203], v13 offset:2688
  ds_read_b64_tr_b16 a[204:205], v13 offset:192
  ds_read_b64_tr_b16 a[206:207], v13 offset:2752
  ds_read_b64_tr_b16 a[208:209], v13 offset:256
  ds_read_b64_tr_b16 a[210:211], v13 offset:2816
  s_waitcnt lgkmcnt(8)
  v_mfma_f32_32x32x16_bf16 v[96:111], a[192:195], a[0:3], 0
  v_mfma_f32_32x32x16_bf16 v[112:127], a[192:195], a[16:19], 0
  ds_read_b64_tr_b16 a[212:213], v13 offset:5120
  ds_read_b64_tr_b16 a[214:215], v13 offset:7680
  s_add_u32 s67, s82, 40960
  s_add_u32 m0, s68, 122880
  s_nop 0
  buffer_load_dwordx4 v4, s[44:47], s67 offen offset:0 lds
  v_accvgpr_read_b32 v80, a32
  v_accvgpr_read_b32 v81, a33
  v_accvgpr_read_b32 v82, a34
  v_accvgpr_read_b32 v83, a35
  v_accvgpr_read_b32 v84, a36
  s_waitcnt lgkmcnt(8)
  v_mfma_f32_32x32x16_bf16 v[128:143], a[196:199], a[0:3], 0
  buffer_load_dwordx4 v5, s[44:47], s67 offen offset:1024 lds
  v_accvgpr_read_b32 v85, a37
  v_accvgpr_read_b32 v86, a38
  v_accvgpr_read_b32 v87, a39
  v_accvgpr_read_b32 v88, a40
  v_mfma_f32_32x32x16_bf16 v[144:159], a[196:199], a[16:19], 0
  ds_read_b64_tr_b16 a[216:217], v13 offset:5184
  ds_read_b64_tr_b16 a[218:219], v13 offset:7744
  buffer_load_dwordx4 v6, s[44:47], s67 offen offset:2048 lds
  v_accvgpr_read_b32 v89, a41
  v_accvgpr_read_b32 v90, a42
  v_accvgpr_read_b32 v91, a43
  v_accvgpr_read_b32 v92, a44
  v_accvgpr_read_b32 v93, a45
  s_waitcnt lgkmcnt(8)
  v_mfma_f32_32x32x16_bf16 v[160:175], a[200:203], a[0:3], 0
  s_add_u32 s67, s83, 40960
  s_add_u32 m0, s68, 135168
  s_nop 0
  buffer_load_dwordx4 v4, s[44:47], s67 offen offset:0 lds
  v_accvgpr_read_b32 v94, a46
  v_accvgpr_read_b32 v95, a47
  v_pk_mul_f32 v[80:81], v[80:81], v[48:49]
  v_pk_mul_f32 v[82:83], v[82:83], v[48:49]
  v_mfma_f32_32x32x16_bf16 v[176:191], a[200:203], a[16:19], 0
  ds_read_b64_tr_b16 a[220:221], v13 offset:5248
  ds_read_b64_tr_b16 a[222:223], v13 offset:7808
  buffer_load_dwordx4 v5, s[44:47], s67 offen offset:1024 lds
  v_pk_mul_f32 v[84:85], v[84:85], v[48:49]
  v_pk_mul_f32 v[86:87], v[86:87], v[48:49]
  v_pk_mul_f32 v[88:89], v[88:89], v[48:49]
  v_pk_mul_f32 v[90:91], v[90:91], v[48:49]
  v_pk_mul_f32 v[92:93], v[92:93], v[48:49]
  s_waitcnt lgkmcnt(8)
  v_mfma_f32_32x32x16_bf16 v[192:207], a[204:207], a[0:3], 0
  buffer_load_dwordx4 v6, s[44:47], s67 offen offset:2048 lds
  v_pk_mul_f32 v[94:95], v[94:95], v[48:49]
  v_cvt_pk_bf16_f32 v64, v80, v81
  v_cvt_pk_bf16_f32 v65, v82, v83
  v_cvt_pk_bf16_f32 v66, v84, v85
  v_mfma_f32_32x32x16_bf16 v[208:223], a[204:207], a[16:19], 0
  ds_read_b64_tr_b16 a[192:193], v13 offset:5312
  ds_read_b64_tr_b16 a[194:195], v13 offset:7872
  v_cvt_pk_bf16_f32 v67, v86, v87
  v_cvt_pk_bf16_f32 v68, v88, v89
  v_cvt_pk_bf16_f32 v69, v90, v91
  v_cvt_pk_bf16_f32 v70, v92, v93
  v_cvt_pk_bf16_f32 v71, v94, v95
  s_waitcnt lgkmcnt(8)
  v_mfma_f32_32x32x16_bf16 v[224:239], a[208:211], a[0:3], 0
  s_mov_b32 s66, 0
  buffer_store_dwordx4 v[64:67], v2, s[84:87], s66 offen offset:2048 sc1
  s_mov_b32 s66, 0
  buffer_store_dwordx4 v[68:71], v2, s[84:87], s66 offen offset:3072 sc1
  v_accvgpr_write_b32 a32, v64
  v_mfma_f32_32x32x16_bf16 v[240:255], a[208:211], a[16:19], 0
  ds_read_b64_tr_b16 a[196:197], v13 offset:5376
  ds_read_b64_tr_b16 a[198:199], v13 offset:7936
  v_accvgpr_write_b32 a33, v65
  v_accvgpr_write_b32 a34, v66
  v_accvgpr_write_b32 a35, v67
  v_accvgpr_write_b32 a36, v68
  v_accvgpr_write_b32 a37, v69
  s_waitcnt lgkmcnt(8)
  v_mfma_f32_32x32x16_bf16 v[96:111], a[212:215], a[4:7], v[96:111]
  v_accvgpr_write_b32 a38, v70
  v_accvgpr_write_b32 a39, v71
  v_accvgpr_read_b32 v80, a48
  v_accvgpr_read_b32 v81, a49
  v_mfma_f32_32x32x16_bf16 v[112:127], a[212:215], a[20:23], v[112:127]
  ds_read_b64_tr_b16 a[200:201], v13 offset:12288
  ds_read_b64_tr_b16 a[202:203], v13 offset:14848
  v_accvgpr_read_b32 v82, a50
  v_accvgpr_read_b32 v83, a51
  v_accvgpr_read_b32 v84, a52
  v_accvgpr_read_b32 v85, a53
  v_accvgpr_read_b32 v86, a54
  s_waitcnt lgkmcnt(8)
  v_mfma_f32_32x32x16_bf16 v[128:143], a[216:219], a[4:7], v[128:143]
  v_accvgpr_read_b32 v87, a55
  v_accvgpr_read_b32 v88, a56
  v_accvgpr_read_b32 v89, a57
  v_accvgpr_read_b32 v90, a58
  v_mfma_f32_32x32x16_bf16 v[144:159], a[216:219], a[20:23], v[144:159]
  ds_read_b64_tr_b16 a[204:205], v13 offset:12352
  ds_read_b64_tr_b16 a[206:207], v13 offset:14912
  v_accvgpr_read_b32 v91, a59
  v_accvgpr_read_b32 v92, a60
  v_accvgpr_read_b32 v93, a61
  v_accvgpr_read_b32 v94, a62
  v_accvgpr_read_b32 v95, a63
  s_waitcnt lgkmcnt(8)
  v_mfma_f32_32x32x16_bf16 v[160:175], a[220:223], a[4:7], v[160:175]
  v_pk_mul_f32 v[80:81], v[80:81], v[50:51]
  v_pk_mul_f32 v[82:83], v[82:83], v[50:51]
  v_pk_mul_f32 v[84:85], v[84:85], v[50:51]
  v_pk_mul_f32 v[86:87], v[86:87], v[50:51]
  v_mfma_f32_32x32x16_bf16 v[176:191], a[220:223], a[20:23], v[176:191]
  ds_read_b64_tr_b16 a[208:209], v13 offset:12416
  ds_read_b64_tr_b16 a[210:211], v13 offset:14976
  v_pk_mul_f32 v[88:89], v[88:89], v[50:51]
  v_pk_mul_f32 v[90:91], v[90:91], v[50:51]
  v_pk_mul_f32 v[92:93], v[92:93], v[50:51]
  v_pk_mul_f32 v[94:95], v[94:95], v[50:51]
  v_cvt_pk_bf16_f32 v72, v80, v81
  s_waitcnt lgkmcnt(8)
  v_mfma_f32_32x32x16_bf16 v[192:207], a[192:195], a[4:7], v[192:207]
  v_cvt_pk_bf16_f32 v73, v82, v83
  v_cvt_pk_bf16_f32 v74, v84, v85
  v_cvt_pk_bf16_f32 v75, v86, v87
  v_cvt_pk_bf16_f32 v76, v88, v89
  v_mfma_f32_32x32x16_bf16 v[208:223], a[192:195], a[20:23], v[208:223]
  ds_read_b64_tr_b16 a[212:213], v13 offset:12480
  ds_read_b64_tr_b16 a[214:215], v13 offset:15040
  v_cvt_pk_bf16_f32 v77, v90, v91
  v_cvt_pk_bf16_f32 v78, v92, v93
  v_cvt_pk_bf16_f32 v79, v94, v95
  s_mov_b32 s66, 12288
  buffer_store_dwordx4 v[72:75], v2, s[84:87], s66 offen offset:2048 sc1
  s_waitcnt lgkmcnt(8)
  v_mfma_f32_32x32x16_bf16 v[224:239], a[196:199], a[4:7], v[224:239]
  s_mov_b32 s66, 12288
  buffer_store_dwordx4 v[76:79], v2, s[84:87], s66 offen offset:3072 sc1
  v_accvgpr_write_b32 a48, v72
  v_accvgpr_write_b32 a49, v73
  v_accvgpr_write_b32 a50, v74
  v_mfma_f32_32x32x16_bf16 v[240:255], a[196:199], a[20:23], v[240:255]
  ds_read_b64_tr_b16 a[216:217], v13 offset:12544
  ds_read_b64_tr_b16 a[218:219], v13 offset:15104
  v_accvgpr_write_b32 a51, v75
  v_accvgpr_write_b32 a52, v76
  v_accvgpr_write_b32 a53, v77
  v_accvgpr_write_b32 a54, v78
  v_accvgpr_write_b32 a55, v79
  s_waitcnt lgkmcnt(8)
  v_mfma_f32_32x32x16_bf16 v[96:111], a[200:203], a[32:35], v[96:111]
  v_mfma_f32_32x32x16_bf16 v[112:127], a[200:203], a[48:51], v[112:127]
  ds_read_b64_tr_b16 a[220:221], v13 offset:17408
  ds_read_b64_tr_b16 a[222:223], v13 offset:19968
  v_accvgpr_read_b32 v80, a64
  v_accvgpr_read_b32 v81, a65
  v_accvgpr_read_b32 v82, a66
  v_accvgpr_read_b32 v83, a67
  s_waitcnt lgkmcnt(8)
  v_mfma_f32_32x32x16_bf16 v[128:143], a[204:207], a[32:35], v[128:143]
  v_accvgpr_read_b32 v84, a68
  v_accvgpr_read_b32 v85, a69
  v_accvgpr_read_b32 v86, a70
  v_accvgpr_read_b32 v87, a71
  v_mfma_f32_32x32x16_bf16 v[144:159], a[204:207], a[48:51], v[144:159]
  ds_read_b64_tr_b16 a[192:193], v13 offset:17472
  ds_read_b64_tr_b16 a[194:195], v13 offset:20032
  v_accvgpr_read_b32 v88, a72
  v_accvgpr_read_b32 v89, a73
  v_accvgpr_read_b32 v90, a74
  v_accvgpr_read_b32 v91, a75
  v_accvgpr_read_b32 v92, a76
  s_waitcnt lgkmcnt(8)
  v_mfma_f32_32x32x16_bf16 v[160:175], a[208:211], a[32:35], v[160:175]
  v_accvgpr_read_b32 v93, a77
  v_accvgpr_read_b32 v94, a78
  v_accvgpr_read_b32 v95, a79
  v_pk_mul_f32 v[80:81], v[80:81], v[48:49]
  v_mfma_f32_32x32x16_bf16 v[176:191], a[208:211], a[48:51], v[176:191]
  ds_read_b64_tr_b16 a[196:197], v13 offset:17536
  ds_read_b64_tr_b16 a[198:199], v13 offset:20096
  v_pk_mul_f32 v[82:83], v[82:83], v[48:49]
  v_pk_mul_f32 v[84:85], v[84:85], v[48:49]
  v_pk_mul_f32 v[86:87], v[86:87], v[48:49]
  v_pk_mul_f32 v[88:89], v[88:89], v[48:49]
  s_waitcnt lgkmcnt(8)
  v_mfma_f32_32x32x16_bf16 v[192:207], a[212:215], a[32:35], v[192:207]
  v_pk_mul_f32 v[90:91], v[90:91], v[48:49]
  v_pk_mul_f32 v[92:93], v[92:93], v[48:49]
  v_pk_mul_f32 v[94:95], v[94:95], v[48:49]
  v_cvt_pk_bf16_f32 v64, v80, v81
  v_mfma_f32_32x32x16_bf16 v[208:223], a[212:215], a[48:51], v[208:223]
  ds_read_b64_tr_b16 a[200:201], v13 offset:17600
  ds_read_b64_tr_b16 a[202:203], v13 offset:20160
  v_cvt_pk_bf16_f32 v65, v82, v83
  v_cvt_pk_bf16_f32 v66, v84, v85
  v_cvt_pk_bf16_f32 v67, v86, v87
  v_cvt_pk_bf16_f32 v68, v88, v89
  s_waitcnt lgkmcnt(8)
  v_mfma_f32_32x32x16_bf16 v[224:239], a[216:219], a[32:35], v[224:239]
  v_cvt_pk_bf16_f32 v69, v90, v91
  v_cvt_pk_bf16_f32 v70, v92, v93
  v_cvt_pk_bf16_f32 v71, v94, v95
  v_accvgpr_write_b32 a64, v64
  v_accvgpr_write_b32 a65, v65
  v_mfma_f32_32x32x16_bf16 v[240:255], a[216:219], a[48:51], v[240:255]
  ds_read_b64_tr_b16 a[204:205], v13 offset:17664
  ds_read_b64_tr_b16 a[206:207], v13 offset:20224
  v_accvgpr_write_b32 a66, v66
  v_accvgpr_write_b32 a67, v67
  v_accvgpr_write_b32 a68, v68
  v_accvgpr_write_b32 a69, v69
  s_waitcnt lgkmcnt(8)
  v_mfma_f32_32x32x16_bf16 v[96:111], a[220:223], a[36:39], v[96:111]
  v_accvgpr_write_b32 a70, v70
  v_accvgpr_write_b32 a71, v71
  v_accvgpr_read_b32 v80, a80
  v_accvgpr_read_b32 v81, a81
  v_mfma_f32_32x32x16_bf16 v[112:127], a[220:223], a[52:55], v[112:127]
  s_waitcnt vmcnt(33)
  s_barrier
  ds_read_b64_tr_b16 a[208:209], v13 offset:24576
  ds_read_b64_tr_b16 a[210:211], v13 offset:27136
  v_accvgpr_read_b32 v82, a82
  v_accvgpr_read_b32 v83, a83
  v_accvgpr_read_b32 v84, a84
  v_accvgpr_read_b32 v85, a85
  s_waitcnt lgkmcnt(8)
  v_mfma_f32_32x32x16_bf16 v[128:143], a[192:195], a[36:39], v[128:143]
  s_add_u32 s67, s81, 81920
  s_add_u32 m0, s68, 147456
  s_nop 0
  buffer_load_dwordx4 v4, s[44:47], s67 offen offset:0 lds
  v_accvgpr_read_b32 v86, a86
  v_accvgpr_read_b32 v87, a87
  v_accvgpr_read_b32 v88, a88
  v_accvgpr_read_b32 v89, a89
  v_accvgpr_read_b32 v90, a90
  v_mfma_f32_32x32x16_bf16 v[144:159], a[192:195], a[52:55], v[144:159]
  ds_read_b64_tr_b16 a[212:213], v13 offset:24640
  ds_read_b64_tr_b16 a[214:215], v13 offset:27200
  buffer_load_dwordx4 v5, s[44:47], s67 offen offset:1024 lds
  v_accvgpr_read_b32 v91, a91
  v_accvgpr_read_b32 v92, a92
  v_accvgpr_read_b32 v93, a93
  v_accvgpr_read_b32 v94, a94
  s_waitcnt lgkmcnt(8)
  v_mfma_f32_32x32x16_bf16 v[160:175], a[196:199], a[36:39], v[160:175]
  buffer_load_dwordx4 v6, s[44:47], s67 offen offset:2048 lds
  v_accvgpr_read_b32 v95, a95
  v_pk_mul_f32 v[80:81], v[80:81], v[50:51]
  v_pk_mul_f32 v[82:83], v[82:83], v[50:51]
  v_pk_mul_f32 v[84:85], v[84:85], v[50:51]
  v_mfma_f32_32x32x16_bf16 v[176:191], a[196:199], a[52:55], v[176:191]
  ds_read_b64_tr_b16 a[216:217], v13 offset:24704
  ds_read_b64_tr_b16 a[218:219], v13 offset:27264
  v_pk_mul_f32 v[86:87], v[86:87], v[50:51]
  v_pk_mul_f32 v[88:89], v[88:89], v[50:51]
  v_pk_mul_f32 v[90:91], v[90:91], v[50:51]
  v_pk_mul_f32 v[92:93], v[92:93], v[50:51]
  s_waitcnt lgkmcnt(8)
  v_mfma_f32_32x32x16_bf16 v[192:207], a[200:203], a[36:39], v[192:207]
  v_pk_mul_f32 v[94:95], v[94:95], v[50:51]
  v_cvt_pk_bf16_f32 v72, v80, v81
  v_cvt_pk_bf16_f32 v73, v82, v83
  v_cvt_pk_bf16_f32 v74, v84, v85
  v_mfma_f32_32x32x16_bf16 v[208:223], a[200:203], a[52:55], v[208:223]
  ds_read_b64_tr_b16 a[220:221], v13 offset:24768
  ds_read_b64_tr_b16 a[222:223], v13 offset:27328
  v_cvt_pk_bf16_f32 v75, v86, v87
  v_cvt_pk_bf16_f32 v76, v88, v89
  v_cvt_pk_bf16_f32 v77, v90, v91
  v_cvt_pk_bf16_f32 v78, v92, v93
  v_cvt_pk_bf16_f32 v79, v94, v95
  s_waitcnt lgkmcnt(8)
  v_mfma_f32_32x32x16_bf16 v[224:239], a[204:207], a[36:39], v[224:239]
  v_accvgpr_write_b32 a80, v72
  v_accvgpr_write_b32 a81, v73
  v_accvgpr_write_b32 a82, v74
  v_accvgpr_write_b32 a83, v75
  v_mfma_f32_32x32x16_bf16 v[240:255], a[204:207], a[52:55], v[240:255]
  ds_read_b64_tr_b16 a[192:193], v13 offset:24832
  ds_read_b64_tr_b16 a[194:195], v13 offset:27392
  v_accvgpr_write_b32 a84, v76
  v_accvgpr_write_b32 a85, v77
  v_accvgpr_write_b32 a86, v78
  v_accvgpr_write_b32 a87, v79
  s_waitcnt lgkmcnt(8)
  v_mfma_f32_32x32x16_bf16 v[96:111], a[208:211], a[64:67], v[96:111]
  v_mfma_f32_32x32x16_bf16 v[112:127], a[208:211], a[80:83], v[112:127]
  ds_read_b64_tr_b16 a[196:197], v13 offset:29696
  ds_read_b64_tr_b16 a[198:199], v13 offset:32256
  v_accvgpr_read_b32 v80, a96
  v_accvgpr_read_b32 v81, a97
  v_accvgpr_read_b32 v82, a98
  v_accvgpr_read_b32 v83, a99
  s_waitcnt lgkmcnt(8)
  v_mfma_f32_32x32x16_bf16 v[128:143], a[212:215], a[64:67], v[128:143]
  v_accvgpr_read_b32 v84, a100
  v_accvgpr_read_b32 v85, a101
  v_accvgpr_read_b32 v86, a102
  v_accvgpr_read_b32 v87, a103
  s_mov_b32 s66, 4096
  buffer_store_dwordx4 a[64:67], v2, s[84:87], s66 offen offset:0 sc1
  v_mfma_f32_32x32x16_bf16 v[144:159], a[212:215], a[80:83], v[144:159]
  ds_read_b64_tr_b16 a[200:201], v13 offset:29760
  ds_read_b64_tr_b16 a[202:203], v13 offset:32320
  v_accvgpr_read_b32 v88, a104
  v_accvgpr_read_b32 v89, a105
  v_accvgpr_read_b32 v90, a106
  v_accvgpr_read_b32 v91, a107
  v_accvgpr_read_b32 v92, a108
  s_waitcnt lgkmcnt(8)
  v_mfma_f32_32x32x16_bf16 v[160:175], a[216:219], a[64:67], v[160:175]
  v_accvgpr_read_b32 v93, a109
  v_accvgpr_read_b32 v94, a110
  v_accvgpr_read_b32 v95, a111
  v_pk_mul_f32 v[80:81], v[80:81], v[48:49]
  v_mfma_f32_32x32x16_bf16 v[176:191], a[216:219], a[80:83], v[176:191]
  ds_read_b64_tr_b16 a[204:205], v13 offset:29824
  ds_read_b64_tr_b16 a[206:207], v13 offset:32384
  v_pk_mul_f32 v[82:83], v[82:83], v[48:49]
  v_pk_mul_f32 v[84:85], v[84:85], v[48:49]
  v_pk_mul_f32 v[86:87], v[86:87], v[48:49]
  v_pk_mul_f32 v[88:89], v[88:89], v[48:49]
  s_waitcnt lgkmcnt(8)
  v_mfma_f32_32x32x16_bf16 v[192:207], a[220:223], a[64:67], v[192:207]
  v_pk_mul_f32 v[90:91], v[90:91], v[48:49]
  v_pk_mul_f32 v[92:93], v[92:93], v[48:49]
  v_pk_mul_f32 v[94:95], v[94:95], v[48:49]
  v_cvt_pk_bf16_f32 v64, v80, v81
  v_mfma_f32_32x32x16_bf16 v[208:223], a[220:223], a[80:83], v[208:223]
  ds_read_b64_tr_b16 a[208:209], v13 offset:29888
  ds_read_b64_tr_b16 a[210:211], v13 offset:32448
  v_cvt_pk_bf16_f32 v65, v82, v83
  v_cvt_pk_bf16_f32 v66, v84, v85
  v_cvt_pk_bf16_f32 v67, v86, v87
  v_cvt_pk_bf16_f32 v68, v88, v89
  s_waitcnt lgkmcnt(8)
  v_mfma_f32_32x32x16_bf16 v[224:239], a[192:195], a[64:67], v[224:239]
  v_cvt_pk_bf16_f32 v69, v90, v91
  v_cvt_pk_bf16_f32 v70, v92, v93
  v_cvt_pk_bf16_f32 v71, v94, v95
  v_accvgpr_write_b32 a96, v64
  v_accvgpr_write_b32 a97, v65
  v_mfma_f32_32x32x16_bf16 v[240:255], a[192:195], a[80:83], v[240:255]
  ds_read_b64_tr_b16 a[212:213], v13 offset:29952
  ds_read_b64_tr_b16 a[214:215], v13 offset:32512
  v_accvgpr_write_b32 a98, v66
  v_accvgpr_write_b32 a99, v67
  v_accvgpr_write_b32 a100, v68
  v_accvgpr_write_b32 a101, v69
  s_waitcnt lgkmcnt(8)
  v_mfma_f32_32x32x16_bf16 v[96:111], a[196:199], a[68:71], v[96:111]
  v_accvgpr_write_b32 a102, v70
  v_accvgpr_write_b32 a103, v71
  v_accvgpr_read_b32 v80, a112
  v_accvgpr_read_b32 v81, a113
  s_waitcnt vmcnt(4)
  s_add_u32 s74, s100, 0
  buffer_store_dword v41, v40, s[92:95], s74 offen sc1
  s_mov_b32 s66, 4096
  buffer_store_dwordx4 a[68:71], v2, s[84:87], s66 offen offset:1024 sc1
  v_mfma_f32_32x32x16_bf16 v[112:127], a[196:199], a[84:87], v[112:127]
  ds_read_b64_tr_b16 a[216:217], v13 offset:36864
  ds_read_b64_tr_b16 a[218:219], v13 offset:39424
  v_accvgpr_read_b32 v82, a114
  v_accvgpr_read_b32 v83, a115
  v_accvgpr_read_b32 v84, a116
  v_accvgpr_read_b32 v85, a117
  s_waitcnt lgkmcnt(8)
  v_mfma_f32_32x32x16_bf16 v[128:143], a[200:203], a[68:71], v[128:143]
  v_accvgpr_read_b32 v86, a118
  v_accvgpr_read_b32 v87, a119
  v_accvgpr_read_b32 v88, a120
  v_accvgpr_read_b32 v89, a121
  v_accvgpr_read_b32 v90, a122
  v_mfma_f32_32x32x16_bf16 v[144:159], a[200:203], a[84:87], v[144:159]
  ds_read_b64_tr_b16 a[220:221], v13 offset:36928
  ds_read_b64_tr_b16 a[222:223], v13 offset:39488
  v_accvgpr_read_b32 v91, a123
  v_accvgpr_read_b32 v92, a124
  v_accvgpr_read_b32 v93, a125
  v_accvgpr_read_b32 v94, a126
  s_waitcnt lgkmcnt(8)
  v_mfma_f32_32x32x16_bf16 v[160:175], a[204:207], a[68:71], v[160:175]
  v_accvgpr_read_b32 v95, a127
  v_pk_mul_f32 v[80:81], v[80:81], v[50:51]
  v_pk_mul_f32 v[82:83], v[82:83], v[50:51]
  v_pk_mul_f32 v[84:85], v[84:85], v[50:51]
  v_mfma_f32_32x32x16_bf16 v[176:191], a[204:207], a[84:87], v[176:191]
  ds_read_b64_tr_b16 a[192:193], v13 offset:36992
  ds_read_b64_tr_b16 a[194:195], v13 offset:39552
  v_pk_mul_f32 v[86:87], v[86:87], v[50:51]
  v_pk_mul_f32 v[88:89], v[88:89], v[50:51]
  v_pk_mul_f32 v[90:91], v[90:91], v[50:51]
  v_pk_mul_f32 v[92:93], v[92:93], v[50:51]
  s_waitcnt lgkmcnt(8)
  v_mfma_f32_32x32x16_bf16 v[192:207], a[208:211], a[68:71], v[192:207]
  v_pk_mul_f32 v[94:95], v[94:95], v[50:51]
  v_cvt_pk_bf16_f32 v72, v80, v81
  v_cvt_pk_bf16_f32 v73, v82, v83
  v_cvt_pk_bf16_f32 v74, v84, v85
  v_mfma_f32_32x32x16_bf16 v[208:223], a[208:211], a[84:87], v[208:223]
  ds_read_b64_tr_b16 a[196:197], v13 offset:37056
  ds_read_b64_tr_b16 a[198:199], v13 offset:39616
  v_cvt_pk_bf16_f32 v75, v86, v87
  v_cvt_pk_bf16_f32 v76, v88, v89
  v_cvt_pk_bf16_f32 v77, v90, v91
  v_cvt_pk_bf16_f32 v78, v92, v93
  v_cvt_pk_bf16_f32 v79, v94, v95
  s_waitcnt lgkmcnt(8)
  v_mfma_f32_32x32x16_bf16 v[224:239], a[212:215], a[68:71], v[224:239]
  v_accvgpr_write_b32 a112, v72
  v_accvgpr_write_b32 a113, v73
  v_accvgpr_write_b32 a114, v74
  v_accvgpr_write_b32 a115, v75
  s_mov_b32 s66, 16384
  buffer_store_dwordx4 a[80:83], v2, s[84:87], s66 offen offset:0 sc1
  v_mfma_f32_32x32x16_bf16 v[240:255], a[212:215], a[84:87], v[240:255]
  ds_read_b64_tr_b16 a[200:201], v13 offset:37120
  ds_read_b64_tr_b16 a[202:203], v13 offset:39680
  v_accvgpr_write_b32 a116, v76
  v_accvgpr_write_b32 a117, v77
  v_accvgpr_write_b32 a118, v78
  v_accvgpr_write_b32 a119, v79
  s_waitcnt lgkmcnt(8)
  v_mfma_f32_32x32x16_bf16 v[96:111], a[216:219], a[96:99], v[96:111]
  v_mfma_f32_32x32x16_bf16 v[112:127], a[216:219], a[112:115], v[112:127]
  ds_read_b64_tr_b16 a[204:205], v13 offset:41984
  ds_read_b64_tr_b16 a[206:207], v13 offset:44544
  v_accvgpr_read_b32 v80, a128
  v_accvgpr_read_b32 v81, a129
  v_accvgpr_read_b32 v82, a130
  v_accvgpr_read_b32 v83, a131
  s_waitcnt lgkmcnt(8)
  v_mfma_f32_32x32x16_bf16 v[128:143], a[220:223], a[96:99], v[128:143]
  v_accvgpr_read_b32 v84, a132
  v_accvgpr_read_b32 v85, a133
  v_accvgpr_read_b32 v86, a134
  v_accvgpr_read_b32 v87, a135
  v_mfma_f32_32x32x16_bf16 v[144:159], a[220:223], a[112:115], v[144:159]
  ds_read_b64_tr_b16 a[208:209], v13 offset:42048
  ds_read_b64_tr_b16 a[210:211], v13 offset:44608
  v_accvgpr_read_b32 v88, a136
  v_accvgpr_read_b32 v89, a137
  v_accvgpr_read_b32 v90, a138
  v_accvgpr_read_b32 v91, a139
  v_accvgpr_read_b32 v92, a140
  s_waitcnt lgkmcnt(8)
  v_mfma_f32_32x32x16_bf16 v[160:175], a[192:195], a[96:99], v[160:175]
  v_accvgpr_read_b32 v93, a141
  v_accvgpr_read_b32 v94, a142
  v_accvgpr_read_b32 v95, a143
  v_pk_mul_f32 v[80:81], v[80:81], v[48:49]
  v_mfma_f32_32x32x16_bf16 v[176:191], a[192:195], a[112:115], v[176:191]
  ds_read_b64_tr_b16 a[212:213], v13 offset:42112
  ds_read_b64_tr_b16 a[214:215], v13 offset:44672
  v_pk_mul_f32 v[82:83], v[82:83], v[48:49]
  v_pk_mul_f32 v[84:85], v[84:85], v[48:49]
  v_pk_mul_f32 v[86:87], v[86:87], v[48:49]
  v_pk_mul_f32 v[88:89], v[88:89], v[48:49]
  s_waitcnt lgkmcnt(8)
  v_mfma_f32_32x32x16_bf16 v[192:207], a[196:199], a[96:99], v[192:207]
  v_pk_mul_f32 v[90:91], v[90:91], v[48:49]
  v_pk_mul_f32 v[92:93], v[92:93], v[48:49]
  v_pk_mul_f32 v[94:95], v[94:95], v[48:49]
  v_cvt_pk_bf16_f32 v64, v80, v81
  s_mov_b32 s66, 16384
  buffer_store_dwordx4 a[84:87], v2, s[84:87], s66 offen offset:1024 sc1
  v_mfma_f32_32x32x16_bf16 v[208:223], a[196:199], a[112:115], v[208:223]
  ds_read_b64_tr_b16 a[216:217], v13 offset:42176
  ds_read_b64_tr_b16 a[218:219], v13 offset:44736
  v_cvt_pk_bf16_f32 v65, v82, v83
  v_cvt_pk_bf16_f32 v66, v84, v85
  v_cvt_pk_bf16_f32 v67, v86, v87
  v_cvt_pk_bf16_f32 v68, v88, v89
  s_waitcnt lgkmcnt(8)
  v_mfma_f32_32x32x16_bf16 v[224:239], a[200:203], a[96:99], v[224:239]
  v_cvt_pk_bf16_f32 v69, v90, v91
  v_cvt_pk_bf16_f32 v70, v92, v93
  v_cvt_pk_bf16_f32 v71, v94, v95
  v_accvgpr_write_b32 a128, v64
  v_accvgpr_write_b32 a129, v65
  v_mfma_f32_32x32x16_bf16 v[240:255], a[200:203], a[112:115], v[240:255]
  ds_read_b64_tr_b16 a[220:221], v13 offset:42240
  ds_read_b64_tr_b16 a[222:223], v13 offset:44800
  v_accvgpr_write_b32 a130, v66
  v_accvgpr_write_b32 a131, v67
  v_accvgpr_write_b32 a132, v68
  v_accvgpr_write_b32 a133, v69
  s_waitcnt lgkmcnt(8)
  v_mfma_f32_32x32x16_bf16 v[96:111], a[204:207], a[100:103], v[96:111]
  v_accvgpr_write_b32 a134, v70
  v_accvgpr_write_b32 a135, v71
  v_accvgpr_read_b32 v80, a144
  v_accvgpr_read_b32 v81, a145
  v_mfma_f32_32x32x16_bf16 v[112:127], a[204:207], a[116:119], v[112:127]
  s_barrier
  ds_read_b64_tr_b16 a[192:193], v13 offset:49152
  ds_read_b64_tr_b16 a[194:195], v13 offset:51712
  v_accvgpr_read_b32 v82, a146
  v_accvgpr_read_b32 v83, a147
  v_accvgpr_read_b32 v84, a148
  v_accvgpr_read_b32 v85, a149
  s_waitcnt lgkmcnt(8)
  v_mfma_f32_32x32x16_bf16 v[128:143], a[208:211], a[100:103], v[128:143]
  s_add_u32 s67, s82, 81920
  s_add_u32 m0, s68, 0
  s_nop 0
  buffer_load_dwordx4 v4, s[44:47], s67 offen offset:0 lds
  v_accvgpr_read_b32 v86, a150
  v_accvgpr_read_b32 v87, a151
  v_accvgpr_read_b32 v88, a152
  v_accvgpr_read_b32 v89, a153
  v_accvgpr_read_b32 v90, a154
  v_mfma_f32_32x32x16_bf16 v[144:159], a[208:211], a[116:119], v[144:159]
  ds_read_b64_tr_b16 a[196:197], v13 offset:49216
  ds_read_b64_tr_b16 a[198:199], v13 offset:51776
  buffer_load_dwordx4 v5, s[44:47], s67 offen offset:1024 lds
  v_accvgpr_read_b32 v91, a155
  v_accvgpr_read_b32 v92, a156
  v_accvgpr_read_b32 v93, a157
  v_accvgpr_read_b32 v94, a158
  s_waitcnt lgkmcnt(8)
  v_mfma_f32_32x32x16_bf16 v[160:175], a[212:215], a[100:103], v[160:175]
  buffer_load_dwordx4 v6, s[44:47], s67 offen offset:2048 lds
  v_accvgpr_read_b32 v95, a159
  v_pk_mul_f32 v[80:81], v[80:81], v[50:51]
  v_pk_mul_f32 v[82:83], v[82:83], v[50:51]
  v_pk_mul_f32 v[84:85], v[84:85], v[50:51]
  s_mov_b32 s66, 4096
  buffer_store_dwordx4 a[96:99], v2, s[84:87], s66 offen offset:2048 sc1
  v_mfma_f32_32x32x16_bf16 v[176:191], a[212:215], a[116:119], v[176:191]
  ds_read_b64_tr_b16 a[200:201], v13 offset:49280
  ds_read_b64_tr_b16 a[202:203], v13 offset:51840
  s_add_u32 s67, s83, 81920
  s_add_u32 m0, s68, 12288
  s_nop 0
  buffer_load_dwordx4 v4, s[44:47], s67 offen offset:0 lds
  v_pk_mul_f32 v[86:87], v[86:87], v[50:51]
  v_pk_mul_f32 v[88:89], v[88:89], v[50:51]
  v_pk_mul_f32 v[90:91], v[90:91], v[50:51]
  v_pk_mul_f32 v[92:93], v[92:93], v[50:51]
  s_waitcnt lgkmcnt(8)
  v_mfma_f32_32x32x16_bf16 v[192:207], a[216:219], a[100:103], v[192:207]
  buffer_load_dwordx4 v5, s[44:47], s67 offen offset:1024 lds
  v_pk_mul_f32 v[94:95], v[94:95], v[50:51]
  v_cvt_pk_bf16_f32 v72, v80, v81
  v_cvt_pk_bf16_f32 v73, v82, v83
  v_cvt_pk_bf16_f32 v74, v84, v85
  v_mfma_f32_32x32x16_bf16 v[208:223], a[216:219], a[116:119], v[208:223]
  ds_read_b64_tr_b16 a[204:205], v13 offset:49344
  ds_read_b64_tr_b16 a[206:207], v13 offset:51904
  buffer_load_dwordx4 v6, s[44:47], s67 offen offset:2048 lds
  v_cvt_pk_bf16_f32 v75, v86, v87
  v_cvt_pk_bf16_f32 v76, v88, v89
  v_cvt_pk_bf16_f32 v77, v90, v91
  v_cvt_pk_bf16_f32 v78, v92, v93
  v_cvt_pk_bf16_f32 v79, v94, v95
  s_waitcnt lgkmcnt(8)
  v_mfma_f32_32x32x16_bf16 v[224:239], a[220:223], a[100:103], v[224:239]
  v_accvgpr_write_b32 a144, v72
  v_accvgpr_write_b32 a145, v73
  v_accvgpr_write_b32 a146, v74
  v_accvgpr_write_b32 a147, v75
  v_mfma_f32_32x32x16_bf16 v[240:255], a[220:223], a[116:119], v[240:255]
  ds_read_b64_tr_b16 a[208:209], v13 offset:49408
  ds_read_b64_tr_b16 a[210:211], v13 offset:51968
  v_accvgpr_write_b32 a148, v76
  v_accvgpr_write_b32 a149, v77
  v_accvgpr_write_b32 a150, v78
  v_accvgpr_write_b32 a151, v79
  s_waitcnt lgkmcnt(8)
  v_mfma_f32_32x32x16_bf16 v[96:111], a[192:195], a[128:131], v[96:111]
  s_add_u32 s74, s75, 0
  buffer_load_dword v43, v42, s[92:95], s74 offen sc1
  v_mfma_f32_32x32x16_bf16 v[112:127], a[192:195], a[144:147], v[112:127]
  ds_read_b64_tr_b16 a[212:213], v13 offset:54272
  ds_read_b64_tr_b16 a[214:215], v13 offset:56832
  v_accvgpr_read_b32 v80, a160
  v_accvgpr_read_b32 v81, a161
  v_accvgpr_read_b32 v82, a162
  v_accvgpr_read_b32 v83, a163
  s_waitcnt lgkmcnt(8)
  v_mfma_f32_32x32x16_bf16 v[128:143], a[196:199], a[128:131], v[128:143]
  v_accvgpr_read_b32 v84, a164
  v_accvgpr_read_b32 v85, a165
  v_accvgpr_read_b32 v86, a166
  v_accvgpr_read_b32 v87, a167
  s_mov_b32 s66, 4096
  buffer_store_dwordx4 a[100:103], v2, s[84:87], s66 offen offset:3072 sc1
  v_mfma_f32_32x32x16_bf16 v[144:159], a[196:199], a[144:147], v[144:159]
  ds_read_b64_tr_b16 a[216:217], v13 offset:54336
  ds_read_b64_tr_b16 a[218:219], v13 offset:56896
  v_accvgpr_read_b32 v88, a168
  v_accvgpr_read_b32 v89, a169
  v_accvgpr_read_b32 v90, a170
  v_accvgpr_read_b32 v91, a171
  v_accvgpr_read_b32 v92, a172
  s_waitcnt lgkmcnt(8)
  v_mfma_f32_32x32x16_bf16 v[160:175], a[200:203], a[128:131], v[160:175]
  v_accvgpr_read_b32 v93, a173
  v_accvgpr_read_b32 v94, a174
  v_accvgpr_read_b32 v95, a175
  v_pk_mul_f32 v[80:81], v[80:81], v[48:49]
  v_mfma_f32_32x32x16_bf16 v[176:191], a[200:203], a[144:147], v[176:191]
  ds_read_b64_tr_b16 a[220:221], v13 offset:54400
  ds_read_b64_tr_b16 a[222:223], v13 offset:56960
  v_pk_mul_f32 v[82:83], v[82:83], v[48:49]
  v_pk_mul_f32 v[84:85], v[84:85], v[48:49]
  v_pk_mul_f32 v[86:87], v[86:87], v[48:49]
  v_pk_mul_f32 v[88:89], v[88:89], v[48:49]
  s_waitcnt lgkmcnt(8)
  v_mfma_f32_32x32x16_bf16 v[192:207], a[204:207], a[128:131], v[192:207]
  v_pk_mul_f32 v[90:91], v[90:91], v[48:49]
  v_pk_mul_f32 v[92:93], v[92:93], v[48:49]
  v_pk_mul_f32 v[94:95], v[94:95], v[48:49]
  v_cvt_pk_bf16_f32 v64, v80, v81
  v_mfma_f32_32x32x16_bf16 v[208:223], a[204:207], a[144:147], v[208:223]
  ds_read_b64_tr_b16 a[192:193], v13 offset:54464
  ds_read_b64_tr_b16 a[194:195], v13 offset:57024
  v_cvt_pk_bf16_f32 v65, v82, v83
  v_cvt_pk_bf16_f32 v66, v84, v85
  v_cvt_pk_bf16_f32 v67, v86, v87
  v_cvt_pk_bf16_f32 v68, v88, v89
  s_waitcnt lgkmcnt(8)
  v_mfma_f32_32x32x16_bf16 v[224:239], a[208:211], a[128:131], v[224:239]
  v_cvt_pk_bf16_f32 v69, v90, v91
  v_cvt_pk_bf16_f32 v70, v92, v93
  v_cvt_pk_bf16_f32 v71, v94, v95
  v_accvgpr_write_b32 a160, v64
  v_accvgpr_write_b32 a161, v65
  v_mfma_f32_32x32x16_bf16 v[240:255], a[208:211], a[144:147], v[240:255]
  ds_read_b64_tr_b16 a[196:197], v13 offset:54528
  ds_read_b64_tr_b16 a[198:199], v13 offset:57088
  v_accvgpr_write_b32 a162, v66
  v_accvgpr_write_b32 a163, v67
  v_accvgpr_write_b32 a164, v68
  v_accvgpr_write_b32 a165, v69
  s_waitcnt lgkmcnt(8)
  v_mfma_f32_32x32x16_bf16 v[96:111], a[212:215], a[132:135], v[96:111]
  v_accvgpr_write_b32 a166, v70
  v_accvgpr_write_b32 a167, v71
  v_accvgpr_read_b32 v80, a176
  v_accvgpr_read_b32 v81, a177
  s_mov_b32 s66, 16384
  buffer_store_dwordx4 a[112:115], v2, s[84:87], s66 offen offset:2048 sc1
  v_mfma_f32_32x32x16_bf16 v[112:127], a[212:215], a[148:151], v[112:127]
  ds_read_b64_tr_b16 a[200:201], v14 offset:0
  ds_read_b64_tr_b16 a[202:203], v14 offset:2560
  v_accvgpr_read_b32 v82, a178
  v_accvgpr_read_b32 v83, a179
  v_accvgpr_read_b32 v84, a180
  v_accvgpr_read_b32 v85, a181
  s_waitcnt lgkmcnt(8)
  v_mfma_f32_32x32x16_bf16 v[128:143], a[216:219], a[132:135], v[128:143]
  v_accvgpr_read_b32 v86, a182
  v_accvgpr_read_b32 v87, a183
  v_accvgpr_read_b32 v88, a184
  v_accvgpr_read_b32 v89, a185
  v_accvgpr_read_b32 v90, a186
  v_mfma_f32_32x32x16_bf16 v[144:159], a[216:219], a[148:151], v[144:159]
  ds_read_b64_tr_b16 a[204:205], v14 offset:64
  ds_read_b64_tr_b16 a[206:207], v14 offset:2624
  v_accvgpr_read_b32 v91, a187
  v_accvgpr_read_b32 v92, a188
  v_accvgpr_read_b32 v93, a189
  v_accvgpr_read_b32 v94, a190
  s_waitcnt lgkmcnt(8)
  v_mfma_f32_32x32x16_bf16 v[160:175], a[220:223], a[132:135], v[160:175]
  v_accvgpr_read_b32 v95, a191
  v_pk_mul_f32 v[80:81], v[80:81], v[50:51]
  v_pk_mul_f32 v[82:83], v[82:83], v[50:51]
  v_pk_mul_f32 v[84:85], v[84:85], v[50:51]
  v_mfma_f32_32x32x16_bf16 v[176:191], a[220:223], a[148:151], v[176:191]
  ds_read_b64_tr_b16 a[208:209], v14 offset:128
  ds_read_b64_tr_b16 a[210:211], v14 offset:2688
  v_pk_mul_f32 v[86:87], v[86:87], v[50:51]
  v_pk_mul_f32 v[88:89], v[88:89], v[50:51]
  v_pk_mul_f32 v[90:91], v[90:91], v[50:51]
  v_pk_mul_f32 v[92:93], v[92:93], v[50:51]
  s_waitcnt lgkmcnt(8)
  v_mfma_f32_32x32x16_bf16 v[192:207], a[192:195], a[132:135], v[192:207]
  v_pk_mul_f32 v[94:95], v[94:95], v[50:51]
  v_cvt_pk_bf16_f32 v72, v80, v81
  v_cvt_pk_bf16_f32 v73, v82, v83
  v_cvt_pk_bf16_f32 v74, v84, v85
  v_mfma_f32_32x32x16_bf16 v[208:223], a[192:195], a[148:151], v[208:223]
  ds_read_b64_tr_b16 a[212:213], v14 offset:192
  ds_read_b64_tr_b16 a[214:215], v14 offset:2752
  v_cvt_pk_bf16_f32 v75, v86, v87
  v_cvt_pk_bf16_f32 v76, v88, v89
  v_cvt_pk_bf16_f32 v77, v90, v91
  v_cvt_pk_bf16_f32 v78, v92, v93
  v_cvt_pk_bf16_f32 v79, v94, v95
  s_waitcnt lgkmcnt(8)
  v_mfma_f32_32x32x16_bf16 v[224:239], a[196:199], a[132:135], v[224:239]
  v_accvgpr_write_b32 a176, v72
  v_accvgpr_write_b32 a177, v73
  v_accvgpr_write_b32 a178, v74
  v_accvgpr_write_b32 a179, v75
  s_mov_b32 s66, 16384
  buffer_store_dwordx4 a[116:119], v2, s[84:87], s66 offen offset:3072 sc1
  v_mfma_f32_32x32x16_bf16 v[240:255], a[196:199], a[148:151], v[240:255]
  ds_read_b64_tr_b16 a[216:217], v14 offset:256
  ds_read_b64_tr_b16 a[218:219], v14 offset:2816
  v_accvgpr_write_b32 a180, v76
  v_accvgpr_write_b32 a181, v77
  v_accvgpr_write_b32 a182, v78
  v_accvgpr_write_b32 a183, v79
  s_add_u32 s74, s75, 0
  s_waitcnt vmcnt(3)
  v_cmp_ne_u32 vcc, s14, v43
  s_cbranch_vccz L_done4
  s_mov_b32 s15, 400000
L_spin4:
  buffer_load_dword v43, v42, s[92:95], s74 offen sc1
  s_waitcnt vmcnt(0)
  v_cmp_ne_u32 vcc, s14, v43
  s_cbranch_vccz L_done4
  s_sub_u32 s15, s15, 1
  s_cbranch_scc0 L_spin4
L_done4:
  s_waitcnt lgkmcnt(8)
  v_mfma_f32_32x32x16_bf16 v[96:111], a[200:203], a[160:163], v[96:111]
  s_add_u32 s66, s77, 0
  buffer_load_dwordx4 a[8:11], v2, s[56:59], s66 offen offset:0 sc1
  v_mfma_f32_32x32x16_bf16 v[112:127], a[200:203], a[176:179], v[112:127]
  ds_read_b64_tr_b16 a[220:221], v14 offset:5120
  ds_read_b64_tr_b16 a[222:223], v14 offset:7680
  s_waitcnt lgkmcnt(8)
  v_mfma_f32_32x32x16_bf16 v[128:143], a[204:207], a[160:163], v[128:143]
  s_add_u32 s66, s77, 12288
  buffer_load_dwordx4 a[12:15], v2, s[56:59], s66 offen offset:0 sc1
  v_mfma_f32_32x32x16_bf16 v[144:159], a[204:207], a[176:179], v[144:159]
  ds_read_b64_tr_b16 a[192:193], v14 offset:5184
  ds_read_b64_tr_b16 a[194:195], v14 offset:7744
  s_waitcnt lgkmcnt(8)
  v_mfma_f32_32x32x16_bf16 v[160:175], a[208:211], a[160:163], v[160:175]
  s_add_u32 s66, s77, 0
  buffer_load_dwordx4 a[24:27], v2, s[56:59], s66 offen offset:1024 sc1
  v_mfma_f32_32x32x16_bf16 v[176:191], a[208:211], a[176:179], v[176:191]
  ds_read_b64_tr_b16 a[196:197], v14 offset:5248
  ds_read_b64_tr_b16 a[198:199], v14 offset:7808
  s_waitcnt lgkmcnt(8)
  v_mfma_f32_32x32x16_bf16 v[192:207], a[212:215], a[160:163], v[192:207]
  s_add_u32 s66, s77, 12288
  buffer_load_dwordx4 a[28:31], v2, s[56:59], s66 offen offset:1024 sc1
  v_mfma_f32_32x32x16_bf16 v[208:223], a[212:215], a[176:179], v[208:223]
  ds_read_b64_tr_b16 a[200:201], v14 offset:5312
  ds_read_b64_tr_b16 a[202:203], v14 offset:7872
  s_waitcnt lgkmcnt(8)
  v_mfma_f32_32x32x16_bf16 v[224:239], a[216:219], a[160:163], v[224:239]
  s_add_u32 s66, s78, 0
  buffer_load_dwordx4 a[40:43], v2, s[56:59], s66 offen offset:0 sc1
  v_mfma_f32_32x32x16_bf16 v[240:255], a[216:219], a[176:179], v[240:255]
  ds_read_b64_tr_b16 a[204:205], v14 offset:5376
  ds_read_b64_tr_b16 a[206:207], v14 offset:7936
  s_waitcnt lgkmcnt(8)
  v_mfma_f32_32x32x16_bf16 v[96:111], a[220:223], a[164:167], v[96:111]
  s_add_u32 s66, s78, 12288
  buffer_load_dwordx4 a[44:47], v2, s[56:59], s66 offen offset:0 sc1
  v_mfma_f32_32x32x16_bf16 v[112:127], a[220:223], a[180:183], v[112:127]
  s_barrier
  ds_read_b64_tr_b16 a[208:209], v14 offset:12288
  ds_read_b64_tr_b16 a[210:211], v14 offset:14848
  s_waitcnt lgkmcnt(8)
  v_mfma_f32_32x32x16_bf16 v[128:143], a[192:195], a[164:167], v[128:143]
  s_add_u32 s67, s81, 122880
  s_add_u32 m0, s68, 24576
  s_nop 0
  buffer_load_dwordx4 v4, s[44:47], s67 offen offset:0 lds
  s_add_u32 s66, s78, 0
  buffer_load_dwordx4 a[56:59], v2, s[56:59], s66 offen offset:1024 sc1
  v_mfma_f32_32x32x16_bf16 v[144:159], a[192:195], a[180:183], v[144:159]
  ds_read_b64_tr_b16 a[212:213], v14 offset:12352
  ds_read_b64_tr_b16 a[214:215], v14 offset:14912
  buffer_load_dwordx4 v5, s[44:47], s67 offen offset:1024 lds
  s_waitcnt lgkmcnt(8)
  v_mfma_f32_32x32x16_bf16 v[160:175], a[196:199], a[164:167], v[160:175]
  buffer_load_dwordx4 v6, s[44:47], s67 offen offset:2048 lds
  s_add_u32 s66, s78, 12288
  buffer_load_dwordx4 a[60:63], v2, s[56:59], s66 offen offset:1024 sc1
  v_mfma_f32_32x32x16_bf16 v[176:191], a[196:199], a[180:183], v[176:191]
  ds_read_b64_tr_b16 a[216:217], v14 offset:12416
  ds_read_b64_tr_b16 a[218:219], v14 offset:14976
  s_add_u32 s67, s82, 122880
  s_add_u32 m0, s68, 36864
  s_nop 0
  buffer_load_dwordx4 v4, s[44:47], s67 offen offset:0 lds
  s_waitcnt lgkmcnt(8)
  v_mfma_f32_32x32x16_bf16 v[192:207], a[200:203], a[164:167], v[192:207]
  buffer_load_dwordx4 v5, s[44:47], s67 offen offset:1024 lds
  s_add_u32 s66, s79, 0
  buffer_load_dwordx4 a[72:75], v2, s[56:59], s66 offen offset:0 sc1
  v_mfma_f32_32x32x16_bf16 v[208:223], a[200:203], a[180:183], v[208:223]
  ds_read_b64_tr_b16 a[220:221], v14 offset:12480
  ds_read_b64_tr_b16 a[222:223], v14 offset:15040
  buffer_load_dwordx4 v6, s[44:47], s67 offen offset:2048 lds
  s_waitcnt lgkmcnt(8)
  v_mfma_f32_32x32x16_bf16 v[224:239], a[204:207], a[164:167], v[224:239]
  s_add_u32 s66, s79, 12288
  buffer_load_dwordx4 a[76:79], v2, s[56:59], s66 offen offset:0 sc1
  v_mfma_f32_32x32x16_bf16 v[240:255], a[204:207], a[180:183], v[240:255]
  ds_read_b64_tr_b16 a[192:193], v14 offset:12544
  ds_read_b64_tr_b16 a[194:195], v14 offset:15104
  s_waitcnt vmcnt(14)
  s_waitcnt lgkmcnt(8)
  v_mfma_f32_32x32x16_bf16 v[96:111], a[208:211], a[8:11], v[96:111]
  s_add_u32 s66, s79, 0
  buffer_load_dwordx4 a[88:91], v2, s[56:59], s66 offen offset:1024 sc1
  v_mfma_f32_32x32x16_bf16 v[112:127], a[208:211], a[12:15], v[112:127]
  ds_read_b64_tr_b16 a[196:197], v14 offset:17408
  ds_read_b64_tr_b16 a[198:199], v14 offset:19968
  s_waitcnt lgkmcnt(8)
  v_mfma_f32_32x32x16_bf16 v[128:143], a[212:215], a[8:11], v[128:143]
  s_add_u32 s66, s79, 12288
  buffer_load_dwordx4 a[92:95], v2, s[56:59], s66 offen offset:1024 sc1
  v_mfma_f32_32x32x16_bf16 v[144:159], a[212:215], a[12:15], v[144:159]
  ds_read_b64_tr_b16 a[200:201], v14 offset:17472
  ds_read_b64_tr_b16 a[202:203], v14 offset:20032
  s_waitcnt lgkmcnt(8)
  v_mfma_f32_32x32x16_bf16 v[160:175], a[216:219], a[8:11], v[160:175]
  v_mfma_f32_32x32x16_bf16 v[176:191], a[216:219], a[12:15], v[176:191]
  ds_read_b64_tr_b16 a[204:205], v14 offset:17536
  ds_read_b64_tr_b16 a[206:207], v14 offset:20096
  s_waitcnt lgkmcnt(8)
  v_mfma_f32_32x32x16_bf16 v[192:207], a[220:223], a[8:11], v[192:207]
  s_add_u32 s74, s100, 4
  buffer_store_dword v41, v40, s[92:95], s74 offen sc1
  v_mfma_f32_32x32x16_bf16 v[208:223], a[220:223], a[12:15], v[208:223]
  ds_read_b64_tr_b16 a[208:209], v14 offset:17600
  ds_read_b64_tr_b16 a[210:211], v14 offset:20160
  s_waitcnt lgkmcnt(8)
  v_mfma_f32_32x32x16_bf16 v[224:239], a[192:195], a[8:11], v[224:239]
  s_mov_b32 s66, 8192
  buffer_store_dwordx4 a[128:131], v2, s[84:87], s66 offen offset:0 sc1
  v_mfma_f32_32x32x16_bf16 v[240:255], a[192:195], a[12:15], v[240:255]
  ds_read_b64_tr_b16 a[212:213], v14 offset:17664
  ds_read_b64_tr_b16 a[214:215], v14 offset:20224
  s_waitcnt vmcnt(16)
  s_waitcnt lgkmcnt(8)
  v_mfma_f32_32x32x16_bf16 v[96:111], a[196:199], a[24:27], v[96:111]
  v_mfma_f32_32x32x16_bf16 v[112:127], a[196:199], a[28:31], v[112:127]
  ds_read_b64_tr_b16 a[216:217], v14 offset:24576
  ds_read_b64_tr_b16 a[218:219], v14 offset:27136
  s_waitcnt lgkmcnt(8)
  v_mfma_f32_32x32x16_bf16 v[128:143], a[200:203], a[24:27], v[128:143]
  s_add_u32 s66, s77, 0
  buffer_load_dwordx4 a[104:107], v2, s[56:59], s66 offen offset:2048 sc1
  v_mfma_f32_32x32x16_bf16 v[144:159], a[200:203], a[28:31], v[144:159]
  ds_read_b64_tr_b16 a[220:221], v14 offset:24640
  ds_read_b64_tr_b16 a[222:223], v14 offset:27200
  s_waitcnt lgkmcnt(8)
  v_mfma_f32_32x32x16_bf16 v[160:175], a[204:207], a[24:27], v[160:175]
  s_add_u32 s66, s77, 12288
  buffer_load_dwordx4 a[108:111], v2, s[56:59], s66 offen offset:2048 sc1
  v_mfma_f32_32x32x16_bf16 v[176:191], a[204:207], a[28:31], v[176:191]
  ds_read_b64_tr_b16 a[192:193], v14 offset:24704
  ds_read_b64_tr_b16 a[194:195], v14 offset:27264
  s_waitcnt lgkmcnt(8)
  v_mfma_f32_32x32x16_bf16 v[192:207], a[208:211], a[24:27], v[192:207]
  s_mov_b32 s66, 8192
  buffer_store_dwordx4 a[132:135], v2, s[84:87], s66 offen offset:1024 sc1
  s_add_u32 s66, s77, 0
  buffer_load_dwordx4 a[120:123], v2, s[56:59], s66 offen offset:3072 sc1
  v_mfma_f32_32x32x16_bf16 v[208:223], a[208:211], a[28:31], v[208:223]
  ds_read_b64_tr_b16 a[196:197], v14 offset:24768
  ds_read_b64_tr_b16 a[198:199], v14 offset:27328
  s_waitcnt lgkmcnt(8)
  v_mfma_f32_32x32x16_bf16 v[224:239], a[212:215], a[24:27], v[224:239]
  s_add_u32 s66, s77, 12288
  buffer_load_dwordx4 a[124:127], v2, s[56:59], s66 offen offset:3072 sc1
  v_mfma_f32_32x32x16_bf16 v[240:255], a[212:215], a[28:31], v[240:255]
  ds_read_b64_tr_b16 a[200:201], v14 offset:24832
  ds_read_b64_tr_b16 a[202:203], v14 offset:27392
  s_waitcnt vmcnt(19)
  s_waitcnt lgkmcnt(8)
  v_mfma_f32_32x32x16_bf16 v[96:111], a[216:219], a[40:43], v[96:111]
  s_add_u32 s66, s78, 0
  buffer_load_dwordx4 a[136:139], v2, s[56:59], s66 offen offset:2048 sc1
  v_mfma_f32_32x32x16_bf16 v[112:127], a[216:219], a[44:47], v[112:127]
  ds_read_b64_tr_b16 a[204:205], v14 offset:29696
  ds_read_b64_tr_b16 a[206:207], v14 offset:32256
  s_waitcnt lgkmcnt(8)
  v_mfma_f32_32x32x16_bf16 v[128:143], a[220:223], a[40:43], v[128:143]
  s_add_u32 s66, s78, 12288
  buffer_load_dwordx4 a[140:143], v2, s[56:59], s66 offen offset:2048 sc1
  v_mfma_f32_32x32x16_bf16 v[144:159], a[220:223], a[44:47], v[144:159]
  ds_read_b64_tr_b16 a[208:209], v14 offset:29760
  ds_read_b64_tr_b16 a[210:211], v14 offset:32320
  s_waitcnt lgkmcnt(8)
  v_mfma_f32_32x32x16_bf16 v[160:175], a[192:195], a[40:43], v[160:175]
  s_mov_b32 s66, 20480
  buffer_store_dwordx4 a[144:147], v2, s[84:87], s66 offen offset:0 sc1
  s_add_u32 s66, s78, 0
  buffer_load_dwordx4 a[152:155], v2, s[56:59], s66 offen offset:3072 sc1
  v_mfma_f32_32x32x16_bf16 v[176:191], a[192:195], a[44:47], v[176:191]
  ds_read_b64_tr_b16 a[212:213], v14 offset:29824
  ds_read_b64_tr_b16 a[214:215], v14 offset:32384
  s_waitcnt lgkmcnt(8)
  v_mfma_f32_32x32x16_bf16 v[192:207], a[196:199], a[40:43], v[192:207]
  s_add_u32 s66, s78, 12288
  buffer_load_dwordx4 a[156:159], v2, s[56:59], s66 offen offset:3072 sc1
  v_mfma_f32_32x32x16_bf16 v[208:223], a[196:199], a[44:47], v[208:223]
  ds_read_b64_tr_b16 a[216:217], v14 offset:29888
  ds_read_b64_tr_b16 a[218:219], v14 offset:32448
  s_waitcnt lgkmcnt(8)
  v_mfma_f32_32x32x16_bf16 v[224:239], a[200:203], a[40:43], v[224:239]
  s_add_u32 s66, s79, 0
  buffer_load_dwordx4 a[168:171], v2, s[56:59], s66 offen offset:2048 sc1
  v_mfma_f32_32x32x16_bf16 v[240:255], a[200:203], a[44:47], v[240:255]
  ds_read_b64_tr_b16 a[220:221], v14 offset:29952
  ds_read_b64_tr_b16 a[222:223], v14 offset:32512
  s_waitcnt vmcnt(20)
  s_waitcnt lgkmcnt(8)
  v_mfma_f32_32x32x16_bf16 v[96:111], a[204:207], a[56:59], v[96:111]
  s_add_u32 s66, s79, 12288
  buffer_load_dwordx4 a[172:175], v2, s[56:59], s66 offen offset:2048 sc1
  v_mfma_f32_32x32x16_bf16 v[112:127], a[204:207], a[60:63], v[112:127]
  s_barrier
  ds_read_b64_tr_b16 a[192:193], v14 offset:36864
  ds_read_b64_tr_b16 a[194:195], v14 offset:39424
  s_waitcnt lgkmcnt(8)
  v_mfma_f32_32x32x16_bf16 v[128:143], a[208:211], a[56:59], v[128:143]
  s_add_u32 s67, s83, 122880
  s_add_u32 m0, s68, 49152
  s_nop 0
  buffer_load_dwordx4 v4, s[44:47], s67 offen offset:0 lds
  s_mov_b32 s66, 20480
  buffer_store_dwordx4 a[148:151], v2, s[84:87], s66 offen offset:1024 sc1
  s_add_u32 s66, s79, 0
  buffer_load_dwordx4 a[184:187], v2, s[56:59], s66 offen offset:3072 sc1
  v_mfma_f32_32x32x16_bf16 v[144:159], a[208:211], a[60:63], v[144:159]
  ds_read_b64_tr_b16 a[196:197], v14 offset:36928
  ds_read_b64_tr_b16 a[198:199], v14 offset:39488
  buffer_load_dwordx4 v5, s[44:47], s67 offen offset:1024 lds
  s_waitcnt lgkmcnt(8)
  v_mfma_f32_32x32x16_bf16 v[160:175], a[212:215], a[56:59], v[160:175]
  buffer_load_dwordx4 v6, s[44:47], s67 offen offset:2048 lds
  s_add_u32 s66, s79, 12288
  buffer_load_dwordx4 a[188:191], v2, s[56:59], s66 offen offset:3072 sc1
  v_mfma_f32_32x32x16_bf16 v[176:191], a[212:215], a[60:63], v[176:191]
  ds_read_b64_tr_b16 a[200:201], v14 offset:36992
  ds_read_b64_tr_b16 a[202:203], v14 offset:39552
  s_add_u32 s67, s81, 163840
  s_add_u32 m0, s68, 61440
  s_nop 0
  buffer_load_dwordx4 v4, s[44:47], s67 offen offset:0 lds
  s_waitcnt lgkmcnt(8)
  v_mfma_f32_32x32x16_bf16 v[192:207], a[216:219], a[56:59], v[192:207]
  buffer_load_dwordx4 v5, s[44:47], s67 offen offset:1024 lds
  v_mfma_f32_32x32x16_bf16 v[208:223], a[216:219], a[60:63], v[208:223]
  ds_read_b64_tr_b16 a[204:205], v14 offset:37056
  ds_read_b64_tr_b16 a[206:207], v14 offset:39616
  buffer_load_dwordx4 v6, s[44:47], s67 offen offset:2048 lds
  s_waitcnt lgkmcnt(8)
  v_mfma_f32_32x32x16_bf16 v[224:239], a[220:223], a[56:59], v[224:239]
  s_add_u32 s74, s75, 4
  buffer_load_dword v43, v42, s[92:95], s74 offen sc1
  v_mfma_f32_32x32x16_bf16 v[240:255], a[220:223], a[60:63], v[240:255]
  ds_read_b64_tr_b16 a[208:209], v14 offset:37120
  ds_read_b64_tr_b16 a[210:211], v14 offset:39680
  s_lshr_b32 s60, s35, 1
  s_mul_i32 s61, s60, 192
  s_sub_u32 s62, 1966080, s61
  s_cmp_lt_u32 s30, 2
  s_cselect_b32 s63, s16, s18
  s_cselect_b32 s64, s17, s19
  s_add_u32 s48, s63, s61
  s_addc_u32 s49, s64, 0
  s_mov_b32 s50, s62
  s_mov_b32 s51, 0x20000
  s_and_b32 s60, s30, 1
  s_mul_i32 s60, s60, 192
  s_waitcnt vmcnt(26)
  s_waitcnt lgkmcnt(8)
  v_mfma_f32_32x32x16_bf16 v[96:111], a[192:195], a[72:75], v[96:111]
  v_add_u32 v44, s60, v1
  v_mfma_f32_32x32x16_bf16 v[112:127], a[192:195], a[76:79], v[112:127]
  ds_read_b64_tr_b16 a[212:213], v14 offset:41984
  ds_read_b64_tr_b16 a[214:215], v14 offset:44544
  v_mul_u32_u24 v45, 5462, v44
  s_waitcnt lgkmcnt(8)
  v_mfma_f32_32x32x16_bf16 v[128:143], a[196:199], a[72:75], v[128:143]
  v_lshrrev_b32 v45, 16, v45
  v_mfma_f32_32x32x16_bf16 v[144:159], a[196:199], a[76:79], v[144:159]
  ds_read_b64_tr_b16 a[216:217], v14 offset:42048
  ds_read_b64_tr_b16 a[218:219], v14 offset:44608
  v_mul_u32_u24 v46, 12, v45
  s_waitcnt lgkmcnt(8)
  v_mfma_f32_32x32x16_bf16 v[160:175], a[200:203], a[72:75], v[160:175]
  v_sub_u32 v46, v44, v46
  v_mfma_f32_32x32x16_bf16 v[176:191], a[200:203], a[76:79], v[176:191]
  ds_read_b64_tr_b16 a[220:221], v14 offset:42112
  ds_read_b64_tr_b16 a[222:223], v14 offset:44672
  v_mul_u32_u24 v47, 3072, v45
  s_waitcnt lgkmcnt(8)
  v_mfma_f32_32x32x16_bf16 v[192:207], a[204:207], a[72:75], v[192:207]
  v_lshl_add_u32 v47, v46, 4, v47
  v_mfma_f32_32x32x16_bf16 v[208:223], a[204:207], a[76:79], v[208:223]
  ds_read_b64_tr_b16 a[192:193], v14 offset:42176
  ds_read_b64_tr_b16 a[194:195], v14 offset:44736
  v_subrev_u32 v16, 0, v47
  s_waitcnt lgkmcnt(8)
  v_mfma_f32_32x32x16_bf16 v[224:239], a[208:211], a[72:75], v[224:239]
  v_add_u32 v44, s60, v1
  v_mfma_f32_32x32x16_bf16 v[240:255], a[208:211], a[76:79], v[240:255]
  ds_read_b64_tr_b16 a[196:197], v14 offset:42240
  ds_read_b64_tr_b16 a[198:199], v14 offset:44800
  v_add_u32 v44, 64, v44
  s_waitcnt vmcnt(24)
  s_waitcnt lgkmcnt(8)
  v_mfma_f32_32x32x16_bf16 v[96:111], a[212:215], a[88:91], v[96:111]
  v_mul_u32_u24 v45, 5462, v44
  v_mfma_f32_32x32x16_bf16 v[112:127], a[212:215], a[92:95], v[112:127]
  ds_read_b64_tr_b16 a[200:201], v14 offset:49152
  ds_read_b64_tr_b16 a[202:203], v14 offset:51712
  v_lshrrev_b32 v45, 16, v45
  s_waitcnt lgkmcnt(8)
  v_mfma_f32_32x32x16_bf16 v[128:143], a[216:219], a[88:91], v[128:143]
  v_mul_u32_u24 v46, 12, v45
  v_mfma_f32_32x32x16_bf16 v[144:159], a[216:219], a[92:95], v[144:159]
  ds_read_b64_tr_b16 a[204:205], v14 offset:49216
  ds_read_b64_tr_b16 a[206:207], v14 offset:51776
  v_sub_u32 v46, v44, v46
  s_waitcnt lgkmcnt(8)
  v_mfma_f32_32x32x16_bf16 v[160:175], a[220:223], a[88:91], v[160:175]
  v_mul_u32_u24 v47, 3072, v45
  v_mfma_f32_32x32x16_bf16 v[176:191], a[220:223], a[92:95], v[176:191]
  ds_read_b64_tr_b16 a[208:209], v14 offset:49280
  ds_read_b64_tr_b16 a[210:211], v14 offset:51840
  v_lshl_add_u32 v47, v46, 4, v47
  s_waitcnt lgkmcnt(8)
  v_mfma_f32_32x32x16_bf16 v[192:207], a[192:195], a[88:91], v[192:207]
  v_subrev_u32 v17, 1024, v47
  v_mfma_f32_32x32x16_bf16 v[208:223], a[192:195], a[92:95], v[208:223]
  ds_read_b64_tr_b16 a[212:213], v14 offset:49344
  ds_read_b64_tr_b16 a[214:215], v14 offset:51904
  s_waitcnt lgkmcnt(8)
  v_mfma_f32_32x32x16_bf16 v[224:239], a[196:199], a[88:91], v[224:239]
  v_add_u32 v44, s60, v1
  s_add_u32 s74, s75, 4
  s_waitcnt vmcnt(0)
  v_cmp_ne_u32 vcc, s14, v43
  s_cbranch_vccz L_done5
  s_mov_b32 s15, 400000
L_spin5:
  buffer_load_dword v43, v42, s[92:95], s74 offen sc1
  s_waitcnt vmcnt(0)
  v_cmp_ne_u32 vcc, s14, v43
  s_cbranch_vccz L_done5
  s_sub_u32 s15, s15, 1
  s_cbranch_scc0 L_spin5
L_done5:
  v_mfma_f32_32x32x16_bf16 v[240:255], a[196:199], a[92:95], v[240:255]
  ds_read_b64_tr_b16 a[216:217], v14 offset:49408
  ds_read_b64_tr_b16 a[218:219], v14 offset:51968
  v_add_u32 v44, 128, v44
  s_add_u32 s66, s77, 4096
  buffer_load_dwordx4 a[0:3], v2, s[56:59], s66 offen offset:0 sc1
  s_waitcnt lgkmcnt(8)
  v_mfma_f32_32x32x16_bf16 v[96:111], a[200:203], a[104:107], v[96:111]
  v_mul_u32_u24 v45, 5462, v44
  v_mfma_f32_32x32x16_bf16 v[112:127], a[200:203], a[108:111], v[112:127]
  ds_read_b64_tr_b16 a[220:221], v14 offset:54272
  ds_read_b64_tr_b16 a[222:223], v14 offset:56832
  v_lshrrev_b32 v45, 16, v45
  s_add_u32 s66, s77, 16384
  buffer_load_dwordx4 a[4:7], v2, s[56:59], s66 offen offset:0 sc1
  s_waitcnt lgkmcnt(8)
  v_mfma_f32_32x32x16_bf16 v[128:143], a[204:207], a[104:107], v[128:143]
  v_mul_u32_u24 v46, 12, v45
  v_mfma_f32_32x32x16_bf16 v[144:159], a[204:207], a[108:111], v[144:159]
  ds_read_b64_tr_b16 a[192:193], v14 offset:54336
  ds_read_b64_tr_b16 a[194:195], v14 offset:56896
  v_sub_u32 v46, v44, v46
  s_add_u32 s66, s77, 4096
  buffer_load_dwordx4 a[16:19], v2, s[56:59], s66 offen offset:1024 sc1
  s_waitcnt lgkmcnt(8)
  v_mfma_f32_32x32x16_bf16 v[160:175], a[208:211], a[104:107], v[160:175]
  v_mul_u32_u24 v47, 3072, v45
  s_mov_b32 s66, 8192
  buffer_store_dwordx4 a[160:163], v2, s[84:87], s66 offen offset:2048 sc1
  v_mfma_f32_32x32x16_bf16 v[176:191], a[208:211], a[108:111], v[176:191]
  ds_read_b64_tr_b16 a[196:197], v14 offset:54400
  ds_read_b64_tr_b16 a[198:199], v14 offset:56960
  v_lshl_add_u32 v47, v46, 4, v47
  s_add_u32 s66, s77, 16384
  buffer_load_dwordx4 a[20:23], v2, s[56:59], s66 offen offset:1024 sc1
  s_waitcnt lgkmcnt(8)
  v_mfma_f32_32x32x16_bf16 v[192:207], a[212:215], a[104:107], v[192:207]
  v_subrev_u32 v18, 2048, v47
  v_mfma_f32_32x32x16_bf16 v[208:223], a[212:215], a[108:111], v[208:223]
  ds_read_b64_tr_b16 a[200:201], v14 offset:54464
  ds_read_b64_tr_b16 a[202:203], v14 offset:57024
  s_add_u32 s66, s78, 4096
  buffer_load_dwordx4 a[32:35], v2, s[56:59], s66 offen offset:0 sc1
  s_waitcnt lgkmcnt(8)
  v_mfma_f32_32x32x16_bf16 v[224:239], a[216:219], a[104:107], v[224:239]
  v_mfma_f32_32x32x16_bf16 v[240:255], a[216:219], a[108:111], v[240:255]
  ds_read_b64_tr_b16 a[204:205], v14 offset:54528
  ds_read_b64_tr_b16 a[206:207], v14 offset:57088
  s_add_u32 s66, s78, 16384
  buffer_load_dwordx4 a[36:39], v2, s[56:59], s66 offen offset:0 sc1
  s_waitcnt lgkmcnt(8)
  v_mfma_f32_32x32x16_bf16 v[96:111], a[220:223], a[120:123], v[96:111]
  v_mfma_f32_32x32x16_bf16 v[112:127], a[220:223], a[124:127], v[112:127]
  s_barrier
  ds_read_b64_tr_b16 a[208:209], v15 offset:0
  ds_read_b64_tr_b16 a[210:211], v15 offset:2560
  s_add_u32 s66, s78, 4096
  buffer_load_dwordx4 a[48:51], v2, s[56:59], s66 offen offset:1024 sc1
  s_waitcnt lgkmcnt(8)
  v_mfma_f32_32x32x16_bf16 v[128:143], a[192:195], a[120:123], v[128:143]
  s_add_u32 s67, s82, 163840
  s_add_u32 m0, s68, 73728
  s_nop 0
  buffer_load_dwordx4 v4, s[44:47], s67 offen offset:0 lds
  s_mov_b32 s66, 8192
  buffer_store_dwordx4 a[164:167], v2, s[84:87], s66 offen offset:3072 sc1
  v_mfma_f32_32x32x16_bf16 v[144:159], a[192:195], a[124:127], v[144:159]
  ds_read_b64_tr_b16 a[212:213], v15 offset:64
  ds_read_b64_tr_b16 a[214:215], v15 offset:2624
  buffer_load_dwordx4 v5, s[44:47], s67 offen offset:1024 lds
  s_add_u32 s66, s78, 16384
  buffer_load_dwordx4 a[52:55], v2, s[56:59], s66 offen offset:1024 sc1
  s_waitcnt lgkmcnt(8)
  v_mfma_f32_32x32x16_bf16 v[160:175], a[196:199], a[120:123], v[160:175]
  buffer_load_dwordx4 v6, s[44:47], s67 offen offset:2048 lds
  v_mfma_f32_32x32x16_bf16 v[176:191], a[196:199], a[124:127], v[176:191]
  ds_read_b64_tr_b16 a[216:217], v15 offset:128
  ds_read_b64_tr_b16 a[218:219], v15 offset:2688
  s_add_u32 s67, s83, 163840
  s_add_u32 m0, s68, 86016
  s_nop 0
  buffer_load_dwordx4 v4, s[44:47], s67 offen offset:0 lds
  s_add_u32 s66, s79, 4096
  buffer_load_dwordx4 a[64:67], v2, s[56:59], s66 offen offset:0 sc1
  s_waitcnt lgkmcnt(8)
  v_mfma_f32_32x32x16_bf16 v[192:207], a[200:203], a[120:123], v[192:207]
  buffer_load_dwordx4 v5, s[44:47], s67 offen offset:1024 lds
  v_mfma_f32_32x32x16_bf16 v[208:223], a[200:203], a[124:127], v[208:223]
  ds_read_b64_tr_b16 a[220:221], v15 offset:192
  ds_read_b64_tr_b16 a[222:223], v15 offset:2752
  buffer_load_dwordx4 v6, s[44:47], s67 offen offset:2048 lds
  s_add_u32 s66, s79, 16384
  buffer_load_dwordx4 a[68:71], v2, s[56:59], s66 offen offset:0 sc1
  s_waitcnt lgkmcnt(8)
  v_mfma_f32_32x32x16_bf16 v[224:239], a[204:207], a[120:123], v[224:239]
  v_mfma_f32_32x32x16_bf16 v[240:255], a[204:207], a[124:127], v[240:255]
  ds_read_b64_tr_b16 a[192:193], v15 offset:256
  ds_read_b64_tr_b16 a[194:195], v15 offset:2816
  s_add_u32 s66, s79, 4096
  buffer_load_dwordx4 a[80:83], v2, s[56:59], s66 offen offset:1024 sc1
  s_waitcnt lgkmcnt(8)
  v_mfma_f32_32x32x16_bf16 v[96:111], a[208:211], a[136:139], v[96:111]
  s_mov_b32 s66, 20480
  buffer_store_dwordx4 a[176:179], v2, s[84:87], s66 offen offset:2048 sc1
  v_mfma_f32_32x32x16_bf16 v[112:127], a[208:211], a[140:143], v[112:127]
  ds_read_b64_tr_b16 a[196:197], v15 offset:5120
  ds_read_b64_tr_b16 a[198:199], v15 offset:7680
  s_add_u32 s66, s79, 16384
  buffer_load_dwordx4 a[84:87], v2, s[56:59], s66 offen offset:1024 sc1
  s_waitcnt lgkmcnt(8)
  v_mfma_f32_32x32x16_bf16 v[128:143], a[212:215], a[136:139], v[128:143]
  v_mfma_f32_32x32x16_bf16 v[144:159], a[212:215], a[140:143], v[144:159]
  ds_read_b64_tr_b16 a[200:201], v15 offset:5184
  ds_read_b64_tr_b16 a[202:203], v15 offset:7744
  s_waitcnt lgkmcnt(8)
  v_mfma_f32_32x32x16_bf16 v[160:175], a[216:219], a[136:139], v[160:175]
  v_mfma_f32_32x32x16_bf16 v[176:191], a[216:219], a[140:143], v[176:191]
  ds_read_b64_tr_b16 a[204:205], v15 offset:5248
  ds_read_b64_tr_b16 a[206:207], v15 offset:7808
  s_waitcnt lgkmcnt(8)
  v_mfma_f32_32x32x16_bf16 v[192:207], a[220:223], a[136:139], v[192:207]
  v_mfma_f32_32x32x16_bf16 v[208:223], a[220:223], a[140:143], v[208:223]
  ds_read_b64_tr_b16 a[208:209], v15 offset:5312
  ds_read_b64_tr_b16 a[210:211], v15 offset:7872
  s_waitcnt lgkmcnt(8)
  v_mfma_f32_32x32x16_bf16 v[224:239], a[192:195], a[136:139], v[224:239]
  s_mov_b32 s66, 20480
  buffer_store_dwordx4 a[180:183], v2, s[84:87], s66 offen offset:3072 sc1
  v_mfma_f32_32x32x16_bf16 v[240:255], a[192:195], a[140:143], v[240:255]
  ds_read_b64_tr_b16 a[212:213], v15 offset:5376
  ds_read_b64_tr_b16 a[214:215], v15 offset:7936
  s_waitcnt lgkmcnt(8)
  v_mfma_f32_32x32x16_bf16 v[96:111], a[196:199], a[152:155], v[96:111]
  v_mfma_f32_32x32x16_bf16 v[112:127], a[196:199], a[156:159], v[112:127]
  ds_read_b64_tr_b16 a[216:217], v15 offset:12288
  ds_read_b64_tr_b16 a[218:219], v15 offset:14848
  s_waitcnt lgkmcnt(8)
  v_mfma_f32_32x32x16_bf16 v[128:143], a[200:203], a[152:155], v[128:143]
  v_mfma_f32_32x32x16_bf16 v[144:159], a[200:203], a[156:159], v[144:159]
  ds_read_b64_tr_b16 a[220:221], v15 offset:12352
  ds_read_b64_tr_b16 a[222:223], v15 offset:14912
  s_waitcnt lgkmcnt(8)
  v_mfma_f32_32x32x16_bf16 v[160:175], a[204:207], a[152:155], v[160:175]
  v_mfma_f32_32x32x16_bf16 v[176:191], a[204:207], a[156:159], v[176:191]
  ds_read_b64_tr_b16 a[192:193], v15 offset:12416
  ds_read_b64_tr_b16 a[194:195], v15 offset:14976
  s_waitcnt lgkmcnt(8)
  v_mfma_f32_32x32x16_bf16 v[192:207], a[208:211], a[152:155], v[192:207]
  v_mfma_f32_32x32x16_bf16 v[208:223], a[208:211], a[156:159], v[208:223]
  ds_read_b64_tr_b16 a[196:197], v15 offset:12480
  ds_read_b64_tr_b16 a[198:199], v15 offset:15040
  s_waitcnt lgkmcnt(8)
  v_mfma_f32_32x32x16_bf16 v[224:239], a[212:215], a[152:155], v[224:239]
  v_mfma_f32_32x32x16_bf16 v[240:255], a[212:215], a[156:159], v[240:255]
  ds_read_b64_tr_b16 a[200:201], v15 offset:12544
  ds_read_b64_tr_b16 a[202:203], v15 offset:15104
  s_waitcnt lgkmcnt(8)
  v_mfma_f32_32x32x16_bf16 v[96:111], a[216:219], a[168:171], v[96:111]
  v_mfma_f32_32x32x16_bf16 v[112:127], a[216:219], a[172:175], v[112:127]
  ds_read_b64_tr_b16 a[204:205], v15 offset:17408
  ds_read_b64_tr_b16 a[206:207], v15 offset:19968
  s_waitcnt lgkmcnt(8)
  v_mfma_f32_32x32x16_bf16 v[128:143], a[220:223], a[168:171], v[128:143]
  v_mfma_f32_32x32x16_bf16 v[144:159], a[220:223], a[172:175], v[144:159]
  ds_read_b64_tr_b16 a[208:209], v15 offset:17472
  ds_read_b64_tr_b16 a[210:211], v15 offset:20032
  s_waitcnt lgkmcnt(8)
  v_mfma_f32_32x32x16_bf16 v[160:175], a[192:195], a[168:171], v[160:175]
  v_mfma_f32_32x32x16_bf16 v[176:191], a[192:195], a[172:175], v[176:191]
  ds_read_b64_tr_b16 a[212:213], v15 offset:17536
  ds_read_b64_tr_b16 a[214:215], v15 offset:20096
  s_waitcnt lgkmcnt(8)
  v_mfma_f32_32x32x16_bf16 v[192:207], a[196:199], a[168:171], v[192:207]
  v_mfma_f32_32x32x16_bf16 v[208:223], a[196:199], a[172:175], v[208:223]
  ds_read_b64_tr_b16 a[216:217], v15 offset:17600
  ds_read_b64_tr_b16 a[218:219], v15 offset:20160
  s_waitcnt lgkmcnt(8)
  v_mfma_f32_32x32x16_bf16 v[224:239], a[200:203], a[168:171], v[224:239]
  v_mfma_f32_32x32x16_bf16 v[240:255], a[200:203], a[172:175], v[240:255]
  ds_read_b64_tr_b16 a[220:221], v15 offset:17664
  ds_read_b64_tr_b16 a[222:223], v15 offset:20224
  s_waitcnt lgkmcnt(8)
  v_mfma_f32_32x32x16_bf16 v[96:111], a[204:207], a[184:187], v[96:111]
  v_mfma_f32_32x32x16_bf16 v[112:127], a[204:207], a[188:191], v[112:127]
  s_barrier
  ds_read_b64_tr_b16 a[192:193], v15 offset:24576
  ds_read_b64_tr_b16 a[194:195], v15 offset:27136
  s_waitcnt lgkmcnt(8)
  v_mfma_f32_32x32x16_bf16 v[128:143], a[208:211], a[184:187], v[128:143]
  s_add_u32 s67, s81, 204800
  s_add_u32 m0, s68, 98304
  s_nop 0
  buffer_load_dwordx4 v4, s[44:47], s67 offen offset:0 lds
  v_mfma_f32_32x32x16_bf16 v[144:159], a[208:211], a[188:191], v[144:159]
  ds_read_b64_tr_b16 a[196:197], v15 offset:24640
  ds_read_b64_tr_b16 a[198:199], v15 offset:27200
  buffer_load_dwordx4 v5, s[44:47], s67 offen offset:1024 lds
  s_waitcnt lgkmcnt(8)
  v_mfma_f32_32x32x16_bf16 v[160:175], a[212:215], a[184:187], v[160:175]
  buffer_load_dwordx4 v6, s[44:47], s67 offen offset:2048 lds
  v_mfma_f32_32x32x16_bf16 v[176:191], a[212:215], a[188:191], v[176:191]
  ds_read_b64_tr_b16 a[200:201], v15 offset:24704
  ds_read_b64_tr_b16 a[202:203], v15 offset:27264
  s_add_u32 s67, s82, 204800
  s_add_u32 m0, s68, 110592
  s_nop 0
  buffer_load_dwordx4 v4, s[44:47], s67 offen offset:0 lds
  s_waitcnt lgkmcnt(8)
  s_getpc_b64 s[96:97]
  s_add_u32 s96, s96, 1024
  s_addc_u32 s97, s97, 0
  v_lshlrev_b32 v36, 6, v0
  v_mov_b32 v37, 0
  v_lshl_add_u64 v[36:37], v[36:37], 0, s[96:97]
  global_load_dword a225, v[36:37], off
  v_mfma_f32_32x32x16_bf16 v[192:207], a[216:219], a[184:187], v[192:207]
  buffer_load_dwordx4 v5, s[44:47], s67 offen offset:1024 lds
  v_mfma_f32_32x32x16_bf16 v[208:223], a[216:219], a[188:191], v[208:223]
  ds_read_b64_tr_b16 a[204:205], v15 offset:24768
  ds_read_b64_tr_b16 a[206:207], v15 offset:27328
  buffer_load_dwordx4 v6, s[44:47], s67 offen offset:2048 lds
  s_waitcnt lgkmcnt(8)
  v_mfma_f32_32x32x16_bf16 v[224:239], a[220:223], a[184:187], v[224:239]
  s_waitcnt vmcnt(7)
  s_add_u32 s74, s100, 8
  buffer_store_dword v41, v40, s[92:95], s74 offen sc1
  v_mfma_f32_32x32x16_bf16 v[240:255], a[220:223], a[188:191], v[240:255]
  ds_read_b64_tr_b16 a[208:209], v15 offset:24832
  ds_read_b64_tr_b16 a[210:211], v15 offset:27392
  s_waitcnt lgkmcnt(8)
  v_mfma_f32_32x32x16_bf16 v[96:111], a[192:195], a[0:3], v[96:111]
  v_mfma_f32_32x32x16_bf16 v[112:127], a[192:195], a[4:7], v[112:127]
  ds_read_b64_tr_b16 a[212:213], v15 offset:29696
  ds_read_b64_tr_b16 a[214:215], v15 offset:32256
  s_waitcnt lgkmcnt(8)
  v_mfma_f32_32x32x16_bf16 v[128:143], a[196:199], a[0:3], v[128:143]
  s_add_u32 s66, s77, 4096
  buffer_load_dwordx4 a[96:99], v2, s[56:59], s66 offen offset:2048 sc1
  v_mfma_f32_32x32x16_bf16 v[144:159], a[196:199], a[4:7], v[144:159]
  ds_read_b64_tr_b16 a[216:217], v15 offset:29760
  ds_read_b64_tr_b16 a[218:219], v15 offset:32320
  s_waitcnt lgkmcnt(8)
  v_mfma_f32_32x32x16_bf16 v[160:175], a[200:203], a[0:3], v[160:175]
  s_add_u32 s66, s77, 16384
  buffer_load_dwordx4 a[100:103], v2, s[56:59], s66 offen offset:2048 sc1
  v_mfma_f32_32x32x16_bf16 v[176:191], a[200:203], a[4:7], v[176:191]
  ds_read_b64_tr_b16 a[220:221], v15 offset:29824
  ds_read_b64_tr_b16 a[222:223], v15 offset:32384
  s_waitcnt lgkmcnt(8)
  v_mfma_f32_32x32x16_bf16 v[192:207], a[204:207], a[0:3], v[192:207]
  s_add_u32 s66, s77, 4096
  buffer_load_dwordx4 a[112:115], v2, s[56:59], s66 offen offset:3072 sc1
  v_mfma_f32_32x32x16_bf16 v[208:223], a[204:207], a[4:7], v[208:223]
  ds_read_b64_tr_b16 a[192:193], v15 offset:29888
  ds_read_b64_tr_b16 a[194:195], v15 offset:32448
  s_waitcnt lgkmcnt(8)
  v_mfma_f32_32x32x16_bf16 v[224:239], a[208:211], a[0:3], v[224:239]
  s_add_u32 s66, s77, 16384
  buffer_load_dwordx4 a[116:119], v2, s[56:59], s66 offen offset:3072 sc1
  v_mfma_f32_32x32x16_bf16 v[240:255], a[208:211], a[4:7], v[240:255]
  ds_read_b64_tr_b16 a[196:197], v15 offset:29952
  ds_read_b64_tr_b16 a[198:199], v15 offset:32512
  s_waitcnt lgkmcnt(8)
  v_mfma_f32_32x32x16_bf16 v[96:111], a[212:215], a[16:19], v[96:111]
  s_add_u32 s66, s78, 4096
  buffer_load_dwordx4 a[128:131], v2, s[56:59], s66 offen offset:2048 sc1
  v_mfma_f32_32x32x16_bf16 v[112:127], a[212:215], a[20:23], v[112:127]
  ds_read_b64_tr_b16 a[200:201], v13 offset:0
  ds_read_b64_tr_b16 a[202:203], v13 offset:2560
  s_waitcnt lgkmcnt(8)
  v_mfma_f32_32x32x16_bf16 v[128:143], a[216:219], a[16:19], v[128:143]
  s_add_u32 s66, s78, 16384
  buffer_load_dwordx4 a[132:135], v2, s[56:59], s66 offen offset:2048 sc1
  v_mfma_f32_32x32x16_bf16 v[144:159], a[216:219], a[20:23], v[144:159]
  ds_read_b64_tr_b16 a[204:205], v13 offset:64
  ds_read_b64_tr_b16 a[206:207], v13 offset:2624
  s_waitcnt lgkmcnt(8)
  v_mfma_f32_32x32x16_bf16 v[160:175], a[220:223], a[16:19], v[160:175]
  s_add_u32 s66, s78, 4096
  buffer_load_dwordx4 a[144:147], v2, s[56:59], s66 offen offset:3072 sc1
  v_mfma_f32_32x32x16_bf16 v[176:191], a[220:223], a[20:23], v[176:191]
  ds_read_b64_tr_b16 a[208:209], v13 offset:128
  ds_read_b64_tr_b16 a[210:211], v13 offset:2688
  s_waitcnt lgkmcnt(8)
  v_mfma_f32_32x32x16_bf16 v[192:207], a[192:195], a[16:19], v[192:207]
  s_add_u32 s66, s78, 16384
  buffer_load_dwordx4 a[148:151], v2, s[56:59], s66 offen offset:3072 sc1
  v_mfma_f32_32x32x16_bf16 v[208:223], a[192:195], a[20:23], v[208:223]
  ds_read_b64_tr_b16 a[212:213], v13 offset:192
  ds_read_b64_tr_b16 a[214:215], v13 offset:2752
  s_waitcnt lgkmcnt(8)
  v_mfma_f32_32x32x16_bf16 v[224:239], a[196:199], a[16:19], v[224:239]
  s_add_u32 s66, s79, 4096
  buffer_load_dwordx4 a[160:163], v2, s[56:59], s66 offen offset:2048 sc1
  v_mfma_f32_32x32x16_bf16 v[240:255], a[196:199], a[20:23], v[240:255]
  ds_read_b64_tr_b16 a[216:217], v13 offset:256
  ds_read_b64_tr_b16 a[218:219], v13 offset:2816
  s_waitcnt lgkmcnt(8)
  v_mfma_f32_32x32x16_bf16 v[96:111], a[200:203], a[32:35], v[96:111]
  s_add_u32 s66, s79, 16384
  buffer_load_dwordx4 a[164:167], v2, s[56:59], s66 offen offset:2048 sc1
  v_mfma_f32_32x32x16_bf16 v[112:127], a[200:203], a[36:39], v[112:127]
  ds_read_b64_tr_b16 a[220:221], v13 offset:5120
  ds_read_b64_tr_b16 a[222:223], v13 offset:7680
  s_waitcnt lgkmcnt(8)
  v_mfma_f32_32x32x16_bf16 v[128:143], a[204:207], a[32:35], v[128:143]
  s_add_u32 s66, s79, 4096
  buffer_load_dwordx4 a[176:179], v2, s[56:59], s66 offen offset:3072 sc1
  v_mfma_f32_32x32x16_bf16 v[144:159], a[204:207], a[36:39], v[144:159]
  ds_read_b64_tr_b16 a[192:193], v13 offset:5184
  ds_read_b64_tr_b16 a[194:195], v13 offset:7744
  s_waitcnt lgkmcnt(8)
  v_mfma_f32_32x32x16_bf16 v[160:175], a[208:211], a[32:35], v[160:175]
  s_add_u32 s66, s79, 16384
  buffer_load_dwordx4 a[180:183], v2, s[56:59], s66 offen offset:3072 sc1
  v_mfma_f32_32x32x16_bf16 v[176:191], a[208:211], a[36:39], v[176:191]
  ds_read_b64_tr_b16 a[196:197], v13 offset:5248
  ds_read_b64_tr_b16 a[198:199], v13 offset:7808
  s_waitcnt lgkmcnt(8)
  v_mfma_f32_32x32x16_bf16 v[192:207], a[212:215], a[32:35], v[192:207]
  v_mfma_f32_32x32x16_bf16 v[208:223], a[212:215], a[36:39], v[208:223]
  ds_read_b64_tr_b16 a[200:201], v13 offset:5312
  ds_read_b64_tr_b16 a[202:203], v13 offset:7872
  s_waitcnt lgkmcnt(8)
  v_mfma_f32_32x32x16_bf16 v[224:239], a[216:219], a[32:35], v[224:239]
  s_add_u32 s74, s75, 8
  buffer_load_dword v43, v42, s[92:95], s74 offen sc1
  v_mfma_f32_32x32x16_bf16 v[240:255], a[216:219], a[36:39], v[240:255]
  ds_read_b64_tr_b16 a[204:205], v13 offset:5376
  ds_read_b64_tr_b16 a[206:207], v13 offset:7936
  s_waitcnt lgkmcnt(8)
  v_mfma_f32_32x32x16_bf16 v[96:111], a[220:223], a[48:51], v[96:111]
  v_mfma_f32_32x32x16_bf16 v[112:127], a[220:223], a[52:55], v[112:127]
  s_barrier
  ds_read_b64_tr_b16 a[208:209], v13 offset:12288
  ds_read_b64_tr_b16 a[210:211], v13 offset:14848
  s_waitcnt lgkmcnt(8)
  v_mfma_f32_32x32x16_bf16 v[128:143], a[192:195], a[48:51], v[128:143]
  s_add_u32 s67, s83, 204800
  s_add_u32 m0, s68, 122880
  s_nop 0
  buffer_load_dwordx4 v4, s[44:47], s67 offen offset:0 lds
  v_mfma_f32_32x32x16_bf16 v[144:159], a[192:195], a[52:55], v[144:159]
  ds_read_b64_tr_b16 a[212:213], v13 offset:12352
  ds_read_b64_tr_b16 a[214:215], v13 offset:14912
  buffer_load_dwordx4 v5, s[44:47], s67 offen offset:1024 lds
  s_waitcnt lgkmcnt(8)
  v_mfma_f32_32x32x16_bf16 v[160:175], a[196:199], a[48:51], v[160:175]
  buffer_load_dwordx4 v6, s[44:47], s67 offen offset:2048 lds
  v_mfma_f32_32x32x16_bf16 v[176:191], a[196:199], a[52:55], v[176:191]
  ds_read_b64_tr_b16 a[216:217], v13 offset:12416
  ds_read_b64_tr_b16 a[218:219], v13 offset:14976
  s_mov_b32 s67, 0
  s_add_u32 m0, s68, 135168
  s_nop 0
  buffer_load_dwordx4 v16, s[48:51], s67 offen offset:0 lds
  s_waitcnt lgkmcnt(8)
  v_mfma_f32_32x32x16_bf16 v[192:207], a[200:203], a[48:51], v[192:207]
  buffer_load_dwordx4 v17, s[48:51], s67 offen offset:1024 lds
  v_mfma_f32_32x32x16_bf16 v[208:223], a[200:203], a[52:55], v[208:223]
  ds_read_b64_tr_b16 a[220:221], v13 offset:12480
  ds_read_b64_tr_b16 a[222:223], v13 offset:15040
  buffer_load_dwordx4 v18, s[48:51], s67 offen offset:2048 lds
  s_waitcnt lgkmcnt(8)
  v_mfma_f32_32x32x16_bf16 v[224:239], a[204:207], a[48:51], v[224:239]
  v_mfma_f32_32x32x16_bf16 v[240:255], a[204:207], a[52:55], v[240:255]
  ds_read_b64_tr_b16 a[192:193], v13 offset:12544
  ds_read_b64_tr_b16 a[194:195], v13 offset:15104
  s_waitcnt lgkmcnt(8)
  v_mfma_f32_32x32x16_bf16 v[96:111], a[208:211], a[64:67], v[96:111]
  v_mfma_f32_32x32x16_bf16 v[112:127], a[208:211], a[68:71], v[112:127]
  ds_read_b64_tr_b16 a[196:197], v13 offset:17408
  ds_read_b64_tr_b16 a[198:199], v13 offset:19968
  s_waitcnt lgkmcnt(8)
  v_mfma_f32_32x32x16_bf16 v[128:143], a[212:215], a[64:67], v[128:143]
  v_mfma_f32_32x32x16_bf16 v[144:159], a[212:215], a[68:71], v[144:159]
  ds_read_b64_tr_b16 a[200:201], v13 offset:17472
  ds_read_b64_tr_b16 a[202:203], v13 offset:20032
  s_waitcnt lgkmcnt(8)
  v_mfma_f32_32x32x16_bf16 v[160:175], a[216:219], a[64:67], v[160:175]
  v_mfma_f32_32x32x16_bf16 v[176:191], a[216:219], a[68:71], v[176:191]
  ds_read_b64_tr_b16 a[204:205], v13 offset:17536
  ds_read_b64_tr_b16 a[206:207], v13 offset:20096
  s_waitcnt lgkmcnt(8)
  v_mfma_f32_32x32x16_bf16 v[192:207], a[220:223], a[64:67], v[192:207]
  v_mfma_f32_32x32x16_bf16 v[208:223], a[220:223], a[68:71], v[208:223]
  ds_read_b64_tr_b16 a[208:209], v13 offset:17600
  ds_read_b64_tr_b16 a[210:211], v13 offset:20160
  s_waitcnt lgkmcnt(8)
  v_mfma_f32_32x32x16_bf16 v[224:239], a[192:195], a[64:67], v[224:239]
  s_add_u32 s74, s75, 8
  s_waitcnt vmcnt(6)
  v_cmp_ne_u32 vcc, s14, v43
  s_cbranch_vccz L_done6
  s_mov_b32 s15, 400000
L_spin6:
  buffer_load_dword v43, v42, s[92:95], s74 offen sc1
  s_waitcnt vmcnt(0)
  v_cmp_ne_u32 vcc, s14, v43
  s_cbranch_vccz L_done6
  s_sub_u32 s15, s15, 1
  s_cbranch_scc0 L_spin6
L_done6:
  v_mfma_f32_32x32x16_bf16 v[240:255], a[192:195], a[68:71], v[240:255]
  ds_read_b64_tr_b16 a[212:213], v13 offset:17664
  ds_read_b64_tr_b16 a[214:215], v13 offset:20224
  s_add_u32 s66, s77, 8192
  buffer_load_dwordx4 a[8:11], v2, s[56:59], s66 offen offset:0 sc1
  s_waitcnt lgkmcnt(8)
  v_mfma_f32_32x32x16_bf16 v[96:111], a[196:199], a[80:83], v[96:111]
  v_mfma_f32_32x32x16_bf16 v[112:127], a[196:199], a[84:87], v[112:127]
  ds_read_b64_tr_b16 a[216:217], v13 offset:24576
  ds_read_b64_tr_b16 a[218:219], v13 offset:27136
  s_add_u32 s66, s77, 20480
  buffer_load_dwordx4 a[12:15], v2, s[56:59], s66 offen offset:0 sc1
  s_waitcnt lgkmcnt(8)
  v_mfma_f32_32x32x16_bf16 v[128:143], a[200:203], a[80:83], v[128:143]
  v_mfma_f32_32x32x16_bf16 v[144:159], a[200:203], a[84:87], v[144:159]
  ds_read_b64_tr_b16 a[220:221], v13 offset:24640
  ds_read_b64_tr_b16 a[222:223], v13 offset:27200
  s_add_u32 s66, s77, 8192
  buffer_load_dwordx4 a[24:27], v2, s[56:59], s66 offen offset:1024 sc1
  s_waitcnt lgkmcnt(8)
  v_mfma_f32_32x32x16_bf16 v[160:175], a[204:207], a[80:83], v[160:175]
  v_mfma_f32_32x32x16_bf16 v[176:191], a[204:207], a[84:87], v[176:191]
  ds_read_b64_tr_b16 a[192:193], v13 offset:24704
  ds_read_b64_tr_b16 a[194:195], v13 offset:27264
  s_add_u32 s66, s77, 20480
  buffer_load_dwordx4 a[28:31], v2, s[56:59], s66 offen offset:1024 sc1
  s_waitcnt lgkmcnt(8)
  v_mfma_f32_32x32x16_bf16 v[192:207], a[208:211], a[80:83], v[192:207]
  v_mfma_f32_32x32x16_bf16 v[208:223], a[208:211], a[84:87], v[208:223]
  ds_read_b64_tr_b16 a[196:197], v13 offset:24768
  ds_read_b64_tr_b16 a[198:199], v13 offset:27328
  s_add_u32 s66, s78, 8192
  buffer_load_dwordx4 a[40:43], v2, s[56:59], s66 offen offset:0 sc1
  s_waitcnt lgkmcnt(8)
  v_mfma_f32_32x32x16_bf16 v[224:239], a[212:215], a[80:83], v[224:239]
  v_mfma_f32_32x32x16_bf16 v[240:255], a[212:215], a[84:87], v[240:255]
  ds_read_b64_tr_b16 a[200:201], v13 offset:24832
  ds_read_b64_tr_b16 a[202:203], v13 offset:27392
  s_add_u32 s66, s78, 20480
  buffer_load_dwordx4 a[44:47], v2, s[56:59], s66 offen offset:0 sc1
  s_waitcnt lgkmcnt(8)
  v_mfma_f32_32x32x16_bf16 v[96:111], a[216:219], a[96:99], v[96:111]
  v_mfma_f32_32x32x16_bf16 v[112:127], a[216:219], a[100:103], v[112:127]
  ds_read_b64_tr_b16 a[204:205], v13 offset:29696
  ds_read_b64_tr_b16 a[206:207], v13 offset:32256
  s_add_u32 s66, s78, 8192
  buffer_load_dwordx4 a[56:59], v2, s[56:59], s66 offen offset:1024 sc1
  s_waitcnt lgkmcnt(8)
  v_mfma_f32_32x32x16_bf16 v[128:143], a[220:223], a[96:99], v[128:143]
  v_mfma_f32_32x32x16_bf16 v[144:159], a[220:223], a[100:103], v[144:159]
  ds_read_b64_tr_b16 a[208:209], v13 offset:29760
  ds_read_b64_tr_b16 a[210:211], v13 offset:32320
  s_add_u32 s66, s78, 20480
  buffer_load_dwordx4 a[60:63], v2, s[56:59], s66 offen offset:1024 sc1
  s_waitcnt lgkmcnt(8)
  v_mfma_f32_32x32x16_bf16 v[160:175], a[192:195], a[96:99], v[160:175]
  v_mfma_f32_32x32x16_bf16 v[176:191], a[192:195], a[100:103], v[176:191]
  ds_read_b64_tr_b16 a[212:213], v13 offset:29824
  ds_read_b64_tr_b16 a[214:215], v13 offset:32384
  s_add_u32 s66, s79, 8192
  buffer_load_dwordx4 a[72:75], v2, s[56:59], s66 offen offset:0 sc1
  s_waitcnt lgkmcnt(8)
  v_mfma_f32_32x32x16_bf16 v[192:207], a[196:199], a[96:99], v[192:207]
  v_mfma_f32_32x32x16_bf16 v[208:223], a[196:199], a[100:103], v[208:223]
  ds_read_b64_tr_b16 a[216:217], v13 offset:29888
  ds_read_b64_tr_b16 a[218:219], v13 offset:32448
  s_add_u32 s66, s79, 20480
  buffer_load_dwordx4 a[76:79], v2, s[56:59], s66 offen offset:0 sc1
  s_waitcnt lgkmcnt(8)
  v_mfma_f32_32x32x16_bf16 v[224:239], a[200:203], a[96:99], v[224:239]
  v_mfma_f32_32x32x16_bf16 v[240:255], a[200:203], a[100:103], v[240:255]
  ds_read_b64_tr_b16 a[220:221], v13 offset:29952
  ds_read_b64_tr_b16 a[222:223], v13 offset:32512
  s_add_u32 s66, s79, 8192
  buffer_load_dwordx4 a[88:91], v2, s[56:59], s66 offen offset:1024 sc1
  s_waitcnt lgkmcnt(8)
  v_mfma_f32_32x32x16_bf16 v[96:111], a[204:207], a[112:115], v[96:111]
  v_mfma_f32_32x32x16_bf16 v[112:127], a[204:207], a[116:119], v[112:127]
  s_barrier
  ds_read_b64_tr_b16 a[192:193], v13 offset:36864
  ds_read_b64_tr_b16 a[194:195], v13 offset:39424
  s_add_u32 s66, s79, 20480
  buffer_load_dwordx4 a[92:95], v2, s[56:59], s66 offen offset:1024 sc1
  s_waitcnt lgkmcnt(8)
  v_mfma_f32_32x32x16_bf16 v[128:143], a[208:211], a[112:115], v[128:143]
  s_mov_b32 s67, 98304
  s_add_u32 m0, s68, 147456
  s_nop 0
  buffer_load_dwordx4 v16, s[48:51], s67 offen offset:0 lds
  v_mfma_f32_32x32x16_bf16 v[144:159], a[208:211], a[116:119], v[144:159]
  ds_read_b64_tr_b16 a[196:197], v13 offset:36928
  ds_read_b64_tr_b16 a[198:199], v13 offset:39488
  buffer_load_dwordx4 v17, s[48:51], s67 offen offset:1024 lds
  s_waitcnt lgkmcnt(8)
  v_mfma_f32_32x32x16_bf16 v[160:175], a[212:215], a[112:115], v[160:175]
  buffer_load_dwordx4 v18, s[48:51], s67 offen offset:2048 lds
  v_mfma_f32_32x32x16_bf16 v[176:191], a[212:215], a[116:119], v[176:191]
  ds_read_b64_tr_b16 a[200:201], v13 offset:36992
  ds_read_b64_tr_b16 a[202:203], v13 offset:39552
  s_mov_b32 s67, 196608
  s_add_u32 m0, s68, 0
  s_nop 0
  buffer_load_dwordx4 v16, s[48:51], s67 offen offset:0 lds
  s_add_u32 s66, s77, 8192
  buffer_load_dwordx4 a[104:107], v2, s[56:59], s66 offen offset:2048 sc1
  s_waitcnt lgkmcnt(8)
  v_mfma_f32_32x32x16_bf16 v[192:207], a[216:219], a[112:115], v[192:207]
  buffer_load_dwordx4 v17, s[48:51], s67 offen offset:1024 lds
  v_mfma_f32_32x32x16_bf16 v[208:223], a[216:219], a[116:119], v[208:223]
  ds_read_b64_tr_b16 a[204:205], v13 offset:37056
  ds_read_b64_tr_b16 a[206:207], v13 offset:39616
  buffer_load_dwordx4 v18, s[48:51], s67 offen offset:2048 lds
  s_add_u32 s66, s77, 20480
  buffer_load_dwordx4 a[108:111], v2, s[56:59], s66 offen offset:2048 sc1
  s_waitcnt lgkmcnt(8)
  v_mfma_f32_32x32x16_bf16 v[224:239], a[220:223], a[112:115], v[224:239]
  v_mfma_f32_32x32x16_bf16 v[240:255], a[220:223], a[116:119], v[240:255]
  ds_read_b64_tr_b16 a[208:209], v13 offset:37120
  ds_read_b64_tr_b16 a[210:211], v13 offset:39680
  s_add_u32 s66, s77, 8192
  buffer_load_dwordx4 a[120:123], v2, s[56:59], s66 offen offset:3072 sc1
  s_waitcnt lgkmcnt(8)
  v_mfma_f32_32x32x16_bf16 v[96:111], a[192:195], a[128:131], v[96:111]
  v_mfma_f32_32x32x16_bf16 v[112:127], a[192:195], a[132:135], v[112:127]
  ds_read_b64_tr_b16 a[212:213], v13 offset:41984
  ds_read_b64_tr_b16 a[214:215], v13 offset:44544
  s_add_u32 s66, s77, 20480
  buffer_load_dwordx4 a[124:127], v2, s[56:59], s66 offen offset:3072 sc1
  s_waitcnt lgkmcnt(8)
  v_mfma_f32_32x32x16_bf16 v[128:143], a[196:199], a[128:131], v[128:143]
  v_mfma_f32_32x32x16_bf16 v[144:159], a[196:199], a[132:135], v[144:159]
  ds_read_b64_tr_b16 a[216:217], v13 offset:42048
  ds_read_b64_tr_b16 a[218:219], v13 offset:44608
  s_add_u32 s66, s78, 8192
  buffer_load_dwordx4 a[136:139], v2, s[56:59], s66 offen offset:2048 sc1
  s_waitcnt lgkmcnt(8)
  v_mfma_f32_32x32x16_bf16 v[160:175], a[200:203], a[128:131], v[160:175]
  v_mfma_f32_32x32x16_bf16 v[176:191], a[200:203], a[132:135], v[176:191]
  ds_read_b64_tr_b16 a[220:221], v13 offset:42112
  ds_read_b64_tr_b16 a[222:223], v13 offset:44672
  s_add_u32 s66, s78, 20480
  buffer_load_dwordx4 a[140:143], v2, s[56:59], s66 offen offset:2048 sc1
  s_waitcnt lgkmcnt(8)
  v_mfma_f32_32x32x16_bf16 v[192:207], a[204:207], a[128:131], v[192:207]
  v_mfma_f32_32x32x16_bf16 v[208:223], a[204:207], a[132:135], v[208:223]
  ds_read_b64_tr_b16 a[192:193], v13 offset:42176
  ds_read_b64_tr_b16 a[194:195], v13 offset:44736
  s_add_u32 s66, s78, 8192
  buffer_load_dwordx4 a[152:155], v2, s[56:59], s66 offen offset:3072 sc1
  s_waitcnt lgkmcnt(8)
  v_mfma_f32_32x32x16_bf16 v[224:239], a[208:211], a[128:131], v[224:239]
  v_mfma_f32_32x32x16_bf16 v[240:255], a[208:211], a[132:135], v[240:255]
  ds_read_b64_tr_b16 a[196:197], v13 offset:42240
  ds_read_b64_tr_b16 a[198:199], v13 offset:44800
  s_add_u32 s66, s78, 20480
  buffer_load_dwordx4 a[156:159], v2, s[56:59], s66 offen offset:3072 sc1
  s_waitcnt lgkmcnt(8)
  v_mfma_f32_32x32x16_bf16 v[96:111], a[212:215], a[144:147], v[96:111]
  v_mfma_f32_32x32x16_bf16 v[112:127], a[212:215], a[148:151], v[112:127]
  ds_read_b64_tr_b16 a[200:201], v13 offset:49152
  ds_read_b64_tr_b16 a[202:203], v13 offset:51712
  s_add_u32 s66, s79, 8192
  buffer_load_dwordx4 a[168:171], v2, s[56:59], s66 offen offset:2048 sc1
  s_waitcnt lgkmcnt(8)
  v_mfma_f32_32x32x16_bf16 v[128:143], a[216:219], a[144:147], v[128:143]
  v_mfma_f32_32x32x16_bf16 v[144:159], a[216:219], a[148:151], v[144:159]
  ds_read_b64_tr_b16 a[204:205], v13 offset:49216
  ds_read_b64_tr_b16 a[206:207], v13 offset:51776
  s_add_u32 s66, s79, 20480
  buffer_load_dwordx4 a[172:175], v2, s[56:59], s66 offen offset:2048 sc1
  s_waitcnt lgkmcnt(8)
  v_mfma_f32_32x32x16_bf16 v[160:175], a[220:223], a[144:147], v[160:175]
  v_mfma_f32_32x32x16_bf16 v[176:191], a[220:223], a[148:151], v[176:191]
  ds_read_b64_tr_b16 a[208:209], v13 offset:49280
  ds_read_b64_tr_b16 a[210:211], v13 offset:51840
  s_add_u32 s66, s79, 8192
  buffer_load_dwordx4 a[184:187], v2, s[56:59], s66 offen offset:3072 sc1
  s_waitcnt lgkmcnt(8)
  v_mfma_f32_32x32x16_bf16 v[192:207], a[192:195], a[144:147], v[192:207]
  v_mfma_f32_32x32x16_bf16 v[208:223], a[192:195], a[148:151], v[208:223]
  ds_read_b64_tr_b16 a[212:213], v13 offset:49344
  ds_read_b64_tr_b16 a[214:215], v13 offset:51904
  s_add_u32 s66, s79, 20480
  buffer_load_dwordx4 a[188:191], v2, s[56:59], s66 offen offset:3072 sc1
  s_waitcnt lgkmcnt(8)
  v_mfma_f32_32x32x16_bf16 v[224:239], a[196:199], a[144:147], v[224:239]
  v_mfma_f32_32x32x16_bf16 v[240:255], a[196:199], a[148:151], v[240:255]
  ds_read_b64_tr_b16 a[216:217], v13 offset:49408
  ds_read_b64_tr_b16 a[218:219], v13 offset:51968
  s_waitcnt lgkmcnt(8)
  v_mfma_f32_32x32x16_bf16 v[96:111], a[200:203], a[160:163], v[96:111]
  v_mfma_f32_32x32x16_bf16 v[112:127], a[200:203], a[164:167], v[112:127]
  ds_read_b64_tr_b16 a[220:221], v13 offset:54272
  ds_read_b64_tr_b16 a[222:223], v13 offset:56832
  s_waitcnt lgkmcnt(8)
  v_mfma_f32_32x32x16_bf16 v[128:143], a[204:207], a[160:163], v[128:143]
  v_mfma_f32_32x32x16_bf16 v[144:159], a[204:207], a[164:167], v[144:159]
  ds_read_b64_tr_b16 a[192:193], v13 offset:54336
  ds_read_b64_tr_b16 a[194:195], v13 offset:56896
  s_waitcnt lgkmcnt(8)
  v_mfma_f32_32x32x16_bf16 v[160:175], a[208:211], a[160:163], v[160:175]
  v_mfma_f32_32x32x16_bf16 v[176:191], a[208:211], a[164:167], v[176:191]
  ds_read_b64_tr_b16 a[196:197], v13 offset:54400
  ds_read_b64_tr_b16 a[198:199], v13 offset:56960
  s_waitcnt lgkmcnt(8)
  v_mfma_f32_32x32x16_bf16 v[192:207], a[212:215], a[160:163], v[192:207]
  v_mfma_f32_32x32x16_bf16 v[208:223], a[212:215], a[164:167], v[208:223]
  ds_read_b64_tr_b16 a[200:201], v13 offset:54464
  ds_read_b64_tr_b16 a[202:203], v13 offset:57024
  s_waitcnt lgkmcnt(8)
  v_mfma_f32_32x32x16_bf16 v[224:239], a[216:219], a[160:163], v[224:239]
  v_mfma_f32_32x32x16_bf16 v[240:255], a[216:219], a[164:167], v[240:255]
  ds_read_b64_tr_b16 a[204:205], v13 offset:54528
  ds_read_b64_tr_b16 a[206:207], v13 offset:57088
  s_waitcnt lgkmcnt(8)
  v_mfma_f32_32x32x16_bf16 v[96:111], a[220:223], a[176:179], v[96:111]
  v_mfma_f32_32x32x16_bf16 v[112:127], a[220:223], a[180:183], v[112:127]
  s_waitcnt vmcnt(33)
  s_barrier
  ds_read_b64_tr_b16 a[208:209], v14 offset:0
  ds_read_b64_tr_b16 a[210:211], v14 offset:2560
  s_waitcnt lgkmcnt(8)
  v_mfma_f32_32x32x16_bf16 v[128:143], a[192:195], a[176:179], v[128:143]
  s_mov_b32 s67, 294912
  s_add_u32 m0, s68, 12288
  s_nop 0
  buffer_load_dwordx4 v16, s[48:51], s67 offen offset:0 lds
  v_mfma_f32_32x32x16_bf16 v[144:159], a[192:195], a[180:183], v[144:159]
  ds_read_b64_tr_b16 a[212:213], v14 offset:5120
  ds_read_b64_tr_b16 a[214:215], v14 offset:7680
  buffer_load_dwordx4 v17, s[48:51], s67 offen offset:1024 lds
  s_waitcnt lgkmcnt(8)
  v_mfma_f32_32x32x16_bf16 v[160:175], a[196:199], a[176:179], v[160:175]
  buffer_load_dwordx4 v18, s[48:51], s67 offen offset:2048 lds
  v_mfma_f32_32x32x16_bf16 v[176:191], a[196:199], a[180:183], v[176:191]
  ds_read_b64_tr_b16 a[216:217], v14 offset:12288
  ds_read_b64_tr_b16 a[218:219], v14 offset:14848
  s_mov_b32 s67, 393216
  s_add_u32 m0, s68, 24576
  s_nop 0
  buffer_load_dwordx4 v16, s[48:51], s67 offen offset:0 lds
  s_waitcnt lgkmcnt(8)
  v_mfma_f32_32x32x16_bf16 v[192:207], a[200:203], a[176:179], v[192:207]
  buffer_load_dwordx4 v17, s[48:51], s67 offen offset:1024 lds
  v_mfma_f32_32x32x16_bf16 v[208:223], a[200:203], a[180:183], v[208:223]
  ds_read_b64_tr_b16 a[220:221], v14 offset:17408
  ds_read_b64_tr_b16 a[222:223], v14 offset:19968
  buffer_load_dwordx4 v18, s[48:51], s67 offen offset:2048 lds
  s_waitcnt lgkmcnt(8)
  v_mfma_f32_32x32x16_bf16 v[224:239], a[204:207], a[176:179], v[224:239]
  v_mfma_f32_32x32x16_bf16 v[240:255], a[204:207], a[180:183], v[240:255]
  ds_read_b64_tr_b16 a[192:193], v14 offset:24576
  ds_read_b64_tr_b16 a[194:195], v14 offset:27136
  s_waitcnt vmcnt(34)
  s_waitcnt lgkmcnt(8)
  v_mfma_f32_32x32x16_bf16 v[96:111], a[208:211], a[8:11], v[96:111]
  v_mfma_f32_32x32x16_bf16 v[112:127], a[208:211], a[12:15], v[112:127]
  ds_read_b64_tr_b16 a[196:197], v14 offset:29696
  ds_read_b64_tr_b16 a[198:199], v14 offset:32256
  s_waitcnt vmcnt(32)
  s_waitcnt lgkmcnt(8)
  v_mfma_f32_32x32x16_bf16 v[96:111], a[212:215], a[24:27], v[96:111]
  s_lshl_b32 s60, s31, 3
  s_lshr_b32 s61, s35, 2
  s_add_u32 s60, s60, s61
  s_and_b32 s63, s35, 3
  s_lshl_b32 s63, s63, 3
  s_mul_i32 s61, s60, 40960
  s_lshl_b32 s62, s60, 5
  s_add_u32 s62, s62, s63
  s_mul_i32 s62, s62, 1280
  s_add_u32 s36, s4, s62
  s_addc_u32 s37, s5, 0
  s_mov_b32 s38, 10240
  s_mov_b32 s39, 0x20000
  s_add_u32 s84, s28, s61
  s_addc_u32 s85, s29, 0
  s_add_u32 s84, s84, 2621440
  s_addc_u32 s85, s85, 0
  s_mov_b32 s86, 40960
  s_mov_b32 s87, 0x20000
  s_add_u32 s40, s28, s61
  s_addc_u32 s41, s29, 0
  s_add_u32 s40, s40, 5242880
  s_addc_u32 s41, s41, 0
  s_mov_b32 s42, 40960
  s_mov_b32 s43, 0x20000
  s_add_u32 s56, s28, s61
  s_addc_u32 s57, s29, 0
  s_add_u32 s56, s56, 39321600
  s_addc_u32 s57, s57, 0
  s_mov_b32 s58, 18391040
  s_mov_b32 s59, 0x20000
  s_lshl_b32 s60, s33, 2
  s_add_u32 s60, s60, s30
  s_lshl_b32 s60, s60, 2
  s_add_u32 s60, s60, s32
  s_lshl_b32 s60, s60, 3
  s_add_u32 s60, s60, s31
  s_lshl_b32 s60, s60, 2
  s_add_u32 s77, s60, 4096
  s_lshl_b32 s60, s31, 2
  s_lshr_b32 s61, s35, 3
  s_add_u32 s60, s60, s61
  s_lshl_b32 s60, s60, 2
  s_add_u32 s60, s60, s30
  s_lshl_b32 s60, s60, 5
  s_add_u32 s78, s60, 4096
  s_mul_i32 s60, s30, 10240
  s_mul_i32 s61, s30, 320
  s_mul_i32 s62, s30, 640
  v_mfma_f32_32x32x16_bf16 v[112:127], a[212:215], a[28:31], v[112:127]
  ds_read_b64_tr_b16 a[200:201], v14 offset:36864
  ds_read_b64_tr_b16 a[202:203], v14 offset:39424
  v_and_b32 v24, 7, v1
  s_waitcnt vmcnt(30)
  s_waitcnt lgkmcnt(8)
  v_mfma_f32_32x32x16_bf16 v[96:111], a[216:219], a[40:43], v[96:111]
  v_lshrrev_b32 v25, 3, v1
  v_mfma_f32_32x32x16_bf16 v[112:127], a[216:219], a[44:47], v[112:127]
  ds_read_b64_tr_b16 a[204:205], v14 offset:41984
  ds_read_b64_tr_b16 a[206:207], v14 offset:44544
  v_add_u32 v29, s63, v24
  s_waitcnt vmcnt(28)
  s_waitcnt lgkmcnt(8)
  v_mfma_f32_32x32x16_bf16 v[96:111], a[220:223], a[56:59], v[96:111]
  v_mfma_f32_32x32x16_bf16 v[112:127], a[220:223], a[60:63], v[112:127]
  ds_read_b64_tr_b16 a[208:209], v14 offset:49152
  ds_read_b64_tr_b16 a[210:211], v14 offset:51712
  v_lshlrev_b32 v29, 4, v29
  s_waitcnt vmcnt(26)
  s_waitcnt lgkmcnt(8)
  v_mfma_f32_32x32x16_bf16 v[96:111], a[192:195], a[72:75], v[96:111]
  v_lshl_add_u32 v29, v25, 9, v29
  v_mfma_f32_32x32x16_bf16 v[112:127], a[192:195], a[76:79], v[112:127]
  ds_read_b64_tr_b16 a[212:213], v14 offset:54272
  ds_read_b64_tr_b16 a[214:215], v14 offset:56832
  v_add_u32 v29, s60, v29
  s_waitcnt vmcnt(24)
  s_waitcnt lgkmcnt(8)
  v_mfma_f32_32x32x16_bf16 v[96:111], a[196:199], a[88:91], v[96:111]
  v_mfma_f32_32x32x16_bf16 v[112:127], a[196:199], a[92:95], v[112:127]
  ds_read_b64_tr_b16 a[216:217], v15 offset:0
  ds_read_b64_tr_b16 a[218:219], v15 offset:2560
  v_lshrrev_b32 v30, 1, v25
  s_waitcnt vmcnt(16)
  s_waitcnt lgkmcnt(8)
  v_mfma_f32_32x32x16_bf16 v[96:111], a[200:203], a[104:107], v[96:111]
  v_and_b32 v31, 1, v25
  v_mfma_f32_32x32x16_bf16 v[112:127], a[200:203], a[108:111], v[112:127]
  ds_read_b64_tr_b16 a[220:221], v15 offset:5120
  ds_read_b64_tr_b16 a[222:223], v15 offset:7680
  v_mul_u32_u24 v26, 1280, v24
  s_waitcnt vmcnt(14)
  s_waitcnt lgkmcnt(8)
  v_mfma_f32_32x32x16_bf16 v[96:111], a[204:207], a[120:123], v[96:111]
  v_mfma_f32_32x32x16_bf16 v[112:127], a[204:207], a[124:127], v[112:127]
  ds_read_b64_tr_b16 a[192:193], v14 offset:64
  ds_read_b64_tr_b16 a[194:195], v14 offset:2624
  v_lshl_add_u32 v26, v30, 5, v26
  s_waitcnt vmcnt(12)
  s_waitcnt lgkmcnt(8)
  v_mfma_f32_32x32x16_bf16 v[96:111], a[208:211], a[136:139], v[96:111]
  v_lshl_add_u32 v26, v31, 3, v26
  v_mfma_f32_32x32x16_bf16 v[112:127], a[208:211], a[140:143], v[112:127]
  ds_read_b64_tr_b16 a[196:197], v14 offset:5184
  ds_read_b64_tr_b16 a[198:199], v14 offset:7744
  v_add_u32 v26, s61, v26
  s_waitcnt vmcnt(10)
  s_waitcnt lgkmcnt(8)
  v_mfma_f32_32x32x16_bf16 v[96:111], a[212:215], a[152:155], v[96:111]
  v_mfma_f32_32x32x16_bf16 v[112:127], a[212:215], a[156:159], v[112:127]
  ds_read_b64_tr_b16 a[200:201], v14 offset:12352
  ds_read_b64_tr_b16 a[202:203], v14 offset:14912
  v_lshlrev_b32 v27, 6, v30
  s_waitcnt vmcnt(8)
  s_waitcnt lgkmcnt(8)
  v_mfma_f32_32x32x16_bf16 v[96:111], a[216:219], a[168:171], v[96:111]
  v_lshl_add_u32 v27, v31, 4, v27
  v_mfma_f32_32x32x16_bf16 v[112:127], a[216:219], a[172:175], v[112:127]
  ds_read_b64_tr_b16 a[204:205], v14 offset:17472
  ds_read_b64_tr_b16 a[206:207], v14 offset:20032
  v_add_u32 v27, s62, v27
  s_waitcnt vmcnt(6)
  s_waitcnt lgkmcnt(8)
  v_mfma_f32_32x32x16_bf16 v[96:111], a[220:223], a[184:187], v[96:111]
  v_mov_b32 v35, 2130706432
  v_mfma_f32_32x32x16_bf16 v[112:127], a[220:223], a[188:191], v[112:127]
  ds_read_b64_tr_b16 a[208:209], v14 offset:24640
  ds_read_b64_tr_b16 a[210:211], v14 offset:27200
  s_waitcnt lgkmcnt(8)
  v_mfma_f32_32x32x16_bf16 v[128:143], a[192:195], a[8:11], v[128:143]
  s_barrier
  v_cmp_gt_u32 vcc, 32, v1
  v_mfma_f32_32x32x16_bf16 v[144:159], a[192:195], a[12:15], v[144:159]
  ds_read_b64_tr_b16 a[212:213], v14 offset:29760
  ds_read_b64_tr_b16 a[214:215], v14 offset:32320
  s_mov_b32 s67, 491520
  s_add_u32 m0, s68, 36864
  s_nop 0
  buffer_load_dwordx4 v16, s[48:51], s67 offen offset:0 lds
  s_nop 1
  s_waitcnt lgkmcnt(8)
  v_mfma_f32_32x32x16_bf16 v[128:143], a[196:199], a[24:27], v[128:143]
  buffer_load_dwordx4 v17, s[48:51], s67 offen offset:1024 lds
  v_cndmask_b32 v34, v35, v29, vcc
  v_mfma_f32_32x32x16_bf16 v[144:159], a[196:199], a[28:31], v[144:159]
  ds_read_b64_tr_b16 a[216:217], v14 offset:36928
  ds_read_b64_tr_b16 a[218:219], v14 offset:39488
  buffer_load_dwordx4 v18, s[48:51], s67 offen offset:2048 lds
  v_cndmask_b32 v32, v35, v26, vcc
  s_waitcnt lgkmcnt(8)
  v_mfma_f32_32x32x16_bf16 v[128:143], a[200:203], a[40:43], v[128:143]
  v_cvt_pk_bf16_f32 v48, v96, v97
  s_mov_b32 s67, 589824
  s_add_u32 m0, s68, 49152
  s_nop 0
  buffer_load_dwordx4 v16, s[48:51], s67 offen offset:0 lds
  v_cndmask_b32 v33, v35, v27, vcc
  v_mfma_f32_32x32x16_bf16 v[144:159], a[200:203], a[44:47], v[144:159]
  ds_read_b64_tr_b16 a[220:221], v14 offset:42048
  ds_read_b64_tr_b16 a[222:223], v14 offset:44608
  v_cvt_pk_bf16_f32 v49, v98, v99
  buffer_load_dwordx4 v17, s[48:51], s67 offen offset:1024 lds
  s_waitcnt lgkmcnt(8)
  v_mfma_f32_32x32x16_bf16 v[128:143], a[204:207], a[56:59], v[128:143]
  v_cvt_pk_bf16_f32 v50, v100, v101
  v_cvt_pk_bf16_f32 v51, v102, v103
  buffer_load_dwordx4 v18, s[48:51], s67 offen offset:2048 lds
  v_lshrrev_b32 v30, 4, v0
  v_mfma_f32_32x32x16_bf16 v[144:159], a[204:207], a[60:63], v[144:159]
  ds_read_b64_tr_b16 a[192:193], v14 offset:49216
  ds_read_b64_tr_b16 a[194:195], v14 offset:51776
  v_cvt_pk_bf16_f32 v52, v104, v105
  v_lshlrev_b32 v30, 2, v30
  s_waitcnt lgkmcnt(8)
  v_mfma_f32_32x32x16_bf16 v[128:143], a[208:211], a[72:75], v[128:143]
  v_cvt_pk_bf16_f32 v53, v106, v107
  v_lshl_add_u32 v30, v24, 6, v30
  v_mfma_f32_32x32x16_bf16 v[144:159], a[208:211], a[76:79], v[144:159]
  ds_read_b64_tr_b16 a[196:197], v14 offset:54336
  ds_read_b64_tr_b16 a[198:199], v14 offset:56896
  v_cvt_pk_bf16_f32 v54, v108, v109
  s_waitcnt lgkmcnt(8)
  v_mfma_f32_32x32x16_bf16 v[128:143], a[212:215], a[88:91], v[128:143]
  v_cvt_pk_bf16_f32 v55, v110, v111
  s_mov_b32 s66, 0
  buffer_store_dwordx4 v[48:51], v2, s[52:55], s66 offen offset:0 sc1
  v_lshlrev_b32 v31, 6, v24
  v_mfma_f32_32x32x16_bf16 v[144:159], a[212:215], a[92:95], v[144:159]
  ds_read_b64_tr_b16 a[200:201], v15 offset:64
  ds_read_b64_tr_b16 a[202:203], v15 offset:2624
  s_mov_b32 s66, 0
  buffer_store_dwordx4 v[52:55], v2, s[52:55], s66 offen offset:1024 sc1
  v_add_u32 v30, 159744, v30
  s_waitcnt lgkmcnt(8)
  v_mfma_f32_32x32x16_bf16 v[128:143], a[216:219], a[104:107], v[128:143]
  v_cvt_pk_bf16_f32 v56, v112, v113
  v_add_u32 v31, 159744, v31
  v_mfma_f32_32x32x16_bf16 v[144:159], a[216:219], a[108:111], v[144:159]
  ds_read_b64_tr_b16 a[204:205], v15 offset:5184
  ds_read_b64_tr_b16 a[206:207], v15 offset:7744
  v_cvt_pk_bf16_f32 v57, v114, v115
  s_waitcnt lgkmcnt(8)
  v_mfma_f32_32x32x16_bf16 v[128:143], a[220:223], a[120:123], v[128:143]
  v_cvt_pk_bf16_f32 v58, v116, v117
  v_cvt_pk_bf16_f32 v59, v118, v119
  v_min_u32 v23, 7, v1
  v_mfma_f32_32x32x16_bf16 v[144:159], a[220:223], a[124:127], v[144:159]
  ds_read_b64_tr_b16 a[208:209], v14 offset:128
  ds_read_b64_tr_b16 a[210:211], v14 offset:2688
  v_cvt_pk_bf16_f32 v60, v120, v121
  v_lshlrev_b32 v23, 2, v23
  s_waitcnt lgkmcnt(8)
  v_mfma_f32_32x32x16_bf16 v[128:143], a[192:195], a[136:139], v[128:143]
  v_cvt_pk_bf16_f32 v61, v122, v123
  v_mfma_f32_32x32x16_bf16 v[144:159], a[192:195], a[140:143], v[144:159]
  ds_read_b64_tr_b16 a[212:213], v14 offset:5248
  ds_read_b64_tr_b16 a[214:215], v14 offset:7808
  v_cvt_pk_bf16_f32 v62, v124, v125
  s_waitcnt lgkmcnt(8)
  v_mfma_f32_32x32x16_bf16 v[128:143], a[196:199], a[152:155], v[128:143]
  v_cvt_pk_bf16_f32 v63, v126, v127
  s_mov_b32 s66, 0
  buffer_store_dwordx4 v[56:59], v3, s[52:55], s66 offen offset:0 sc1
  v_mfma_f32_32x32x16_bf16 v[144:159], a[196:199], a[156:159], v[144:159]
  ds_read_b64_tr_b16 a[216:217], v14 offset:12416
  ds_read_b64_tr_b16 a[218:219], v14 offset:14976
  s_mov_b32 s66, 0
  buffer_store_dwordx4 v[60:63], v3, s[52:55], s66 offen offset:1024 sc1
  s_waitcnt lgkmcnt(8)
  v_mfma_f32_32x32x16_bf16 v[128:143], a[200:203], a[168:171], v[128:143]
  v_mfma_f32_32x32x16_bf16 v[144:159], a[200:203], a[172:175], v[144:159]
  ds_read_b64_tr_b16 a[220:221], v14 offset:17536
  ds_read_b64_tr_b16 a[222:223], v14 offset:20096
  s_waitcnt lgkmcnt(8)
  v_mfma_f32_32x32x16_bf16 v[128:143], a[204:207], a[184:187], v[128:143]
  v_mfma_f32_32x32x16_bf16 v[144:159], a[204:207], a[188:191], v[144:159]
  ds_read_b64_tr_b16 a[192:193], v14 offset:24704
  ds_read_b64_tr_b16 a[194:195], v14 offset:27264
  s_waitcnt lgkmcnt(8)
  v_mfma_f32_32x32x16_bf16 v[160:175], a[208:211], a[8:11], v[160:175]
  v_mfma_f32_32x32x16_bf16 v[176:191], a[208:211], a[12:15], v[176:191]
  ds_read_b64_tr_b16 a[196:197], v14 offset:29824
  ds_read_b64_tr_b16 a[198:199], v14 offset:32384
  s_waitcnt lgkmcnt(8)
  v_mfma_f32_32x32x16_bf16 v[160:175], a[212:215], a[24:27], v[160:175]
  v_mfma_f32_32x32x16_bf16 v[176:191], a[212:215], a[28:31], v[176:191]
  ds_read_b64_tr_b16 a[200:201], v14 offset:36992
  ds_read_b64_tr_b16 a[202:203], v14 offset:39552
  s_waitcnt lgkmcnt(8)
  v_mfma_f32_32x32x16_bf16 v[160:175], a[216:219], a[40:43], v[160:175]
  v_cvt_pk_bf16_f32 v64, v128, v129
  v_mfma_f32_32x32x16_bf16 v[176:191], a[216:219], a[44:47], v[176:191]
  ds_read_b64_tr_b16 a[204:205], v14 offset:42112
  ds_read_b64_tr_b16 a[206:207], v14 offset:44672
  v_cvt_pk_bf16_f32 v65, v130, v131
  s_waitcnt lgkmcnt(8)
  v_mfma_f32_32x32x16_bf16 v[160:175], a[220:223], a[56:59], v[160:175]
  v_cvt_pk_bf16_f32 v66, v132, v133
  v_cvt_pk_bf16_f32 v67, v134, v135
  v_mfma_f32_32x32x16_bf16 v[176:191], a[220:223], a[60:63], v[176:191]
  ds_read_b64_tr_b16 a[208:209], v14 offset:49280
  ds_read_b64_tr_b16 a[210:211], v14 offset:51840
  v_cvt_pk_bf16_f32 v68, v136, v137
  s_waitcnt lgkmcnt(8)
  v_mfma_f32_32x32x16_bf16 v[160:175], a[192:195], a[72:75], v[160:175]
  v_cvt_pk_bf16_f32 v69, v138, v139
  v_mfma_f32_32x32x16_bf16 v[176:191], a[192:195], a[76:79], v[176:191]
  ds_read_b64_tr_b16 a[212:213], v14 offset:54400
  ds_read_b64_tr_b16 a[214:215], v14 offset:56960
  v_cvt_pk_bf16_f32 v70, v140, v141
  s_waitcnt lgkmcnt(8)
  v_mfma_f32_32x32x16_bf16 v[160:175], a[196:199], a[88:91], v[160:175]
  v_cvt_pk_bf16_f32 v71, v142, v143
  s_mov_b32 s66, 0
  buffer_store_dwordx4 v[64:67], v2, s[52:55], s66 offen offset:2048 sc1
  v_mfma_f32_32x32x16_bf16 v[176:191], a[196:199], a[92:95], v[176:191]
  ds_read_b64_tr_b16 a[216:217], v15 offset:128
  ds_read_b64_tr_b16 a[218:219], v15 offset:2688
  s_mov_b32 s66, 0
  buffer_store_dwordx4 v[68:71], v2, s[52:55], s66 offen offset:3072 sc1
  s_waitcnt lgkmcnt(8)
  v_mfma_f32_32x32x16_bf16 v[160:175], a[200:203], a[104:107], v[160:175]
  v_cvt_pk_bf16_f32 v72, v144, v145
  v_mfma_f32_32x32x16_bf16 v[176:191], a[200:203], a[108:111], v[176:191]
  ds_read_b64_tr_b16 a[220:221], v15 offset:5248
  ds_read_b64_tr_b16 a[222:223], v15 offset:7808
  v_cvt_pk_bf16_f32 v73, v146, v147
  s_waitcnt lgkmcnt(8)
  v_mfma_f32_32x32x16_bf16 v[160:175], a[204:207], a[120:123], v[160:175]
  v_cvt_pk_bf16_f32 v74, v148, v149
  v_cvt_pk_bf16_f32 v75, v150, v151
  v_mfma_f32_32x32x16_bf16 v[176:191], a[204:207], a[124:127], v[176:191]
  ds_read_b64_tr_b16 a[192:193], v14 offset:192
  ds_read_b64_tr_b16 a[194:195], v14 offset:2752
  v_cvt_pk_bf16_f32 v76, v152, v153
  s_waitcnt lgkmcnt(8)
  v_mfma_f32_32x32x16_bf16 v[160:175], a[208:211], a[136:139], v[160:175]
  v_cvt_pk_bf16_f32 v77, v154, v155
  v_mfma_f32_32x32x16_bf16 v[176:191], a[208:211], a[140:143], v[176:191]
  ds_read_b64_tr_b16 a[196:197], v14 offset:5312
  ds_read_b64_tr_b16 a[198:199], v14 offset:7872
  v_cvt_pk_bf16_f32 v78, v156, v157
  s_waitcnt lgkmcnt(8)
  v_mfma_f32_32x32x16_bf16 v[160:175], a[212:215], a[152:155], v[160:175]
  v_cvt_pk_bf16_f32 v79, v158, v159
  s_mov_b32 s66, 0
  buffer_store_dwordx4 v[72:75], v3, s[52:55], s66 offen offset:2048 sc1
  v_mfma_f32_32x32x16_bf16 v[176:191], a[212:215], a[156:159], v[176:191]
  ds_read_b64_tr_b16 a[200:201], v14 offset:12480
  ds_read_b64_tr_b16 a[202:203], v14 offset:15040
  s_mov_b32 s66, 0
  buffer_store_dwordx4 v[76:79], v3, s[52:55], s66 offen offset:3072 sc1
  s_waitcnt lgkmcnt(8)
  v_mfma_f32_32x32x16_bf16 v[160:175], a[216:219], a[168:171], v[160:175]
  v_mfma_f32_32x32x16_bf16 v[176:191], a[216:219], a[172:175], v[176:191]
  ds_read_b64_tr_b16 a[204:205], v14 offset:17600
  ds_read_b64_tr_b16 a[206:207], v14 offset:20160
  s_waitcnt lgkmcnt(8)
  v_mfma_f32_32x32x16_bf16 v[160:175], a[220:223], a[184:187], v[160:175]
  v_mfma_f32_32x32x16_bf16 v[176:191], a[220:223], a[188:191], v[176:191]
  ds_read_b64_tr_b16 a[208:209], v14 offset:24768
  ds_read_b64_tr_b16 a[210:211], v14 offset:27328
  s_waitcnt lgkmcnt(8)
  v_mfma_f32_32x32x16_bf16 v[192:207], a[192:195], a[8:11], v[192:207]
  v_mfma_f32_32x32x16_bf16 v[208:223], a[192:195], a[12:15], v[208:223]
  ds_read_b64_tr_b16 a[212:213], v14 offset:29888
  ds_read_b64_tr_b16 a[214:215], v14 offset:32448
  s_waitcnt lgkmcnt(8)
  v_mfma_f32_32x32x16_bf16 v[192:207], a[196:199], a[24:27], v[192:207]
  v_mfma_f32_32x32x16_bf16 v[208:223], a[196:199], a[28:31], v[208:223]
  ds_read_b64_tr_b16 a[216:217], v14 offset:37056
  ds_read_b64_tr_b16 a[218:219], v14 offset:39616
  s_waitcnt lgkmcnt(8)
  v_mfma_f32_32x32x16_bf16 v[192:207], a[200:203], a[40:43], v[192:207]
  v_cvt_pk_bf16_f32 v48, v160, v161
  v_mfma_f32_32x32x16_bf16 v[208:223], a[200:203], a[44:47], v[208:223]
  ds_read_b64_tr_b16 a[220:221], v14 offset:42176
  ds_read_b64_tr_b16 a[222:223], v14 offset:44736
  v_cvt_pk_bf16_f32 v49, v162, v163
  s_waitcnt lgkmcnt(8)
  v_mfma_f32_32x32x16_bf16 v[192:207], a[204:207], a[56:59], v[192:207]
  v_cvt_pk_bf16_f32 v50, v164, v165
  v_cvt_pk_bf16_f32 v51, v166, v167
  v_mfma_f32_32x32x16_bf16 v[208:223], a[204:207], a[60:63], v[208:223]
  ds_read_b64_tr_b16 a[192:193], v14 offset:49344
  ds_read_b64_tr_b16 a[194:195], v14 offset:51904
  v_cvt_pk_bf16_f32 v52, v168, v169
  s_waitcnt lgkmcnt(8)
  v_mfma_f32_32x32x16_bf16 v[192:207], a[208:211], a[72:75], v[192:207]
  v_cvt_pk_bf16_f32 v53, v170, v171
  v_mfma_f32_32x32x16_bf16 v[208:223], a[208:211], a[76:79], v[208:223]
  ds_read_b64_tr_b16 a[196:197], v14 offset:54464
  ds_read_b64_tr_b16 a[198:199], v14 offset:57024
  v_cvt_pk_bf16_f32 v54, v172, v173
  s_waitcnt lgkmcnt(8)
  v_mfma_f32_32x32x16_bf16 v[192:207], a[212:215], a[88:91], v[192:207]
  v_cvt_pk_bf16_f32 v55, v174, v175
  s_mov_b32 s66, 4096
  buffer_store_dwordx4 v[48:51], v2, s[52:55], s66 offen offset:0 sc1
  v_mfma_f32_32x32x16_bf16 v[208:223], a[212:215], a[92:95], v[208:223]
  ds_read_b64_tr_b16 a[200:201], v15 offset:192
  ds_read_b64_tr_b16 a[202:203], v15 offset:2752
  s_mov_b32 s66, 4096
  buffer_store_dwordx4 v[52:55], v2, s[52:55], s66 offen offset:1024 sc1
  s_waitcnt lgkmcnt(8)
  v_mfma_f32_32x32x16_bf16 v[192:207], a[216:219], a[104:107], v[192:207]
  v_cvt_pk_bf16_f32 v56, v176, v177
  v_mfma_f32_32x32x16_bf16 v[208:223], a[216:219], a[108:111], v[208:223]
  ds_read_b64_tr_b16 a[204:205], v15 offset:5312
  ds_read_b64_tr_b16 a[206:207], v15 offset:7872
  v_cvt_pk_bf16_f32 v57, v178, v179
  s_waitcnt lgkmcnt(8)
  v_mfma_f32_32x32x16_bf16 v[192:207], a[220:223], a[120:123], v[192:207]
  v_cvt_pk_bf16_f32 v58, v180, v181
  v_cvt_pk_bf16_f32 v59, v182, v183
  v_mfma_f32_32x32x16_bf16 v[208:223], a[220:223], a[124:127], v[208:223]
  ds_read_b64_tr_b16 a[208:209], v14 offset:256
  ds_read_b64_tr_b16 a[210:211], v14 offset:2816
  v_cvt_pk_bf16_f32 v60, v184, v185
  s_waitcnt lgkmcnt(8)
  v_mfma_f32_32x32x16_bf16 v[192:207], a[192:195], a[136:139], v[192:207]
  v_cvt_pk_bf16_f32 v61, v186, v187
  v_mfma_f32_32x32x16_bf16 v[208:223], a[192:195], a[140:143], v[208:223]
  ds_read_b64_tr_b16 a[212:213], v14 offset:5376
  ds_read_b64_tr_b16 a[214:215], v14 offset:7936
  v_cvt_pk_bf16_f32 v62, v188, v189
  s_waitcnt lgkmcnt(8)
  v_mfma_f32_32x32x16_bf16 v[192:207], a[196:199], a[152:155], v[192:207]
  v_cvt_pk_bf16_f32 v63, v190, v191
  s_mov_b32 s66, 4096
  buffer_store_dwordx4 v[56:59], v3, s[52:55], s66 offen offset:0 sc1
  v_mfma_f32_32x32x16_bf16 v[208:223], a[196:199], a[156:159], v[208:223]
  ds_read_b64_tr_b16 a[216:217], v14 offset:12544
  ds_read_b64_tr_b16 a[218:219], v14 offset:15104
  s_mov_b32 s66, 4096
  buffer_store_dwordx4 v[60:63], v3, s[52:55], s66 offen offset:1024 sc1
  s_waitcnt lgkmcnt(8)
  v_mfma_f32_32x32x16_bf16 v[192:207], a[200:203], a[168:171], v[192:207]
  v_mfma_f32_32x32x16_bf16 v[208:223], a[200:203], a[172:175], v[208:223]
  ds_read_b64_tr_b16 a[220:221], v14 offset:17664
  ds_read_b64_tr_b16 a[222:223], v14 offset:20224
  s_waitcnt lgkmcnt(8)
  v_mfma_f32_32x32x16_bf16 v[192:207], a[204:207], a[184:187], v[192:207]
  v_mfma_f32_32x32x16_bf16 v[208:223], a[204:207], a[188:191], v[208:223]
  ds_read_b64_tr_b16 a[192:193], v14 offset:24832
  ds_read_b64_tr_b16 a[194:195], v14 offset:27392
  s_waitcnt lgkmcnt(8)
  v_mfma_f32_32x32x16_bf16 v[224:239], a[208:211], a[8:11], v[224:239]
  v_mfma_f32_32x32x16_bf16 v[240:255], a[208:211], a[12:15], v[240:255]
  ds_read_b64_tr_b16 a[196:197], v14 offset:29952
  ds_read_b64_tr_b16 a[198:199], v14 offset:32512
  s_waitcnt lgkmcnt(8)
  v_mfma_f32_32x32x16_bf16 v[224:239], a[212:215], a[24:27], v[224:239]
  s_waitcnt vmcnt(4)
  s_mov_b32 s74, s77
  buffer_store_dword v41, v40, s[92:95], s74 offen sc1
  v_mfma_f32_32x32x16_bf16 v[240:255], a[212:215], a[28:31], v[240:255]
  ds_read_b64_tr_b16 a[200:201], v14 offset:37120
  ds_read_b64_tr_b16 a[202:203], v14 offset:39680
  s_waitcnt lgkmcnt(8)
  v_mfma_f32_32x32x16_bf16 v[224:239], a[216:219], a[40:43], v[224:239]
  v_cvt_pk_bf16_f32 v64, v192, v193
  v_mfma_f32_32x32x16_bf16 v[240:255], a[216:219], a[44:47], v[240:255]
  ds_read_b64_tr_b16 a[204:205], v14 offset:42240
  ds_read_b64_tr_b16 a[206:207], v14 offset:44800
  v_cvt_pk_bf16_f32 v65, v194, v195
  s_waitcnt lgkmcnt(8)
  v_mfma_f32_32x32x16_bf16 v[224:239], a[220:223], a[56:59], v[224:239]
  v_cvt_pk_bf16_f32 v66, v196, v197
  v_cvt_pk_bf16_f32 v67, v198, v199
  v_mfma_f32_32x32x16_bf16 v[240:255], a[220:223], a[60:63], v[240:255]
  ds_read_b64_tr_b16 a[208:209], v14 offset:49408
  ds_read_b64_tr_b16 a[210:211], v14 offset:51968
  v_cvt_pk_bf16_f32 v68, v200, v201
  s_waitcnt lgkmcnt(8)
  v_mfma_f32_32x32x16_bf16 v[224:239], a[192:195], a[72:75], v[224:239]
  v_cvt_pk_bf16_f32 v69, v202, v203
  v_mfma_f32_32x32x16_bf16 v[240:255], a[192:195], a[76:79], v[240:255]
  ds_read_b64_tr_b16 a[212:213], v14 offset:54528
  ds_read_b64_tr_b16 a[214:215], v14 offset:57088
  v_cvt_pk_bf16_f32 v70, v204, v205
  s_waitcnt lgkmcnt(8)
  v_mfma_f32_32x32x16_bf16 v[224:239], a[196:199], a[88:91], v[224:239]
  v_cvt_pk_bf16_f32 v71, v206, v207
  s_mov_b32 s66, 4096
  buffer_store_dwordx4 v[64:67], v2, s[52:55], s66 offen offset:2048 sc1
  v_mfma_f32_32x32x16_bf16 v[240:255], a[196:199], a[92:95], v[240:255]
  ds_read_b64_tr_b16 a[216:217], v15 offset:256
  ds_read_b64_tr_b16 a[218:219], v15 offset:2816
  s_mov_b32 s66, 4096
  buffer_store_dwordx4 v[68:71], v2, s[52:55], s66 offen offset:3072 sc1
  s_waitcnt lgkmcnt(8)
  v_mfma_f32_32x32x16_bf16 v[224:239], a[200:203], a[104:107], v[224:239]
  v_cvt_pk_bf16_f32 v72, v208, v209
  v_mfma_f32_32x32x16_bf16 v[240:255], a[200:203], a[108:111], v[240:255]
  ds_read_b64_tr_b16 a[220:221], v15 offset:5376
  ds_read_b64_tr_b16 a[222:223], v15 offset:7936
  v_cvt_pk_bf16_f32 v73, v210, v211
  s_waitcnt lgkmcnt(8)
  v_mfma_f32_32x32x16_bf16 v[224:239], a[204:207], a[120:123], v[224:239]
  v_cvt_pk_bf16_f32 v74, v212, v213
  v_cvt_pk_bf16_f32 v75, v214, v215
  v_mfma_f32_32x32x16_bf16 v[240:255], a[204:207], a[124:127], v[240:255]
  v_cvt_pk_bf16_f32 v76, v216, v217
  s_waitcnt lgkmcnt(6)
  v_mfma_f32_32x32x16_bf16 v[224:239], a[208:211], a[136:139], v[224:239]
  v_cvt_pk_bf16_f32 v77, v218, v219
  v_mfma_f32_32x32x16_bf16 v[240:255], a[208:211], a[140:143], v[240:255]
  v_cvt_pk_bf16_f32 v78, v220, v221
  s_waitcnt lgkmcnt(4)
  v_mfma_f32_32x32x16_bf16 v[224:239], a[212:215], a[152:155], v[224:239]
  v_cvt_pk_bf16_f32 v79, v222, v223
  s_mov_b32 s66, 4096
  buffer_store_dwordx4 v[72:75], v3, s[52:55], s66 offen offset:2048 sc1
  v_mfma_f32_32x32x16_bf16 v[240:255], a[212:215], a[156:159], v[240:255]
  s_mov_b32 s66, 4096
  buffer_store_dwordx4 v[76:79], v3, s[52:55], s66 offen offset:3072 sc1
  s_waitcnt lgkmcnt(2)
  v_mfma_f32_32x32x16_bf16 v[224:239], a[216:219], a[168:171], v[224:239]
  v_mfma_f32_32x32x16_bf16 v[240:255], a[216:219], a[172:175], v[240:255]
  s_waitcnt lgkmcnt(0)
  v_mfma_f32_32x32x16_bf16 v[224:239], a[220:223], a[184:187], v[224:239]
  v_mfma_f32_32x32x16_bf16 v[240:255], a[220:223], a[188:191], v[240:255]
  s_nop 10
  v_cvt_pk_bf16_f32 v48, v224, v225
  v_cvt_pk_bf16_f32 v49, v226, v227
  v_cvt_pk_bf16_f32 v50, v228, v229
  v_cvt_pk_bf16_f32 v51, v230, v231
  v_cvt_pk_bf16_f32 v52, v232, v233
  v_cvt_pk_bf16_f32 v53, v234, v235
  v_cvt_pk_bf16_f32 v54, v236, v237
  v_cvt_pk_bf16_f32 v55, v238, v239
  s_mov_b32 s66, 8192
  buffer_store_dwordx4 v[48:51], v2, s[52:55], s66 offen offset:0 sc1
  s_mov_b32 s66, 8192
  buffer_store_dwordx4 v[52:55], v2, s[52:55], s66 offen offset:1024 sc1
  v_cvt_pk_bf16_f32 v56, v240, v241
  v_cvt_pk_bf16_f32 v57, v242, v243
  v_cvt_pk_bf16_f32 v58, v244, v245
  v_cvt_pk_bf16_f32 v59, v246, v247
  v_cvt_pk_bf16_f32 v60, v248, v249
  v_cvt_pk_bf16_f32 v61, v250, v251
  v_cvt_pk_bf16_f32 v62, v252, v253
  v_cvt_pk_bf16_f32 v63, v254, v255
  s_mov_b32 s66, 8192
  buffer_store_dwordx4 v[56:59], v3, s[52:55], s66 offen offset:0 sc1
  s_mov_b32 s66, 8192
  buffer_store_dwordx4 v[60:63], v3, s[52:55], s66 offen offset:1024 sc1
  s_waitcnt vmcnt(4)
  s_add_u32 s74, s77, 4096
  v_cmp_eq_u32 vcc, 0, v1
  v_mov_b32 v19, 2130706432
  v_mov_b32 v20, s14
  v_cndmask_b32 v19, v19, v1, vcc
  buffer_store_dword v20, v19, s[92:95], s74 offen sc1
  s_mov_b32 s74, s78
  buffer_load_dword v22, v23, s[92:95], s74 offen sc1
  s_waitcnt vmcnt(2)
  s_add_u32 s74, s77, 8192
  v_cmp_eq_u32 vcc, 0, v1
  v_mov_b32 v19, 2130706432
  v_mov_b32 v20, s14
  v_cndmask_b32 v19, v19, v1, vcc
  buffer_store_dword v20, v19, s[92:95], s74 offen sc1
  s_mov_b32 s74, s78
  s_waitcnt vmcnt(1)
  v_cmp_ne_u32 vcc, s14, v22
  s_cbranch_vccz L_done7
  s_mov_b32 s15, 400000
L_spin7:
  buffer_load_dword v22, v23, s[92:95], s74 offen sc1
  s_waitcnt vmcnt(0)
  v_cmp_ne_u32 vcc, s14, v22
  s_cbranch_vccz L_done7
  s_sub_u32 s15, s15, 1
  s_cbranch_scc0 L_spin7
L_done7:
  s_mov_b32 s66, 0
  buffer_load_dwordx4 v[96:99], v29, s[56:59], s66 offen sc1
  s_mov_b32 s66, 2621440
  buffer_load_dwordx4 v[100:103], v29, s[56:59], s66 offen sc1
  s_mov_b32 s66, 5242880
  buffer_load_dwordx4 v[104:107], v29, s[56:59], s66 offen sc1
  s_mov_b32 s66, 7864320
  buffer_load_dwordx4 v[108:111], v29, s[56:59], s66 offen sc1
  s_mov_b32 s66, 10485760
  buffer_load_dwordx4 v[112:115], v29, s[56:59], s66 offen sc1
  s_mov_b32 s66, 13107200
  buffer_load_dwordx4 v[116:119], v29, s[56:59], s66 offen sc1
  s_mov_b32 s66, 15728640
  buffer_load_dwordx4 v[120:123], v29, s[56:59], s66 offen sc1
  s_mov_b32 s66, 18350080
  buffer_load_dwordx4 v[124:127], v29, s[56:59], s66 offen sc1
  buffer_load_dwordx2 v[36:37], v26, s[36:39], 0 offen offset:0
  buffer_load_dwordx2 v[38:39], v26, s[36:39], 0 offen offset:16
  buffer_load_dwordx2 v[40:41], v26, s[36:39], 0 offen offset:128
  buffer_load_dwordx2 v[42:43], v26, s[36:39], 0 offen offset:144
  buffer_load_dwordx2 v[44:45], v32, s[36:39], 0 offen offset:256
  buffer_load_dwordx2 v[46:47], v32, s[36:39], 0 offen offset:272
  s_mov_b32 s66, 5120
  buffer_load_dwordx4 v[48:51], v27, s[88:91], s66 offen sc1
  buffer_load_dwordx4 v[52:55], v27, s[88:91], s66 offen offset:32 sc1
  s_mov_b32 s66, 5376
  buffer_load_dwordx4 v[56:59], v27, s[88:91], s66 offen sc1
  buffer_load_dwordx4 v[60:63], v27, s[88:91], s66 offen offset:32 sc1
  s_mov_b32 s66, 5632
  buffer_load_dwordx4 v[64:67], v33, s[88:91], s66 offen sc1
  buffer_load_dwordx4 v[68:71], v33, s[88:91], s66 offen offset:32 sc1
  s_barrier
  s_mov_b32 s67, 688128
  s_add_u32 m0, s68, 61440
  s_nop 0
  buffer_load_dwordx4 v16, s[48:51], s67 offen offset:0 lds
  buffer_load_dwordx4 v17, s[48:51], s67 offen offset:1024 lds
  buffer_load_dwordx4 v18, s[48:51], s67 offen offset:2048 lds
  s_mov_b32 s67, 786432
  s_add_u32 m0, s68, 73728
  s_nop 0
  buffer_load_dwordx4 v16, s[48:51], s67 offen offset:0 lds
  buffer_load_dwordx4 v17, s[48:51], s67 offen offset:1024 lds
  buffer_load_dwordx4 v18, s[48:51], s67 offen offset:2048 lds
  s_mov_b32 s67, 884736
  s_add_u32 m0, s68, 86016
  s_nop 0
  buffer_load_dwordx4 v16, s[48:51], s67 offen offset:0 lds
  buffer_load_dwordx4 v17, s[48:51], s67 offen offset:1024 lds
  buffer_load_dwordx4 v18, s[48:51], s67 offen offset:2048 lds
  s_add_u32 s74, s78, 4096
  s_mov_b32 s15, 400000
L_spin8:
  buffer_load_dword v22, v23, s[92:95], s74 offen offset:0 sc1
  s_waitcnt vmcnt(0)
  v_cmp_ne_u32 vcc, s14, v22
  s_cbranch_vccz L_done8
  s_sub_u32 s15, s15, 1
  s_cbranch_scc0 L_spin8
L_done8:
  s_mov_b32 s66, 4096
  buffer_load_dwordx4 v[128:131], v29, s[56:59], s66 offen sc1
  s_mov_b32 s66, 2625536
  buffer_load_dwordx4 v[132:135], v29, s[56:59], s66 offen sc1
  s_mov_b32 s66, 5246976
  buffer_load_dwordx4 v[136:139], v29, s[56:59], s66 offen sc1
  s_mov_b32 s66, 7868416
  buffer_load_dwordx4 v[140:143], v29, s[56:59], s66 offen sc1
  s_mov_b32 s66, 10489856
  buffer_load_dwordx4 v[144:147], v29, s[56:59], s66 offen sc1
  s_mov_b32 s66, 13111296
  buffer_load_dwordx4 v[148:151], v29, s[56:59], s66 offen sc1
  s_mov_b32 s66, 15732736
  buffer_load_dwordx4 v[152:155], v29, s[56:59], s66 offen sc1
  s_mov_b32 s66, 18354176
  buffer_load_dwordx4 v[156:159], v29, s[56:59], s66 offen sc1
  s_mov_b32 s66, 10240
  buffer_load_dwordx4 v[72:75], v27, s[88:91], s66 offen sc1
  buffer_load_dwordx4 v[76:79], v27, s[88:91], s66 offen offset:32 sc1
  s_mov_b32 s66, 10496
  buffer_load_dwordx4 v[80:83], v27, s[88:91], s66 offen sc1
  buffer_load_dwordx4 v[84:87], v27, s[88:91], s66 offen offset:32 sc1
  s_mov_b32 s66, 10752
  buffer_load_dwordx4 v[88:91], v33, s[88:91], s66 offen sc1
  buffer_load_dwordx4 v[92:95], v33, s[88:91], s66 offen offset:32 sc1
  s_mov_b32 s72, 0xffff0000
  v_lshlrev_b32 v216, 16, v36
  v_and_b32 v217, s72, v36
  v_lshlrev_b32 v218, 16, v37
  v_and_b32 v219, s72, v37
  v_lshlrev_b32 v220, 16, v38
  v_and_b32 v221, s72, v38
  v_lshlrev_b32 v222, 16, v39
  v_and_b32 v223, s72, v39
  v_lshlrev_b32 v224, 16, v40
  v_and_b32 v225, s72, v40
  v_lshlrev_b32 v226, 16, v41
  v_and_b32 v227, s72, v41
  v_lshlrev_b32 v228, 16, v42
  v_and_b32 v229, s72, v42
  v_lshlrev_b32 v230, 16, v43
  v_and_b32 v231, s72, v43
  v_lshlrev_b32 v232, 16, v44
  v_and_b32 v233, s72, v44
  v_lshlrev_b32 v234, 16, v45
  v_and_b32 v235, s72, v45
  v_lshlrev_b32 v236, 16, v46
  v_and_b32 v237, s72, v46
  v_lshlrev_b32 v238, 16, v47
  v_and_b32 v239, s72, v47
  v_lshlrev_b32 v240, 16, v96
  v_and_b32 v241, s72, v96
  v_lshlrev_b32 v242, 16, v97
  v_and_b32 v243, s72, v97
  v_lshlrev_b32 v244, 16, v98
  v_and_b32 v245, s72, v98
  v_lshlrev_b32 v246, 16, v99
  v_and_b32 v247, s72, v99
  v_lshlrev_b32 v248, 16, v100
  v_and_b32 v249, s72, v100
  v_lshlrev_b32 v250, 16, v101
  v_and_b32 v251, s72, v101
  v_lshlrev_b32 v252, 16, v102
  v_and_b32 v253, s72, v102
  v_lshlrev_b32 v254, 16, v103
  v_and_b32 v255, s72, v103
  v_pk_add_f32 v[240:241], v[240:241], v[248:249]
  v_pk_add_f32 v[242:243], v[242:243], v[250:251]
  v_pk_add_f32 v[244:245], v[244:245], v[252:253]
  v_pk_add_f32 v[246:247], v[246:247], v[254:255]
  v_lshlrev_b32 v248, 16, v104
  v_and_b32 v249, s72, v104
  v_lshlrev_b32 v250, 16, v105
  v_and_b32 v251, s72, v105
  v_lshlrev_b32 v252, 16, v106
  v_and_b32 v253, s72, v106
  v_lshlrev_b32 v254, 16, v107
  v_and_b32 v255, s72, v107
  v_pk_add_f32 v[240:241], v[240:241], v[248:249]
  v_pk_add_f32 v[242:243], v[242:243], v[250:251]
  v_pk_add_f32 v[244:245], v[244:245], v[252:253]
  v_pk_add_f32 v[246:247], v[246:247], v[254:255]
  v_lshlrev_b32 v248, 16, v108
  v_and_b32 v249, s72, v108
  v_lshlrev_b32 v250, 16, v109
  v_and_b32 v251, s72, v109
  v_lshlrev_b32 v252, 16, v110
  v_and_b32 v253, s72, v110
  v_lshlrev_b32 v254, 16, v111
  v_and_b32 v255, s72, v111
  v_pk_add_f32 v[240:241], v[240:241], v[248:249]
  v_pk_add_f32 v[242:243], v[242:243], v[250:251]
  v_pk_add_f32 v[244:245], v[244:245], v[252:253]
  v_pk_add_f32 v[246:247], v[246:247], v[254:255]
  v_lshlrev_b32 v248, 16, v112
  v_and_b32 v249, s72, v112
  v_lshlrev_b32 v250, 16, v113
  v_and_b32 v251, s72, v113
  v_lshlrev_b32 v252, 16, v114
  v_and_b32 v253, s72, v114
  v_lshlrev_b32 v254, 16, v115
  v_and_b32 v255, s72, v115
  v_pk_add_f32 v[240:241], v[240:241], v[248:249]
  v_pk_add_f32 v[242:243], v[242:243], v[250:251]
  v_pk_add_f32 v[244:245], v[244:245], v[252:253]
  v_pk_add_f32 v[246:247], v[246:247], v[254:255]
  v_lshlrev_b32 v248, 16, v116
  v_and_b32 v249, s72, v116
  v_lshlrev_b32 v250, 16, v117
  v_and_b32 v251, s72, v117
  v_lshlrev_b32 v252, 16, v118
  v_and_b32 v253, s72, v118
  v_lshlrev_b32 v254, 16, v119
  v_and_b32 v255, s72, v119
  v_pk_add_f32 v[240:241], v[240:241], v[248:249]
  v_pk_add_f32 v[242:243], v[242:243], v[250:251]
  v_pk_add_f32 v[244:245], v[244:245], v[252:253]
  v_pk_add_f32 v[246:247], v[246:247], v[254:255]
  v_lshlrev_b32 v248, 16, v120
  v_and_b32 v249, s72, v120
  v_lshlrev_b32 v250, 16, v121
  v_and_b32 v251, s72, v121
  v_lshlrev_b32 v252, 16, v122
  v_and_b32 v253, s72, v122
  v_lshlrev_b32 v254, 16, v123
  v_and_b32 v255, s72, v123
  v_pk_add_f32 v[240:241], v[240:241], v[248:249]
  v_pk_add_f32 v[242:243], v[242:243], v[250:251]
  v_pk_add_f32 v[244:245], v[244:245], v[252:253]
  v_pk_add_f32 v[246:247], v[246:247], v[254:255]
  v_lshlrev_b32 v248, 16, v124
  v_and_b32 v249, s72, v124
  v_lshlrev_b32 v250, 16, v125
  v_and_b32 v251, s72, v125
  v_lshlrev_b32 v252, 16, v126
  v_and_b32 v253, s72, v126
  v_lshlrev_b32 v254, 16, v127
  v_and_b32 v255, s72, v127
  v_pk_add_f32 v[240:241], v[240:241], v[248:249]
  v_pk_add_f32 v[242:243], v[242:243], v[250:251]
  v_pk_add_f32 v[244:245], v[244:245], v[252:253]
  v_pk_add_f32 v[246:247], v[246:247], v[254:255]
  v_fma_f32 v240, v240, v48, v216
  v_fma_f32 v241, v241, v49, v217
  v_fma_f32 v242, v242, v50, v218
  v_fma_f32 v243, v243, v51, v219
  v_fma_f32 v244, v244, v52, v220
  v_fma_f32 v245, v245, v53, v221
  v_fma_f32 v246, v246, v54, v222
  v_fma_f32 v247, v247, v55, v223
  v_cvt_pk_bf16_f32 v36, v240, v241
  v_cvt_pk_bf16_f32 v37, v242, v243
  v_cvt_pk_bf16_f32 v38, v244, v245
  v_cvt_pk_bf16_f32 v39, v246, v247
  v_lshlrev_b32 v216, 16, v36
  v_and_b32 v217, s72, v36
  v_lshlrev_b32 v218, 16, v37
  v_and_b32 v219, s72, v37
  v_lshlrev_b32 v220, 16, v38
  v_and_b32 v221, s72, v38
  v_lshlrev_b32 v222, 16, v39
  v_and_b32 v223, s72, v39
  s_mov_b32 s66, 0
  buffer_store_dwordx4 v[36:39], v29, s[40:43], s66 offen sc1
  s_add_u32 s74, s78, 8192
  s_mov_b32 s15, 400000
L_spin9:
  buffer_load_dword v22, v23, s[92:95], s74 offen offset:0 sc1
  s_waitcnt vmcnt(0)
  v_cmp_ne_u32 vcc, s14, v22
  s_cbranch_vccz L_done9
  s_sub_u32 s15, s15, 1
  s_cbranch_scc0 L_spin9
L_done9:
  s_mov_b32 s66, 8192
  buffer_load_dwordx4 v[160:163], v34, s[56:59], s66 offen sc1
  s_mov_b32 s66, 2629632
  buffer_load_dwordx4 v[164:167], v34, s[56:59], s66 offen sc1
  s_mov_b32 s66, 5251072
  buffer_load_dwordx4 v[168:171], v34, s[56:59], s66 offen sc1
  s_mov_b32 s66, 7872512
  buffer_load_dwordx4 v[172:175], v34, s[56:59], s66 offen sc1
  s_mov_b32 s66, 10493952
  buffer_load_dwordx4 v[176:179], v34, s[56:59], s66 offen sc1
  s_mov_b32 s66, 13115392
  buffer_load_dwordx4 v[180:183], v34, s[56:59], s66 offen sc1
  s_mov_b32 s66, 15736832
  buffer_load_dwordx4 v[184:187], v34, s[56:59], s66 offen sc1
  s_mov_b32 s66, 18358272
  buffer_load_dwordx4 v[188:191], v34, s[56:59], s66 offen sc1
  s_mov_b32 s66, 7680
  buffer_load_dwordx4 v[192:195], v27, s[88:91], s66 offen sc1
  buffer_load_dwordx4 v[196:199], v27, s[88:91], s66 offen offset:32 sc1
  s_mov_b32 s66, 7936
  buffer_load_dwordx4 v[200:203], v27, s[88:91], s66 offen sc1
  buffer_load_dwordx4 v[204:207], v27, s[88:91], s66 offen offset:32 sc1
  s_mov_b32 s66, 8192
  buffer_load_dwordx4 v[208:211], v33, s[88:91], s66 offen sc1
  buffer_load_dwordx4 v[212:215], v33, s[88:91], s66 offen offset:32 sc1
  v_lshlrev_b32 v240, 16, v128
  v_and_b32 v241, s72, v128
  v_lshlrev_b32 v242, 16, v129
  v_and_b32 v243, s72, v129
  v_lshlrev_b32 v244, 16, v130
  v_and_b32 v245, s72, v130
  v_lshlrev_b32 v246, 16, v131
  v_and_b32 v247, s72, v131
  v_lshlrev_b32 v248, 16, v132
  v_and_b32 v249, s72, v132
  v_lshlrev_b32 v250, 16, v133
  v_and_b32 v251, s72, v133
  v_lshlrev_b32 v252, 16, v134
  v_and_b32 v253, s72, v134
  v_lshlrev_b32 v254, 16, v135
  v_and_b32 v255, s72, v135
  v_pk_add_f32 v[240:241], v[240:241], v[248:249]
  v_pk_add_f32 v[242:243], v[242:243], v[250:251]
  v_pk_add_f32 v[244:245], v[244:245], v[252:253]
  v_pk_add_f32 v[246:247], v[246:247], v[254:255]
  v_lshlrev_b32 v248, 16, v136
  v_and_b32 v249, s72, v136
  v_lshlrev_b32 v250, 16, v137
  v_and_b32 v251, s72, v137
  v_lshlrev_b32 v252, 16, v138
  v_and_b32 v253, s72, v138
  v_lshlrev_b32 v254, 16, v139
  v_and_b32 v255, s72, v139
  v_pk_add_f32 v[240:241], v[240:241], v[248:249]
  v_pk_add_f32 v[242:243], v[242:243], v[250:251]
  v_pk_add_f32 v[244:245], v[244:245], v[252:253]
  v_pk_add_f32 v[246:247], v[246:247], v[254:255]
  v_lshlrev_b32 v248, 16, v140
  v_and_b32 v249, s72, v140
  v_lshlrev_b32 v250, 16, v141
  v_and_b32 v251, s72, v141
  v_lshlrev_b32 v252, 16, v142
  v_and_b32 v253, s72, v142
  v_lshlrev_b32 v254, 16, v143
  v_and_b32 v255, s72, v143
  v_pk_add_f32 v[240:241], v[240:241], v[248:249]
  v_pk_add_f32 v[242:243], v[242:243], v[250:251]
  v_pk_add_f32 v[244:245], v[244:245], v[252:253]
  v_pk_add_f32 v[246:247], v[246:247], v[254:255]
  v_lshlrev_b32 v248, 16, v144
  v_and_b32 v249, s72, v144
  v_lshlrev_b32 v250, 16, v145
  v_and_b32 v251, s72, v145
  v_lshlrev_b32 v252, 16, v146
  v_and_b32 v253, s72, v146
  v_lshlrev_b32 v254, 16, v147
  v_and_b32 v255, s72, v147
  v_pk_add_f32 v[240:241], v[240:241], v[248:249]
  v_pk_add_f32 v[242:243], v[242:243], v[250:251]
  v_pk_add_f32 v[244:245], v[244:245], v[252:253]
  v_pk_add_f32 v[246:247], v[246:247], v[254:255]
  v_lshlrev_b32 v248, 16, v148
  v_and_b32 v249, s72, v148
  v_lshlrev_b32 v250, 16, v149
  v_and_b32 v251, s72, v149
  v_lshlrev_b32 v252, 16, v150
  v_and_b32 v253, s72, v150
  v_lshlrev_b32 v254, 16, v151
  v_and_b32 v255, s72, v151
  v_pk_add_f32 v[240:241], v[240:241], v[248:249]
  v_pk_add_f32 v[242:243], v[242:243], v[250:251]
  v_pk_add_f32 v[244:245], v[244:245], v[252:253]
  v_pk_add_f32 v[246:247], v[246:247], v[254:255]
  v_lshlrev_b32 v248, 16, v152
  v_and_b32 v249, s72, v152
  v_lshlrev_b32 v250, 16, v153
  v_and_b32 v251, s72, v153
  v_lshlrev_b32 v252, 16, v154
  v_and_b32 v253, s72, v154
  v_lshlrev_b32 v254, 16, v155
  v_and_b32 v255, s72, v155
  v_pk_add_f32 v[240:241], v[240:241], v[248:249]
  v_pk_add_f32 v[242:243], v[242:243], v[250:251]
  v_pk_add_f32 v[244:245], v[244:245], v[252:253]
  v_pk_add_f32 v[246:247], v[246:247], v[254:255]
  v_lshlrev_b32 v248, 16, v156
  v_and_b32 v249, s72, v156
  v_lshlrev_b32 v250, 16, v157
  v_and_b32 v251, s72, v157
  v_lshlrev_b32 v252, 16, v158
  v_and_b32 v253, s72, v158
  v_lshlrev_b32 v254, 16, v159
  v_and_b32 v255, s72, v159
  v_pk_add_f32 v[240:241], v[240:241], v[248:249]
  v_pk_add_f32 v[242:243], v[242:243], v[250:251]
  v_pk_add_f32 v[244:245], v[244:245], v[252:253]
  v_pk_add_f32 v[246:247], v[246:247], v[254:255]
  v_fma_f32 v240, v240, v56, v224
  v_fma_f32 v241, v241, v57, v225
  v_fma_f32 v242, v242, v58, v226
  v_fma_f32 v243, v243, v59, v227
  v_fma_f32 v244, v244, v60, v228
  v_fma_f32 v245, v245, v61, v229
  v_fma_f32 v246, v246, v62, v230
  v_fma_f32 v247, v247, v63, v231
  v_cvt_pk_bf16_f32 v40, v240, v241
  v_cvt_pk_bf16_f32 v41, v242, v243
  v_cvt_pk_bf16_f32 v42, v244, v245
  v_cvt_pk_bf16_f32 v43, v246, v247
  v_lshlrev_b32 v224, 16, v40
  v_and_b32 v225, s72, v40
  v_lshlrev_b32 v226, 16, v41
  v_and_b32 v227, s72, v41
  v_lshlrev_b32 v228, 16, v42
  v_and_b32 v229, s72, v42
  v_lshlrev_b32 v230, 16, v43
  v_and_b32 v231, s72, v43
  s_mov_b32 s66, 4096
  buffer_store_dwordx4 v[40:43], v29, s[40:43], s66 offen sc1
  s_waitcnt vmcnt(7)
  v_lshlrev_b32 v240, 16, v160
  v_and_b32 v241, s72, v160
  v_lshlrev_b32 v242, 16, v161
  v_and_b32 v243, s72, v161
  v_lshlrev_b32 v244, 16, v162
  v_and_b32 v245, s72, v162
  v_lshlrev_b32 v246, 16, v163
  v_and_b32 v247, s72, v163
  v_lshlrev_b32 v248, 16, v164
  v_and_b32 v249, s72, v164
  v_lshlrev_b32 v250, 16, v165
  v_and_b32 v251, s72, v165
  v_lshlrev_b32 v252, 16, v166
  v_and_b32 v253, s72, v166
  v_lshlrev_b32 v254, 16, v167
  v_and_b32 v255, s72, v167
  v_pk_add_f32 v[240:241], v[240:241], v[248:249]
  v_pk_add_f32 v[242:243], v[242:243], v[250:251]
  v_pk_add_f32 v[244:245], v[244:245], v[252:253]
  v_pk_add_f32 v[246:247], v[246:247], v[254:255]
  v_lshlrev_b32 v248, 16, v168
  v_and_b32 v249, s72, v168
  v_lshlrev_b32 v250, 16, v169
  v_and_b32 v251, s72, v169
  v_lshlrev_b32 v252, 16, v170
  v_and_b32 v253, s72, v170
  v_lshlrev_b32 v254, 16, v171
  v_and_b32 v255, s72, v171
  v_pk_add_f32 v[240:241], v[240:241], v[248:249]
  v_pk_add_f32 v[242:243], v[242:243], v[250:251]
  v_pk_add_f32 v[244:245], v[244:245], v[252:253]
  v_pk_add_f32 v[246:247], v[246:247], v[254:255]
  v_lshlrev_b32 v248, 16, v172
  v_and_b32 v249, s72, v172
  v_lshlrev_b32 v250, 16, v173
  v_and_b32 v251, s72, v173
  v_lshlrev_b32 v252, 16, v174
  v_and_b32 v253, s72, v174
  v_lshlrev_b32 v254, 16, v175
  v_and_b32 v255, s72, v175
  v_pk_add_f32 v[240:241], v[240:241], v[248:249]
  v_pk_add_f32 v[242:243], v[242:243], v[250:251]
  v_pk_add_f32 v[244:245], v[244:245], v[252:253]
  v_pk_add_f32 v[246:247], v[246:247], v[254:255]
  v_lshlrev_b32 v248, 16, v176
  v_and_b32 v249, s72, v176
  v_lshlrev_b32 v250, 16, v177
  v_and_b32 v251, s72, v177
  v_lshlrev_b32 v252, 16, v178
  v_and_b32 v253, s72, v178
  v_lshlrev_b32 v254, 16, v179
  v_and_b32 v255, s72, v179
  v_pk_add_f32 v[240:241], v[240:241], v[248:249]
  v_pk_add_f32 v[242:243], v[242:243], v[250:251]
  v_pk_add_f32 v[244:245], v[244:245], v[252:253]
  v_pk_add_f32 v[246:247], v[246:247], v[254:255]
  v_lshlrev_b32 v248, 16, v180
  v_and_b32 v249, s72, v180
  v_lshlrev_b32 v250, 16, v181
  v_and_b32 v251, s72, v181
  v_lshlrev_b32 v252, 16, v182
  v_and_b32 v253, s72, v182
  v_lshlrev_b32 v254, 16, v183
  v_and_b32 v255, s72, v183
  v_pk_add_f32 v[240:241], v[240:241], v[248:249]
  v_pk_add_f32 v[242:243], v[242:243], v[250:251]
  v_pk_add_f32 v[244:245], v[244:245], v[252:253]
  v_pk_add_f32 v[246:247], v[246:247], v[254:255]
  v_lshlrev_b32 v248, 16, v184
  v_and_b32 v249, s72, v184
  v_lshlrev_b32 v250, 16, v185
  v_and_b32 v251, s72, v185
  v_lshlrev_b32 v252, 16, v186
  v_and_b32 v253, s72, v186
  v_lshlrev_b32 v254, 16, v187
  v_and_b32 v255, s72, v187
  v_pk_add_f32 v[240:241], v[240:241], v[248:249]
  v_pk_add_f32 v[242:243], v[242:243], v[250:251]
  v_pk_add_f32 v[244:245], v[244:245], v[252:253]
  v_pk_add_f32 v[246:247], v[246:247], v[254:255]
  v_lshlrev_b32 v248, 16, v188
  v_and_b32 v249, s72, v188
  v_lshlrev_b32 v250, 16, v189
  v_and_b32 v251, s72, v189
  v_lshlrev_b32 v252, 16, v190
  v_and_b32 v253, s72, v190
  v_lshlrev_b32 v254, 16, v191
  v_and_b32 v255, s72, v191
  v_pk_add_f32 v[240:241], v[240:241], v[248:249]
  v_pk_add_f32 v[242:243], v[242:243], v[250:251]
  v_pk_add_f32 v[244:245], v[244:245], v[252:253]
  v_pk_add_f32 v[246:247], v[246:247], v[254:255]
  v_fma_f32 v240, v240, v64, v232
  v_fma_f32 v241, v241, v65, v233
  v_fma_f32 v242, v242, v66, v234
  v_fma_f32 v243, v243, v67, v235
  v_fma_f32 v244, v244, v68, v236
  v_fma_f32 v245, v245, v69, v237
  v_fma_f32 v246, v246, v70, v238
  v_fma_f32 v247, v247, v71, v239
  v_cvt_pk_bf16_f32 v44, v240, v241
  v_cvt_pk_bf16_f32 v45, v242, v243
  v_cvt_pk_bf16_f32 v46, v244, v245
  v_cvt_pk_bf16_f32 v47, v246, v247
  v_lshlrev_b32 v232, 16, v44
  v_and_b32 v233, s72, v44
  v_lshlrev_b32 v234, 16, v45
  v_and_b32 v235, s72, v45
  v_lshlrev_b32 v236, 16, v46
  v_and_b32 v237, s72, v46
  v_lshlrev_b32 v238, 16, v47
  v_and_b32 v239, s72, v47
  s_mov_b32 s66, 8192
  buffer_store_dwordx4 v[44:47], v34, s[40:43], s66 offen sc1
  v_add_f32 v19, v216, v217
  v_add_f32 v19, v19, v218
  v_add_f32 v19, v19, v219
  v_add_f32 v19, v19, v220
  v_add_f32 v19, v19, v221
  v_add_f32 v19, v19, v222
  v_add_f32 v19, v19, v223
  v_add_f32 v19, v19, v224
  v_add_f32 v19, v19, v225
  v_add_f32 v19, v19, v226
  v_add_f32 v19, v19, v227
  v_add_f32 v19, v19, v228
  v_add_f32 v19, v19, v229
  v_add_f32 v19, v19, v230
  v_add_f32 v19, v19, v231
  v_add_f32 v19, v19, v232
  v_add_f32 v19, v19, v233
  v_add_f32 v19, v19, v234
  v_add_f32 v19, v19, v235
  v_add_f32 v19, v19, v236
  v_add_f32 v19, v19, v237
  v_add_f32 v19, v19, v238
  v_add_f32 v19, v19, v239
  s_nop 1
  v_add_f32_dpp v19, v19, v19 row_ror:8 row_mask:0xf bank_mask:0xf
  ds_write_b32 v30, v19 offset:0
  s_waitcnt lgkmcnt(0)
  s_getpc_b64 s[96:97]
  s_add_u32 s96, s96, 1024
  s_addc_u32 s97, s97, 0
  v_lshlrev_b32 v14, 6, v0
  v_mov_b32 v15, 0
  v_lshl_add_u64 v[14:15], v[14:15], 0, s[96:97]
  global_load_dword a225, v[14:15], off
  s_barrier
  ds_read_b128 v[240:243], v31 offset:0
  ds_read_b128 v[244:247], v31 offset:16
  ds_read_b128 v[248:251], v31 offset:32
  ds_read_b128 v[252:255], v31 offset:48
  s_waitcnt lgkmcnt(0)
  v_add_f32 v240, v240, v248
  v_add_f32 v241, v241, v249
  v_add_f32 v242, v242, v250
  v_add_f32 v243, v243, v251
  v_add_f32 v244, v244, v252
  v_add_f32 v245, v245, v253
  v_add_f32 v246, v246, v254
  v_add_f32 v247, v247, v255
  v_add_f32 v240, v240, v244
  v_add_f32 v241, v241, v245
  v_add_f32 v242, v242, v246
  v_add_f32 v243, v243, v247
  v_add_f32 v240, v240, v242
  v_add_f32 v241, v241, v243
  v_add_f32 v19, v240, v241
  s_mov_b32 s69, 0x3acccccd
  v_mul_f32 v19, s69, v19
  v_cmp_gt_u32 vcc, 32, v1
  v_sub_f32 v216, v216, v19
  v_sub_f32 v217, v217, v19
  v_sub_f32 v218, v218, v19
  v_sub_f32 v219, v219, v19
  v_sub_f32 v220, v220, v19
  v_sub_f32 v221, v221, v19
  v_sub_f32 v222, v222, v19
  v_sub_f32 v223, v223, v19
  v_sub_f32 v224, v224, v19
  v_sub_f32 v225, v225, v19
  v_sub_f32 v226, v226, v19
  v_sub_f32 v227, v227, v19
  v_sub_f32 v228, v228, v19
  v_sub_f32 v229, v229, v19
  v_sub_f32 v230, v230, v19
  v_sub_f32 v231, v231, v19
  v_sub_f32 v232, v232, v19
  v_sub_f32 v233, v233, v19
  v_sub_f32 v234, v234, v19
  v_sub_f32 v235, v235, v19
  v_sub_f32 v236, v236, v19
  v_sub_f32 v237, v237, v19
  v_sub_f32 v238, v238, v19
  v_sub_f32 v239, v239, v19
  v_cndmask_b32 v232, 0, v232, vcc
  v_cndmask_b32 v233, 0, v233, vcc
  v_cndmask_b32 v234, 0, v234, vcc
  v_cndmask_b32 v235, 0, v235, vcc
  v_cndmask_b32 v236, 0, v236, vcc
  v_cndmask_b32 v237, 0, v237, vcc
  v_cndmask_b32 v238, 0, v238, vcc
  v_cndmask_b32 v239, 0, v239, vcc
  v_mul_f32 v20, v216, v216
  v_fmac_f32 v20, v217, v217
  v_fmac_f32 v20, v218, v218
  v_fmac_f32 v20, v219, v219
  v_fmac_f32 v20, v220, v220
  v_fmac_f32 v20, v221, v221
  v_fmac_f32 v20, v222, v222
  v_fmac_f32 v20, v223, v223
  v_fmac_f32 v20, v224, v224
  v_fmac_f32 v20, v225, v225
  v_fmac_f32 v20, v226, v226
  v_fmac_f32 v20, v227, v227
  v_fmac_f32 v20, v228, v228
  v_fmac_f32 v20, v229, v229
  v_fmac_f32 v20, v230, v230
  v_fmac_f32 v20, v231, v231
  v_fmac_f32 v20, v232, v232
  v_fmac_f32 v20, v233, v233
  v_fmac_f32 v20, v234, v234
  v_fmac_f32 v20, v235, v235
  v_fmac_f32 v20, v236, v236
  v_fmac_f32 v20, v237, v237
  v_fmac_f32 v20, v238, v238
  v_fmac_f32 v20, v239, v239
  s_nop 1
  v_add_f32_dpp v20, v20, v20 row_ror:8 row_mask:0xf bank_mask:0xf
  ds_write_b32 v30, v20 offset:512
  s_waitcnt lgkmcnt(0)
  s_barrier
  ds_read_b128 v[240:243], v31 offset:512
  ds_read_b128 v[244:247], v31 offset:528
  ds_read_b128 v[248:251], v31 offset:544
  ds_read_b128 v[252:255], v31 offset:560
  s_waitcnt lgkmcnt(0)
  v_add_f32 v240, v240, v248
  v_add_f32 v241, v241, v249
  v_add_f32 v242, v242, v250
  v_add_f32 v243, v243, v251
  v_add_f32 v244, v244, v252
  v_add_f32 v245, v245, v253
  v_add_f32 v246, v246, v254
  v_add_f32 v247, v247, v255
  v_add_f32 v240, v240, v244
  v_add_f32 v241, v241, v245
  v_add_f32 v242, v242, v246
  v_add_f32 v243, v243, v247
  v_add_f32 v240, v240, v242
  v_add_f32 v241, v241, v243
  v_add_f32 v20, v240, v241
  s_mov_b32 s73, 0x3727c5ac
  v_mov_b32 v19, s73
  v_fmac_f32 v19, s69, v20
  v_rsq_f32 v19, v19
  s_nop 0
  v_mul_f32 v216, v216, v19
  v_mul_f32 v217, v217, v19
  v_mul_f32 v218, v218, v19
  v_mul_f32 v219, v219, v19
  v_mul_f32 v220, v220, v19
  v_mul_f32 v221, v221, v19
  v_mul_f32 v222, v222, v19
  v_mul_f32 v223, v223, v19
  v_mul_f32 v224, v224, v19
  v_mul_f32 v225, v225, v19
  v_mul_f32 v226, v226, v19
  v_mul_f32 v227, v227, v19
  v_mul_f32 v228, v228, v19
  v_mul_f32 v229, v229, v19
  v_mul_f32 v230, v230, v19
  v_mul_f32 v231, v231, v19
  v_mul_f32 v232, v232, v19
  v_mul_f32 v233, v233, v19
  v_mul_f32 v234, v234, v19
  v_mul_f32 v235, v235, v19
  v_mul_f32 v236, v236, v19
  v_mul_f32 v237, v237, v19
  v_mul_f32 v238, v238, v19
  v_mul_f32 v239, v239, v19
  s_waitcnt vmcnt(3)
  v_fma_f32 v216, v216, v72, v192
  v_fma_f32 v217, v217, v73, v193
  v_fma_f32 v218, v218, v74, v194
  v_fma_f32 v219, v219, v75, v195
  v_fma_f32 v220, v220, v76, v196
  v_fma_f32 v221, v221, v77, v197
  v_fma_f32 v222, v222, v78, v198
  v_fma_f32 v223, v223, v79, v199
  v_fma_f32 v224, v224, v80, v200
  v_fma_f32 v225, v225, v81, v201
  v_fma_f32 v226, v226, v82, v202
  v_fma_f32 v227, v227, v83, v203
  v_fma_f32 v228, v228, v84, v204
  v_fma_f32 v229, v229, v85, v205
  v_fma_f32 v230, v230, v86, v206
  v_fma_f32 v231, v231, v87, v207
  v_fma_f32 v232, v232, v88, v208
  v_fma_f32 v233, v233, v89, v209
  v_fma_f32 v234, v234, v90, v210
  v_fma_f32 v235, v235, v91, v211
  v_fma_f32 v236, v236, v92, v212
  v_fma_f32 v237, v237, v93, v213
  v_fma_f32 v238, v238, v94, v214
  v_fma_f32 v239, v239, v95, v215
  v_cvt_pk_bf16_f32 v240, v216, v217
  v_cvt_pk_bf16_f32 v241, v218, v219
  v_cvt_pk_bf16_f32 v242, v220, v221
  v_cvt_pk_bf16_f32 v243, v222, v223
  s_mov_b32 s66, 0
  buffer_store_dwordx4 v[240:243], v29, s[84:87], s66 offen sc1
  v_cvt_pk_bf16_f32 v244, v224, v225
  v_cvt_pk_bf16_f32 v245, v226, v227
  v_cvt_pk_bf16_f32 v246, v228, v229
  v_cvt_pk_bf16_f32 v247, v230, v231
  s_mov_b32 s66, 4096
  buffer_store_dwordx4 v[244:247], v29, s[84:87], s66 offen sc1
  v_cvt_pk_bf16_f32 v248, v232, v233
  v_cvt_pk_bf16_f32 v249, v234, v235
  v_cvt_pk_bf16_f32 v250, v236, v237
  v_cvt_pk_bf16_f32 v251, v238, v239
  s_mov_b32 s66, 8192
  buffer_store_dwordx4 v[248:251], v34, s[84:87], s66 offen sc1
  s_and_b32 s61, s35, 1
  s_lshl_b32 s61, s61, 2
  s_lshl_b32 s62, s31, 3
  s_add_u32 s61, s61, s62
  s_add_u32 s76, s61, s30
  s_mul_i32 s62, s76, 40960
  s_add_u32 s56, s28, s62
  s_addc_u32 s57, s29, 0
  s_add_u32 s56, s56, 2621440
  s_addc_u32 s57, s57, 0
  s_mov_b32 s58, 40960
  s_mov_b32 s59, 0x20000
  v_lshrrev_b32 v24, 5, v1
  v_bfe_u32 v25, v1, 4, 1
  v_bfe_u32 v26, v1, 2, 2
  v_and_b32 v27, 3, v1
  v_lshl_add_u32 v24, v24, 2, v26
  v_mul_u32_u24 v24, 192, v24
  v_lshl_add_u32 v24, v25, 5, v24
  v_lshl_add_u32 v20, v27, 3, v24
  v_add_u32 v21, 61440, v20
  v_add_u32 v22, 122880, v20
  s_waitcnt vmcnt(0)
  s_barrier
  s_cmp_lg_u32 s30, 0
  s_cbranch_scc1 L_nf10
  s_lshl_b32 s60, s31, 5
  s_add_u32 s60, s60, s35
  s_mul_i32 s60, s60, 128
  s_add_u32 s74, s60, 147456
  v_cmp_eq_u32 vcc, 0, v1
  v_mov_b32 v10, 2130706432
  v_mov_b32 v11, s14
  v_cndmask_b32 v10, v10, v1, vcc
  buffer_store_dword v11, v10, s[92:95], s74 offen sc1
L_nf10:
  s_mov_b32 s67, 983040
  s_add_u32 m0, s68, 98304
  s_nop 0
  buffer_load_dwordx4 v16, s[48:51], s67 offen offset:0 lds
  buffer_load_dwordx4 v17, s[48:51], s67 offen offset:1024 lds
  buffer_load_dwordx4 v18, s[48:51], s67 offen offset:2048 lds
  s_mov_b32 s67, 1081344
  s_add_u32 m0, s68, 110592
  s_nop 0
  buffer_load_dwordx4 v16, s[48:51], s67 offen offset:0 lds
  buffer_load_dwordx4 v17, s[48:51], s67 offen offset:1024 lds
  buffer_load_dwordx4 v18, s[48:51], s67 offen offset:2048 lds
  s_mov_b32 s67, 1179648
  s_add_u32 m0, s68, 122880
  s_nop 0
  buffer_load_dwordx4 v16, s[48:51], s67 offen offset:0 lds
  buffer_load_dwordx4 v17, s[48:51], s67 offen offset:1024 lds
  buffer_load_dwordx4 v18, s[48:51], s67 offen offset:2048 lds
  s_lshr_b32 s60, s35, 1
  s_mul_i32 s62, s76, 98304
  s_mul_i32 s63, s60, 3072
  s_add_u32 s62, s62, s63
  s_add_u32 s84, s28, s62
  s_addc_u32 s85, s29, 0
  s_add_u32 s84, s84, 7864320
  s_addc_u32 s85, s85, 0
  s_mov_b32 s86, 52224
  s_mov_b32 s87, 0x20000
  v_lshlrev_b32 v2, 4, v1
  v_and_b32 v10, 15, v1
  v_lshlrev_b32 v14, 4, v10
  v_lshrrev_b32 v10, 5, v1
  v_lshl_add_u32 v14, v10, 8, v14
  v_bfe_u32 v10, v1, 4, 1
  v_mul_u32_u24 v10, 49152, v10
  v_add_u32 v14, v14, v10
  v_min_u32 v10, 3, v1
  v_lshlrev_b32 v10, 7, v10
  s_mul_i32 s60, s76, 512
  s_add_u32 s74, s60, 147456
  s_mov_b32 s15, 400000
L_spin11:
  buffer_load_dword v11, v10, s[92:95], s74 offen offset:0 sc1
  s_waitcnt vmcnt(0)
  v_cmp_ne_u32 vcc, s14, v11
  s_cbranch_vccz L_done11
  s_sub_u32 s15, s15, 1
  s_cbranch_scc0 L_spin11
L_done11:
  s_mov_b32 s69, 0xbfb8aa3b
  s_mov_b32 s66, 0
  buffer_load_dwordx4 a[0:3], v2, s[56:59], s66 offen offset:0 sc1
  s_mov_b32 s66, 0
  buffer_load_dwordx4 a[4:7], v2, s[56:59], s66 offen offset:1024 sc1
  s_mov_b32 s66, 0
  buffer_load_dwordx4 a[8:11], v2, s[56:59], s66 offen offset:2048 sc1
  s_mov_b32 s66, 0
  buffer_load_dwordx4 a[12:15], v2, s[56:59], s66 offen offset:3072 sc1
  s_mov_b32 s66, 4096
  buffer_load_dwordx4 a[16:19], v2, s[56:59], s66 offen offset:0 sc1
  s_mov_b32 s66, 4096
  buffer_load_dwordx4 a[20:23], v2, s[56:59], s66 offen offset:1024 sc1
  s_barrier
  ds_read_b64_tr_b16 a[192:193], v22 offset:12288
  ds_read_b64_tr_b16 a[194:195], v22 offset:13824
  ds_read_b64_tr_b16 a[196:197], v22 offset:18432
  ds_read_b64_tr_b16 a[198:199], v22 offset:19968
  ds_read_b64_tr_b16 a[200:201], v22 offset:12352
  ds_read_b64_tr_b16 a[202:203], v22 offset:13888
  ds_read_b64_tr_b16 a[204:205], v22 offset:18496
  ds_read_b64_tr_b16 a[206:207], v22 offset:20032
  ds_read_b64_tr_b16 a[208:209], v22 offset:12416
  ds_read_b64_tr_b16 a[210:211], v22 offset:13952
  ds_read_b64_tr_b16 a[212:213], v22 offset:18560
  ds_read_b64_tr_b16 a[214:215], v22 offset:20096
  ds_read_b64_tr_b16 a[216:217], v22 offset:15360
  ds_read_b64_tr_b16 a[218:219], v22 offset:16896
  s_waitcnt vmcnt(5)
  s_waitcnt lgkmcnt(12)
  v_mfma_f32_32x32x16_bf16 v[160:175], a[192:195], a[0:3], 0
  ds_read_b64_tr_b16 a[220:221], v22 offset:21504
  ds_read_b64_tr_b16 a[222:223], v22 offset:23040
  s_mov_b32 s66, 4096
  buffer_load_dwordx4 a[24:27], v2, s[56:59], s66 offen offset:2048 sc1
  s_waitcnt lgkmcnt(12)
  v_mfma_f32_32x32x16_bf16 v[208:223], a[196:199], a[0:3], 0
  ds_read_b64_tr_b16 a[192:193], v22 offset:15424
  ds_read_b64_tr_b16 a[194:195], v22 offset:16960
  s_waitcnt lgkmcnt(12)
  v_mfma_f32_32x32x16_bf16 v[176:191], a[200:203], a[0:3], 0
  ds_read_b64_tr_b16 a[196:197], v22 offset:21568
  ds_read_b64_tr_b16 a[198:199], v22 offset:23104
  s_mov_b32 s66, 4096
  buffer_load_dwordx4 a[28:31], v2, s[56:59], s66 offen offset:3072 sc1
  s_waitcnt lgkmcnt(12)
  v_mfma_f32_32x32x16_bf16 v[224:239], a[204:207], a[0:3], 0
  ds_read_b64_tr_b16 a[200:201], v22 offset:15488
  ds_read_b64_tr_b16 a[202:203], v22 offset:17024
  s_waitcnt lgkmcnt(12)
  v_mfma_f32_32x32x16_bf16 v[192:207], a[208:211], a[0:3], 0
  ds_read_b64_tr_b16 a[204:205], v22 offset:21632
  ds_read_b64_tr_b16 a[206:207], v22 offset:23168
  s_mov_b32 s66, 8192
  buffer_load_dwordx4 a[32:35], v2, s[56:59], s66 offen offset:0 sc1
  s_waitcnt lgkmcnt(12)
  v_mfma_f32_32x32x16_bf16 v[240:255], a[212:215], a[0:3], 0
  ds_read_b64_tr_b16 a[208:209], v22 offset:24576
  ds_read_b64_tr_b16 a[210:211], v22 offset:26112
  s_waitcnt vmcnt(7)
  s_waitcnt lgkmcnt(12)
  v_mfma_f32_32x32x16_bf16 v[160:175], a[216:219], a[4:7], v[160:175]
  ds_read_b64_tr_b16 a[212:213], v22 offset:30720
  ds_read_b64_tr_b16 a[214:215], v22 offset:32256
  s_mov_b32 s66, 8192
  buffer_load_dwordx4 a[36:39], v2, s[56:59], s66 offen offset:1024 sc1
  s_waitcnt lgkmcnt(12)
  v_mfma_f32_32x32x16_bf16 v[208:223], a[220:223], a[4:7], v[208:223]
  ds_read_b64_tr_b16 a[216:217], v22 offset:24640
  ds_read_b64_tr_b16 a[218:219], v22 offset:26176
  s_waitcnt lgkmcnt(12)
  v_mfma_f32_32x32x16_bf16 v[176:191], a[192:195], a[4:7], v[176:191]
  ds_read_b64_tr_b16 a[220:221], v22 offset:30784
  ds_read_b64_tr_b16 a[222:223], v22 offset:32320
  s_mov_b32 s66, 8192
  buffer_load_dwordx4 a[40:43], v2, s[56:59], s66 offen offset:2048 sc1
  s_waitcnt lgkmcnt(12)
  v_mfma_f32_32x32x16_bf16 v[224:239], a[196:199], a[4:7], v[224:239]
  ds_read_b64_tr_b16 a[192:193], v22 offset:24704
  ds_read_b64_tr_b16 a[194:195], v22 offset:26240
  s_waitcnt lgkmcnt(12)
  v_mfma_f32_32x32x16_bf16 v[192:207], a[200:203], a[4:7], v[192:207]
  ds_read_b64_tr_b16 a[196:197], v22 offset:30848
  ds_read_b64_tr_b16 a[198:199], v22 offset:32384
  s_mov_b32 s66, 8192
  buffer_load_dwordx4 a[44:47], v2, s[56:59], s66 offen offset:3072 sc1
  s_waitcnt lgkmcnt(12)
  v_mfma_f32_32x32x16_bf16 v[240:255], a[204:207], a[4:7], v[240:255]
  ds_read_b64_tr_b16 a[200:201], v22 offset:27648
  ds_read_b64_tr_b16 a[202:203], v22 offset:29184
  s_waitcnt vmcnt(9)
  s_waitcnt lgkmcnt(12)
  v_mfma_f32_32x32x16_bf16 v[160:175], a[208:211], a[8:11], v[160:175]
  ds_read_b64_tr_b16 a[204:205], v22 offset:33792
  ds_read_b64_tr_b16 a[206:207], v22 offset:35328
  s_and_b32 s60, s35, 7
  s_mul_i32 s62, s60, 160
  s_mul_i32 s63, s30, 491520
  s_add_u32 s62, s62, s63
  s_sub_u32 s63, 1966080, s62
  s_add_u32 s44, s20, s62
  s_addc_u32 s45, s21, 0
  s_mov_b32 s46, s63
  s_mov_b32 s47, 0x20000
  s_mov_b32 s66, 12288
  buffer_load_dwordx4 a[48:51], v2, s[56:59], s66 offen offset:0 sc1
  s_waitcnt lgkmcnt(12)
  v_mfma_f32_32x32x16_bf16 v[208:223], a[212:215], a[8:11], v[208:223]
  ds_read_b64_tr_b16 a[208:209], v22 offset:27712
  ds_read_b64_tr_b16 a[210:211], v22 offset:29248
  v_mov_b32 v28, 2130706432
  s_waitcnt lgkmcnt(12)
  v_mfma_f32_32x32x16_bf16 v[176:191], a[216:219], a[8:11], v[176:191]
  ds_read_b64_tr_b16 a[212:213], v22 offset:33856
  ds_read_b64_tr_b16 a[214:215], v22 offset:35392
  v_add_u32 v24, 0, v1
  s_mov_b32 s66, 12288
  buffer_load_dwordx4 a[52:55], v2, s[56:59], s66 offen offset:1024 sc1
  s_waitcnt lgkmcnt(12)
  v_mfma_f32_32x32x16_bf16 v[224:239], a[220:223], a[8:11], v[224:239]
  ds_read_b64_tr_b16 a[216:217], v22 offset:27776
  ds_read_b64_tr_b16 a[218:219], v22 offset:29312
  v_mul_u32_u24 v25, 6554, v24
  s_waitcnt lgkmcnt(12)
  v_mfma_f32_32x32x16_bf16 v[192:207], a[192:195], a[8:11], v[192:207]
  ds_read_b64_tr_b16 a[220:221], v22 offset:33920
  ds_read_b64_tr_b16 a[222:223], v22 offset:35456
  v_lshrrev_b32 v25, 16, v25
  s_mov_b32 s66, 12288
  buffer_load_dwordx4 a[56:59], v2, s[56:59], s66 offen offset:2048 sc1
  s_waitcnt lgkmcnt(12)
  v_mfma_f32_32x32x16_bf16 v[240:255], a[196:199], a[8:11], v[240:255]
  s_barrier
  ds_read_b64_tr_b16 a[192:193], v20 offset:0
  ds_read_b64_tr_b16 a[194:195], v20 offset:1536
  v_mul_u32_u24 v26, 10, v25
  s_waitcnt vmcnt(11)
  s_waitcnt lgkmcnt(12)
  v_mfma_f32_32x32x16_bf16 v[160:175], a[200:203], a[12:15], v[160:175]
  ds_read_b64_tr_b16 a[196:197], v20 offset:6144
  ds_read_b64_tr_b16 a[198:199], v20 offset:7680
  v_sub_u32 v26, v24, v26
  s_mov_b32 s66, 12288
  buffer_load_dwordx4 a[60:63], v2, s[56:59], s66 offen offset:3072 sc1
  s_waitcnt lgkmcnt(12)
  v_mfma_f32_32x32x16_bf16 v[208:223], a[204:207], a[12:15], v[208:223]
  ds_read_b64_tr_b16 a[200:201], v20 offset:64
  ds_read_b64_tr_b16 a[202:203], v20 offset:1600
  v_mul_u32_u24 v27, 1280, v25
  s_waitcnt lgkmcnt(12)
  v_mfma_f32_32x32x16_bf16 v[176:191], a[208:211], a[12:15], v[176:191]
  ds_read_b64_tr_b16 a[204:205], v20 offset:6208
  ds_read_b64_tr_b16 a[206:207], v20 offset:7744
  v_lshl_add_u32 v27, v26, 4, v27
  s_mov_b32 s66, 16384
  buffer_load_dwordx4 a[64:67], v2, s[56:59], s66 offen offset:0 sc1
  s_waitcnt lgkmcnt(12)
  v_mfma_f32_32x32x16_bf16 v[224:239], a[212:215], a[12:15], v[224:239]
  ds_read_b64_tr_b16 a[208:209], v20 offset:128
  ds_read_b64_tr_b16 a[210:211], v20 offset:1664
  s_waitcnt lgkmcnt(12)
  v_mfma_f32_32x32x16_bf16 v[192:207], a[216:219], a[12:15], v[192:207]
  ds_read_b64_tr_b16 a[212:213], v20 offset:6272
  ds_read_b64_tr_b16 a[214:215], v20 offset:7808
  v_subrev_u32 v4, 0, v27
  s_mov_b32 s66, 16384
  buffer_load_dwordx4 a[68:71], v2, s[56:59], s66 offen offset:1024 sc1
  s_waitcnt lgkmcnt(12)
  v_mfma_f32_32x32x16_bf16 v[240:255], a[220:223], a[12:15], v[240:255]
  ds_read_b64_tr_b16 a[216:217], v20 offset:3072
  ds_read_b64_tr_b16 a[218:219], v20 offset:4608
  v_add_u32 v24, 64, v1
  s_waitcnt vmcnt(13)
  s_waitcnt lgkmcnt(12)
  v_mfma_f32_32x32x16_bf16 v[160:175], a[192:195], a[16:19], v[160:175]
  ds_read_b64_tr_b16 a[220:221], v20 offset:9216
  ds_read_b64_tr_b16 a[222:223], v20 offset:10752
  v_mul_u32_u24 v25, 6554, v24
  s_mov_b32 s66, 16384
  buffer_load_dwordx4 a[72:75], v2, s[56:59], s66 offen offset:2048 sc1
  s_waitcnt lgkmcnt(12)
  v_mfma_f32_32x32x16_bf16 v[208:223], a[196:199], a[16:19], v[208:223]
  ds_read_b64_tr_b16 a[192:193], v20 offset:3136
  ds_read_b64_tr_b16 a[194:195], v20 offset:4672
  v_lshrrev_b32 v25, 16, v25
  s_waitcnt lgkmcnt(12)
  v_mfma_f32_32x32x16_bf16 v[176:191], a[200:203], a[16:19], v[176:191]
  ds_read_b64_tr_b16 a[196:197], v20 offset:9280
  ds_read_b64_tr_b16 a[198:199], v20 offset:10816
  v_mul_u32_u24 v26, 10, v25
  s_mov_b32 s66, 16384
  buffer_load_dwordx4 a[76:79], v2, s[56:59], s66 offen offset:3072 sc1
  s_waitcnt lgkmcnt(12)
  v_mfma_f32_32x32x16_bf16 v[224:239], a[204:207], a[16:19], v[224:239]
  ds_read_b64_tr_b16 a[200:201], v20 offset:3200
  ds_read_b64_tr_b16 a[202:203], v20 offset:4736
  v_sub_u32 v26, v24, v26
  s_waitcnt lgkmcnt(12)
  v_mfma_f32_32x32x16_bf16 v[192:207], a[208:211], a[16:19], v[192:207]
  ds_read_b64_tr_b16 a[204:205], v20 offset:9344
  ds_read_b64_tr_b16 a[206:207], v20 offset:10880
  v_mul_u32_u24 v27, 1280, v25
  s_mov_b32 s66, 20480
  buffer_load_dwordx4 a[80:83], v2, s[56:59], s66 offen offset:0 sc1
  s_waitcnt lgkmcnt(12)
  v_mfma_f32_32x32x16_bf16 v[240:255], a[212:215], a[16:19], v[240:255]
  ds_read_b64_tr_b16 a[208:209], v20 offset:12288
  ds_read_b64_tr_b16 a[210:211], v20 offset:13824
  v_lshl_add_u32 v27, v26, 4, v27
  s_waitcnt vmcnt(15)
  s_waitcnt lgkmcnt(12)
  v_mfma_f32_32x32x16_bf16 v[160:175], a[216:219], a[20:23], v[160:175]
  ds_read_b64_tr_b16 a[212:213], v20 offset:18432
  ds_read_b64_tr_b16 a[214:215], v20 offset:19968
  v_subrev_u32 v5, 1024, v27
  s_mov_b32 s66, 20480
  buffer_load_dwordx4 a[84:87], v2, s[56:59], s66 offen offset:1024 sc1
  s_waitcnt lgkmcnt(12)
  v_mfma_f32_32x32x16_bf16 v[208:223], a[220:223], a[20:23], v[208:223]
  ds_read_b64_tr_b16 a[216:217], v20 offset:12352
  ds_read_b64_tr_b16 a[218:219], v20 offset:13888
  s_waitcnt lgkmcnt(12)
  v_mfma_f32_32x32x16_bf16 v[176:191], a[192:195], a[20:23], v[176:191]
  ds_read_b64_tr_b16 a[220:221], v20 offset:18496
  ds_read_b64_tr_b16 a[222:223], v20 offset:20032
  v_add_u32 v24, 128, v1
  s_mov_b32 s66, 20480
  buffer_load_dwordx4 a[88:91], v2, s[56:59], s66 offen offset:2048 sc1
  s_waitcnt lgkmcnt(12)
  v_mfma_f32_32x32x16_bf16 v[224:239], a[196:199], a[20:23], v[224:239]
  ds_read_b64_tr_b16 a[192:193], v20 offset:12416
  ds_read_b64_tr_b16 a[194:195], v20 offset:13952
  v_mul_u32_u24 v25, 6554, v24
  s_waitcnt lgkmcnt(12)
  v_mfma_f32_32x32x16_bf16 v[192:207], a[200:203], a[20:23], v[192:207]
  ds_read_b64_tr_b16 a[196:197], v20 offset:18560
  ds_read_b64_tr_b16 a[198:199], v20 offset:20096
  v_lshrrev_b32 v25, 16, v25
  s_mov_b32 s66, 20480
  buffer_load_dwordx4 a[92:95], v2, s[56:59], s66 offen offset:3072 sc1
  s_waitcnt lgkmcnt(12)
  v_mfma_f32_32x32x16_bf16 v[240:255], a[204:207], a[20:23], v[240:255]
  ds_read_b64_tr_b16 a[200:201], v20 offset:15360
  ds_read_b64_tr_b16 a[202:203], v20 offset:16896
  v_mul_u32_u24 v26, 10, v25
  s_waitcnt vmcnt(17)
  s_waitcnt lgkmcnt(12)
  v_mfma_f32_32x32x16_bf16 v[160:175], a[208:211], a[24:27], v[160:175]
  ds_read_b64_tr_b16 a[204:205], v20 offset:21504
  ds_read_b64_tr_b16 a[206:207], v20 offset:23040
  v_sub_u32 v26, v24, v26
  s_mov_b32 s66, 24576
  buffer_load_dwordx4 a[96:99], v2, s[56:59], s66 offen offset:0 sc1
  s_waitcnt lgkmcnt(12)
  v_mfma_f32_32x32x16_bf16 v[208:223], a[212:215], a[24:27], v[208:223]
  ds_read_b64_tr_b16 a[208:209], v20 offset:15424
  ds_read_b64_tr_b16 a[210:211], v20 offset:16960
  v_mul_u32_u24 v27, 1280, v25
  s_waitcnt lgkmcnt(12)
  v_mfma_f32_32x32x16_bf16 v[176:191], a[216:219], a[24:27], v[176:191]
  ds_read_b64_tr_b16 a[212:213], v20 offset:21568
  ds_read_b64_tr_b16 a[214:215], v20 offset:23104
  v_lshl_add_u32 v27, v26, 4, v27
  s_mov_b32 s66, 24576
  buffer_load_dwordx4 a[100:103], v2, s[56:59], s66 offen offset:1024 sc1
  s_waitcnt lgkmcnt(12)
  v_mfma_f32_32x32x16_bf16 v[224:239], a[220:223], a[24:27], v[224:239]
  ds_read_b64_tr_b16 a[216:217], v20 offset:15488
  ds_read_b64_tr_b16 a[218:219], v20 offset:17024
  v_subrev_u32 v27, 2048, v27
  s_waitcnt lgkmcnt(12)
  v_mfma_f32_32x32x16_bf16 v[192:207], a[192:195], a[24:27], v[192:207]
  ds_read_b64_tr_b16 a[220:221], v20 offset:21632
  ds_read_b64_tr_b16 a[222:223], v20 offset:23168
  s_mov_b32 s66, 24576
  buffer_load_dwordx4 a[104:107], v2, s[56:59], s66 offen offset:2048 sc1
  s_waitcnt lgkmcnt(12)
  v_mfma_f32_32x32x16_bf16 v[240:255], a[196:199], a[24:27], v[240:255]
  s_barrier
  ds_read_b64_tr_b16 a[192:193], v20 offset:24576
  ds_read_b64_tr_b16 a[194:195], v20 offset:26112
  v_cmp_gt_u32 vcc, 160, v24
  s_nop 1
  s_waitcnt vmcnt(19)
  s_waitcnt lgkmcnt(12)
  v_mfma_f32_32x32x16_bf16 v[160:175], a[200:203], a[28:31], v[160:175]
  ds_read_b64_tr_b16 a[196:197], v20 offset:30720
  ds_read_b64_tr_b16 a[198:199], v20 offset:32256
  v_cndmask_b32 v6, v28, v27, vcc
  s_mov_b32 s67, 1277952
  s_add_u32 m0, s68, 135168
  s_nop 0
  buffer_load_dwordx4 v16, s[48:51], s67 offen offset:0 lds
  s_mov_b32 s66, 24576
  buffer_load_dwordx4 a[108:111], v2, s[56:59], s66 offen offset:3072 sc1
  s_waitcnt lgkmcnt(12)
  v_mfma_f32_32x32x16_bf16 v[208:223], a[204:207], a[28:31], v[208:223]
  ds_read_b64_tr_b16 a[200:201], v20 offset:24640
  ds_read_b64_tr_b16 a[202:203], v20 offset:26176
  v_lshrrev_b32 v24, 5, v1
  buffer_load_dwordx4 v17, s[48:51], s67 offen offset:1024 lds
  s_waitcnt lgkmcnt(12)
  v_mfma_f32_32x32x16_bf16 v[176:191], a[208:211], a[28:31], v[176:191]
  ds_read_b64_tr_b16 a[204:205], v20 offset:30784
  ds_read_b64_tr_b16 a[206:207], v20 offset:32320
  v_bfe_u32 v25, v1, 4, 1
  buffer_load_dwordx4 v18, s[48:51], s67 offen offset:2048 lds
  s_mov_b32 s66, 28672
  buffer_load_dwordx4 a[112:115], v2, s[56:59], s66 offen offset:0 sc1
  s_waitcnt lgkmcnt(12)
  v_mfma_f32_32x32x16_bf16 v[224:239], a[212:215], a[28:31], v[224:239]
  ds_read_b64_tr_b16 a[208:209], v20 offset:24704
  ds_read_b64_tr_b16 a[210:211], v20 offset:26240
  s_mov_b32 s67, 1376256
  s_add_u32 m0, s68, 147456
  s_nop 0
  buffer_load_dwordx4 v16, s[48:51], s67 offen offset:0 lds
  s_waitcnt lgkmcnt(12)
  v_mfma_f32_32x32x16_bf16 v[192:207], a[216:219], a[28:31], v[192:207]
  ds_read_b64_tr_b16 a[212:213], v20 offset:30848
  ds_read_b64_tr_b16 a[214:215], v20 offset:32384
  v_bfe_u32 v26, v1, 2, 2
  buffer_load_dwordx4 v17, s[48:51], s67 offen offset:1024 lds
  s_mov_b32 s66, 28672
  buffer_load_dwordx4 a[116:119], v2, s[56:59], s66 offen offset:1024 sc1
  s_waitcnt lgkmcnt(12)
  v_mfma_f32_32x32x16_bf16 v[240:255], a[220:223], a[28:31], v[240:255]
  ds_read_b64_tr_b16 a[216:217], v20 offset:27648
  ds_read_b64_tr_b16 a[218:219], v20 offset:29184
  v_and_b32 v27, 3, v1
  buffer_load_dwordx4 v18, s[48:51], s67 offen offset:2048 lds
  s_waitcnt vmcnt(27)
  s_waitcnt lgkmcnt(12)
  v_mfma_f32_32x32x16_bf16 v[160:175], a[192:195], a[32:35], v[160:175]
  ds_read_b64_tr_b16 a[220:221], v20 offset:33792
  ds_read_b64_tr_b16 a[222:223], v20 offset:35328
  v_lshl_add_u32 v25, v25, 2, v26
  s_mov_b32 s66, 28672
  buffer_load_dwordx4 a[120:123], v2, s[56:59], s66 offen offset:2048 sc1
  s_waitcnt lgkmcnt(12)
  v_mfma_f32_32x32x16_bf16 v[208:223], a[196:199], a[32:35], v[208:223]
  ds_read_b64_tr_b16 a[192:193], v20 offset:27712
  ds_read_b64_tr_b16 a[194:195], v20 offset:29248
  v_mul_u32_u24 v25, 160, v25
  s_waitcnt lgkmcnt(12)
  v_mfma_f32_32x32x16_bf16 v[176:191], a[200:203], a[32:35], v[176:191]
  ds_read_b64_tr_b16 a[196:197], v20 offset:33856
  ds_read_b64_tr_b16 a[198:199], v20 offset:35392
  v_lshl_add_u32 v25, v27, 3, v25
  s_mov_b32 s66, 28672
  buffer_load_dwordx4 a[124:127], v2, s[56:59], s66 offen offset:3072 sc1
  s_waitcnt lgkmcnt(12)
  v_mfma_f32_32x32x16_bf16 v[224:239], a[204:207], a[32:35], v[224:239]
  ds_read_b64_tr_b16 a[200:201], v20 offset:27776
  ds_read_b64_tr_b16 a[202:203], v20 offset:29312
  v_add_u32 v25, s68, v25
  s_waitcnt lgkmcnt(12)
  v_mfma_f32_32x32x16_bf16 v[192:207], a[208:211], a[32:35], v[192:207]
  ds_read_b64_tr_b16 a[204:205], v20 offset:33920
  ds_read_b64_tr_b16 a[206:207], v20 offset:35456
  v_mul_u32_u24 v26, 12288, v24
  s_mov_b32 s66, 32768
  buffer_load_dwordx4 a[128:131], v2, s[56:59], s66 offen offset:0 sc1
  s_waitcnt lgkmcnt(12)
  v_mfma_f32_32x32x16_bf16 v[240:255], a[212:215], a[32:35], v[240:255]
  ds_read_b64_tr_b16 a[208:209], v20 offset:36864
  ds_read_b64_tr_b16 a[210:211], v20 offset:38400
  v_add_u32 v7, v25, v26
  s_waitcnt vmcnt(29)
  s_waitcnt lgkmcnt(12)
  v_mfma_f32_32x32x16_bf16 v[160:175], a[216:219], a[36:39], v[160:175]
  ds_read_b64_tr_b16 a[212:213], v20 offset:43008
  ds_read_b64_tr_b16 a[214:215], v20 offset:44544
  v_add_u32 v8, 61440, v7
  s_mov_b32 s66, 32768
  buffer_load_dwordx4 a[132:135], v2, s[56:59], s66 offen offset:1024 sc1
  s_waitcnt lgkmcnt(12)
  v_mfma_f32_32x32x16_bf16 v[208:223], a[220:223], a[36:39], v[208:223]
  ds_read_b64_tr_b16 a[216:217], v20 offset:36928
  ds_read_b64_tr_b16 a[218:219], v20 offset:38464
  s_waitcnt lgkmcnt(12)
  v_mfma_f32_32x32x16_bf16 v[176:191], a[192:195], a[36:39], v[176:191]
  ds_read_b64_tr_b16 a[220:221], v20 offset:43072
  ds_read_b64_tr_b16 a[222:223], v20 offset:44608
  v_add_u32 v9, 122880, v7
  s_mov_b32 s66, 32768
  buffer_load_dwordx4 a[136:139], v2, s[56:59], s66 offen offset:2048 sc1
  s_waitcnt lgkmcnt(12)
  v_mfma_f32_32x32x16_bf16 v[224:239], a[196:199], a[36:39], v[224:239]
  ds_read_b64_tr_b16 a[192:193], v20 offset:36992
  ds_read_b64_tr_b16 a[194:195], v20 offset:38528
  v_xor_b32 v24, 1, v24
  s_waitcnt lgkmcnt(12)
  v_mfma_f32_32x32x16_bf16 v[192:207], a[200:203], a[36:39], v[192:207]
  ds_read_b64_tr_b16 a[196:197], v20 offset:43136
  ds_read_b64_tr_b16 a[198:199], v20 offset:44672
  v_mul_u32_u24 v26, 147456, v24
  s_mov_b32 s66, 32768
  buffer_load_dwordx4 a[140:143], v2, s[56:59], s66 offen offset:3072 sc1
  s_waitcnt lgkmcnt(12)
  v_mfma_f32_32x32x16_bf16 v[240:255], a[204:207], a[36:39], v[240:255]
  ds_read_b64_tr_b16 a[200:201], v20 offset:39936
  ds_read_b64_tr_b16 a[202:203], v20 offset:41472
  v_add_u32 v10, v25, v26
  s_waitcnt vmcnt(31)
  s_waitcnt lgkmcnt(12)
  v_mfma_f32_32x32x16_bf16 v[160:175], a[208:211], a[40:43], v[160:175]
  ds_read_b64_tr_b16 a[204:205], v20 offset:46080
  ds_read_b64_tr_b16 a[206:207], v20 offset:47616
  s_mov_b32 s66, 36864
  buffer_load_dwordx4 a[144:147], v2, s[56:59], s66 offen offset:0 sc1
  s_waitcnt lgkmcnt(12)
  v_mfma_f32_32x32x16_bf16 v[208:223], a[212:215], a[40:43], v[208:223]
  ds_read_b64_tr_b16 a[208:209], v20 offset:40000
  ds_read_b64_tr_b16 a[210:211], v20 offset:41536
  s_waitcnt lgkmcnt(12)
  v_mfma_f32_32x32x16_bf16 v[176:191], a[216:219], a[40:43], v[176:191]
  ds_read_b64_tr_b16 a[212:213], v20 offset:46144
  ds_read_b64_tr_b16 a[214:215], v20 offset:47680
  s_mov_b32 s66, 36864
  buffer_load_dwordx4 a[148:151], v2, s[56:59], s66 offen offset:1024 sc1
  s_waitcnt lgkmcnt(12)
  v_mfma_f32_32x32x16_bf16 v[224:239], a[220:223], a[40:43], v[224:239]
  ds_read_b64_tr_b16 a[216:217], v20 offset:40064
  ds_read_b64_tr_b16 a[218:219], v20 offset:41600
  s_waitcnt lgkmcnt(12)
  v_mfma_f32_32x32x16_bf16 v[192:207], a[192:195], a[40:43], v[192:207]
  ds_read_b64_tr_b16 a[220:221], v20 offset:46208
  ds_read_b64_tr_b16 a[222:223], v20 offset:47744
  s_mov_b32 s66, 36864
  buffer_load_dwordx4 a[152:155], v2, s[56:59], s66 offen offset:2048 sc1
  s_waitcnt lgkmcnt(12)
  v_mfma_f32_32x32x16_bf16 v[240:255], a[196:199], a[40:43], v[240:255]
  s_barrier
  ds_read_b64_tr_b16 a[192:193], v20 offset:49152
  ds_read_b64_tr_b16 a[194:195], v20 offset:50688
  s_waitcnt vmcnt(33)
  s_waitcnt lgkmcnt(12)
  v_mfma_f32_32x32x16_bf16 v[160:175], a[200:203], a[44:47], v[160:175]
  ds_read_b64_tr_b16 a[196:197], v20 offset:55296
  ds_read_b64_tr_b16 a[198:199], v20 offset:56832
  s_mov_b32 s67, 1474560
  s_add_u32 m0, s68, 0
  s_nop 0
  buffer_load_dwordx4 v16, s[48:51], s67 offen offset:0 lds
  s_mov_b32 s66, 36864
  buffer_load_dwordx4 a[156:159], v2, s[56:59], s66 offen offset:3072 sc1
  s_waitcnt lgkmcnt(12)
  v_mfma_f32_32x32x16_bf16 v[208:223], a[204:207], a[44:47], v[208:223]
  ds_read_b64_tr_b16 a[200:201], v20 offset:49216
  ds_read_b64_tr_b16 a[202:203], v20 offset:50752
  buffer_load_dwordx4 v17, s[48:51], s67 offen offset:1024 lds
  s_waitcnt lgkmcnt(12)
  v_mfma_f32_32x32x16_bf16 v[176:191], a[208:211], a[44:47], v[176:191]
  ds_read_b64_tr_b16 a[204:205], v20 offset:55360
  ds_read_b64_tr_b16 a[206:207], v20 offset:56896
  buffer_load_dwordx4 v18, s[48:51], s67 offen offset:2048 lds
  s_waitcnt lgkmcnt(12)
  v_mfma_f32_32x32x16_bf16 v[224:239], a[212:215], a[44:47], v[224:239]
  ds_read_b64_tr_b16 a[208:209], v20 offset:49280
  ds_read_b64_tr_b16 a[210:211], v20 offset:50816
  s_mov_b32 s67, 1572864
  s_add_u32 m0, s68, 12288
  s_nop 0
  buffer_load_dwordx4 v16, s[48:51], s67 offen offset:0 lds
  s_waitcnt lgkmcnt(12)
  v_mfma_f32_32x32x16_bf16 v[192:207], a[216:219], a[44:47], v[192:207]
  ds_read_b64_tr_b16 a[212:213], v20 offset:55424
  ds_read_b64_tr_b16 a[214:215], v20 offset:56960
  buffer_load_dwordx4 v17, s[48:51], s67 offen offset:1024 lds
  s_waitcnt lgkmcnt(12)
  v_mfma_f32_32x32x16_bf16 v[240:255], a[220:223], a[44:47], v[240:255]
  ds_read_b64_tr_b16 a[216:217], v20 offset:52224
  ds_read_b64_tr_b16 a[218:219], v20 offset:53760
  buffer_load_dwordx4 v18, s[48:51], s67 offen offset:2048 lds
  s_waitcnt vmcnt(39)
  s_waitcnt lgkmcnt(12)
  v_mfma_f32_32x32x16_bf16 v[160:175], a[192:195], a[48:51], v[160:175]
  ds_read_b64_tr_b16 a[220:221], v20 offset:58368
  ds_read_b64_tr_b16 a[222:223], v20 offset:59904
  s_waitcnt lgkmcnt(12)
  v_mfma_f32_32x32x16_bf16 v[208:223], a[196:199], a[48:51], v[208:223]
  ds_read_b64_tr_b16 a[192:193], v20 offset:52288
  ds_read_b64_tr_b16 a[194:195], v20 offset:53824
  s_waitcnt lgkmcnt(12)
  v_mfma_f32_32x32x16_bf16 v[176:191], a[200:203], a[48:51], v[176:191]
  ds_read_b64_tr_b16 a[196:197], v20 offset:58432
  ds_read_b64_tr_b16 a[198:199], v20 offset:59968
  s_waitcnt lgkmcnt(12)
  v_mfma_f32_32x32x16_bf16 v[224:239], a[204:207], a[48:51], v[224:239]
  ds_read_b64_tr_b16 a[200:201], v20 offset:52352
  ds_read_b64_tr_b16 a[202:203], v20 offset:53888
  s_waitcnt lgkmcnt(12)
  v_mfma_f32_32x32x16_bf16 v[192:207], a[208:211], a[48:51], v[192:207]
  ds_read_b64_tr_b16 a[204:205], v20 offset:58496
  ds_read_b64_tr_b16 a[206:207], v20 offset:60032
  s_waitcnt lgkmcnt(12)
  v_mfma_f32_32x32x16_bf16 v[240:255], a[212:215], a[48:51], v[240:255]
  ds_read_b64_tr_b16 a[208:209], v21 offset:0
  ds_read_b64_tr_b16 a[210:211], v21 offset:1536
  s_waitcnt vmcnt(38)
  s_waitcnt lgkmcnt(12)
  v_mfma_f32_32x32x16_bf16 v[160:175], a[216:219], a[52:55], v[160:175]
  ds_read_b64_tr_b16 a[212:213], v21 offset:6144
  ds_read_b64_tr_b16 a[214:215], v21 offset:7680
  s_waitcnt lgkmcnt(12)
  v_mfma_f32_32x32x16_bf16 v[208:223], a[220:223], a[52:55], v[208:223]
  ds_read_b64_tr_b16 a[216:217], v21 offset:64
  ds_read_b64_tr_b16 a[218:219], v21 offset:1600
  s_waitcnt lgkmcnt(12)
  v_mfma_f32_32x32x16_bf16 v[176:191], a[192:195], a[52:55], v[176:191]
  ds_read_b64_tr_b16 a[220:221], v21 offset:6208
  ds_read_b64_tr_b16 a[222:223], v21 offset:7744
  s_waitcnt lgkmcnt(12)
  v_mfma_f32_32x32x16_bf16 v[224:239], a[196:199], a[52:55], v[224:239]
  ds_read_b64_tr_b16 a[192:193], v21 offset:128
  ds_read_b64_tr_b16 a[194:195], v21 offset:1664
  s_waitcnt lgkmcnt(12)
  v_mfma_f32_32x32x16_bf16 v[192:207], a[200:203], a[52:55], v[192:207]
  ds_read_b64_tr_b16 a[196:197], v21 offset:6272
  ds_read_b64_tr_b16 a[198:199], v21 offset:7808
  s_waitcnt lgkmcnt(12)
  v_mfma_f32_32x32x16_bf16 v[240:255], a[204:207], a[52:55], v[240:255]
  ds_read_b64_tr_b16 a[200:201], v21 offset:3072
  ds_read_b64_tr_b16 a[202:203], v21 offset:4608
  s_waitcnt vmcnt(37)
  s_waitcnt lgkmcnt(12)
  v_mfma_f32_32x32x16_bf16 v[160:175], a[208:211], a[56:59], v[160:175]
  ds_read_b64_tr_b16 a[204:205], v21 offset:9216
  ds_read_b64_tr_b16 a[206:207], v21 offset:10752
  s_waitcnt lgkmcnt(12)
  v_mfma_f32_32x32x16_bf16 v[208:223], a[212:215], a[56:59], v[208:223]
  ds_read_b64_tr_b16 a[208:209], v21 offset:3136
  ds_read_b64_tr_b16 a[210:211], v21 offset:4672
  s_waitcnt lgkmcnt(12)
  v_mfma_f32_32x32x16_bf16 v[176:191], a[216:219], a[56:59], v[176:191]
  ds_read_b64_tr_b16 a[212:213], v21 offset:9280
  ds_read_b64_tr_b16 a[214:215], v21 offset:10816
  s_waitcnt lgkmcnt(12)
  v_mfma_f32_32x32x16_bf16 v[224:239], a[220:223], a[56:59], v[224:239]
  ds_read_b64_tr_b16 a[216:217], v21 offset:3200
  ds_read_b64_tr_b16 a[218:219], v21 offset:4736
  s_waitcnt lgkmcnt(12)
  v_mfma_f32_32x32x16_bf16 v[192:207], a[192:195], a[56:59], v[192:207]
  ds_read_b64_tr_b16 a[220:221], v21 offset:9344
  ds_read_b64_tr_b16 a[222:223], v21 offset:10880
  s_waitcnt lgkmcnt(12)
  v_mfma_f32_32x32x16_bf16 v[240:255], a[196:199], a[56:59], v[240:255]
  s_barrier
  ds_read_b64_tr_b16 a[192:193], v21 offset:12288
  ds_read_b64_tr_b16 a[194:195], v21 offset:13824
  s_waitcnt vmcnt(36)
  s_waitcnt lgkmcnt(12)
  v_mfma_f32_32x32x16_bf16 v[160:175], a[200:203], a[60:63], v[160:175]
  ds_read_b64_tr_b16 a[196:197], v21 offset:18432
  ds_read_b64_tr_b16 a[198:199], v21 offset:19968
  s_mov_b32 s67, 1671168
  s_add_u32 m0, s68, 24576
  s_nop 0
  buffer_load_dwordx4 v16, s[48:51], s67 offen offset:0 lds
  s_waitcnt lgkmcnt(12)
  v_mfma_f32_32x32x16_bf16 v[208:223], a[204:207], a[60:63], v[208:223]
  ds_read_b64_tr_b16 a[200:201], v21 offset:12352
  ds_read_b64_tr_b16 a[202:203], v21 offset:13888
  buffer_load_dwordx4 v17, s[48:51], s67 offen offset:1024 lds
  s_waitcnt lgkmcnt(12)
  v_mfma_f32_32x32x16_bf16 v[176:191], a[208:211], a[60:63], v[176:191]
  ds_read_b64_tr_b16 a[204:205], v21 offset:18496
  ds_read_b64_tr_b16 a[206:207], v21 offset:20032
  buffer_load_dwordx4 v18, s[48:51], s67 offen offset:2048 lds
  s_waitcnt lgkmcnt(12)
  v_mfma_f32_32x32x16_bf16 v[224:239], a[212:215], a[60:63], v[224:239]
  ds_read_b64_tr_b16 a[208:209], v21 offset:12416
  ds_read_b64_tr_b16 a[210:211], v21 offset:13952
  s_mov_b32 s67, 1769472
  s_add_u32 m0, s68, 36864
  s_nop 0
  buffer_load_dwordx4 v16, s[48:51], s67 offen offset:0 lds
  s_waitcnt lgkmcnt(12)
  v_mfma_f32_32x32x16_bf16 v[192:207], a[216:219], a[60:63], v[192:207]
  ds_read_b64_tr_b16 a[212:213], v21 offset:18560
  ds_read_b64_tr_b16 a[214:215], v21 offset:20096
  buffer_load_dwordx4 v17, s[48:51], s67 offen offset:1024 lds
  s_waitcnt lgkmcnt(12)
  v_mfma_f32_32x32x16_bf16 v[240:255], a[220:223], a[60:63], v[240:255]
  ds_read_b64_tr_b16 a[216:217], v21 offset:15360
  ds_read_b64_tr_b16 a[218:219], v21 offset:16896
  buffer_load_dwordx4 v18, s[48:51], s67 offen offset:2048 lds
  s_waitcnt vmcnt(41)
  s_waitcnt lgkmcnt(12)
  v_mfma_f32_32x32x16_bf16 v[160:175], a[192:195], a[64:67], v[160:175]
  ds_read_b64_tr_b16 a[220:221], v21 offset:21504
  ds_read_b64_tr_b16 a[222:223], v21 offset:23040
  s_waitcnt lgkmcnt(12)
  v_mfma_f32_32x32x16_bf16 v[208:223], a[196:199], a[64:67], v[208:223]
  ds_read_b64_tr_b16 a[192:193], v21 offset:15424
  ds_read_b64_tr_b16 a[194:195], v21 offset:16960
  s_waitcnt lgkmcnt(12)
  v_mfma_f32_32x32x16_bf16 v[176:191], a[200:203], a[64:67], v[176:191]
  ds_read_b64_tr_b16 a[196:197], v21 offset:21568
  ds_read_b64_tr_b16 a[198:199], v21 offset:23104
  s_waitcnt lgkmcnt(12)
  v_mfma_f32_32x32x16_bf16 v[224:239], a[204:207], a[64:67], v[224:239]
  ds_read_b64_tr_b16 a[200:201], v21 offset:15488
  ds_read_b64_tr_b16 a[202:203], v21 offset:17024
  s_waitcnt lgkmcnt(12)
  v_mfma_f32_32x32x16_bf16 v[192:207], a[208:211], a[64:67], v[192:207]
  ds_read_b64_tr_b16 a[204:205], v21 offset:21632
  ds_read_b64_tr_b16 a[206:207], v21 offset:23168
  s_waitcnt lgkmcnt(12)
  v_mfma_f32_32x32x16_bf16 v[240:255], a[212:215], a[64:67], v[240:255]
  ds_read_b64_tr_b16 a[208:209], v21 offset:24576
  ds_read_b64_tr_b16 a[210:211], v21 offset:26112
  s_waitcnt vmcnt(40)
  s_waitcnt lgkmcnt(12)
  v_mfma_f32_32x32x16_bf16 v[160:175], a[216:219], a[68:71], v[160:175]
  ds_read_b64_tr_b16 a[212:213], v21 offset:30720
  ds_read_b64_tr_b16 a[214:215], v21 offset:32256
  s_waitcnt lgkmcnt(12)
  v_mfma_f32_32x32x16_bf16 v[208:223], a[220:223], a[68:71], v[208:223]
  ds_read_b64_tr_b16 a[216:217], v21 offset:24640
  ds_read_b64_tr_b16 a[218:219], v21 offset:26176
  s_waitcnt lgkmcnt(12)
  v_mfma_f32_32x32x16_bf16 v[176:191], a[192:195], a[68:71], v[176:191]
  ds_read_b64_tr_b16 a[220:221], v21 offset:30784
  ds_read_b64_tr_b16 a[222:223], v21 offset:32320
  s_waitcnt lgkmcnt(12)
  v_mfma_f32_32x32x16_bf16 v[224:239], a[196:199], a[68:71], v[224:239]
  ds_read_b64_tr_b16 a[192:193], v21 offset:24704
  ds_read_b64_tr_b16 a[194:195], v21 offset:26240
  s_waitcnt lgkmcnt(12)
  v_mfma_f32_32x32x16_bf16 v[192:207], a[200:203], a[68:71], v[192:207]
  ds_read_b64_tr_b16 a[196:197], v21 offset:30848
  ds_read_b64_tr_b16 a[198:199], v21 offset:32384
  s_waitcnt lgkmcnt(12)
  v_mfma_f32_32x32x16_bf16 v[240:255], a[204:207], a[68:71], v[240:255]
  ds_read_b64_tr_b16 a[200:201], v21 offset:27648
  ds_read_b64_tr_b16 a[202:203], v21 offset:29184
  s_waitcnt vmcnt(39)
  s_waitcnt lgkmcnt(12)
  v_mfma_f32_32x32x16_bf16 v[160:175], a[208:211], a[72:75], v[160:175]
  ds_read_b64_tr_b16 a[204:205], v21 offset:33792
  ds_read_b64_tr_b16 a[206:207], v21 offset:35328
  s_waitcnt lgkmcnt(12)
  v_mfma_f32_32x32x16_bf16 v[208:223], a[212:215], a[72:75], v[208:223]
  ds_read_b64_tr_b16 a[208:209], v21 offset:27712
  ds_read_b64_tr_b16 a[210:211], v21 offset:29248
  s_waitcnt lgkmcnt(12)
  v_mfma_f32_32x32x16_bf16 v[176:191], a[216:219], a[72:75], v[176:191]
  ds_read_b64_tr_b16 a[212:213], v21 offset:33856
  ds_read_b64_tr_b16 a[214:215], v21 offset:35392
  s_waitcnt lgkmcnt(12)
  v_mfma_f32_32x32x16_bf16 v[224:239], a[220:223], a[72:75], v[224:239]
  ds_read_b64_tr_b16 a[216:217], v21 offset:27776
  ds_read_b64_tr_b16 a[218:219], v21 offset:29312
  s_waitcnt lgkmcnt(12)
  v_mfma_f32_32x32x16_bf16 v[192:207], a[192:195], a[72:75], v[192:207]
  ds_read_b64_tr_b16 a[220:221], v21 offset:33920
  ds_read_b64_tr_b16 a[222:223], v21 offset:35456
  s_waitcnt lgkmcnt(12)
  v_mfma_f32_32x32x16_bf16 v[240:255], a[196:199], a[72:75], v[240:255]
  s_barrier
  ds_read_b64_tr_b16 a[192:193], v21 offset:36864
  ds_read_b64_tr_b16 a[194:195], v21 offset:38400
  s_waitcnt vmcnt(38)
  s_waitcnt lgkmcnt(12)
  v_mfma_f32_32x32x16_bf16 v[160:175], a[200:203], a[76:79], v[160:175]
  ds_read_b64_tr_b16 a[196:197], v21 offset:43008
  ds_read_b64_tr_b16 a[198:199], v21 offset:44544
  s_mov_b32 s67, 1867776
  s_add_u32 m0, s68, 49152
  s_nop 0
  buffer_load_dwordx4 v16, s[48:51], s67 offen offset:0 lds
  s_waitcnt lgkmcnt(12)
  v_mfma_f32_32x32x16_bf16 v[208:223], a[204:207], a[76:79], v[208:223]
  ds_read_b64_tr_b16 a[200:201], v21 offset:36928
  ds_read_b64_tr_b16 a[202:203], v21 offset:38464
  buffer_load_dwordx4 v17, s[48:51], s67 offen offset:1024 lds
  s_waitcnt lgkmcnt(12)
  v_mfma_f32_32x32x16_bf16 v[176:191], a[208:211], a[76:79], v[176:191]
  ds_read_b64_tr_b16 a[204:205], v21 offset:43072
  ds_read_b64_tr_b16 a[206:207], v21 offset:44608
  buffer_load_dwordx4 v18, s[48:51], s67 offen offset:2048 lds
  s_waitcnt lgkmcnt(12)
  v_mfma_f32_32x32x16_bf16 v[224:239], a[212:215], a[76:79], v[224:239]
  ds_read_b64_tr_b16 a[208:209], v21 offset:36992
  ds_read_b64_tr_b16 a[210:211], v21 offset:38528
  s_mov_b32 s67, 0
  s_add_u32 m0, s68, 61440
  s_nop 0
  buffer_load_dwordx4 v4, s[44:47], s67 offen offset:0 lds
  s_waitcnt lgkmcnt(12)
  v_mfma_f32_32x32x16_bf16 v[192:207], a[216:219], a[76:79], v[192:207]
  ds_read_b64_tr_b16 a[212:213], v21 offset:43136
  ds_read_b64_tr_b16 a[214:215], v21 offset:44672
  buffer_load_dwordx4 v5, s[44:47], s67 offen offset:1024 lds
  s_waitcnt lgkmcnt(12)
  v_mfma_f32_32x32x16_bf16 v[240:255], a[220:223], a[76:79], v[240:255]
  ds_read_b64_tr_b16 a[216:217], v21 offset:39936
  ds_read_b64_tr_b16 a[218:219], v21 offset:41472
  buffer_load_dwordx4 v6, s[44:47], s67 offen offset:2048 lds
  s_waitcnt vmcnt(43)
  s_waitcnt lgkmcnt(12)
  v_mfma_f32_32x32x16_bf16 v[160:175], a[192:195], a[80:83], v[160:175]
  ds_read_b64_tr_b16 a[220:221], v21 offset:46080
  ds_read_b64_tr_b16 a[222:223], v21 offset:47616
  s_waitcnt lgkmcnt(12)
  v_mfma_f32_32x32x16_bf16 v[208:223], a[196:199], a[80:83], v[208:223]
  ds_read_b64_tr_b16 a[192:193], v21 offset:40000
  ds_read_b64_tr_b16 a[194:195], v21 offset:41536
  s_waitcnt lgkmcnt(12)
  v_mfma_f32_32x32x16_bf16 v[176:191], a[200:203], a[80:83], v[176:191]
  ds_read_b64_tr_b16 a[196:197], v21 offset:46144
  ds_read_b64_tr_b16 a[198:199], v21 offset:47680
  s_waitcnt lgkmcnt(12)
  v_mfma_f32_32x32x16_bf16 v[224:239], a[204:207], a[80:83], v[224:239]
  ds_read_b64_tr_b16 a[200:201], v21 offset:40064
  ds_read_b64_tr_b16 a[202:203], v21 offset:41600
  s_waitcnt lgkmcnt(12)
  v_mfma_f32_32x32x16_bf16 v[192:207], a[208:211], a[80:83], v[192:207]
  ds_read_b64_tr_b16 a[204:205], v21 offset:46208
  ds_read_b64_tr_b16 a[206:207], v21 offset:47744
  s_waitcnt lgkmcnt(12)
  v_mfma_f32_32x32x16_bf16 v[240:255], a[212:215], a[80:83], v[240:255]
  ds_read_b64_tr_b16 a[208:209], v21 offset:49152
  ds_read_b64_tr_b16 a[210:211], v21 offset:50688
  s_waitcnt vmcnt(42)
  s_waitcnt lgkmcnt(12)
  v_mfma_f32_32x32x16_bf16 v[160:175], a[216:219], a[84:87], v[160:175]
  ds_read_b64_tr_b16 a[212:213], v21 offset:55296
  ds_read_b64_tr_b16 a[214:215], v21 offset:56832
  s_waitcnt lgkmcnt(12)
  v_mfma_f32_32x32x16_bf16 v[208:223], a[220:223], a[84:87], v[208:223]
  ds_read_b64_tr_b16 a[216:217], v21 offset:49216
  ds_read_b64_tr_b16 a[218:219], v21 offset:50752
  s_waitcnt lgkmcnt(12)
  v_mfma_f32_32x32x16_bf16 v[176:191], a[192:195], a[84:87], v[176:191]
  ds_read_b64_tr_b16 a[220:221], v21 offset:55360
  ds_read_b64_tr_b16 a[222:223], v21 offset:56896
  s_waitcnt lgkmcnt(12)
  v_mfma_f32_32x32x16_bf16 v[224:239], a[196:199], a[84:87], v[224:239]
  ds_read_b64_tr_b16 a[192:193], v21 offset:49280
  ds_read_b64_tr_b16 a[194:195], v21 offset:50816
  s_waitcnt lgkmcnt(12)
  v_mfma_f32_32x32x16_bf16 v[192:207], a[200:203], a[84:87], v[192:207]
  ds_read_b64_tr_b16 a[196:197], v21 offset:55424
  ds_read_b64_tr_b16 a[198:199], v21 offset:56960
  s_waitcnt lgkmcnt(12)
  v_mfma_f32_32x32x16_bf16 v[240:255], a[204:207], a[84:87], v[240:255]
  ds_read_b64_tr_b16 a[200:201], v21 offset:52224
  ds_read_b64_tr_b16 a[202:203], v21 offset:53760
  s_waitcnt vmcnt(41)
  s_waitcnt lgkmcnt(12)
  v_mfma_f32_32x32x16_bf16 v[160:175], a[208:211], a[88:91], v[160:175]
  ds_read_b64_tr_b16 a[204:205], v21 offset:58368
  ds_read_b64_tr_b16 a[206:207], v21 offset:59904
  s_waitcnt lgkmcnt(12)
  v_mfma_f32_32x32x16_bf16 v[208:223], a[212:215], a[88:91], v[208:223]
  ds_read_b64_tr_b16 a[208:209], v21 offset:52288
  ds_read_b64_tr_b16 a[210:211], v21 offset:53824
  s_waitcnt lgkmcnt(12)
  v_mfma_f32_32x32x16_bf16 v[176:191], a[216:219], a[88:91], v[176:191]
  ds_read_b64_tr_b16 a[212:213], v21 offset:58432
  ds_read_b64_tr_b16 a[214:215], v21 offset:59968
  s_waitcnt lgkmcnt(12)
  v_mfma_f32_32x32x16_bf16 v[224:239], a[220:223], a[88:91], v[224:239]
  ds_read_b64_tr_b16 a[216:217], v21 offset:52352
  ds_read_b64_tr_b16 a[218:219], v21 offset:53888
  s_waitcnt lgkmcnt(12)
  v_mfma_f32_32x32x16_bf16 v[192:207], a[192:195], a[88:91], v[192:207]
  ds_read_b64_tr_b16 a[220:221], v21 offset:58496
  ds_read_b64_tr_b16 a[222:223], v21 offset:60032
  s_waitcnt lgkmcnt(12)
  v_mfma_f32_32x32x16_bf16 v[240:255], a[196:199], a[88:91], v[240:255]
  s_waitcnt vmcnt(33)
  s_barrier
  ds_read_b64_tr_b16 a[192:193], v22 offset:0
  ds_read_b64_tr_b16 a[194:195], v22 offset:1536
  s_waitcnt lgkmcnt(12)
  v_mfma_f32_32x32x16_bf16 v[160:175], a[200:203], a[92:95], v[160:175]
  ds_read_b64_tr_b16 a[196:197], v22 offset:6144
  ds_read_b64_tr_b16 a[198:199], v22 offset:7680
  s_mov_b32 s67, 20480
  s_add_u32 m0, s68, 73728
  s_nop 0
  buffer_load_dwordx4 v4, s[44:47], s67 offen offset:0 lds
  s_waitcnt lgkmcnt(12)
  v_mfma_f32_32x32x16_bf16 v[208:223], a[204:207], a[92:95], v[208:223]
  ds_read_b64_tr_b16 a[200:201], v22 offset:64
  ds_read_b64_tr_b16 a[202:203], v22 offset:1600
  buffer_load_dwordx4 v5, s[44:47], s67 offen offset:1024 lds
  s_waitcnt lgkmcnt(12)
  v_mfma_f32_32x32x16_bf16 v[176:191], a[208:211], a[92:95], v[176:191]
  ds_read_b64_tr_b16 a[204:205], v22 offset:6208
  ds_read_b64_tr_b16 a[206:207], v22 offset:7744
  buffer_load_dwordx4 v6, s[44:47], s67 offen offset:2048 lds
  s_waitcnt lgkmcnt(12)
  v_mfma_f32_32x32x16_bf16 v[224:239], a[212:215], a[92:95], v[224:239]
  ds_read_b64_tr_b16 a[208:209], v22 offset:128
  ds_read_b64_tr_b16 a[210:211], v22 offset:1664
  s_mov_b32 s67, 40960
  s_add_u32 m0, s68, 86016
  s_nop 0
  buffer_load_dwordx4 v4, s[44:47], s67 offen offset:0 lds
  s_waitcnt lgkmcnt(12)
  v_mfma_f32_32x32x16_bf16 v[192:207], a[216:219], a[92:95], v[192:207]
  ds_read_b64_tr_b16 a[212:213], v22 offset:6272
  ds_read_b64_tr_b16 a[214:215], v22 offset:7808
  buffer_load_dwordx4 v5, s[44:47], s67 offen offset:1024 lds
  s_waitcnt lgkmcnt(12)
  v_mfma_f32_32x32x16_bf16 v[240:255], a[220:223], a[92:95], v[240:255]
  ds_read_b64_tr_b16 a[216:217], v22 offset:3072
  ds_read_b64_tr_b16 a[218:219], v22 offset:4608
  buffer_load_dwordx4 v6, s[44:47], s67 offen offset:2048 lds
  s_waitcnt lgkmcnt(12)
  v_mfma_f32_32x32x16_bf16 v[160:175], a[192:195], a[96:99], v[160:175]
  ds_read_b64_tr_b16 a[220:221], v22 offset:9216
  ds_read_b64_tr_b16 a[222:223], v22 offset:10752
  s_waitcnt lgkmcnt(12)
  v_mfma_f32_32x32x16_bf16 v[208:223], a[196:199], a[96:99], v[208:223]
  ds_read_b64_tr_b16 a[192:193], v22 offset:3136
  ds_read_b64_tr_b16 a[194:195], v22 offset:4672
  s_waitcnt lgkmcnt(12)
  v_mfma_f32_32x32x16_bf16 v[176:191], a[200:203], a[96:99], v[176:191]
  ds_read_b64_tr_b16 a[196:197], v22 offset:9280
  ds_read_b64_tr_b16 a[198:199], v22 offset:10816
  s_waitcnt lgkmcnt(12)
  v_mfma_f32_32x32x16_bf16 v[224:239], a[204:207], a[96:99], v[224:239]
  ds_read_b64_tr_b16 a[200:201], v22 offset:3200
  ds_read_b64_tr_b16 a[202:203], v22 offset:4736
  s_waitcnt lgkmcnt(12)
  v_mfma_f32_32x32x16_bf16 v[192:207], a[208:211], a[96:99], v[192:207]
  ds_read_b64_tr_b16 a[204:205], v22 offset:9344
  ds_read_b64_tr_b16 a[206:207], v22 offset:10880
  s_waitcnt lgkmcnt(12)
  v_mfma_f32_32x32x16_bf16 v[240:255], a[212:215], a[96:99], v[240:255]
  ds_read_b64_tr_b16 a[208:209], v22 offset:12288
  ds_read_b64_tr_b16 a[210:211], v22 offset:13824
  s_waitcnt lgkmcnt(12)
  v_mfma_f32_32x32x16_bf16 v[160:175], a[216:219], a[100:103], v[160:175]
  ds_read_b64_tr_b16 a[212:213], v22 offset:18432
  ds_read_b64_tr_b16 a[214:215], v22 offset:19968
  s_waitcnt lgkmcnt(12)
  v_mfma_f32_32x32x16_bf16 v[208:223], a[220:223], a[100:103], v[208:223]
  ds_read_b64_tr_b16 a[216:217], v22 offset:12352
  ds_read_b64_tr_b16 a[218:219], v22 offset:13888
  s_waitcnt lgkmcnt(12)
  v_mfma_f32_32x32x16_bf16 v[176:191], a[192:195], a[100:103], v[176:191]
  ds_read_b64_tr_b16 a[220:221], v22 offset:18496
  ds_read_b64_tr_b16 a[222:223], v22 offset:20032
  s_waitcnt lgkmcnt(12)
  v_mfma_f32_32x32x16_bf16 v[224:239], a[196:199], a[100:103], v[224:239]
  ds_read_b64_tr_b16 a[192:193], v22 offset:12416
  ds_read_b64_tr_b16 a[194:195], v22 offset:13952
  s_waitcnt lgkmcnt(12)
  v_mfma_f32_32x32x16_bf16 v[192:207], a[200:203], a[100:103], v[192:207]
  ds_read_b64_tr_b16 a[196:197], v22 offset:18560
  ds_read_b64_tr_b16 a[198:199], v22 offset:20096
  s_waitcnt lgkmcnt(12)
  v_mfma_f32_32x32x16_bf16 v[240:255], a[204:207], a[100:103], v[240:255]
  ds_read_b64_tr_b16 a[200:201], v22 offset:15360
  ds_read_b64_tr_b16 a[202:203], v22 offset:16896
  s_waitcnt lgkmcnt(12)
  v_mfma_f32_32x32x16_bf16 v[160:175], a[208:211], a[104:107], v[160:175]
  ds_read_b64_tr_b16 a[204:205], v22 offset:21504
  ds_read_b64_tr_b16 a[206:207], v22 offset:23040
  s_waitcnt lgkmcnt(12)
  v_mfma_f32_32x32x16_bf16 v[208:223], a[212:215], a[104:107], v[208:223]
  ds_read_b64_tr_b16 a[208:209], v22 offset:15424
  ds_read_b64_tr_b16 a[210:211], v22 offset:16960
  s_waitcnt lgkmcnt(12)
  v_mfma_f32_32x32x16_bf16 v[176:191], a[216:219], a[104:107], v[176:191]
  ds_read_b64_tr_b16 a[212:213], v22 offset:21568
  ds_read_b64_tr_b16 a[214:215], v22 offset:23104
  s_waitcnt lgkmcnt(12)
  v_mfma_f32_32x32x16_bf16 v[224:239], a[220:223], a[104:107], v[224:239]
  ds_read_b64_tr_b16 a[216:217], v22 offset:15488
  ds_read_b64_tr_b16 a[218:219], v22 offset:17024
  s_waitcnt lgkmcnt(12)
  v_mfma_f32_32x32x16_bf16 v[192:207], a[192:195], a[104:107], v[192:207]
  ds_read_b64_tr_b16 a[220:221], v22 offset:21632
  ds_read_b64_tr_b16 a[222:223], v22 offset:23168
  s_waitcnt lgkmcnt(12)
  v_mfma_f32_32x32x16_bf16 v[240:255], a[196:199], a[104:107], v[240:255]
  s_waitcnt vmcnt(21)
  s_barrier
  ds_read_b64_tr_b16 a[192:193], v22 offset:24576
  ds_read_b64_tr_b16 a[194:195], v22 offset:26112
  s_waitcnt lgkmcnt(12)
  v_mfma_f32_32x32x16_bf16 v[160:175], a[200:203], a[108:111], v[160:175]
  ds_read_b64_tr_b16 a[196:197], v22 offset:30720
  ds_read_b64_tr_b16 a[198:199], v22 offset:32256
  s_mov_b32 s67, 61440
  s_add_u32 m0, s68, 98304
  s_nop 0
  buffer_load_dwordx4 v4, s[44:47], s67 offen offset:0 lds
  s_waitcnt lgkmcnt(12)
  v_mfma_f32_32x32x16_bf16 v[208:223], a[204:207], a[108:111], v[208:223]
  ds_read_b64_tr_b16 a[200:201], v22 offset:24640
  ds_read_b64_tr_b16 a[202:203], v22 offset:26176
  buffer_load_dwordx4 v5, s[44:47], s67 offen offset:1024 lds
  s_waitcnt lgkmcnt(12)
  v_mfma_f32_32x32x16_bf16 v[176:191], a[208:211], a[108:111], v[176:191]
  ds_read_b64_tr_b16 a[204:205], v22 offset:30784
  ds_read_b64_tr_b16 a[206:207], v22 offset:32320
  buffer_load_dwordx4 v6, s[44:47], s67 offen offset:2048 lds
  s_waitcnt lgkmcnt(12)
  v_mfma_f32_32x32x16_bf16 v[224:239], a[212:215], a[108:111], v[224:239]
  ds_read_b64_tr_b16 a[208:209], v22 offset:24704
  ds_read_b64_tr_b16 a[210:211], v22 offset:26240
  s_mov_b32 s67, 81920
  s_add_u32 m0, s68, 110592
  s_nop 0
  buffer_load_dwordx4 v4, s[44:47], s67 offen offset:0 lds
  s_waitcnt lgkmcnt(12)
  v_mfma_f32_32x32x16_bf16 v[192:207], a[216:219], a[108:111], v[192:207]
  ds_read_b64_tr_b16 a[212:213], v22 offset:30848
  ds_read_b64_tr_b16 a[214:215], v22 offset:32384
  buffer_load_dwordx4 v5, s[44:47], s67 offen offset:1024 lds
  s_waitcnt lgkmcnt(12)
  v_mfma_f32_32x32x16_bf16 v[240:255], a[220:223], a[108:111], v[240:255]
  ds_read_b64_tr_b16 a[216:217], v22 offset:27648
  ds_read_b64_tr_b16 a[218:219], v22 offset:29184
  buffer_load_dwordx4 v6, s[44:47], s67 offen offset:2048 lds
  s_waitcnt lgkmcnt(12)
  v_mfma_f32_32x32x16_bf16 v[160:175], a[192:195], a[112:115], v[160:175]
  ds_read_b64_tr_b16 a[220:221], v22 offset:33792
  ds_read_b64_tr_b16 a[222:223], v22 offset:35328
  s_waitcnt lgkmcnt(12)
  v_mfma_f32_32x32x16_bf16 v[208:223], a[196:199], a[112:115], v[208:223]
  ds_read_b64_tr_b16 a[192:193], v22 offset:27712
  ds_read_b64_tr_b16 a[194:195], v22 offset:29248
  s_waitcnt lgkmcnt(12)
  v_mfma_f32_32x32x16_bf16 v[176:191], a[200:203], a[112:115], v[176:191]
  ds_read_b64_tr_b16 a[196:197], v22 offset:33856
  ds_read_b64_tr_b16 a[198:199], v22 offset:35392
  s_waitcnt lgkmcnt(12)
  v_mfma_f32_32x32x16_bf16 v[224:239], a[204:207], a[112:115], v[224:239]
  ds_read_b64_tr_b16 a[200:201], v22 offset:27776
  ds_read_b64_tr_b16 a[202:203], v22 offset:29312
  s_waitcnt lgkmcnt(12)
  v_mfma_f32_32x32x16_bf16 v[192:207], a[208:211], a[112:115], v[192:207]
  ds_read_b64_tr_b16 a[204:205], v22 offset:33920
  ds_read_b64_tr_b16 a[206:207], v22 offset:35456
  s_waitcnt lgkmcnt(12)
  v_mfma_f32_32x32x16_bf16 v[240:255], a[212:215], a[112:115], v[240:255]
  ds_read_b64_tr_b16 a[208:209], v20 offset:0
  ds_read_b64_tr_b16 a[210:211], v20 offset:1536
  s_waitcnt lgkmcnt(12)
  v_mfma_f32_32x32x16_bf16 v[160:175], a[216:219], a[116:119], v[160:175]
  ds_read_b64_tr_b16 a[212:213], v20 offset:6144
  ds_read_b64_tr_b16 a[214:215], v20 offset:7680
  s_waitcnt lgkmcnt(12)
  v_mfma_f32_32x32x16_bf16 v[208:223], a[220:223], a[116:119], v[208:223]
  ds_read_b64_tr_b16 a[216:217], v20 offset:64
  ds_read_b64_tr_b16 a[218:219], v20 offset:1600
  s_waitcnt lgkmcnt(12)
  v_mfma_f32_32x32x16_bf16 v[176:191], a[192:195], a[116:119], v[176:191]
  ds_read_b64_tr_b16 a[220:221], v20 offset:6208
  ds_read_b64_tr_b16 a[222:223], v20 offset:7744
  s_waitcnt lgkmcnt(12)
  v_mfma_f32_32x32x16_bf16 v[224:239], a[196:199], a[116:119], v[224:239]
  ds_read_b64_tr_b16 a[192:193], v20 offset:128
  ds_read_b64_tr_b16 a[194:195], v20 offset:1664
  s_waitcnt lgkmcnt(12)
  v_mfma_f32_32x32x16_bf16 v[192:207], a[200:203], a[116:119], v[192:207]
  ds_read_b64_tr_b16 a[196:197], v20 offset:6272
  ds_read_b64_tr_b16 a[198:199], v20 offset:7808
  s_waitcnt lgkmcnt(12)
  v_mfma_f32_32x32x16_bf16 v[240:255], a[204:207], a[116:119], v[240:255]
  ds_read_b64_tr_b16 a[200:201], v20 offset:3072
  ds_read_b64_tr_b16 a[202:203], v20 offset:4608
  s_waitcnt lgkmcnt(12)
  v_mfma_f32_32x32x16_bf16 v[160:175], a[208:211], a[120:123], v[160:175]
  ds_read_b64_tr_b16 a[204:205], v20 offset:9216
  ds_read_b64_tr_b16 a[206:207], v20 offset:10752
  s_waitcnt lgkmcnt(12)
  v_mfma_f32_32x32x16_bf16 v[208:223], a[212:215], a[120:123], v[208:223]
  ds_read_b64_tr_b16 a[208:209], v20 offset:3136
  ds_read_b64_tr_b16 a[210:211], v20 offset:4672
  s_waitcnt lgkmcnt(12)
  v_mfma_f32_32x32x16_bf16 v[176:191], a[216:219], a[120:123], v[176:191]
  ds_read_b64_tr_b16 a[212:213], v20 offset:9280
  ds_read_b64_tr_b16 a[214:215], v20 offset:10816
  s_waitcnt lgkmcnt(12)
  v_mfma_f32_32x32x16_bf16 v[224:239], a[220:223], a[120:123], v[224:239]
  ds_read_b64_tr_b16 a[216:217], v20 offset:3200
  ds_read_b64_tr_b16 a[218:219], v20 offset:4736
  s_waitcnt lgkmcnt(12)
  v_mfma_f32_32x32x16_bf16 v[192:207], a[192:195], a[120:123], v[192:207]
  ds_read_b64_tr_b16 a[220:221], v20 offset:9344
  ds_read_b64_tr_b16 a[222:223], v20 offset:10880
  s_waitcnt lgkmcnt(12)
  v_mfma_f32_32x32x16_bf16 v[240:255], a[196:199], a[120:123], v[240:255]
  s_waitcnt vmcnt(15)
  s_barrier
  ds_read_b64_tr_b16 a[192:193], v20 offset:12288
  ds_read_b64_tr_b16 a[194:195], v20 offset:13824
  s_waitcnt lgkmcnt(12)
  v_mfma_f32_32x32x16_bf16 v[160:175], a[200:203], a[124:127], v[160:175]
  ds_read_b64_tr_b16 a[196:197], v20 offset:18432
  ds_read_b64_tr_b16 a[198:199], v20 offset:19968
  s_mov_b32 s67, 102400
  s_add_u32 m0, s68, 122880
  s_nop 0
  buffer_load_dwordx4 v4, s[44:47], s67 offen offset:0 lds
  s_waitcnt lgkmcnt(12)
  v_mfma_f32_32x32x16_bf16 v[208:223], a[204:207], a[124:127], v[208:223]
  ds_read_b64_tr_b16 a[200:201], v20 offset:15360
  ds_read_b64_tr_b16 a[202:203], v20 offset:16896
  buffer_load_dwordx4 v5, s[44:47], s67 offen offset:1024 lds
  s_waitcnt lgkmcnt(12)
  v_mfma_f32_32x32x16_bf16 v[176:191], a[208:211], a[124:127], v[176:191]
  ds_read_b64_tr_b16 a[204:205], v20 offset:21504
  ds_read_b64_tr_b16 a[206:207], v20 offset:23040
  buffer_load_dwordx4 v6, s[44:47], s67 offen offset:2048 lds
  s_waitcnt lgkmcnt(12)
  v_mfma_f32_32x32x16_bf16 v[224:239], a[212:215], a[124:127], v[224:239]
  ds_read_b64_tr_b16 a[208:209], v20 offset:24576
  ds_read_b64_tr_b16 a[210:211], v20 offset:26112
  s_mov_b32 s67, 122880
  s_add_u32 m0, s68, 135168
  s_nop 0
  buffer_load_dwordx4 v4, s[44:47], s67 offen offset:0 lds
  s_waitcnt lgkmcnt(12)
  v_mfma_f32_32x32x16_bf16 v[192:207], a[216:219], a[124:127], v[192:207]
  ds_read_b64_tr_b16 a[212:213], v20 offset:30720
  ds_read_b64_tr_b16 a[214:215], v20 offset:32256
  buffer_load_dwordx4 v5, s[44:47], s67 offen offset:1024 lds
  s_waitcnt lgkmcnt(12)
  v_mfma_f32_32x32x16_bf16 v[240:255], a[220:223], a[124:127], v[240:255]
  ds_read_b64_tr_b16 a[216:217], v20 offset:27648
  ds_read_b64_tr_b16 a[218:219], v20 offset:29184
  buffer_load_dwordx4 v6, s[44:47], s67 offen offset:2048 lds
  s_waitcnt lgkmcnt(12)
  v_mfma_f32_32x32x16_bf16 v[160:175], a[192:195], a[128:131], v[160:175]
  ds_read_b64_tr_b16 a[220:221], v20 offset:33792
  ds_read_b64_tr_b16 a[222:223], v20 offset:35328
  s_waitcnt lgkmcnt(12)
  v_mfma_f32_32x32x16_bf16 v[208:223], a[196:199], a[128:131], v[208:223]
  ds_read_b64_tr_b16 a[192:193], v20 offset:36864
  ds_read_b64_tr_b16 a[194:195], v20 offset:38400
  s_waitcnt lgkmcnt(12)
  v_mfma_f32_32x32x16_bf16 v[160:175], a[200:203], a[132:135], v[160:175]
  ds_read_b64_tr_b16 a[196:197], v20 offset:43008
  ds_read_b64_tr_b16 a[198:199], v20 offset:44544
  s_waitcnt lgkmcnt(12)
  v_mfma_f32_32x32x16_bf16 v[208:223], a[204:207], a[132:135], v[208:223]
  ds_read_b64_tr_b16 a[200:201], v20 offset:39936
  ds_read_b64_tr_b16 a[202:203], v20 offset:41472
  s_waitcnt lgkmcnt(12)
  v_mfma_f32_32x32x16_bf16 v[160:175], a[208:211], a[136:139], v[160:175]
  ds_read_b64_tr_b16 a[204:205], v20 offset:46080
  ds_read_b64_tr_b16 a[206:207], v20 offset:47616
  s_waitcnt lgkmcnt(12)
  v_mfma_f32_32x32x16_bf16 v[208:223], a[212:215], a[136:139], v[208:223]
  ds_read_b64_tr_b16 a[208:209], v20 offset:49152
  ds_read_b64_tr_b16 a[210:211], v20 offset:50688
  s_waitcnt lgkmcnt(12)
  v_mfma_f32_32x32x16_bf16 v[160:175], a[216:219], a[140:143], v[160:175]
  ds_read_b64_tr_b16 a[212:213], v20 offset:55296
  ds_read_b64_tr_b16 a[214:215], v20 offset:56832
  s_waitcnt lgkmcnt(12)
  v_mfma_f32_32x32x16_bf16 v[208:223], a[220:223], a[140:143], v[208:223]
  ds_read_b64_tr_b16 a[216:217], v20 offset:52224
  ds_read_b64_tr_b16 a[218:219], v20 offset:53760
  s_waitcnt lgkmcnt(12)
  v_mfma_f32_32x32x16_bf16 v[160:175], a[192:195], a[144:147], v[160:175]
  ds_read_b64_tr_b16 a[220:221], v20 offset:58368
  ds_read_b64_tr_b16 a[222:223], v20 offset:59904
  s_barrier
  s_waitcnt lgkmcnt(12)
  v_mfma_f32_32x32x16_bf16 v[208:223], a[196:199], a[144:147], v[208:223]
  ds_read_b64_tr_b16 a[192:193], v20 offset:12352
  ds_read_b64_tr_b16 a[194:195], v20 offset:13888
  s_mov_b32 s67, 143360
  s_add_u32 m0, s68, 147456
  s_nop 0
  buffer_load_dwordx4 v4, s[44:47], s67 offen offset:0 lds
  s_waitcnt lgkmcnt(12)
  v_mfma_f32_32x32x16_bf16 v[160:175], a[200:203], a[148:151], v[160:175]
  ds_read_b64_tr_b16 a[196:197], v20 offset:18496
  ds_read_b64_tr_b16 a[198:199], v20 offset:20032
  buffer_load_dwordx4 v5, s[44:47], s67 offen offset:1024 lds
  s_waitcnt lgkmcnt(12)
  v_mfma_f32_32x32x16_bf16 v[208:223], a[204:207], a[148:151], v[208:223]
  ds_read_b64_tr_b16 a[200:201], v20 offset:15424
  ds_read_b64_tr_b16 a[202:203], v20 offset:16960
  buffer_load_dwordx4 v6, s[44:47], s67 offen offset:2048 lds
  s_waitcnt lgkmcnt(12)
  v_mfma_f32_32x32x16_bf16 v[160:175], a[208:211], a[152:155], v[160:175]
  ds_read_b64_tr_b16 a[204:205], v20 offset:21568
  ds_read_b64_tr_b16 a[206:207], v20 offset:23104
  s_mov_b32 s67, 163840
  s_add_u32 m0, s68, 0
  s_nop 0
  buffer_load_dwordx4 v4, s[44:47], s67 offen offset:0 lds
  s_waitcnt lgkmcnt(12)
  v_mfma_f32_32x32x16_bf16 v[208:223], a[212:215], a[152:155], v[208:223]
  ds_read_b64_tr_b16 a[208:209], v20 offset:24640
  ds_read_b64_tr_b16 a[210:211], v20 offset:26176
  buffer_load_dwordx4 v5, s[44:47], s67 offen offset:1024 lds
  s_waitcnt lgkmcnt(12)
  v_mfma_f32_32x32x16_bf16 v[160:175], a[216:219], a[156:159], v[160:175]
  ds_read_b64_tr_b16 a[212:213], v20 offset:30784
  ds_read_b64_tr_b16 a[214:215], v20 offset:32320
  buffer_load_dwordx4 v6, s[44:47], s67 offen offset:2048 lds
  s_waitcnt lgkmcnt(12)
  v_mfma_f32_32x32x16_bf16 v[208:223], a[220:223], a[156:159], v[208:223]
  ds_read_b64_tr_b16 a[216:217], v20 offset:27712
  ds_read_b64_tr_b16 a[218:219], v20 offset:29248
  s_waitcnt lgkmcnt(12)
  v_mfma_f32_32x32x16_bf16 v[176:191], a[192:195], a[128:131], v[176:191]
  ds_read_b64_tr_b16 a[220:221], v20 offset:33856
  ds_read_b64_tr_b16 a[222:223], v20 offset:35392
  s_waitcnt lgkmcnt(12)
  v_mfma_f32_32x32x16_bf16 v[224:239], a[196:199], a[128:131], v[224:239]
  ds_read_b64_tr_b16 a[192:193], v20 offset:36928
  ds_read_b64_tr_b16 a[194:195], v20 offset:38464
  s_waitcnt lgkmcnt(12)
  v_mfma_f32_32x32x16_bf16 v[176:191], a[200:203], a[132:135], v[176:191]
  ds_read_b64_tr_b16 a[196:197], v20 offset:43072
  ds_read_b64_tr_b16 a[198:199], v20 offset:44608
  s_waitcnt lgkmcnt(12)
  v_mfma_f32_32x32x16_bf16 v[224:239], a[204:207], a[132:135], v[224:239]
  ds_read_b64_tr_b16 a[200:201], v20 offset:40000
  ds_read_b64_tr_b16 a[202:203], v20 offset:41536
  v_mul_f32 v24, s69, v160
  v_mul_f32 v25, s69, v161
  v_mul_f32 v26, s69, v162
  v_mul_f32 v27, s69, v163
  v_mul_f32 v28, s69, v164
  v_mul_f32 v29, s69, v165
  v_mul_f32 v30, s69, v166
  v_mul_f32 v31, s69, v167
  v_exp_f32 v24, v24
  s_waitcnt lgkmcnt(12)
  v_mfma_f32_32x32x16_bf16 v[176:191], a[208:211], a[136:139], v[176:191]
  ds_read_b64_tr_b16 a[204:205], v20 offset:46144
  ds_read_b64_tr_b16 a[206:207], v20 offset:47680
  v_exp_f32 v25, v25
  v_exp_f32 v26, v26
  v_exp_f32 v27, v27
  v_exp_f32 v28, v28
  v_exp_f32 v29, v29
  v_exp_f32 v30, v30
  s_waitcnt lgkmcnt(12)
  v_mfma_f32_32x32x16_bf16 v[224:239], a[212:215], a[136:139], v[224:239]
  ds_read_b64_tr_b16 a[208:209], v20 offset:49216
  ds_read_b64_tr_b16 a[210:211], v20 offset:50752
  v_exp_f32 v31, v31
  v_mul_f32 v160, v160, v208
  v_mul_f32 v161, v161, v209
  v_mul_f32 v162, v162, v210
  v_mul_f32 v163, v163, v211
  v_mul_f32 v164, v164, v212
  v_mul_f32 v165, v165, v213
  v_mul_f32 v166, v166, v214
  v_mul_f32 v167, v167, v215
  s_waitcnt lgkmcnt(12)
  v_mfma_f32_32x32x16_bf16 v[176:191], a[216:219], a[140:143], v[176:191]
  ds_read_b64_tr_b16 a[212:213], v20 offset:55360
  ds_read_b64_tr_b16 a[214:215], v20 offset:56896
  v_add_f32 v24, 1.0, v24
  v_add_f32 v25, 1.0, v25
  v_add_f32 v26, 1.0, v26
  v_add_f32 v27, 1.0, v27
  v_add_f32 v28, 1.0, v28
  v_add_f32 v29, 1.0, v29
  v_add_f32 v30, 1.0, v30
  v_add_f32 v31, 1.0, v31
  v_rcp_f32 v24, v24
  v_rcp_f32 v25, v25
  s_waitcnt lgkmcnt(12)
  v_mfma_f32_32x32x16_bf16 v[224:239], a[220:223], a[140:143], v[224:239]
  ds_read_b64_tr_b16 a[216:217], v20 offset:52288
  ds_read_b64_tr_b16 a[218:219], v20 offset:53824
  v_rcp_f32 v26, v26
  v_rcp_f32 v27, v27
  v_rcp_f32 v28, v28
  v_rcp_f32 v29, v29
  v_rcp_f32 v30, v30
  s_waitcnt lgkmcnt(12)
  v_mfma_f32_32x32x16_bf16 v[176:191], a[192:195], a[144:147], v[176:191]
  ds_read_b64_tr_b16 a[220:221], v20 offset:58432
  ds_read_b64_tr_b16 a[222:223], v20 offset:59968
  v_rcp_f32 v31, v31
  s_nop 0
  v_mul_f32 v160, v160, v24
  v_mul_f32 v161, v161, v25
  v_mul_f32 v162, v162, v26
  v_mul_f32 v163, v163, v27
  v_mul_f32 v164, v164, v28
  v_mul_f32 v165, v165, v29
  v_mul_f32 v166, v166, v30
  v_mul_f32 v167, v167, v31
  s_waitcnt lgkmcnt(12)
  v_mfma_f32_32x32x16_bf16 v[224:239], a[196:199], a[144:147], v[224:239]
  ds_read_b64_tr_b16 a[192:193], v20 offset:12416
  ds_read_b64_tr_b16 a[194:195], v20 offset:13952
  v_cvt_pk_bf16_f32 v40, v160, v161
  v_cvt_pk_bf16_f32 v41, v162, v163
  v_cvt_pk_bf16_f32 v42, v164, v165
  v_cvt_pk_bf16_f32 v43, v166, v167
  buffer_store_dwordx4 v[40:43], v14, s[84:87], 0 offen offset:0 sc1
  v_mul_f32 v32, s69, v168
  v_mul_f32 v33, s69, v169
  v_mul_f32 v34, s69, v170
  v_mul_f32 v35, s69, v171
  v_mul_f32 v36, s69, v172
  s_waitcnt lgkmcnt(12)
  v_mfma_f32_32x32x16_bf16 v[176:191], a[200:203], a[148:151], v[176:191]
  ds_read_b64_tr_b16 a[196:197], v20 offset:18560
  ds_read_b64_tr_b16 a[198:199], v20 offset:20096
  v_mul_f32 v37, s69, v173
  v_mul_f32 v38, s69, v174
  v_mul_f32 v39, s69, v175
  v_exp_f32 v32, v32
  v_exp_f32 v33, v33
  v_exp_f32 v34, v34
  v_exp_f32 v35, v35
  s_waitcnt lgkmcnt(12)
  v_mfma_f32_32x32x16_bf16 v[224:239], a[204:207], a[148:151], v[224:239]
  ds_read_b64_tr_b16 a[200:201], v20 offset:15488
  ds_read_b64_tr_b16 a[202:203], v20 offset:17024
  v_exp_f32 v36, v36
  v_exp_f32 v37, v37
  v_exp_f32 v38, v38
  v_exp_f32 v39, v39
  v_mul_f32 v168, v168, v216
  v_mul_f32 v169, v169, v217
  v_mul_f32 v170, v170, v218
  s_waitcnt lgkmcnt(12)
  v_mfma_f32_32x32x16_bf16 v[176:191], a[208:211], a[152:155], v[176:191]
  ds_read_b64_tr_b16 a[204:205], v20 offset:21632
  ds_read_b64_tr_b16 a[206:207], v20 offset:23168
  v_mul_f32 v171, v171, v219
  v_mul_f32 v172, v172, v220
  v_mul_f32 v173, v173, v221
  v_mul_f32 v174, v174, v222
  v_mul_f32 v175, v175, v223
  v_add_f32 v32, 1.0, v32
  v_add_f32 v33, 1.0, v33
  v_add_f32 v34, 1.0, v34
  v_add_f32 v35, 1.0, v35
  v_add_f32 v36, 1.0, v36
  v_add_f32 v37, 1.0, v37
  s_waitcnt lgkmcnt(12)
  v_mfma_f32_32x32x16_bf16 v[224:239], a[212:215], a[152:155], v[224:239]
  ds_read_b64_tr_b16 a[208:209], v20 offset:24704
  ds_read_b64_tr_b16 a[210:211], v20 offset:26240
  v_add_f32 v38, 1.0, v38
  v_add_f32 v39, 1.0, v39
  v_rcp_f32 v32, v32
  v_rcp_f32 v33, v33
  v_rcp_f32 v34, v34
  v_rcp_f32 v35, v35
  s_waitcnt lgkmcnt(12)
  v_mfma_f32_32x32x16_bf16 v[176:191], a[216:219], a[156:159], v[176:191]
  ds_read_b64_tr_b16 a[212:213], v20 offset:30848
  ds_read_b64_tr_b16 a[214:215], v20 offset:32384
  v_rcp_f32 v36, v36
  v_rcp_f32 v37, v37
  v_rcp_f32 v38, v38
  v_rcp_f32 v39, v39
  s_nop 0
  v_mul_f32 v168, v168, v32
  v_mul_f32 v169, v169, v33
  s_waitcnt lgkmcnt(12)
  v_mfma_f32_32x32x16_bf16 v[224:239], a[220:223], a[156:159], v[224:239]
  ds_read_b64_tr_b16 a[216:217], v20 offset:27776
  ds_read_b64_tr_b16 a[218:219], v20 offset:29312
  v_mul_f32 v170, v170, v34
  v_mul_f32 v171, v171, v35
  v_mul_f32 v172, v172, v36
  v_mul_f32 v173, v173, v37
  v_mul_f32 v174, v174, v38
  v_mul_f32 v175, v175, v39
  v_cvt_pk_bf16_f32 v44, v168, v169
  v_cvt_pk_bf16_f32 v45, v170, v171
  v_cvt_pk_bf16_f32 v46, v172, v173
  v_cvt_pk_bf16_f32 v47, v174, v175
  buffer_store_dwordx4 v[44:47], v14, s[84:87], 0 offen offset:512 sc1
  s_waitcnt lgkmcnt(12)
  v_mfma_f32_32x32x16_bf16 v[192:207], a[192:195], a[128:131], v[192:207]
  ds_read_b64_tr_b16 a[220:221], v20 offset:33920
  ds_read_b64_tr_b16 a[222:223], v20 offset:35456
  s_waitcnt lgkmcnt(12)
  v_mfma_f32_32x32x16_bf16 v[240:255], a[196:199], a[128:131], v[240:255]
  ds_read_b64_tr_b16 a[192:193], v20 offset:36992
  ds_read_b64_tr_b16 a[194:195], v20 offset:38528
  s_waitcnt lgkmcnt(12)
  v_mfma_f32_32x32x16_bf16 v[192:207], a[200:203], a[132:135], v[192:207]
  ds_read_b64_tr_b16 a[196:197], v20 offset:43136
  ds_read_b64_tr_b16 a[198:199], v20 offset:44672
  s_waitcnt lgkmcnt(12)
  v_mfma_f32_32x32x16_bf16 v[240:255], a[204:207], a[132:135], v[240:255]
  ds_read_b64_tr_b16 a[200:201], v20 offset:40064
  ds_read_b64_tr_b16 a[202:203], v20 offset:41600
  v_mul_f32 v24, s69, v176
  v_mul_f32 v25, s69, v177
  v_mul_f32 v26, s69, v178
  v_mul_f32 v27, s69, v179
  v_mul_f32 v28, s69, v180
  v_mul_f32 v29, s69, v181
  v_mul_f32 v30, s69, v182
  v_mul_f32 v31, s69, v183
  v_exp_f32 v24, v24
  s_waitcnt lgkmcnt(12)
  v_mfma_f32_32x32x16_bf16 v[192:207], a[208:211], a[136:139], v[192:207]
  ds_read_b64_tr_b16 a[204:205], v20 offset:46208
  ds_read_b64_tr_b16 a[206:207], v20 offset:47744
  v_exp_f32 v25, v25
  v_exp_f32 v26, v26
  v_exp_f32 v27, v27
  v_exp_f32 v28, v28
  v_exp_f32 v29, v29
  v_exp_f32 v30, v30
  s_waitcnt lgkmcnt(12)
  v_mfma_f32_32x32x16_bf16 v[240:255], a[212:215], a[136:139], v[240:255]
  ds_read_b64_tr_b16 a[208:209], v20 offset:49280
  ds_read_b64_tr_b16 a[210:211], v20 offset:50816
  v_exp_f32 v31, v31
  v_mul_f32 v176, v176, v224
  v_mul_f32 v177, v177, v225
  v_mul_f32 v178, v178, v226
  v_mul_f32 v179, v179, v227
  v_mul_f32 v180, v180, v228
  v_mul_f32 v181, v181, v229
  v_mul_f32 v182, v182, v230
  v_mul_f32 v183, v183, v231
  s_waitcnt lgkmcnt(12)
  v_mfma_f32_32x32x16_bf16 v[192:207], a[216:219], a[140:143], v[192:207]
  ds_read_b64_tr_b16 a[212:213], v20 offset:55424
  ds_read_b64_tr_b16 a[214:215], v20 offset:56960
  v_add_f32 v24, 1.0, v24
  v_add_f32 v25, 1.0, v25
  v_add_f32 v26, 1.0, v26
  v_add_f32 v27, 1.0, v27
  v_add_f32 v28, 1.0, v28
  v_add_f32 v29, 1.0, v29
  v_add_f32 v30, 1.0, v30
  v_add_f32 v31, 1.0, v31
  v_rcp_f32 v24, v24
  v_rcp_f32 v25, v25
  s_waitcnt lgkmcnt(12)
  v_mfma_f32_32x32x16_bf16 v[240:255], a[220:223], a[140:143], v[240:255]
  ds_read_b64_tr_b16 a[216:217], v20 offset:52352
  ds_read_b64_tr_b16 a[218:219], v20 offset:53888
  v_rcp_f32 v26, v26
  v_rcp_f32 v27, v27
  v_rcp_f32 v28, v28
  v_rcp_f32 v29, v29
  v_rcp_f32 v30, v30
  s_waitcnt lgkmcnt(12)
  v_mfma_f32_32x32x16_bf16 v[192:207], a[192:195], a[144:147], v[192:207]
  ds_read_b64_tr_b16 a[220:221], v20 offset:58496
  ds_read_b64_tr_b16 a[222:223], v20 offset:60032
  v_rcp_f32 v31, v31
  s_nop 0
  v_mul_f32 v176, v176, v24
  v_mul_f32 v177, v177, v25
  v_mul_f32 v178, v178, v26
  v_mul_f32 v179, v179, v27
  v_mul_f32 v180, v180, v28
  v_mul_f32 v181, v181, v29
  v_mul_f32 v182, v182, v30
  v_mul_f32 v183, v183, v31
  s_waitcnt lgkmcnt(12)
  v_mfma_f32_32x32x16_bf16 v[240:255], a[196:199], a[144:147], v[240:255]
  v_cvt_pk_bf16_f32 v48, v176, v177
  v_cvt_pk_bf16_f32 v49, v178, v179
  v_cvt_pk_bf16_f32 v50, v180, v181
  v_cvt_pk_bf16_f32 v51, v182, v183
  buffer_store_dwordx4 v[48:51], v14, s[84:87], 0 offen offset:1024 sc1
  v_mul_f32 v32, s69, v184
  v_mul_f32 v33, s69, v185
  v_mul_f32 v34, s69, v186
  v_mul_f32 v35, s69, v187
  v_mul_f32 v36, s69, v188
  s_waitcnt lgkmcnt(10)
  v_mfma_f32_32x32x16_bf16 v[192:207], a[200:203], a[148:151], v[192:207]
  v_mul_f32 v37, s69, v189
  v_mul_f32 v38, s69, v190
  v_mul_f32 v39, s69, v191
  v_exp_f32 v32, v32
  v_exp_f32 v33, v33
  v_exp_f32 v34, v34
  v_exp_f32 v35, v35
  s_waitcnt lgkmcnt(8)
  v_mfma_f32_32x32x16_bf16 v[240:255], a[204:207], a[148:151], v[240:255]
  v_exp_f32 v36, v36
  v_exp_f32 v37, v37
  v_exp_f32 v38, v38
  v_exp_f32 v39, v39
  v_mul_f32 v184, v184, v232
  v_mul_f32 v185, v185, v233
  v_mul_f32 v186, v186, v234
  s_waitcnt lgkmcnt(6)
  v_mfma_f32_32x32x16_bf16 v[192:207], a[208:211], a[152:155], v[192:207]
  v_mul_f32 v187, v187, v235
  v_mul_f32 v188, v188, v236
  v_mul_f32 v189, v189, v237
  v_mul_f32 v190, v190, v238
  v_mul_f32 v191, v191, v239
  v_add_f32 v32, 1.0, v32
  v_add_f32 v33, 1.0, v33
  v_add_f32 v34, 1.0, v34
  v_add_f32 v35, 1.0, v35
  v_add_f32 v36, 1.0, v36
  v_add_f32 v37, 1.0, v37
  s_waitcnt lgkmcnt(4)
  v_mfma_f32_32x32x16_bf16 v[240:255], a[212:215], a[152:155], v[240:255]
  v_add_f32 v38, 1.0, v38
  v_add_f32 v39, 1.0, v39
  v_rcp_f32 v32, v32
  v_rcp_f32 v33, v33
  v_rcp_f32 v34, v34
  v_rcp_f32 v35, v35
  s_waitcnt lgkmcnt(2)
  v_mfma_f32_32x32x16_bf16 v[192:207], a[216:219], a[156:159], v[192:207]
  v_rcp_f32 v36, v36
  v_rcp_f32 v37, v37
  v_rcp_f32 v38, v38
  v_rcp_f32 v39, v39
  s_nop 0
  v_mul_f32 v184, v184, v32
  v_mul_f32 v185, v185, v33
  s_waitcnt lgkmcnt(0)
  v_mfma_f32_32x32x16_bf16 v[240:255], a[220:223], a[156:159], v[240:255]
  v_mul_f32 v186, v186, v34
  v_mul_f32 v187, v187, v35
  v_mul_f32 v188, v188, v36
  v_mul_f32 v189, v189, v37
  v_mul_f32 v190, v190, v38
  v_mul_f32 v191, v191, v39
  v_cvt_pk_bf16_f32 v52, v184, v185
  v_cvt_pk_bf16_f32 v53, v186, v187
  v_cvt_pk_bf16_f32 v54, v188, v189
  v_cvt_pk_bf16_f32 v55, v190, v191
  buffer_store_dwordx4 v[52:55], v14, s[84:87], 0 offen offset:1536 sc1
  v_mul_f32 v24, s69, v192
  v_mul_f32 v25, s69, v193
  v_mul_f32 v26, s69, v194
  v_mul_f32 v27, s69, v195
  v_mul_f32 v28, s69, v196
  v_mul_f32 v29, s69, v197
  v_mul_f32 v30, s69, v198
  v_mul_f32 v31, s69, v199
  v_exp_f32 v24, v24
  v_exp_f32 v25, v25
  v_exp_f32 v26, v26
  v_exp_f32 v27, v27
  v_exp_f32 v28, v28
  v_exp_f32 v29, v29
  v_exp_f32 v30, v30
  v_exp_f32 v31, v31
  v_mul_f32 v192, v192, v240
  v_mul_f32 v193, v193, v241
  v_mul_f32 v194, v194, v242
  v_mul_f32 v195, v195, v243
  v_mul_f32 v196, v196, v244
  v_mul_f32 v197, v197, v245
  v_mul_f32 v198, v198, v246
  v_mul_f32 v199, v199, v247
  v_add_f32 v24, 1.0, v24
  v_add_f32 v25, 1.0, v25
  v_add_f32 v26, 1.0, v26
  v_add_f32 v27, 1.0, v27
  v_add_f32 v28, 1.0, v28
  v_add_f32 v29, 1.0, v29
  v_add_f32 v30, 1.0, v30
  v_add_f32 v31, 1.0, v31
  v_rcp_f32 v24, v24
  v_rcp_f32 v25, v25
  v_rcp_f32 v26, v26
  v_rcp_f32 v27, v27
  v_rcp_f32 v28, v28
  v_rcp_f32 v29, v29
  v_rcp_f32 v30, v30
  v_rcp_f32 v31, v31
  s_nop 0
  v_mul_f32 v192, v192, v24
  v_mul_f32 v193, v193, v25
  v_mul_f32 v194, v194, v26
  v_mul_f32 v195, v195, v27
  v_mul_f32 v196, v196, v28
  v_mul_f32 v197, v197, v29
  v_mul_f32 v198, v198, v30
  v_mul_f32 v199, v199, v31
  v_cvt_pk_bf16_f32 v56, v192, v193
  v_cvt_pk_bf16_f32 v57, v194, v195
  v_cvt_pk_bf16_f32 v58, v196, v197
  v_cvt_pk_bf16_f32 v59, v198, v199
  buffer_store_dwordx4 v[56:59], v14, s[84:87], 0 offen offset:2048 sc1
  v_mul_f32 v32, s69, v200
  v_mul_f32 v33, s69, v201
  v_mul_f32 v34, s69, v202
  v_mul_f32 v35, s69, v203
  v_mul_f32 v36, s69, v204
  v_mul_f32 v37, s69, v205
  v_mul_f32 v38, s69, v206
  v_mul_f32 v39, s69, v207
  v_exp_f32 v32, v32
  v_exp_f32 v33, v33
  v_exp_f32 v34, v34
  v_exp_f32 v35, v35
  v_exp_f32 v36, v36
  v_exp_f32 v37, v37
  v_exp_f32 v38, v38
  v_exp_f32 v39, v39
  v_mul_f32 v200, v200, v248
  v_mul_f32 v201, v201, v249
  v_mul_f32 v202, v202, v250
  v_mul_f32 v203, v203, v251
  v_mul_f32 v204, v204, v252
  v_mul_f32 v205, v205, v253
  v_mul_f32 v206, v206, v254
  v_mul_f32 v207, v207, v255
  v_add_f32 v32, 1.0, v32
  v_add_f32 v33, 1.0, v33
  v_add_f32 v34, 1.0, v34
  v_add_f32 v35, 1.0, v35
  v_add_f32 v36, 1.0, v36
  v_add_f32 v37, 1.0, v37
  v_add_f32 v38, 1.0, v38
  v_add_f32 v39, 1.0, v39
  v_rcp_f32 v32, v32
  v_rcp_f32 v33, v33
  v_rcp_f32 v34, v34
  v_rcp_f32 v35, v35
  v_rcp_f32 v36, v36
  v_rcp_f32 v37, v37
  v_rcp_f32 v38, v38
  v_rcp_f32 v39, v39
  s_nop 0
  v_mul_f32 v200, v200, v32
  v_mul_f32 v201, v201, v33
  v_mul_f32 v202, v202, v34
  v_mul_f32 v203, v203, v35
  v_mul_f32 v204, v204, v36
  v_mul_f32 v205, v205, v37
  v_mul_f32 v206, v206, v38
  v_mul_f32 v207, v207, v39
  v_cvt_pk_bf16_f32 v60, v200, v201
  v_cvt_pk_bf16_f32 v61, v202, v203
  v_cvt_pk_bf16_f32 v62, v204, v205
  v_cvt_pk_bf16_f32 v63, v206, v207
  buffer_store_dwordx4 v[60:63], v14, s[84:87], 0 offen offset:2560 sc1
  s_and_b32 s60, s35, 7
  s_lshr_b32 s61, s35, 3
  s_lshl_b32 s62, s31, 2
  s_add_u32 s61, s61, s62
  s_mul_i32 s62, s61, 196608
  s_mul_i32 s63, s30, 12288
  s_add_u32 s62, s62, s63
  s_add_u32 s56, s28, s62
  s_addc_u32 s57, s29, 0
  s_add_u32 s56, s56, 7864320
  s_addc_u32 s57, s57, 0
  s_mov_b32 s58, 159744
  s_mov_b32 s59, 0x20000
  s_lshl_b32 s62, s61, 1
  s_lshr_b32 s63, s30, 1
  s_add_u32 s62, s62, s63
  s_mul_i32 s62, s62, 40960
  s_mul_i32 s63, s60, 5120
  s_add_u32 s62, s62, s63
  s_add_u32 s36, s28, s62
  s_addc_u32 s37, s29, 0
  s_add_u32 s36, s36, 5242880
  s_addc_u32 s37, s37, 0
  s_mov_b32 s38, 5120
  s_mov_b32 s39, 0x20000
  s_lshl_b32 s62, s61, 6
  s_lshl_b32 s63, s30, 4
  s_add_u32 s62, s62, s63
  s_mul_i32 s62, s62, 1280
  s_mul_i32 s63, s60, 160
  s_add_u32 s62, s62, s63
  s_add_u32 s52, s26, s62
  s_addc_u32 s53, s27, 0
  s_mov_b32 s54, 19360
  s_mov_b32 s55, 0x20000
  s_mul_i32 s62, s60, 320
  s_add_u32 s40, s28, s62
  s_addc_u32 s41, s29, 0
  s_add_u32 s40, s40, 60305920
  s_addc_u32 s41, s41, 0
  s_mov_b32 s42, 320
  s_mov_b32 s43, 0x20000
  v_lshrrev_b32 v28, 4, v1
  v_and_b32 v29, 15, v1
  v_and_b32 v30, 1, v28
  v_lshlrev_b32 v11, 9, v30
  v_lshrrev_b32 v30, 1, v28
  v_lshl_add_u32 v11, v30, 3, v11
  s_and_b32 s62, s30, 1
  s_lshl_b32 s62, s62, 4
  v_add_u32 v30, s62, v29
  v_lshl_add_u32 v11, v30, 4, v11
  v_lshlrev_b32 v12, 4, v28
  v_mul_u32_u24 v13, 1280, v29
  v_lshl_add_u32 v13, v28, 3, v13
  s_waitcnt vmcnt(0)
  s_lshl_b32 s60, s31, 1
  s_and_b32 s61, s35, 1
  s_add_u32 s60, s60, s61
  s_lshl_b32 s60, s60, 4
  s_lshr_b32 s61, s35, 1
  s_add_u32 s60, s60, s61
  s_lshl_b32 s60, s60, 2
  s_add_u32 s60, s60, s30
  s_mul_i32 s60, s60, 128
  s_add_u32 s74, s60, 180224
  v_cmp_eq_u32 vcc, 0, v1
  v_mov_b32 v17, 2130706432
  v_mov_b32 v18, s14
  v_cndmask_b32 v17, v17, v1, vcc
  buffer_store_dword v18, v17, s[92:95], s74 offen sc1
  s_barrier
  s_mov_b32 s67, 184320
  s_add_u32 m0, s68, 12288
  s_nop 0
  buffer_load_dwordx4 v4, s[44:47], s67 offen offset:0 lds
  buffer_load_dwordx4 v5, s[44:47], s67 offen offset:1024 lds
  buffer_load_dwordx4 v6, s[44:47], s67 offen offset:2048 lds
  s_mov_b32 s67, 204800
  s_add_u32 m0, s68, 24576
  s_nop 0
  buffer_load_dwordx4 v4, s[44:47], s67 offen offset:0 lds
  buffer_load_dwordx4 v5, s[44:47], s67 offen offset:1024 lds
  buffer_load_dwordx4 v6, s[44:47], s67 offen offset:2048 lds
  s_mov_b32 s67, 225280
  s_add_u32 m0, s68, 36864
  s_nop 0
  buffer_load_dwordx4 v4, s[44:47], s67 offen offset:0 lds
  buffer_load_dwordx4 v5, s[44:47], s67 offen offset:1024 lds
  buffer_load_dwordx4 v6, s[44:47], s67 offen offset:2048 lds
  s_mov_b32 s67, 245760
  s_add_u32 m0, s68, 49152
  s_nop 0
  buffer_load_dwordx4 v4, s[44:47], s67 offen offset:0 lds
  buffer_load_dwordx4 v5, s[44:47], s67 offen offset:1024 lds
  buffer_load_dwordx4 v6, s[44:47], s67 offen offset:2048 lds
  v_min_u32 v16, 15, v1
  v_lshlrev_b32 v16, 7, v16
  s_lshr_b32 s62, s35, 4
  s_lshl_b32 s63, s31, 1
  s_add_u32 s62, s62, s63
  s_lshl_b32 s62, s62, 2
  s_add_u32 s62, s62, s30
  s_mul_i32 s62, s62, 2048
  s_add_u32 s74, s62, 180224
  s_mov_b32 s15, 400000
L_spin12:
  buffer_load_dword v17, v16, s[92:95], s74 offen offset:0 sc1
  s_waitcnt vmcnt(0)
  v_cmp_ne_u32 vcc, s14, v17
  s_cbranch_vccz L_done12
  s_sub_u32 s15, s15, 1
  s_cbranch_scc0 L_spin12
L_done12:
  s_mov_b32 s66, 0
  buffer_load_dwordx4 a[0:3], v2, s[56:59], s66 offen offset:0 sc1
  s_mov_b32 s66, 49152
  buffer_load_dwordx4 a[4:7], v2, s[56:59], s66 offen offset:0 sc1
  s_mov_b32 s66, 98304
  buffer_load_dwordx4 a[8:11], v2, s[56:59], s66 offen offset:0 sc1
  s_mov_b32 s66, 147456
  buffer_load_dwordx4 a[12:15], v2, s[56:59], s66 offen offset:0 sc1
  s_mov_b32 s66, 0
  buffer_load_dwordx4 a[16:19], v2, s[56:59], s66 offen offset:1024 sc1
  s_mov_b32 s66, 49152
  buffer_load_dwordx4 a[20:23], v2, s[56:59], s66 offen offset:1024 sc1
  s_mov_b32 s66, 98304
  buffer_load_dwordx4 a[24:27], v2, s[56:59], s66 offen offset:1024 sc1
  s_mov_b32 s66, 147456
  buffer_load_dwordx4 a[28:31], v2, s[56:59], s66 offen offset:1024 sc1
  s_mov_b32 s66, 0
  buffer_load_dwordx4 a[32:35], v2, s[56:59], s66 offen offset:2048 sc1
  s_mov_b32 s66, 49152
  buffer_load_dwordx4 a[36:39], v2, s[56:59], s66 offen offset:2048 sc1
  s_mov_b32 s66, 98304
  buffer_load_dwordx4 a[40:43], v2, s[56:59], s66 offen offset:2048 sc1
  s_mov_b32 s66, 147456
  buffer_load_dwordx4 a[44:47], v2, s[56:59], s66 offen offset:2048 sc1
  s_mov_b32 s66, 0
  buffer_load_dwordx4 a[48:51], v2, s[56:59], s66 offen offset:3072 sc1
  s_mov_b32 s66, 49152
  buffer_load_dwordx4 a[52:55], v2, s[56:59], s66 offen offset:3072 sc1
  s_mov_b32 s66, 98304
  buffer_load_dwordx4 a[56:59], v2, s[56:59], s66 offen offset:3072 sc1
  s_mov_b32 s66, 147456
  buffer_load_dwordx4 a[60:63], v2, s[56:59], s66 offen offset:3072 sc1
  ds_read_b64_tr_b16 a[192:193], v8 offset:0
  ds_read_b64_tr_b16 a[194:195], v8 offset:1280
  ds_read_b64_tr_b16 a[196:197], v8 offset:32
  ds_read_b64_tr_b16 a[198:199], v8 offset:1312
  ds_read_b64_tr_b16 a[200:201], v8 offset:64
  ds_read_b64_tr_b16 a[202:203], v8 offset:1344
  s_waitcnt vmcnt(12)
  s_waitcnt lgkmcnt(4)
  v_mfma_f32_16x16x32_bf16 v[96:99], a[192:195], a[0:3], 0
  s_mov_b32 s66, 4096
  buffer_load_dwordx4 a[64:67], v2, s[56:59], s66 offen offset:0 sc1
  v_mfma_f32_16x16x32_bf16 v[100:103], a[192:195], a[4:7], 0
  ds_read_b64_tr_b16 a[204:205], v8 offset:96
  ds_read_b64_tr_b16 a[206:207], v8 offset:1376
  v_mfma_f32_16x16x32_bf16 v[104:107], a[192:195], a[8:11], 0
  s_mov_b32 s66, 53248
  buffer_load_dwordx4 a[68:71], v2, s[56:59], s66 offen offset:0 sc1
  v_mfma_f32_16x16x32_bf16 v[108:111], a[192:195], a[12:15], 0
  s_mov_b32 s66, 102400
  buffer_load_dwordx4 a[72:75], v2, s[56:59], s66 offen offset:0 sc1
  s_waitcnt lgkmcnt(4)
  v_mfma_f32_16x16x32_bf16 v[112:115], a[196:199], a[0:3], 0
  s_mov_b32 s66, 151552
  buffer_load_dwordx4 a[76:79], v2, s[56:59], s66 offen offset:0 sc1
  v_mfma_f32_16x16x32_bf16 v[116:119], a[196:199], a[4:7], 0
  ds_read_b64_tr_b16 a[208:209], v8 offset:128
  ds_read_b64_tr_b16 a[210:211], v8 offset:1408
  v_mfma_f32_16x16x32_bf16 v[120:123], a[196:199], a[8:11], 0
  v_mfma_f32_16x16x32_bf16 v[124:127], a[196:199], a[12:15], 0
  s_waitcnt lgkmcnt(4)
  v_mfma_f32_16x16x32_bf16 v[128:131], a[200:203], a[0:3], 0
  v_mfma_f32_16x16x32_bf16 v[132:135], a[200:203], a[4:7], 0
  ds_read_b64_tr_b16 a[212:213], v8 offset:24576
  ds_read_b64_tr_b16 a[214:215], v8 offset:25856
  v_mfma_f32_16x16x32_bf16 v[136:139], a[200:203], a[8:11], 0
  v_mfma_f32_16x16x32_bf16 v[140:143], a[200:203], a[12:15], 0
  s_waitcnt lgkmcnt(4)
  v_mfma_f32_16x16x32_bf16 v[144:147], a[204:207], a[0:3], 0
  v_mfma_f32_16x16x32_bf16 v[148:151], a[204:207], a[4:7], 0
  ds_read_b64_tr_b16 a[216:217], v8 offset:24608
  ds_read_b64_tr_b16 a[218:219], v8 offset:25888
  v_mfma_f32_16x16x32_bf16 v[152:155], a[204:207], a[8:11], 0
  v_mfma_f32_16x16x32_bf16 v[156:159], a[204:207], a[12:15], 0
  s_waitcnt lgkmcnt(4)
  v_mfma_f32_16x16x32_bf16 v[160:163], a[208:211], a[0:3], 0
  v_mfma_f32_16x16x32_bf16 v[164:167], a[208:211], a[4:7], 0
  ds_read_b64_tr_b16 a[220:221], v8 offset:24640
  ds_read_b64_tr_b16 a[222:223], v8 offset:25920
  v_mfma_f32_16x16x32_bf16 v[168:171], a[208:211], a[8:11], 0
  v_mfma_f32_16x16x32_bf16 v[172:175], a[208:211], a[12:15], 0
  s_waitcnt vmcnt(12)
  s_waitcnt lgkmcnt(4)
  v_mfma_f32_16x16x32_bf16 v[96:99], a[212:215], a[16:19], v[96:99]
  s_mov_b32 s66, 4096
  buffer_load_dwordx4 a[80:83], v2, s[56:59], s66 offen offset:1024 sc1
  v_mfma_f32_16x16x32_bf16 v[100:103], a[212:215], a[20:23], v[100:103]
  ds_read_b64_tr_b16 a[192:193], v8 offset:24672
  ds_read_b64_tr_b16 a[194:195], v8 offset:25952
  v_mfma_f32_16x16x32_bf16 v[104:107], a[212:215], a[24:27], v[104:107]
  s_mov_b32 s66, 53248
  buffer_load_dwordx4 a[84:87], v2, s[56:59], s66 offen offset:1024 sc1
  v_mfma_f32_16x16x32_bf16 v[108:111], a[212:215], a[28:31], v[108:111]
  s_mov_b32 s66, 102400
  buffer_load_dwordx4 a[88:91], v2, s[56:59], s66 offen offset:1024 sc1
  s_waitcnt lgkmcnt(4)
  v_mfma_f32_16x16x32_bf16 v[112:115], a[216:219], a[16:19], v[112:115]
  s_mov_b32 s66, 151552
  buffer_load_dwordx4 a[92:95], v2, s[56:59], s66 offen offset:1024 sc1
  v_mfma_f32_16x16x32_bf16 v[116:119], a[216:219], a[20:23], v[116:119]
  ds_read_b64_tr_b16 a[196:197], v8 offset:24704
  ds_read_b64_tr_b16 a[198:199], v8 offset:25984
  v_mfma_f32_16x16x32_bf16 v[120:123], a[216:219], a[24:27], v[120:123]
  s_mov_b32 s67, 266240
  s_add_u32 m0, s68, 61440
  s_nop 0
  buffer_load_dwordx4 v4, s[44:47], s67 offen offset:0 lds
  v_mfma_f32_16x16x32_bf16 v[124:127], a[216:219], a[28:31], v[124:127]
  buffer_load_dwordx4 v5, s[44:47], s67 offen offset:1024 lds
  s_waitcnt lgkmcnt(4)
  v_mfma_f32_16x16x32_bf16 v[128:131], a[220:223], a[16:19], v[128:131]
  buffer_load_dwordx4 v6, s[44:47], s67 offen offset:2048 lds
  v_mfma_f32_16x16x32_bf16 v[132:135], a[220:223], a[20:23], v[132:135]
  ds_read_b64_tr_b16 a[200:201], v8 offset:49152
  ds_read_b64_tr_b16 a[202:203], v8 offset:50432
  v_mfma_f32_16x16x32_bf16 v[136:139], a[220:223], a[24:27], v[136:139]
  s_mov_b32 s67, 286720
  s_add_u32 m0, s68, 73728
  s_nop 0
  buffer_load_dwordx4 v4, s[44:47], s67 offen offset:0 lds
  v_mfma_f32_16x16x32_bf16 v[140:143], a[220:223], a[28:31], v[140:143]
  buffer_load_dwordx4 v5, s[44:47], s67 offen offset:1024 lds
  s_waitcnt lgkmcnt(4)
  v_mfma_f32_16x16x32_bf16 v[144:147], a[192:195], a[16:19], v[144:147]
  buffer_load_dwordx4 v6, s[44:47], s67 offen offset:2048 lds
  v_mfma_f32_16x16x32_bf16 v[148:151], a[192:195], a[20:23], v[148:151]
  ds_read_b64_tr_b16 a[204:205], v8 offset:49184
  ds_read_b64_tr_b16 a[206:207], v8 offset:50464
  v_mfma_f32_16x16x32_bf16 v[152:155], a[192:195], a[24:27], v[152:155]
  v_mfma_f32_16x16x32_bf16 v[156:159], a[192:195], a[28:31], v[156:159]
  s_waitcnt lgkmcnt(4)
  v_mfma_f32_16x16x32_bf16 v[160:163], a[196:199], a[16:19], v[160:163]
  v_mfma_f32_16x16x32_bf16 v[164:167], a[196:199], a[20:23], v[164:167]
  ds_read_b64_tr_b16 a[208:209], v8 offset:49216
  ds_read_b64_tr_b16 a[210:211], v8 offset:50496
  v_mfma_f32_16x16x32_bf16 v[168:171], a[196:199], a[24:27], v[168:171]
  v_mfma_f32_16x16x32_bf16 v[172:175], a[196:199], a[28:31], v[172:175]
  s_waitcnt vmcnt(18)
  s_waitcnt lgkmcnt(4)
  v_mfma_f32_16x16x32_bf16 v[96:99], a[200:203], a[32:35], v[96:99]
  s_mov_b32 s66, 4096
  buffer_load_dwordx4 a[96:99], v2, s[56:59], s66 offen offset:2048 sc1
  v_mfma_f32_16x16x32_bf16 v[100:103], a[200:203], a[36:39], v[100:103]
  ds_read_b64_tr_b16 a[212:213], v8 offset:49248
  ds_read_b64_tr_b16 a[214:215], v8 offset:50528
  v_mfma_f32_16x16x32_bf16 v[104:107], a[200:203], a[40:43], v[104:107]
  s_mov_b32 s66, 53248
  buffer_load_dwordx4 a[100:103], v2, s[56:59], s66 offen offset:2048 sc1
  v_mfma_f32_16x16x32_bf16 v[108:111], a[200:203], a[44:47], v[108:111]
  s_mov_b32 s66, 102400
  buffer_load_dwordx4 a[104:107], v2, s[56:59], s66 offen offset:2048 sc1
  s_waitcnt lgkmcnt(4)
  v_mfma_f32_16x16x32_bf16 v[112:115], a[204:207], a[32:35], v[112:115]
  s_mov_b32 s66, 151552
  buffer_load_dwordx4 a[108:111], v2, s[56:59], s66 offen offset:2048 sc1
  v_mfma_f32_16x16x32_bf16 v[116:119], a[204:207], a[36:39], v[116:119]
  ds_read_b64_tr_b16 a[216:217], v8 offset:49280
  ds_read_b64_tr_b16 a[218:219], v8 offset:50560
  v_mfma_f32_16x16x32_bf16 v[120:123], a[204:207], a[40:43], v[120:123]
  s_mov_b32 s67, 307200
  s_add_u32 m0, s68, 86016
  s_nop 0
  buffer_load_dwordx4 v4, s[44:47], s67 offen offset:0 lds
  v_mfma_f32_16x16x32_bf16 v[124:127], a[204:207], a[44:47], v[124:127]
  buffer_load_dwordx4 v5, s[44:47], s67 offen offset:1024 lds
  s_waitcnt lgkmcnt(4)
  v_mfma_f32_16x16x32_bf16 v[128:131], a[208:211], a[32:35], v[128:131]
  buffer_load_dwordx4 v6, s[44:47], s67 offen offset:2048 lds
  v_mfma_f32_16x16x32_bf16 v[132:135], a[208:211], a[36:39], v[132:135]
  ds_read_b64_tr_b16 a[220:221], v9 offset:12288
  ds_read_b64_tr_b16 a[222:223], v9 offset:13568
  v_mfma_f32_16x16x32_bf16 v[136:139], a[208:211], a[40:43], v[136:139]
  s_mov_b32 s67, 327680
  s_add_u32 m0, s68, 98304
  s_nop 0
  buffer_load_dwordx4 v4, s[44:47], s67 offen offset:0 lds
  v_mfma_f32_16x16x32_bf16 v[140:143], a[208:211], a[44:47], v[140:143]
  buffer_load_dwordx4 v5, s[44:47], s67 offen offset:1024 lds
  s_waitcnt lgkmcnt(4)
  v_mfma_f32_16x16x32_bf16 v[144:147], a[212:215], a[32:35], v[144:147]
  buffer_load_dwordx4 v6, s[44:47], s67 offen offset:2048 lds
  v_mfma_f32_16x16x32_bf16 v[148:151], a[212:215], a[36:39], v[148:151]
  ds_read_b64_tr_b16 a[192:193], v9 offset:12320
  ds_read_b64_tr_b16 a[194:195], v9 offset:13600
  v_mfma_f32_16x16x32_bf16 v[152:155], a[212:215], a[40:43], v[152:155]
  v_mfma_f32_16x16x32_bf16 v[156:159], a[212:215], a[44:47], v[156:159]
  s_waitcnt lgkmcnt(4)
  v_mfma_f32_16x16x32_bf16 v[160:163], a[216:219], a[32:35], v[160:163]
  v_mfma_f32_16x16x32_bf16 v[164:167], a[216:219], a[36:39], v[164:167]
  ds_read_b64_tr_b16 a[196:197], v9 offset:12352
  ds_read_b64_tr_b16 a[198:199], v9 offset:13632
  v_mfma_f32_16x16x32_bf16 v[168:171], a[216:219], a[40:43], v[168:171]
  v_mfma_f32_16x16x32_bf16 v[172:175], a[216:219], a[44:47], v[172:175]
  s_waitcnt vmcnt(24)
  s_waitcnt lgkmcnt(4)
  v_mfma_f32_16x16x32_bf16 v[96:99], a[220:223], a[48:51], v[96:99]
  s_mov_b32 s66, 4096
  buffer_load_dwordx4 a[112:115], v2, s[56:59], s66 offen offset:3072 sc1
  v_mfma_f32_16x16x32_bf16 v[100:103], a[220:223], a[52:55], v[100:103]
  ds_read_b64_tr_b16 a[200:201], v9 offset:12384
  ds_read_b64_tr_b16 a[202:203], v9 offset:13664
  v_mfma_f32_16x16x32_bf16 v[104:107], a[220:223], a[56:59], v[104:107]
  s_mov_b32 s66, 53248
  buffer_load_dwordx4 a[116:119], v2, s[56:59], s66 offen offset:3072 sc1
  v_mfma_f32_16x16x32_bf16 v[108:111], a[220:223], a[60:63], v[108:111]
  s_mov_b32 s66, 102400
  buffer_load_dwordx4 a[120:123], v2, s[56:59], s66 offen offset:3072 sc1
  s_waitcnt lgkmcnt(4)
  v_mfma_f32_16x16x32_bf16 v[112:115], a[192:195], a[48:51], v[112:115]
  s_mov_b32 s66, 151552
  buffer_load_dwordx4 a[124:127], v2, s[56:59], s66 offen offset:3072 sc1
  v_mfma_f32_16x16x32_bf16 v[116:119], a[192:195], a[52:55], v[116:119]
  ds_read_b64_tr_b16 a[204:205], v9 offset:12416
  ds_read_b64_tr_b16 a[206:207], v9 offset:13696
  v_mfma_f32_16x16x32_bf16 v[120:123], a[192:195], a[56:59], v[120:123]
  s_mov_b32 s67, 348160
  s_add_u32 m0, s68, 110592
  s_nop 0
  buffer_load_dwordx4 v4, s[44:47], s67 offen offset:0 lds
  v_mfma_f32_16x16x32_bf16 v[124:127], a[192:195], a[60:63], v[124:127]
  buffer_load_dwordx4 v5, s[44:47], s67 offen offset:1024 lds
  s_waitcnt lgkmcnt(4)
  v_mfma_f32_16x16x32_bf16 v[128:131], a[196:199], a[48:51], v[128:131]
  buffer_load_dwordx4 v6, s[44:47], s67 offen offset:2048 lds
  v_mfma_f32_16x16x32_bf16 v[132:135], a[196:199], a[52:55], v[132:135]
  ds_read_b64_tr_b16 a[208:209], v7 offset:0
  ds_read_b64_tr_b16 a[210:211], v7 offset:1280
  v_mfma_f32_16x16x32_bf16 v[136:139], a[196:199], a[56:59], v[136:139]
  s_mov_b32 s67, 368640
  s_add_u32 m0, s68, 122880
  s_nop 0
  buffer_load_dwordx4 v4, s[44:47], s67 offen offset:0 lds
  v_mfma_f32_16x16x32_bf16 v[140:143], a[196:199], a[60:63], v[140:143]
  buffer_load_dwordx4 v5, s[44:47], s67 offen offset:1024 lds
  s_waitcnt lgkmcnt(4)
  v_mfma_f32_16x16x32_bf16 v[144:147], a[200:203], a[48:51], v[144:147]
  buffer_load_dwordx4 v6, s[44:47], s67 offen offset:2048 lds
  v_mfma_f32_16x16x32_bf16 v[148:151], a[200:203], a[52:55], v[148:151]
  ds_read_b64_tr_b16 a[212:213], v7 offset:32
  ds_read_b64_tr_b16 a[214:215], v7 offset:1312
  v_mfma_f32_16x16x32_bf16 v[152:155], a[200:203], a[56:59], v[152:155]
  v_mfma_f32_16x16x32_bf16 v[156:159], a[200:203], a[60:63], v[156:159]
  s_waitcnt lgkmcnt(4)
  v_mfma_f32_16x16x32_bf16 v[160:163], a[204:207], a[48:51], v[160:163]
  v_mfma_f32_16x16x32_bf16 v[164:167], a[204:207], a[52:55], v[164:167]
  ds_read_b64_tr_b16 a[216:217], v7 offset:64
  ds_read_b64_tr_b16 a[218:219], v7 offset:1344
  v_mfma_f32_16x16x32_bf16 v[168:171], a[204:207], a[56:59], v[168:171]
  v_mfma_f32_16x16x32_bf16 v[172:175], a[204:207], a[60:63], v[172:175]
  s_waitcnt vmcnt(30)
  s_waitcnt lgkmcnt(4)
  v_mfma_f32_16x16x32_bf16 v[96:99], a[208:211], a[64:67], v[96:99]
  s_mov_b32 s66, 8192
  buffer_load_dwordx4 a[128:131], v2, s[56:59], s66 offen offset:0 sc1
  v_mfma_f32_16x16x32_bf16 v[100:103], a[208:211], a[68:71], v[100:103]
  ds_read_b64_tr_b16 a[220:221], v7 offset:96
  ds_read_b64_tr_b16 a[222:223], v7 offset:1376
  v_mfma_f32_16x16x32_bf16 v[104:107], a[208:211], a[72:75], v[104:107]
  s_mov_b32 s66, 57344
  buffer_load_dwordx4 a[132:135], v2, s[56:59], s66 offen offset:0 sc1
  v_mfma_f32_16x16x32_bf16 v[108:111], a[208:211], a[76:79], v[108:111]
  s_mov_b32 s66, 106496
  buffer_load_dwordx4 a[136:139], v2, s[56:59], s66 offen offset:0 sc1
  s_waitcnt lgkmcnt(4)
  v_mfma_f32_16x16x32_bf16 v[112:115], a[212:215], a[64:67], v[112:115]
  s_mov_b32 s66, 155648
  buffer_load_dwordx4 a[140:143], v2, s[56:59], s66 offen offset:0 sc1
  v_mfma_f32_16x16x32_bf16 v[116:119], a[212:215], a[68:71], v[116:119]
  ds_read_b64_tr_b16 a[192:193], v7 offset:128
  ds_read_b64_tr_b16 a[194:195], v7 offset:1408
  v_mfma_f32_16x16x32_bf16 v[120:123], a[212:215], a[72:75], v[120:123]
  s_mov_b32 s67, 389120
  s_add_u32 m0, s68, 135168
  s_nop 0
  buffer_load_dwordx4 v4, s[44:47], s67 offen offset:0 lds
  v_mfma_f32_16x16x32_bf16 v[124:127], a[212:215], a[76:79], v[124:127]
  buffer_load_dwordx4 v5, s[44:47], s67 offen offset:1024 lds
  s_waitcnt lgkmcnt(4)
  v_mfma_f32_16x16x32_bf16 v[128:131], a[216:219], a[64:67], v[128:131]
  buffer_load_dwordx4 v6, s[44:47], s67 offen offset:2048 lds
  v_mfma_f32_16x16x32_bf16 v[132:135], a[216:219], a[68:71], v[132:135]
  ds_read_b64_tr_b16 a[196:197], v7 offset:24576
  ds_read_b64_tr_b16 a[198:199], v7 offset:25856
  v_mfma_f32_16x16x32_bf16 v[136:139], a[216:219], a[72:75], v[136:139]
  s_mov_b32 s67, 409600
  s_add_u32 m0, s68, 147456
  s_nop 0
  buffer_load_dwordx4 v4, s[44:47], s67 offen offset:0 lds
  v_mfma_f32_16x16x32_bf16 v[140:143], a[216:219], a[76:79], v[140:143]
  buffer_load_dwordx4 v5, s[44:47], s67 offen offset:1024 lds
  s_waitcnt lgkmcnt(4)
  v_mfma_f32_16x16x32_bf16 v[144:147], a[220:223], a[64:67], v[144:147]
  buffer_load_dwordx4 v6, s[44:47], s67 offen offset:2048 lds
  v_mfma_f32_16x16x32_bf16 v[148:151], a[220:223], a[68:71], v[148:151]
  ds_read_b64_tr_b16 a[200:201], v7 offset:24608
  ds_read_b64_tr_b16 a[202:203], v7 offset:25888
  v_mfma_f32_16x16x32_bf16 v[152:155], a[220:223], a[72:75], v[152:155]
  v_mfma_f32_16x16x32_bf16 v[156:159], a[220:223], a[76:79], v[156:159]
  s_waitcnt lgkmcnt(4)
  v_mfma_f32_16x16x32_bf16 v[160:163], a[192:195], a[64:67], v[160:163]
  v_mfma_f32_16x16x32_bf16 v[164:167], a[192:195], a[68:71], v[164:167]
  ds_read_b64_tr_b16 a[204:205], v7 offset:24640
  ds_read_b64_tr_b16 a[206:207], v7 offset:25920
  v_mfma_f32_16x16x32_bf16 v[168:171], a[192:195], a[72:75], v[168:171]
  v_mfma_f32_16x16x32_bf16 v[172:175], a[192:195], a[76:79], v[172:175]
  s_waitcnt vmcnt(36)
  s_waitcnt lgkmcnt(4)
  v_mfma_f32_16x16x32_bf16 v[96:99], a[196:199], a[80:83], v[96:99]
  s_mov_b32 s66, 8192
  buffer_load_dwordx4 a[144:147], v2, s[56:59], s66 offen offset:1024 sc1
  v_mfma_f32_16x16x32_bf16 v[100:103], a[196:199], a[84:87], v[100:103]
  ds_read_b64_tr_b16 a[208:209], v7 offset:24672
  ds_read_b64_tr_b16 a[210:211], v7 offset:25952
  v_mfma_f32_16x16x32_bf16 v[104:107], a[196:199], a[88:91], v[104:107]
  s_mov_b32 s66, 57344
  buffer_load_dwordx4 a[148:151], v2, s[56:59], s66 offen offset:1024 sc1
  v_mfma_f32_16x16x32_bf16 v[108:111], a[196:199], a[92:95], v[108:111]
  s_mov_b32 s66, 106496
  buffer_load_dwordx4 a[152:155], v2, s[56:59], s66 offen offset:1024 sc1
  s_waitcnt lgkmcnt(4)
  v_mfma_f32_16x16x32_bf16 v[112:115], a[200:203], a[80:83], v[112:115]
  s_mov_b32 s66, 155648
  buffer_load_dwordx4 a[156:159], v2, s[56:59], s66 offen offset:1024 sc1
  v_mfma_f32_16x16x32_bf16 v[116:119], a[200:203], a[84:87], v[116:119]
  ds_read_b64_tr_b16 a[212:213], v7 offset:24704
  ds_read_b64_tr_b16 a[214:215], v7 offset:25984
  v_mfma_f32_16x16x32_bf16 v[120:123], a[200:203], a[88:91], v[120:123]
  s_mov_b32 s67, 430080
  s_add_u32 m0, s68, 0
  s_nop 0
  buffer_load_dwordx4 v4, s[44:47], s67 offen offset:0 lds
  v_mfma_f32_16x16x32_bf16 v[124:127], a[200:203], a[92:95], v[124:127]
  buffer_load_dwordx4 v5, s[44:47], s67 offen offset:1024 lds
  s_waitcnt lgkmcnt(4)
  v_mfma_f32_16x16x32_bf16 v[128:131], a[204:207], a[80:83], v[128:131]
  buffer_load_dwordx4 v6, s[44:47], s67 offen offset:2048 lds
  v_mfma_f32_16x16x32_bf16 v[132:135], a[204:207], a[84:87], v[132:135]
  s_waitcnt vmcnt(40)
  ds_read_b64_tr_b16 a[216:217], v7 offset:49152
  ds_read_b64_tr_b16 a[218:219], v7 offset:50432
  v_mfma_f32_16x16x32_bf16 v[136:139], a[204:207], a[88:91], v[136:139]
  s_mov_b32 s67, 450560
  s_add_u32 m0, s68, 12288
  s_nop 0
  buffer_load_dwordx4 v4, s[44:47], s67 offen offset:0 lds
  v_mfma_f32_16x16x32_bf16 v[140:143], a[204:207], a[92:95], v[140:143]
  buffer_load_dwordx4 v5, s[44:47], s67 offen offset:1024 lds
  s_waitcnt lgkmcnt(4)
  v_mfma_f32_16x16x32_bf16 v[144:147], a[208:211], a[80:83], v[144:147]
  buffer_load_dwordx4 v6, s[44:47], s67 offen offset:2048 lds
  v_mfma_f32_16x16x32_bf16 v[148:151], a[208:211], a[84:87], v[148:151]
  ds_read_b64_tr_b16 a[220:221], v7 offset:49184
  ds_read_b64_tr_b16 a[222:223], v7 offset:50464
  v_mfma_f32_16x16x32_bf16 v[152:155], a[208:211], a[88:91], v[152:155]
  v_mfma_f32_16x16x32_bf16 v[156:159], a[208:211], a[92:95], v[156:159]
  s_waitcnt lgkmcnt(4)
  v_mfma_f32_16x16x32_bf16 v[160:163], a[212:215], a[80:83], v[160:163]
  v_mfma_f32_16x16x32_bf16 v[164:167], a[212:215], a[84:87], v[164:167]
  ds_read_b64_tr_b16 a[192:193], v7 offset:49216
  ds_read_b64_tr_b16 a[194:195], v7 offset:50496
  v_mfma_f32_16x16x32_bf16 v[168:171], a[212:215], a[88:91], v[168:171]
  v_mfma_f32_16x16x32_bf16 v[172:175], a[212:215], a[92:95], v[172:175]
  s_waitcnt vmcnt(36)
  s_waitcnt lgkmcnt(4)
  v_mfma_f32_16x16x32_bf16 v[96:99], a[216:219], a[96:99], v[96:99]
  s_mov_b32 s66, 8192
  buffer_load_dwordx4 a[160:163], v2, s[56:59], s66 offen offset:2048 sc1
  v_mfma_f32_16x16x32_bf16 v[100:103], a[216:219], a[100:103], v[100:103]
  ds_read_b64_tr_b16 a[196:197], v7 offset:49248
  ds_read_b64_tr_b16 a[198:199], v7 offset:50528
  v_mfma_f32_16x16x32_bf16 v[104:107], a[216:219], a[104:107], v[104:107]
  s_mov_b32 s66, 57344
  buffer_load_dwordx4 a[164:167], v2, s[56:59], s66 offen offset:2048 sc1
  v_mfma_f32_16x16x32_bf16 v[108:111], a[216:219], a[108:111], v[108:111]
  s_mov_b32 s66, 106496
  buffer_load_dwordx4 a[168:171], v2, s[56:59], s66 offen offset:2048 sc1
  s_waitcnt lgkmcnt(4)
  v_mfma_f32_16x16x32_bf16 v[112:115], a[220:223], a[96:99], v[112:115]
  s_mov_b32 s66, 155648
  buffer_load_dwordx4 a[172:175], v2, s[56:59], s66 offen offset:2048 sc1
  v_mfma_f32_16x16x32_bf16 v[116:119], a[220:223], a[100:103], v[116:119]
  ds_read_b64_tr_b16 a[200:201], v7 offset:49280
  ds_read_b64_tr_b16 a[202:203], v7 offset:50560
  v_mfma_f32_16x16x32_bf16 v[120:123], a[220:223], a[104:107], v[120:123]
  s_mov_b32 s67, 471040
  s_add_u32 m0, s68, 24576
  s_nop 0
  buffer_load_dwordx4 v4, s[44:47], s67 offen offset:0 lds
  v_mfma_f32_16x16x32_bf16 v[124:127], a[220:223], a[108:111], v[124:127]
  buffer_load_dwordx4 v5, s[44:47], s67 offen offset:1024 lds
  s_waitcnt lgkmcnt(4)
  v_mfma_f32_16x16x32_bf16 v[128:131], a[192:195], a[96:99], v[128:131]
  buffer_load_dwordx4 v6, s[44:47], s67 offen offset:2048 lds
  v_mfma_f32_16x16x32_bf16 v[132:135], a[192:195], a[100:103], v[132:135]
  s_waitcnt vmcnt(40)
  ds_read_b64_tr_b16 a[204:205], v8 offset:12288
  ds_read_b64_tr_b16 a[206:207], v8 offset:13568
  v_mfma_f32_16x16x32_bf16 v[136:139], a[192:195], a[104:107], v[136:139]
  buffer_load_dwordx2 v[20:21], v11, s[36:39], 0 offen offset:0 sc1
  v_mfma_f32_16x16x32_bf16 v[140:143], a[192:195], a[108:111], v[140:143]
  buffer_load_dwordx2 v[22:23], v11, s[36:39], 0 offen offset:1024 sc1
  s_waitcnt lgkmcnt(4)
  v_mfma_f32_16x16x32_bf16 v[144:147], a[196:199], a[96:99], v[144:147]
  buffer_load_dwordx2 v[24:25], v11, s[36:39], 0 offen offset:2048 sc1
  v_mfma_f32_16x16x32_bf16 v[148:151], a[196:199], a[100:103], v[148:151]
  ds_read_b64_tr_b16 a[208:209], v8 offset:12320
  ds_read_b64_tr_b16 a[210:211], v8 offset:13600
  v_mfma_f32_16x16x32_bf16 v[152:155], a[196:199], a[104:107], v[152:155]
  buffer_load_dwordx2 v[26:27], v11, s[36:39], 0 offen offset:3072 sc1
  v_mfma_f32_16x16x32_bf16 v[156:159], a[196:199], a[108:111], v[156:159]
  s_mov_b32 s66, 4096
  buffer_load_dwordx2 v[28:29], v11, s[36:39], s66 offen sc1
  s_waitcnt lgkmcnt(4)
  v_mfma_f32_16x16x32_bf16 v[160:163], a[200:203], a[96:99], v[160:163]
  buffer_load_dwordx4 v[32:35], v12, s[40:43], 0 offen offset:0 sc1
  v_mfma_f32_16x16x32_bf16 v[164:167], a[200:203], a[100:103], v[164:167]
  ds_read_b64_tr_b16 a[212:213], v8 offset:12352
  ds_read_b64_tr_b16 a[214:215], v8 offset:13632
  v_mfma_f32_16x16x32_bf16 v[168:171], a[200:203], a[104:107], v[168:171]
  buffer_load_dwordx4 v[36:39], v12, s[40:43], 0 offen offset:64 sc1
  v_mfma_f32_16x16x32_bf16 v[172:175], a[200:203], a[108:111], v[172:175]
  buffer_load_dwordx4 v[40:43], v12, s[40:43], 0 offen offset:128 sc1
  buffer_load_dwordx4 v[44:47], v12, s[40:43], 0 offen offset:192 sc1
  buffer_load_dwordx4 v[48:51], v12, s[40:43], 0 offen offset:256 sc1
  s_waitcnt vmcnt(43)
  s_waitcnt lgkmcnt(4)
  v_mfma_f32_16x16x32_bf16 v[96:99], a[204:207], a[112:115], v[96:99]
  s_mov_b32 s66, 8192
  buffer_load_dwordx4 a[176:179], v2, s[56:59], s66 offen offset:3072 sc1
  v_mfma_f32_16x16x32_bf16 v[100:103], a[204:207], a[116:119], v[100:103]
  ds_read_b64_tr_b16 a[216:217], v8 offset:12384
  ds_read_b64_tr_b16 a[218:219], v8 offset:13664
  v_mfma_f32_16x16x32_bf16 v[104:107], a[204:207], a[120:123], v[104:107]
  s_mov_b32 s66, 57344
  buffer_load_dwordx4 a[180:183], v2, s[56:59], s66 offen offset:3072 sc1
  v_mfma_f32_16x16x32_bf16 v[108:111], a[204:207], a[124:127], v[108:111]
  s_mov_b32 s66, 106496
  buffer_load_dwordx4 a[184:187], v2, s[56:59], s66 offen offset:3072 sc1
  s_waitcnt lgkmcnt(4)
  v_mfma_f32_16x16x32_bf16 v[112:115], a[208:211], a[112:115], v[112:115]
  s_mov_b32 s66, 155648
  buffer_load_dwordx4 a[188:191], v2, s[56:59], s66 offen offset:3072 sc1
  v_mfma_f32_16x16x32_bf16 v[116:119], a[208:211], a[116:119], v[116:119]
  ds_read_b64_tr_b16 a[220:221], v8 offset:12416
  ds_read_b64_tr_b16 a[222:223], v8 offset:13696
  v_mfma_f32_16x16x32_bf16 v[120:123], a[208:211], a[120:123], v[120:123]
  v_mfma_f32_16x16x32_bf16 v[124:127], a[208:211], a[124:127], v[124:127]
  s_waitcnt lgkmcnt(4)
  v_mfma_f32_16x16x32_bf16 v[128:131], a[212:215], a[112:115], v[128:131]
  v_mfma_f32_16x16x32_bf16 v[132:135], a[212:215], a[116:119], v[132:135]
  s_waitcnt vmcnt(44)
  ds_read_b64_tr_b16 a[192:193], v8 offset:36864
  ds_read_b64_tr_b16 a[194:195], v8 offset:38144
  v_mfma_f32_16x16x32_bf16 v[136:139], a[212:215], a[120:123], v[136:139]
  v_mfma_f32_16x16x32_bf16 v[140:143], a[212:215], a[124:127], v[140:143]
  s_waitcnt lgkmcnt(4)
  v_mfma_f32_16x16x32_bf16 v[144:147], a[216:219], a[112:115], v[144:147]
  v_mfma_f32_16x16x32_bf16 v[148:151], a[216:219], a[116:119], v[148:151]
  ds_read_b64_tr_b16 a[196:197], v8 offset:36896
  ds_read_b64_tr_b16 a[198:199], v8 offset:38176
  v_mfma_f32_16x16x32_bf16 v[152:155], a[216:219], a[120:123], v[152:155]
  v_mfma_f32_16x16x32_bf16 v[156:159], a[216:219], a[124:127], v[156:159]
  s_waitcnt lgkmcnt(4)
  v_mfma_f32_16x16x32_bf16 v[160:163], a[220:223], a[112:115], v[160:163]
  v_mfma_f32_16x16x32_bf16 v[164:167], a[220:223], a[116:119], v[164:167]
  ds_read_b64_tr_b16 a[200:201], v8 offset:36928
  ds_read_b64_tr_b16 a[202:203], v8 offset:38208
  v_mfma_f32_16x16x32_bf16 v[168:171], a[220:223], a[120:123], v[168:171]
  v_mfma_f32_16x16x32_bf16 v[172:175], a[220:223], a[124:127], v[172:175]
  s_waitcnt vmcnt(37)
  s_waitcnt lgkmcnt(4)
  v_mfma_f32_16x16x32_bf16 v[96:99], a[192:195], a[128:131], v[96:99]
  v_mfma_f32_16x16x32_bf16 v[100:103], a[192:195], a[132:135], v[100:103]
  ds_read_b64_tr_b16 a[204:205], v8 offset:36960
  ds_read_b64_tr_b16 a[206:207], v8 offset:38240
  v_mfma_f32_16x16x32_bf16 v[104:107], a[192:195], a[136:139], v[104:107]
  v_mfma_f32_16x16x32_bf16 v[108:111], a[192:195], a[140:143], v[108:111]
  s_waitcnt lgkmcnt(4)
  v_mfma_f32_16x16x32_bf16 v[112:115], a[196:199], a[128:131], v[112:115]
  v_mfma_f32_16x16x32_bf16 v[116:119], a[196:199], a[132:135], v[116:119]
  ds_read_b64_tr_b16 a[208:209], v8 offset:36992
  ds_read_b64_tr_b16 a[210:211], v8 offset:38272
  v_mfma_f32_16x16x32_bf16 v[120:123], a[196:199], a[136:139], v[120:123]
  v_mfma_f32_16x16x32_bf16 v[124:127], a[196:199], a[140:143], v[124:127]
  s_waitcnt lgkmcnt(4)
  v_mfma_f32_16x16x32_bf16 v[128:131], a[200:203], a[128:131], v[128:131]
  v_mfma_f32_16x16x32_bf16 v[132:135], a[200:203], a[132:135], v[132:135]
  s_waitcnt vmcnt(34)
  ds_read_b64_tr_b16 a[212:213], v9 offset:0
  ds_read_b64_tr_b16 a[214:215], v9 offset:1280
  v_mfma_f32_16x16x32_bf16 v[136:139], a[200:203], a[136:139], v[136:139]
  v_mfma_f32_16x16x32_bf16 v[140:143], a[200:203], a[140:143], v[140:143]
  s_waitcnt lgkmcnt(4)
  v_mfma_f32_16x16x32_bf16 v[144:147], a[204:207], a[128:131], v[144:147]
  v_mfma_f32_16x16x32_bf16 v[148:151], a[204:207], a[132:135], v[148:151]
  ds_read_b64_tr_b16 a[216:217], v9 offset:32
  ds_read_b64_tr_b16 a[218:219], v9 offset:1312
  v_mfma_f32_16x16x32_bf16 v[152:155], a[204:207], a[136:139], v[152:155]
  v_mfma_f32_16x16x32_bf16 v[156:159], a[204:207], a[140:143], v[156:159]
  s_waitcnt lgkmcnt(4)
  v_mfma_f32_16x16x32_bf16 v[160:163], a[208:211], a[128:131], v[160:163]
  v_mfma_f32_16x16x32_bf16 v[164:167], a[208:211], a[132:135], v[164:167]
  ds_read_b64_tr_b16 a[220:221], v9 offset:64
  ds_read_b64_tr_b16 a[222:223], v9 offset:1344
  v_mfma_f32_16x16x32_bf16 v[168:171], a[208:211], a[136:139], v[168:171]
  v_mfma_f32_16x16x32_bf16 v[172:175], a[208:211], a[140:143], v[172:175]
  s_waitcnt vmcnt(27)
  s_waitcnt lgkmcnt(4)
  v_mfma_f32_16x16x32_bf16 v[96:99], a[212:215], a[144:147], v[96:99]
  v_mfma_f32_16x16x32_bf16 v[100:103], a[212:215], a[148:151], v[100:103]
  ds_read_b64_tr_b16 a[192:193], v9 offset:96
  ds_read_b64_tr_b16 a[194:195], v9 offset:1376
  v_mfma_f32_16x16x32_bf16 v[104:107], a[212:215], a[152:155], v[104:107]
  v_mfma_f32_16x16x32_bf16 v[108:111], a[212:215], a[156:159], v[108:111]
  s_waitcnt lgkmcnt(4)
  v_mfma_f32_16x16x32_bf16 v[112:115], a[216:219], a[144:147], v[112:115]
  v_mfma_f32_16x16x32_bf16 v[116:119], a[216:219], a[148:151], v[116:119]
  ds_read_b64_tr_b16 a[196:197], v9 offset:128
  ds_read_b64_tr_b16 a[198:199], v9 offset:1408
  v_mfma_f32_16x16x32_bf16 v[120:123], a[216:219], a[152:155], v[120:123]
  v_mfma_f32_16x16x32_bf16 v[124:127], a[216:219], a[156:159], v[124:127]
  s_waitcnt lgkmcnt(4)
  v_mfma_f32_16x16x32_bf16 v[128:131], a[220:223], a[144:147], v[128:131]
  v_mfma_f32_16x16x32_bf16 v[132:135], a[220:223], a[148:151], v[132:135]
  s_waitcnt vmcnt(24)
  ds_read_b64_tr_b16 a[200:201], v10 offset:0
  ds_read_b64_tr_b16 a[202:203], v10 offset:1280
  v_mfma_f32_16x16x32_bf16 v[136:139], a[220:223], a[152:155], v[136:139]
  v_mfma_f32_16x16x32_bf16 v[140:143], a[220:223], a[156:159], v[140:143]
  s_waitcnt lgkmcnt(4)
  v_mfma_f32_16x16x32_bf16 v[144:147], a[192:195], a[144:147], v[144:147]
  v_mfma_f32_16x16x32_bf16 v[148:151], a[192:195], a[148:151], v[148:151]
  ds_read_b64_tr_b16 a[204:205], v10 offset:32
  ds_read_b64_tr_b16 a[206:207], v10 offset:1312
  v_mfma_f32_16x16x32_bf16 v[152:155], a[192:195], a[152:155], v[152:155]
  v_mfma_f32_16x16x32_bf16 v[156:159], a[192:195], a[156:159], v[156:159]
  s_waitcnt lgkmcnt(4)
  v_mfma_f32_16x16x32_bf16 v[160:163], a[196:199], a[144:147], v[160:163]
  v_mfma_f32_16x16x32_bf16 v[164:167], a[196:199], a[148:151], v[164:167]
  ds_read_b64_tr_b16 a[208:209], v10 offset:64
  ds_read_b64_tr_b16 a[210:211], v10 offset:1344
  v_mfma_f32_16x16x32_bf16 v[168:171], a[196:199], a[152:155], v[168:171]
  v_mfma_f32_16x16x32_bf16 v[172:175], a[196:199], a[156:159], v[172:175]
  s_waitcnt vmcnt(17)
  s_waitcnt lgkmcnt(4)
  v_mfma_f32_16x16x32_bf16 v[96:99], a[200:203], a[160:163], v[96:99]
  v_mfma_f32_16x16x32_bf16 v[100:103], a[200:203], a[164:167], v[100:103]
  ds_read_b64_tr_b16 a[212:213], v10 offset:96
  ds_read_b64_tr_b16 a[214:215], v10 offset:1376
  v_mfma_f32_16x16x32_bf16 v[104:107], a[200:203], a[168:171], v[104:107]
  v_mfma_f32_16x16x32_bf16 v[108:111], a[200:203], a[172:175], v[108:111]
  s_waitcnt lgkmcnt(4)
  v_mfma_f32_16x16x32_bf16 v[112:115], a[204:207], a[160:163], v[112:115]
  v_mfma_f32_16x16x32_bf16 v[116:119], a[204:207], a[164:167], v[116:119]
  ds_read_b64_tr_b16 a[216:217], v10 offset:128
  ds_read_b64_tr_b16 a[218:219], v10 offset:1408
  v_mfma_f32_16x16x32_bf16 v[120:123], a[204:207], a[168:171], v[120:123]
  v_mfma_f32_16x16x32_bf16 v[124:127], a[204:207], a[172:175], v[124:127]
  s_waitcnt lgkmcnt(4)
  v_mfma_f32_16x16x32_bf16 v[128:131], a[208:211], a[160:163], v[128:131]
  v_mfma_f32_16x16x32_bf16 v[132:135], a[208:211], a[164:167], v[132:135]
  s_waitcnt vmcnt(14)
  ds_read_b64_tr_b16 a[220:221], v7 offset:12288
  ds_read_b64_tr_b16 a[222:223], v7 offset:13568
  v_mfma_f32_16x16x32_bf16 v[136:139], a[208:211], a[168:171], v[136:139]
  v_mfma_f32_16x16x32_bf16 v[140:143], a[208:211], a[172:175], v[140:143]
  s_waitcnt lgkmcnt(4)
  v_mfma_f32_16x16x32_bf16 v[144:147], a[212:215], a[160:163], v[144:147]
  v_mfma_f32_16x16x32_bf16 v[148:151], a[212:215], a[164:167], v[148:151]
  ds_read_b64_tr_b16 a[192:193], v7 offset:12320
  ds_read_b64_tr_b16 a[194:195], v7 offset:13600
  v_mfma_f32_16x16x32_bf16 v[152:155], a[212:215], a[168:171], v[152:155]
  v_mfma_f32_16x16x32_bf16 v[156:159], a[212:215], a[172:175], v[156:159]
  s_waitcnt lgkmcnt(4)
  v_mfma_f32_16x16x32_bf16 v[160:163], a[216:219], a[160:163], v[160:163]
  v_mfma_f32_16x16x32_bf16 v[164:167], a[216:219], a[164:167], v[164:167]
  ds_read_b64_tr_b16 a[196:197], v7 offset:12352
  ds_read_b64_tr_b16 a[198:199], v7 offset:13632
  v_mfma_f32_16x16x32_bf16 v[168:171], a[216:219], a[168:171], v[168:171]
  v_mfma_f32_16x16x32_bf16 v[172:175], a[216:219], a[172:175], v[172:175]
  s_waitcnt vmcnt(0)
  s_waitcnt lgkmcnt(4)
  v_mfma_f32_16x16x32_bf16 v[96:99], a[220:223], a[176:179], v[96:99]
  v_mfma_f32_16x16x32_bf16 v[100:103], a[220:223], a[180:183], v[100:103]
  ds_read_b64_tr_b16 a[200:201], v7 offset:12384
  ds_read_b64_tr_b16 a[202:203], v7 offset:13664
  v_mfma_f32_16x16x32_bf16 v[104:107], a[220:223], a[184:187], v[104:107]
  v_mfma_f32_16x16x32_bf16 v[108:111], a[220:223], a[188:191], v[108:111]
  s_waitcnt lgkmcnt(4)
  v_mfma_f32_16x16x32_bf16 v[112:115], a[192:195], a[176:179], v[112:115]
  v_mfma_f32_16x16x32_bf16 v[116:119], a[192:195], a[180:183], v[116:119]
  ds_read_b64_tr_b16 a[204:205], v7 offset:12416
  ds_read_b64_tr_b16 a[206:207], v7 offset:13696
  v_mfma_f32_16x16x32_bf16 v[120:123], a[192:195], a[184:187], v[120:123]
  v_mfma_f32_16x16x32_bf16 v[124:127], a[192:195], a[188:191], v[124:127]
  s_waitcnt lgkmcnt(4)
  v_mfma_f32_16x16x32_bf16 v[128:131], a[196:199], a[176:179], v[128:131]
  v_mfma_f32_16x16x32_bf16 v[132:135], a[196:199], a[180:183], v[132:135]
  v_mfma_f32_16x16x32_bf16 v[136:139], a[196:199], a[184:187], v[136:139]
  v_mfma_f32_16x16x32_bf16 v[140:143], a[196:199], a[188:191], v[140:143]
  s_waitcnt lgkmcnt(2)
  v_mfma_f32_16x16x32_bf16 v[144:147], a[200:203], a[176:179], v[144:147]
  v_mfma_f32_16x16x32_bf16 v[148:151], a[200:203], a[180:183], v[148:151]
  v_mfma_f32_16x16x32_bf16 v[152:155], a[200:203], a[184:187], v[152:155]
  v_mfma_f32_16x16x32_bf16 v[156:159], a[200:203], a[188:191], v[156:159]
  s_waitcnt lgkmcnt(0)
  v_mfma_f32_16x16x32_bf16 v[160:163], a[204:207], a[176:179], v[160:163]
  v_mfma_f32_16x16x32_bf16 v[164:167], a[204:207], a[180:183], v[164:167]
  v_mfma_f32_16x16x32_bf16 v[168:171], a[204:207], a[184:187], v[168:171]
  v_mfma_f32_16x16x32_bf16 v[172:175], a[204:207], a[188:191], v[172:175]
  s_barrier
  s_mul_i32 s62, s30, 20480
  v_add_u32 v17, s62, v2
  s_mul_i32 s63, s30, 5120
  v_add_u32 v18, s63, v2
  ds_write_b128 v17, v[96:99] offset:0
  ds_write_b128 v17, v[112:115] offset:1024
  ds_write_b128 v17, v[128:131] offset:2048
  ds_write_b128 v17, v[144:147] offset:3072
  ds_write_b128 v17, v[160:163] offset:4096
  ds_write_b128 v17, v[100:103] offset:5120
  ds_write_b128 v17, v[116:119] offset:6144
  ds_write_b128 v17, v[132:135] offset:7168
  ds_write_b128 v17, v[148:151] offset:8192
  ds_write_b128 v17, v[164:167] offset:9216
  ds_write_b128 v17, v[104:107] offset:10240
  ds_write_b128 v17, v[120:123] offset:11264
  ds_write_b128 v17, v[136:139] offset:12288
  s_waitcnt lgkmcnt(11)
  ds_write_b128 v17, v[152:155] offset:13312
  s_waitcnt lgkmcnt(11)
  ds_write_b128 v17, v[168:171] offset:14336
  s_waitcnt lgkmcnt(11)
  ds_write_b128 v17, v[108:111] offset:15360
  s_waitcnt lgkmcnt(11)
  ds_write_b128 v17, v[124:127] offset:16384
  s_waitcnt lgkmcnt(11)
  ds_write_b128 v17, v[140:143] offset:17408
  s_waitcnt lgkmcnt(11)
  ds_write_b128 v17, v[156:159] offset:18432
  s_waitcnt lgkmcnt(11)
  ds_write_b128 v17, v[172:175] offset:19456
  s_waitcnt lgkmcnt(11)
  s_waitcnt lgkmcnt(0)
  s_barrier
  v_add_u32 v19, 40960, v18
  ds_read_b128 v[96:99], v18 offset:0
  ds_read_b128 v[100:103], v18 offset:1024
  ds_read_b128 v[104:107], v18 offset:2048
  ds_read_b128 v[108:111], v18 offset:3072
  ds_read_b128 v[112:115], v18 offset:4096
  ds_read_b128 v[116:119], v18 offset:20480
  ds_read_b128 v[120:123], v18 offset:21504
  ds_read_b128 v[124:127], v18 offset:22528
  ds_read_b128 v[128:131], v18 offset:23552
  ds_read_b128 v[132:135], v18 offset:24576
  s_waitcnt lgkmcnt(5)
  ds_read_b128 v[136:139], v19 offset:0
  ds_read_b128 v[140:143], v19 offset:1024
  ds_read_b128 v[144:147], v19 offset:2048
  ds_read_b128 v[148:151], v19 offset:3072
  ds_read_b128 v[152:155], v19 offset:4096
  ds_read_b128 v[156:159], v19 offset:20480
  ds_read_b128 v[160:163], v19 offset:21504
  ds_read_b128 v[164:167], v19 offset:22528
  ds_read_b128 v[168:171], v19 offset:23552
  ds_read_b128 v[172:175], v19 offset:24576
  s_mov_b32 s72, 0xffff0000
  s_waitcnt lgkmcnt(10)
  v_add_f32 v96, v96, v116
  v_add_f32 v97, v97, v117
  v_add_f32 v98, v98, v118
  v_add_f32 v99, v99, v119
  v_add_f32 v100, v100, v120
  v_add_f32 v101, v101, v121
  v_add_f32 v102, v102, v122
  v_add_f32 v103, v103, v123
  v_add_f32 v104, v104, v124
  v_add_f32 v105, v105, v125
  v_add_f32 v106, v106, v126
  v_add_f32 v107, v107, v127
  v_add_f32 v108, v108, v128
  v_add_f32 v109, v109, v129
  v_add_f32 v110, v110, v130
  v_add_f32 v111, v111, v131
  v_add_f32 v112, v112, v132
  v_add_f32 v113, v113, v133
  v_add_f32 v114, v114, v134
  v_add_f32 v115, v115, v135
  s_waitcnt lgkmcnt(0)
  v_add_f32 v136, v136, v156
  v_add_f32 v137, v137, v157
  v_add_f32 v138, v138, v158
  v_add_f32 v139, v139, v159
  v_add_f32 v140, v140, v160
  v_add_f32 v141, v141, v161
  v_add_f32 v142, v142, v162
  v_add_f32 v143, v143, v163
  v_add_f32 v144, v144, v164
  v_add_f32 v145, v145, v165
  v_add_f32 v146, v146, v166
  v_add_f32 v147, v147, v167
  v_add_f32 v148, v148, v168
  v_add_f32 v149, v149, v169
  v_add_f32 v150, v150, v170
  v_add_f32 v151, v151, v171
  v_add_f32 v152, v152, v172
  v_add_f32 v153, v153, v173
  v_add_f32 v154, v154, v174
  v_add_f32 v155, v155, v175
  v_add_f32 v96, v96, v136
  v_add_f32 v97, v97, v137
  v_add_f32 v98, v98, v138
  v_add_f32 v99, v99, v139
  v_add_f32 v100, v100, v140
  v_add_f32 v101, v101, v141
  v_add_f32 v102, v102, v142
  v_add_f32 v103, v103, v143
  v_add_f32 v104, v104, v144
  v_add_f32 v105, v105, v145
  v_add_f32 v106, v106, v146
  v_add_f32 v107, v107, v147
  v_add_f32 v108, v108, v148
  v_add_f32 v109, v109, v149
  v_add_f32 v110, v110, v150
  v_add_f32 v111, v111, v151
  v_add_f32 v112, v112, v152
  v_add_f32 v113, v113, v153
  v_add_f32 v114, v114, v154
  v_add_f32 v115, v115, v155
  v_lshlrev_b32 v55, 16, v20
  v_and_b32 v56, s72, v20
  v_fma_f32 v53, v96, v32, v55
  v_fma_f32 v54, v97, v33, v56
  v_cvt_pk_bf16_f32 v60, v53, v54
  v_lshlrev_b32 v55, 16, v21
  v_and_b32 v56, s72, v21
  v_fma_f32 v53, v98, v34, v55
  v_fma_f32 v54, v99, v35, v56
  v_cvt_pk_bf16_f32 v61, v53, v54
  buffer_store_dwordx2 v[60:61], v13, s[52:55], 0 offen offset:0
  v_lshlrev_b32 v55, 16, v22
  v_and_b32 v56, s72, v22
  v_fma_f32 v53, v100, v36, v55
  v_fma_f32 v54, v101, v37, v56
  v_cvt_pk_bf16_f32 v62, v53, v54
  v_lshlrev_b32 v55, 16, v23
  v_and_b32 v56, s72, v23
  v_fma_f32 v53, v102, v38, v55
  v_fma_f32 v54, v103, v39, v56
  v_cvt_pk_bf16_f32 v63, v53, v54
  buffer_store_dwordx2 v[62:63], v13, s[52:55], 0 offen offset:32
  v_lshlrev_b32 v55, 16, v24
  v_and_b32 v56, s72, v24
  v_fma_f32 v53, v104, v40, v55
  v_fma_f32 v54, v105, v41, v56
  v_cvt_pk_bf16_f32 v64, v53, v54
  v_lshlrev_b32 v55, 16, v25
  v_and_b32 v56, s72, v25
  v_fma_f32 v53, v106, v42, v55
  v_fma_f32 v54, v107, v43, v56
  v_cvt_pk_bf16_f32 v65, v53, v54
  buffer_store_dwordx2 v[64:65], v13, s[52:55], 0 offen offset:64
  v_lshlrev_b32 v55, 16, v26
  v_and_b32 v56, s72, v26
  v_fma_f32 v53, v108, v44, v55
  v_fma_f32 v54, v109, v45, v56
  v_cvt_pk_bf16_f32 v66, v53, v54
  v_lshlrev_b32 v55, 16, v27
  v_and_b32 v56, s72, v27
  v_fma_f32 v53, v110, v46, v55
  v_fma_f32 v54, v111, v47, v56
  v_cvt_pk_bf16_f32 v67, v53, v54
  buffer_store_dwordx2 v[66:67], v13, s[52:55], 0 offen offset:96
  v_lshlrev_b32 v55, 16, v28
  v_and_b32 v56, s72, v28
  v_fma_f32 v53, v112, v48, v55
  v_fma_f32 v54, v113, v49, v56
  v_cvt_pk_bf16_f32 v68, v53, v54
  v_lshlrev_b32 v55, 16, v29
  v_and_b32 v56, s72, v29
  v_fma_f32 v53, v114, v50, v55
  v_fma_f32 v54, v115, v51, v56
  v_cvt_pk_bf16_f32 v69, v53, v54
  buffer_store_dwordx2 v[68:69], v13, s[52:55], 0 offen offset:128
  s_branch L_end
L_rescale0:
  s_nop 15
  v_mov_b32 v41, v39
  v_mov_b32 v42, v40
  s_nop 1
  v_permlane32_swap_b32 v41, v39
  v_permlane32_swap_b32 v42, v40
  v_max3_f32 v39, v39, v41, 0
  v_max3_f32 v40, v40, v42, 0
  v_sub_f32 v41, 0, v39
  v_sub_f32 v42, 0, v40
  v_exp_f32 v41, v41
  v_exp_f32 v42, v42
  v_sub_f32 v160, v160, v39
  v_sub_f32 v224, v224, v39
  v_sub_f32 v161, v161, v39
  v_sub_f32 v225, v225, v39
  v_sub_f32 v162, v162, v39
  v_sub_f32 v226, v226, v39
  v_sub_f32 v163, v163, v39
  v_sub_f32 v227, v227, v39
  v_sub_f32 v164, v164, v39
  v_sub_f32 v228, v228, v39
  v_sub_f32 v165, v165, v39
  v_sub_f32 v229, v229, v39
  v_sub_f32 v166, v166, v39
  v_sub_f32 v230, v230, v39
  v_sub_f32 v167, v167, v39
  v_sub_f32 v231, v231, v39
  v_sub_f32 v168, v168, v39
  v_sub_f32 v232, v232, v39
  v_sub_f32 v169, v169, v39
  v_sub_f32 v233, v233, v39
  v_sub_f32 v170, v170, v39
  v_sub_f32 v234, v234, v39
  v_sub_f32 v171, v171, v39
  v_sub_f32 v235, v235, v39
  v_sub_f32 v172, v172, v39
  v_sub_f32 v236, v236, v39
  v_sub_f32 v173, v173, v39
  v_sub_f32 v237, v237, v39
  v_sub_f32 v174, v174, v39
  v_sub_f32 v238, v238, v39
  v_sub_f32 v175, v175, v39
  v_sub_f32 v239, v239, v39
  v_mul_f32 v37, v37, v41
  v_sub_f32 v176, v176, v40
  v_sub_f32 v240, v240, v40
  v_sub_f32 v177, v177, v40
  v_sub_f32 v241, v241, v40
  v_sub_f32 v178, v178, v40
  v_sub_f32 v242, v242, v40
  v_sub_f32 v179, v179, v40
  v_sub_f32 v243, v243, v40
  v_sub_f32 v180, v180, v40
  v_sub_f32 v244, v244, v40
  v_sub_f32 v181, v181, v40
  v_sub_f32 v245, v245, v40
  v_sub_f32 v182, v182, v40
  v_sub_f32 v246, v246, v40
  v_sub_f32 v183, v183, v40
  v_sub_f32 v247, v247, v40
  v_sub_f32 v184, v184, v40
  v_sub_f32 v248, v248, v40
  v_sub_f32 v185, v185, v40
  v_sub_f32 v249, v249, v40
  v_sub_f32 v186, v186, v40
  v_sub_f32 v250, v250, v40
  v_sub_f32 v187, v187, v40
  v_sub_f32 v251, v251, v40
  v_sub_f32 v188, v188, v40
  v_sub_f32 v252, v252, v40
  v_sub_f32 v189, v189, v40
  v_sub_f32 v253, v253, v40
  v_sub_f32 v190, v190, v40
  v_sub_f32 v254, v254, v40
  v_sub_f32 v191, v191, v40
  v_sub_f32 v255, v255, v40
  v_mul_f32 v38, v38, v42
  v_accvgpr_read_b32 v43, a0
  v_accvgpr_read_b32 v44, a1
  v_accvgpr_read_b32 v45, a2
  v_accvgpr_read_b32 v46, a3
  v_mul_f32 v43, v43, v41
  v_mul_f32 v44, v44, v41
  v_mul_f32 v45, v45, v41
  v_mul_f32 v46, v46, v41
  v_accvgpr_write_b32 a0, v43
  v_accvgpr_write_b32 a1, v44
  v_accvgpr_write_b32 a2, v45
  v_accvgpr_write_b32 a3, v46
  v_accvgpr_read_b32 v43, a4
  v_accvgpr_read_b32 v44, a5
  v_accvgpr_read_b32 v45, a6
  v_accvgpr_read_b32 v46, a7
  v_mul_f32 v43, v43, v41
  v_mul_f32 v44, v44, v41
  v_mul_f32 v45, v45, v41
  v_mul_f32 v46, v46, v41
  v_accvgpr_write_b32 a4, v43
  v_accvgpr_write_b32 a5, v44
  v_accvgpr_write_b32 a6, v45
  v_accvgpr_write_b32 a7, v46
  v_accvgpr_read_b32 v43, a8
  v_accvgpr_read_b32 v44, a9
  v_accvgpr_read_b32 v45, a10
  v_accvgpr_read_b32 v46, a11
  v_mul_f32 v43, v43, v41
  v_mul_f32 v44, v44, v41
  v_mul_f32 v45, v45, v41
  v_mul_f32 v46, v46, v41
  v_accvgpr_write_b32 a8, v43
  v_accvgpr_write_b32 a9, v44
  v_accvgpr_write_b32 a10, v45
  v_accvgpr_write_b32 a11, v46
  v_accvgpr_read_b32 v43, a12
  v_accvgpr_read_b32 v44, a13
  v_accvgpr_read_b32 v45, a14
  v_accvgpr_read_b32 v46, a15
  v_mul_f32 v43, v43, v41
  v_mul_f32 v44, v44, v41
  v_mul_f32 v45, v45, v41
  v_mul_f32 v46, v46, v41
  v_accvgpr_write_b32 a12, v43
  v_accvgpr_write_b32 a13, v44
  v_accvgpr_write_b32 a14, v45
  v_accvgpr_write_b32 a15, v46
  v_accvgpr_read_b32 v43, a16
  v_accvgpr_read_b32 v44, a17
  v_accvgpr_read_b32 v45, a18
  v_accvgpr_read_b32 v46, a19
  v_mul_f32 v43, v43, v42
  v_mul_f32 v44, v44, v42
  v_mul_f32 v45, v45, v42
  v_mul_f32 v46, v46, v42
  v_accvgpr_write_b32 a16, v43
  v_accvgpr_write_b32 a17, v44
  v_accvgpr_write_b32 a18, v45
  v_accvgpr_write_b32 a19, v46
  v_accvgpr_read_b32 v43, a20
  v_accvgpr_read_b32 v44, a21
  v_accvgpr_read_b32 v45, a22
  v_accvgpr_read_b32 v46, a23
  v_mul_f32 v43, v43, v42
  v_mul_f32 v44, v44, v42
  v_mul_f32 v45, v45, v42
  v_mul_f32 v46, v46, v42
  v_accvgpr_write_b32 a20, v43
  v_accvgpr_write_b32 a21, v44
  v_accvgpr_write_b32 a22, v45
  v_accvgpr_write_b32 a23, v46
  v_accvgpr_read_b32 v43, a24
  v_accvgpr_read_b32 v44, a25
  v_accvgpr_read_b32 v45, a26
  v_accvgpr_read_b32 v46, a27
  v_mul_f32 v43, v43, v42
  v_mul_f32 v44, v44, v42
  v_mul_f32 v45, v45, v42
  v_mul_f32 v46, v46, v42
  v_accvgpr_write_b32 a24, v43
  v_accvgpr_write_b32 a25, v44
  v_accvgpr_write_b32 a26, v45
  v_accvgpr_write_b32 a27, v46
  v_accvgpr_read_b32 v43, a28
  v_accvgpr_read_b32 v44, a29
  v_accvgpr_read_b32 v45, a30
  v_accvgpr_read_b32 v46, a31
  v_mul_f32 v43, v43, v42
  v_mul_f32 v44, v44, v42
  v_mul_f32 v45, v45, v42
  v_mul_f32 v46, v46, v42
  v_accvgpr_write_b32 a28, v43
  v_accvgpr_write_b32 a29, v44
  v_accvgpr_write_b32 a30, v45
  v_accvgpr_write_b32 a31, v46
  v_accvgpr_read_b32 v43, a32
  v_accvgpr_read_b32 v44, a33
  v_accvgpr_read_b32 v45, a34
  v_accvgpr_read_b32 v46, a35
  v_mul_f32 v43, v43, v41
  v_mul_f32 v44, v44, v41
  v_mul_f32 v45, v45, v41
  v_mul_f32 v46, v46, v41
  v_accvgpr_write_b32 a32, v43
  v_accvgpr_write_b32 a33, v44
  v_accvgpr_write_b32 a34, v45
  v_accvgpr_write_b32 a35, v46
  v_accvgpr_read_b32 v43, a36
  v_accvgpr_read_b32 v44, a37
  v_accvgpr_read_b32 v45, a38
  v_accvgpr_read_b32 v46, a39
  v_mul_f32 v43, v43, v41
  v_mul_f32 v44, v44, v41
  v_mul_f32 v45, v45, v41
  v_mul_f32 v46, v46, v41
  v_accvgpr_write_b32 a36, v43
  v_accvgpr_write_b32 a37, v44
  v_accvgpr_write_b32 a38, v45
  v_accvgpr_write_b32 a39, v46
  v_accvgpr_read_b32 v43, a40
  v_accvgpr_read_b32 v44, a41
  v_accvgpr_read_b32 v45, a42
  v_accvgpr_read_b32 v46, a43
  v_mul_f32 v43, v43, v41
  v_mul_f32 v44, v44, v41
  v_mul_f32 v45, v45, v41
  v_mul_f32 v46, v46, v41
  v_accvgpr_write_b32 a40, v43
  v_accvgpr_write_b32 a41, v44
  v_accvgpr_write_b32 a42, v45
  v_accvgpr_write_b32 a43, v46
  v_accvgpr_read_b32 v43, a44
  v_accvgpr_read_b32 v44, a45
  v_accvgpr_read_b32 v45, a46
  v_accvgpr_read_b32 v46, a47
  v_mul_f32 v43, v43, v41
  v_mul_f32 v44, v44, v41
  v_mul_f32 v45, v45, v41
  v_mul_f32 v46, v46, v41
  v_accvgpr_write_b32 a44, v43
  v_accvgpr_write_b32 a45, v44
  v_accvgpr_write_b32 a46, v45
  v_accvgpr_write_b32 a47, v46
  v_accvgpr_read_b32 v43, a48
  v_accvgpr_read_b32 v44, a49
  v_accvgpr_read_b32 v45, a50
  v_accvgpr_read_b32 v46, a51
  v_mul_f32 v43, v43, v42
  v_mul_f32 v44, v44, v42
  v_mul_f32 v45, v45, v42
  v_mul_f32 v46, v46, v42
  v_accvgpr_write_b32 a48, v43
  v_accvgpr_write_b32 a49, v44
  v_accvgpr_write_b32 a50, v45
  v_accvgpr_write_b32 a51, v46
  v_accvgpr_read_b32 v43, a52
  v_accvgpr_read_b32 v44, a53
  v_accvgpr_read_b32 v45, a54
  v_accvgpr_read_b32 v46, a55
  v_mul_f32 v43, v43, v42
  v_mul_f32 v44, v44, v42
  v_mul_f32 v45, v45, v42
  v_mul_f32 v46, v46, v42
  v_accvgpr_write_b32 a52, v43
  v_accvgpr_write_b32 a53, v44
  v_accvgpr_write_b32 a54, v45
  v_accvgpr_write_b32 a55, v46
  v_accvgpr_read_b32 v43, a56
  v_accvgpr_read_b32 v44, a57
  v_accvgpr_read_b32 v45, a58
  v_accvgpr_read_b32 v46, a59
  v_mul_f32 v43, v43, v42
  v_mul_f32 v44, v44, v42
  v_mul_f32 v45, v45, v42
  v_mul_f32 v46, v46, v42
  v_accvgpr_write_b32 a56, v43
  v_accvgpr_write_b32 a57, v44
  v_accvgpr_write_b32 a58, v45
  v_accvgpr_write_b32 a59, v46
  v_accvgpr_read_b32 v43, a60
  v_accvgpr_read_b32 v44, a61
  v_accvgpr_read_b32 v45, a62
  v_accvgpr_read_b32 v46, a63
  v_mul_f32 v43, v43, v42
  v_mul_f32 v44, v44, v42
  v_mul_f32 v45, v45, v42
  v_mul_f32 v46, v46, v42
  v_accvgpr_write_b32 a60, v43
  v_accvgpr_write_b32 a61, v44
  v_accvgpr_write_b32 a62, v45
  v_accvgpr_write_b32 a63, v46
  v_accvgpr_read_b32 v43, a64
  v_accvgpr_read_b32 v44, a65
  v_accvgpr_read_b32 v45, a66
  v_accvgpr_read_b32 v46, a67
  v_mul_f32 v43, v43, v41
  v_mul_f32 v44, v44, v41
  v_mul_f32 v45, v45, v41
  v_mul_f32 v46, v46, v41
  v_accvgpr_write_b32 a64, v43
  v_accvgpr_write_b32 a65, v44
  v_accvgpr_write_b32 a66, v45
  v_accvgpr_write_b32 a67, v46
  v_accvgpr_read_b32 v43, a68
  v_accvgpr_read_b32 v44, a69
  v_accvgpr_read_b32 v45, a70
  v_accvgpr_read_b32 v46, a71
  v_mul_f32 v43, v43, v41
  v_mul_f32 v44, v44, v41
  v_mul_f32 v45, v45, v41
  v_mul_f32 v46, v46, v41
  v_accvgpr_write_b32 a68, v43
  v_accvgpr_write_b32 a69, v44
  v_accvgpr_write_b32 a70, v45
  v_accvgpr_write_b32 a71, v46
  v_accvgpr_read_b32 v43, a72
  v_accvgpr_read_b32 v44, a73
  v_accvgpr_read_b32 v45, a74
  v_accvgpr_read_b32 v46, a75
  v_mul_f32 v43, v43, v41
  v_mul_f32 v44, v44, v41
  v_mul_f32 v45, v45, v41
  v_mul_f32 v46, v46, v41
  v_accvgpr_write_b32 a72, v43
  v_accvgpr_write_b32 a73, v44
  v_accvgpr_write_b32 a74, v45
  v_accvgpr_write_b32 a75, v46
  v_accvgpr_read_b32 v43, a76
  v_accvgpr_read_b32 v44, a77
  v_accvgpr_read_b32 v45, a78
  v_accvgpr_read_b32 v46, a79
  v_mul_f32 v43, v43, v41
  v_mul_f32 v44, v44, v41
  v_mul_f32 v45, v45, v41
  v_mul_f32 v46, v46, v41
  v_accvgpr_write_b32 a76, v43
  v_accvgpr_write_b32 a77, v44
  v_accvgpr_write_b32 a78, v45
  v_accvgpr_write_b32 a79, v46
  v_accvgpr_read_b32 v43, a80
  v_accvgpr_read_b32 v44, a81
  v_accvgpr_read_b32 v45, a82
  v_accvgpr_read_b32 v46, a83
  v_mul_f32 v43, v43, v42
  v_mul_f32 v44, v44, v42
  v_mul_f32 v45, v45, v42
  v_mul_f32 v46, v46, v42
  v_accvgpr_write_b32 a80, v43
  v_accvgpr_write_b32 a81, v44
  v_accvgpr_write_b32 a82, v45
  v_accvgpr_write_b32 a83, v46
  v_accvgpr_read_b32 v43, a84
  v_accvgpr_read_b32 v44, a85
  v_accvgpr_read_b32 v45, a86
  v_accvgpr_read_b32 v46, a87
  v_mul_f32 v43, v43, v42
  v_mul_f32 v44, v44, v42
  v_mul_f32 v45, v45, v42
  v_mul_f32 v46, v46, v42
  v_accvgpr_write_b32 a84, v43
  v_accvgpr_write_b32 a85, v44
  v_accvgpr_write_b32 a86, v45
  v_accvgpr_write_b32 a87, v46
  v_accvgpr_read_b32 v43, a88
  v_accvgpr_read_b32 v44, a89
  v_accvgpr_read_b32 v45, a90
  v_accvgpr_read_b32 v46, a91
  v_mul_f32 v43, v43, v42
  v_mul_f32 v44, v44, v42
  v_mul_f32 v45, v45, v42
  v_mul_f32 v46, v46, v42
  v_accvgpr_write_b32 a88, v43
  v_accvgpr_write_b32 a89, v44
  v_accvgpr_write_b32 a90, v45
  v_accvgpr_write_b32 a91, v46
  v_accvgpr_read_b32 v43, a92
  v_accvgpr_read_b32 v44, a93
  v_accvgpr_read_b32 v45, a94
  v_accvgpr_read_b32 v46, a95
  v_mul_f32 v43, v43, v42
  v_mul_f32 v44, v44, v42
  v_mul_f32 v45, v45, v42
  v_mul_f32 v46, v46, v42
  v_accvgpr_write_b32 a92, v43
  v_accvgpr_write_b32 a93, v44
  v_accvgpr_write_b32 a94, v45
  v_accvgpr_write_b32 a95, v46
  v_accvgpr_read_b32 v43, a96
  v_accvgpr_read_b32 v44, a97
  v_accvgpr_read_b32 v45, a98
  v_accvgpr_read_b32 v46, a99
  v_mul_f32 v43, v43, v41
  v_mul_f32 v44, v44, v41
  v_mul_f32 v45, v45, v41
  v_mul_f32 v46, v46, v41
  v_accvgpr_write_b32 a96, v43
  v_accvgpr_write_b32 a97, v44
  v_accvgpr_write_b32 a98, v45
  v_accvgpr_write_b32 a99, v46
  v_accvgpr_read_b32 v43, a100
  v_accvgpr_read_b32 v44, a101
  v_accvgpr_read_b32 v45, a102
  v_accvgpr_read_b32 v46, a103
  v_mul_f32 v43, v43, v41
  v_mul_f32 v44, v44, v41
  v_mul_f32 v45, v45, v41
  v_mul_f32 v46, v46, v41
  v_accvgpr_write_b32 a100, v43
  v_accvgpr_write_b32 a101, v44
  v_accvgpr_write_b32 a102, v45
  v_accvgpr_write_b32 a103, v46
  v_accvgpr_read_b32 v43, a104
  v_accvgpr_read_b32 v44, a105
  v_accvgpr_read_b32 v45, a106
  v_accvgpr_read_b32 v46, a107
  v_mul_f32 v43, v43, v41
  v_mul_f32 v44, v44, v41
  v_mul_f32 v45, v45, v41
  v_mul_f32 v46, v46, v41
  v_accvgpr_write_b32 a104, v43
  v_accvgpr_write_b32 a105, v44
  v_accvgpr_write_b32 a106, v45
  v_accvgpr_write_b32 a107, v46
  v_accvgpr_read_b32 v43, a108
  v_accvgpr_read_b32 v44, a109
  v_accvgpr_read_b32 v45, a110
  v_accvgpr_read_b32 v46, a111
  v_mul_f32 v43, v43, v41
  v_mul_f32 v44, v44, v41
  v_mul_f32 v45, v45, v41
  v_mul_f32 v46, v46, v41
  v_accvgpr_write_b32 a108, v43
  v_accvgpr_write_b32 a109, v44
  v_accvgpr_write_b32 a110, v45
  v_accvgpr_write_b32 a111, v46
  v_accvgpr_read_b32 v43, a112
  v_accvgpr_read_b32 v44, a113
  v_accvgpr_read_b32 v45, a114
  v_accvgpr_read_b32 v46, a115
  v_mul_f32 v43, v43, v42
  v_mul_f32 v44, v44, v42
  v_mul_f32 v45, v45, v42
  v_mul_f32 v46, v46, v42
  v_accvgpr_write_b32 a112, v43
  v_accvgpr_write_b32 a113, v44
  v_accvgpr_write_b32 a114, v45
  v_accvgpr_write_b32 a115, v46
  v_accvgpr_read_b32 v43, a116
  v_accvgpr_read_b32 v44, a117
  v_accvgpr_read_b32 v45, a118
  v_accvgpr_read_b32 v46, a119
  v_mul_f32 v43, v43, v42
  v_mul_f32 v44, v44, v42
  v_mul_f32 v45, v45, v42
  v_mul_f32 v46, v46, v42
  v_accvgpr_write_b32 a116, v43
  v_accvgpr_write_b32 a117, v44
  v_accvgpr_write_b32 a118, v45
  v_accvgpr_write_b32 a119, v46
  v_accvgpr_read_b32 v43, a120
  v_accvgpr_read_b32 v44, a121
  v_accvgpr_read_b32 v45, a122
  v_accvgpr_read_b32 v46, a123
  v_mul_f32 v43, v43, v42
  v_mul_f32 v44, v44, v42
  v_mul_f32 v45, v45, v42
  v_mul_f32 v46, v46, v42
  v_accvgpr_write_b32 a120, v43
  v_accvgpr_write_b32 a121, v44
  v_accvgpr_write_b32 a122, v45
  v_accvgpr_write_b32 a123, v46
  v_accvgpr_read_b32 v43, a124
  v_accvgpr_read_b32 v44, a125
  v_accvgpr_read_b32 v45, a126
  v_accvgpr_read_b32 v46, a127
  v_mul_f32 v43, v43, v42
  v_mul_f32 v44, v44, v42
  v_mul_f32 v45, v45, v42
  v_mul_f32 v46, v46, v42
  v_accvgpr_write_b32 a124, v43
  v_accvgpr_write_b32 a125, v44
  v_accvgpr_write_b32 a126, v45
  v_accvgpr_write_b32 a127, v46
  v_accvgpr_read_b32 v43, a128
  v_accvgpr_read_b32 v44, a129
  v_accvgpr_read_b32 v45, a130
  v_accvgpr_read_b32 v46, a131
  v_mul_f32 v43, v43, v41
  v_mul_f32 v44, v44, v41
  v_mul_f32 v45, v45, v41
  v_mul_f32 v46, v46, v41
  v_accvgpr_write_b32 a128, v43
  v_accvgpr_write_b32 a129, v44
  v_accvgpr_write_b32 a130, v45
  v_accvgpr_write_b32 a131, v46
  v_accvgpr_read_b32 v43, a132
  v_accvgpr_read_b32 v44, a133
  v_accvgpr_read_b32 v45, a134
  v_accvgpr_read_b32 v46, a135
  v_mul_f32 v43, v43, v41
  v_mul_f32 v44, v44, v41
  v_mul_f32 v45, v45, v41
  v_mul_f32 v46, v46, v41
  v_accvgpr_write_b32 a132, v43
  v_accvgpr_write_b32 a133, v44
  v_accvgpr_write_b32 a134, v45
  v_accvgpr_write_b32 a135, v46
  v_accvgpr_read_b32 v43, a136
  v_accvgpr_read_b32 v44, a137
  v_accvgpr_read_b32 v45, a138
  v_accvgpr_read_b32 v46, a139
  v_mul_f32 v43, v43, v41
  v_mul_f32 v44, v44, v41
  v_mul_f32 v45, v45, v41
  v_mul_f32 v46, v46, v41
  v_accvgpr_write_b32 a136, v43
  v_accvgpr_write_b32 a137, v44
  v_accvgpr_write_b32 a138, v45
  v_accvgpr_write_b32 a139, v46
  v_accvgpr_read_b32 v43, a140
  v_accvgpr_read_b32 v44, a141
  v_accvgpr_read_b32 v45, a142
  v_accvgpr_read_b32 v46, a143
  v_mul_f32 v43, v43, v41
  v_mul_f32 v44, v44, v41
  v_mul_f32 v45, v45, v41
  v_mul_f32 v46, v46, v41
  v_accvgpr_write_b32 a140, v43
  v_accvgpr_write_b32 a141, v44
  v_accvgpr_write_b32 a142, v45
  v_accvgpr_write_b32 a143, v46
  v_accvgpr_read_b32 v43, a144
  v_accvgpr_read_b32 v44, a145
  v_accvgpr_read_b32 v45, a146
  v_accvgpr_read_b32 v46, a147
  v_mul_f32 v43, v43, v42
  v_mul_f32 v44, v44, v42
  v_mul_f32 v45, v45, v42
  v_mul_f32 v46, v46, v42
  v_accvgpr_write_b32 a144, v43
  v_accvgpr_write_b32 a145, v44
  v_accvgpr_write_b32 a146, v45
  v_accvgpr_write_b32 a147, v46
  v_accvgpr_read_b32 v43, a148
  v_accvgpr_read_b32 v44, a149
  v_accvgpr_read_b32 v45, a150
  v_accvgpr_read_b32 v46, a151
  v_mul_f32 v43, v43, v42
  v_mul_f32 v44, v44, v42
  v_mul_f32 v45, v45, v42
  v_mul_f32 v46, v46, v42
  v_accvgpr_write_b32 a148, v43
  v_accvgpr_write_b32 a149, v44
  v_accvgpr_write_b32 a150, v45
  v_accvgpr_write_b32 a151, v46
  v_accvgpr_read_b32 v43, a152
  v_accvgpr_read_b32 v44, a153
  v_accvgpr_read_b32 v45, a154
  v_accvgpr_read_b32 v46, a155
  v_mul_f32 v43, v43, v42
  v_mul_f32 v44, v44, v42
  v_mul_f32 v45, v45, v42
  v_mul_f32 v46, v46, v42
  v_accvgpr_write_b32 a152, v43
  v_accvgpr_write_b32 a153, v44
  v_accvgpr_write_b32 a154, v45
  v_accvgpr_write_b32 a155, v46
  v_accvgpr_read_b32 v43, a156
  v_accvgpr_read_b32 v44, a157
  v_accvgpr_read_b32 v45, a158
  v_accvgpr_read_b32 v46, a159
  v_mul_f32 v43, v43, v42
  v_mul_f32 v44, v44, v42
  v_mul_f32 v45, v45, v42
  v_mul_f32 v46, v46, v42
  v_accvgpr_write_b32 a156, v43
  v_accvgpr_write_b32 a157, v44
  v_accvgpr_write_b32 a158, v45
  v_accvgpr_write_b32 a159, v46
  v_accvgpr_read_b32 v43, a160
  v_accvgpr_read_b32 v44, a161
  v_accvgpr_read_b32 v45, a162
  v_accvgpr_read_b32 v46, a163
  v_mul_f32 v43, v43, v41
  v_mul_f32 v44, v44, v41
  v_mul_f32 v45, v45, v41
  v_mul_f32 v46, v46, v41
  v_accvgpr_write_b32 a160, v43
  v_accvgpr_write_b32 a161, v44
  v_accvgpr_write_b32 a162, v45
  v_accvgpr_write_b32 a163, v46
  v_accvgpr_read_b32 v43, a164
  v_accvgpr_read_b32 v44, a165
  v_accvgpr_read_b32 v45, a166
  v_accvgpr_read_b32 v46, a167
  v_mul_f32 v43, v43, v41
  v_mul_f32 v44, v44, v41
  v_mul_f32 v45, v45, v41
  v_mul_f32 v46, v46, v41
  v_accvgpr_write_b32 a164, v43
  v_accvgpr_write_b32 a165, v44
  v_accvgpr_write_b32 a166, v45
  v_accvgpr_write_b32 a167, v46
  v_accvgpr_read_b32 v43, a168
  v_accvgpr_read_b32 v44, a169
  v_accvgpr_read_b32 v45, a170
  v_accvgpr_read_b32 v46, a171
  v_mul_f32 v43, v43, v41
  v_mul_f32 v44, v44, v41
  v_mul_f32 v45, v45, v41
  v_mul_f32 v46, v46, v41
  v_accvgpr_write_b32 a168, v43
  v_accvgpr_write_b32 a169, v44
  v_accvgpr_write_b32 a170, v45
  v_accvgpr_write_b32 a171, v46
  v_accvgpr_read_b32 v43, a172
  v_accvgpr_read_b32 v44, a173
  v_accvgpr_read_b32 v45, a174
  v_accvgpr_read_b32 v46, a175
  v_mul_f32 v43, v43, v41
  v_mul_f32 v44, v44, v41
  v_mul_f32 v45, v45, v41
  v_mul_f32 v46, v46, v41
  v_accvgpr_write_b32 a172, v43
  v_accvgpr_write_b32 a173, v44
  v_accvgpr_write_b32 a174, v45
  v_accvgpr_write_b32 a175, v46
  v_accvgpr_read_b32 v43, a176
  v_accvgpr_read_b32 v44, a177
  v_accvgpr_read_b32 v45, a178
  v_accvgpr_read_b32 v46, a179
  v_mul_f32 v43, v43, v42
  v_mul_f32 v44, v44, v42
  v_mul_f32 v45, v45, v42
  v_mul_f32 v46, v46, v42
  v_accvgpr_write_b32 a176, v43
  v_accvgpr_write_b32 a177, v44
  v_accvgpr_write_b32 a178, v45
  v_accvgpr_write_b32 a179, v46
  v_accvgpr_read_b32 v43, a180
  v_accvgpr_read_b32 v44, a181
  v_accvgpr_read_b32 v45, a182
  v_accvgpr_read_b32 v46, a183
  v_mul_f32 v43, v43, v42
  v_mul_f32 v44, v44, v42
  v_mul_f32 v45, v45, v42
  v_mul_f32 v46, v46, v42
  v_accvgpr_write_b32 a180, v43
  v_accvgpr_write_b32 a181, v44
  v_accvgpr_write_b32 a182, v45
  v_accvgpr_write_b32 a183, v46
  v_accvgpr_read_b32 v43, a184
  v_accvgpr_read_b32 v44, a185
  v_accvgpr_read_b32 v45, a186
  v_accvgpr_read_b32 v46, a187
  v_mul_f32 v43, v43, v42
  v_mul_f32 v44, v44, v42
  v_mul_f32 v45, v45, v42
  v_mul_f32 v46, v46, v42
  v_accvgpr_write_b32 a184, v43
  v_accvgpr_write_b32 a185, v44
  v_accvgpr_write_b32 a186, v45
  v_accvgpr_write_b32 a187, v46
  v_accvgpr_read_b32 v43, a188
  v_accvgpr_read_b32 v44, a189
  v_accvgpr_read_b32 v45, a190
  v_accvgpr_read_b32 v46, a191
  v_mul_f32 v43, v43, v42
  v_mul_f32 v44, v44, v42
  v_mul_f32 v45, v45, v42
  v_mul_f32 v46, v46, v42
  v_accvgpr_write_b32 a188, v43
  v_accvgpr_write_b32 a189, v44
  v_accvgpr_write_b32 a190, v45
  v_accvgpr_write_b32 a191, v46
  s_nop 3
  s_setpc_b64 s[70:71]
L_rescale1:
  s_nop 15
  v_mov_b32 v41, v39
  v_mov_b32 v42, v40
  s_nop 1
  v_permlane32_swap_b32 v41, v39
  v_permlane32_swap_b32 v42, v40
  v_max3_f32 v39, v39, v41, 0
  v_max3_f32 v40, v40, v42, 0
  v_sub_f32 v41, 0, v39
  v_sub_f32 v42, 0, v40
  v_exp_f32 v41, v41
  v_exp_f32 v42, v42
  v_sub_f32 v192, v192, v39
  v_sub_f32 v224, v224, v39
  v_sub_f32 v193, v193, v39
  v_sub_f32 v225, v225, v39
  v_sub_f32 v194, v194, v39
  v_sub_f32 v226, v226, v39
  v_sub_f32 v195, v195, v39
  v_sub_f32 v227, v227, v39
  v_sub_f32 v196, v196, v39
  v_sub_f32 v228, v228, v39
  v_sub_f32 v197, v197, v39
  v_sub_f32 v229, v229, v39
  v_sub_f32 v198, v198, v39
  v_sub_f32 v230, v230, v39
  v_sub_f32 v199, v199, v39
  v_sub_f32 v231, v231, v39
  v_sub_f32 v200, v200, v39
  v_sub_f32 v232, v232, v39
  v_sub_f32 v201, v201, v39
  v_sub_f32 v233, v233, v39
  v_sub_f32 v202, v202, v39
  v_sub_f32 v234, v234, v39
  v_sub_f32 v203, v203, v39
  v_sub_f32 v235, v235, v39
  v_sub_f32 v204, v204, v39
  v_sub_f32 v236, v236, v39
  v_sub_f32 v205, v205, v39
  v_sub_f32 v237, v237, v39
  v_sub_f32 v206, v206, v39
  v_sub_f32 v238, v238, v39
  v_sub_f32 v207, v207, v39
  v_sub_f32 v239, v239, v39
  v_mul_f32 v37, v37, v41
  v_sub_f32 v208, v208, v40
  v_sub_f32 v240, v240, v40
  v_sub_f32 v209, v209, v40
  v_sub_f32 v241, v241, v40
  v_sub_f32 v210, v210, v40
  v_sub_f32 v242, v242, v40
  v_sub_f32 v211, v211, v40
  v_sub_f32 v243, v243, v40
  v_sub_f32 v212, v212, v40
  v_sub_f32 v244, v244, v40
  v_sub_f32 v213, v213, v40
  v_sub_f32 v245, v245, v40
  v_sub_f32 v214, v214, v40
  v_sub_f32 v246, v246, v40
  v_sub_f32 v215, v215, v40
  v_sub_f32 v247, v247, v40
  v_sub_f32 v216, v216, v40
  v_sub_f32 v248, v248, v40
  v_sub_f32 v217, v217, v40
  v_sub_f32 v249, v249, v40
  v_sub_f32 v218, v218, v40
  v_sub_f32 v250, v250, v40
  v_sub_f32 v219, v219, v40
  v_sub_f32 v251, v251, v40
  v_sub_f32 v220, v220, v40
  v_sub_f32 v252, v252, v40
  v_sub_f32 v221, v221, v40
  v_sub_f32 v253, v253, v40
  v_sub_f32 v222, v222, v40
  v_sub_f32 v254, v254, v40
  v_sub_f32 v223, v223, v40
  v_sub_f32 v255, v255, v40
  v_mul_f32 v38, v38, v42
  v_accvgpr_read_b32 v43, a0
  v_accvgpr_read_b32 v44, a1
  v_accvgpr_read_b32 v45, a2
  v_accvgpr_read_b32 v46, a3
  v_mul_f32 v43, v43, v41
  v_mul_f32 v44, v44, v41
  v_mul_f32 v45, v45, v41
  v_mul_f32 v46, v46, v41
  v_accvgpr_write_b32 a0, v43
  v_accvgpr_write_b32 a1, v44
  v_accvgpr_write_b32 a2, v45
  v_accvgpr_write_b32 a3, v46
  v_accvgpr_read_b32 v43, a4
  v_accvgpr_read_b32 v44, a5
  v_accvgpr_read_b32 v45, a6
  v_accvgpr_read_b32 v46, a7
  v_mul_f32 v43, v43, v41
  v_mul_f32 v44, v44, v41
  v_mul_f32 v45, v45, v41
  v_mul_f32 v46, v46, v41
  v_accvgpr_write_b32 a4, v43
  v_accvgpr_write_b32 a5, v44
  v_accvgpr_write_b32 a6, v45
  v_accvgpr_write_b32 a7, v46
  v_accvgpr_read_b32 v43, a8
  v_accvgpr_read_b32 v44, a9
  v_accvgpr_read_b32 v45, a10
  v_accvgpr_read_b32 v46, a11
  v_mul_f32 v43, v43, v41
  v_mul_f32 v44, v44, v41
  v_mul_f32 v45, v45, v41
  v_mul_f32 v46, v46, v41
  v_accvgpr_write_b32 a8, v43
  v_accvgpr_write_b32 a9, v44
  v_accvgpr_write_b32 a10, v45
  v_accvgpr_write_b32 a11, v46
  v_accvgpr_read_b32 v43, a12
  v_accvgpr_read_b32 v44, a13
  v_accvgpr_read_b32 v45, a14
  v_accvgpr_read_b32 v46, a15
  v_mul_f32 v43, v43, v41
  v_mul_f32 v44, v44, v41
  v_mul_f32 v45, v45, v41
  v_mul_f32 v46, v46, v41
  v_accvgpr_write_b32 a12, v43
  v_accvgpr_write_b32 a13, v44
  v_accvgpr_write_b32 a14, v45
  v_accvgpr_write_b32 a15, v46
  v_accvgpr_read_b32 v43, a16
  v_accvgpr_read_b32 v44, a17
  v_accvgpr_read_b32 v45, a18
  v_accvgpr_read_b32 v46, a19
  v_mul_f32 v43, v43, v42
  v_mul_f32 v44, v44, v42
  v_mul_f32 v45, v45, v42
  v_mul_f32 v46, v46, v42
  v_accvgpr_write_b32 a16, v43
  v_accvgpr_write_b32 a17, v44
  v_accvgpr_write_b32 a18, v45
  v_accvgpr_write_b32 a19, v46
  v_accvgpr_read_b32 v43, a20
  v_accvgpr_read_b32 v44, a21
  v_accvgpr_read_b32 v45, a22
  v_accvgpr_read_b32 v46, a23
  v_mul_f32 v43, v43, v42
  v_mul_f32 v44, v44, v42
  v_mul_f32 v45, v45, v42
  v_mul_f32 v46, v46, v42
  v_accvgpr_write_b32 a20, v43
  v_accvgpr_write_b32 a21, v44
  v_accvgpr_write_b32 a22, v45
  v_accvgpr_write_b32 a23, v46
  v_accvgpr_read_b32 v43, a24
  v_accvgpr_read_b32 v44, a25
  v_accvgpr_read_b32 v45, a26
  v_accvgpr_read_b32 v46, a27
  v_mul_f32 v43, v43, v42
  v_mul_f32 v44, v44, v42
  v_mul_f32 v45, v45, v42
  v_mul_f32 v46, v46, v42
  v_accvgpr_write_b32 a24, v43
  v_accvgpr_write_b32 a25, v44
  v_accvgpr_write_b32 a26, v45
  v_accvgpr_write_b32 a27, v46
  v_accvgpr_read_b32 v43, a28
  v_accvgpr_read_b32 v44, a29
  v_accvgpr_read_b32 v45, a30
  v_accvgpr_read_b32 v46, a31
  v_mul_f32 v43, v43, v42
  v_mul_f32 v44, v44, v42
  v_mul_f32 v45, v45, v42
  v_mul_f32 v46, v46, v42
  v_accvgpr_write_b32 a28, v43
  v_accvgpr_write_b32 a29, v44
  v_accvgpr_write_b32 a30, v45
  v_accvgpr_write_b32 a31, v46
  v_accvgpr_read_b32 v43, a32
  v_accvgpr_read_b32 v44, a33
  v_accvgpr_read_b32 v45, a34
  v_accvgpr_read_b32 v46, a35
  v_mul_f32 v43, v43, v41
  v_mul_f32 v44, v44, v41
  v_mul_f32 v45, v45, v41
  v_mul_f32 v46, v46, v41
  v_accvgpr_write_b32 a32, v43
  v_accvgpr_write_b32 a33, v44
  v_accvgpr_write_b32 a34, v45
  v_accvgpr_write_b32 a35, v46
  v_accvgpr_read_b32 v43, a36
  v_accvgpr_read_b32 v44, a37
  v_accvgpr_read_b32 v45, a38
  v_accvgpr_read_b32 v46, a39
  v_mul_f32 v43, v43, v41
  v_mul_f32 v44, v44, v41
  v_mul_f32 v45, v45, v41
  v_mul_f32 v46, v46, v41
  v_accvgpr_write_b32 a36, v43
  v_accvgpr_write_b32 a37, v44
  v_accvgpr_write_b32 a38, v45
  v_accvgpr_write_b32 a39, v46
  v_accvgpr_read_b32 v43, a40
  v_accvgpr_read_b32 v44, a41
  v_accvgpr_read_b32 v45, a42
  v_accvgpr_read_b32 v46, a43
  v_mul_f32 v43, v43, v41
  v_mul_f32 v44, v44, v41
  v_mul_f32 v45, v45, v41
  v_mul_f32 v46, v46, v41
  v_accvgpr_write_b32 a40, v43
  v_accvgpr_write_b32 a41, v44
  v_accvgpr_write_b32 a42, v45
  v_accvgpr_write_b32 a43, v46
  v_accvgpr_read_b32 v43, a44
  v_accvgpr_read_b32 v44, a45
  v_accvgpr_read_b32 v45, a46
  v_accvgpr_read_b32 v46, a47
  v_mul_f32 v43, v43, v41
  v_mul_f32 v44, v44, v41
  v_mul_f32 v45, v45, v41
  v_mul_f32 v46, v46, v41
  v_accvgpr_write_b32 a44, v43
  v_accvgpr_write_b32 a45, v44
  v_accvgpr_write_b32 a46, v45
  v_accvgpr_write_b32 a47, v46
  v_accvgpr_read_b32 v43, a48
  v_accvgpr_read_b32 v44, a49
  v_accvgpr_read_b32 v45, a50
  v_accvgpr_read_b32 v46, a51
  v_mul_f32 v43, v43, v42
  v_mul_f32 v44, v44, v42
  v_mul_f32 v45, v45, v42
  v_mul_f32 v46, v46, v42
  v_accvgpr_write_b32 a48, v43
  v_accvgpr_write_b32 a49, v44
  v_accvgpr_write_b32 a50, v45
  v_accvgpr_write_b32 a51, v46
  v_accvgpr_read_b32 v43, a52
  v_accvgpr_read_b32 v44, a53
  v_accvgpr_read_b32 v45, a54
  v_accvgpr_read_b32 v46, a55
  v_mul_f32 v43, v43, v42
  v_mul_f32 v44, v44, v42
  v_mul_f32 v45, v45, v42
  v_mul_f32 v46, v46, v42
  v_accvgpr_write_b32 a52, v43
  v_accvgpr_write_b32 a53, v44
  v_accvgpr_write_b32 a54, v45
  v_accvgpr_write_b32 a55, v46
  v_accvgpr_read_b32 v43, a56
  v_accvgpr_read_b32 v44, a57
  v_accvgpr_read_b32 v45, a58
  v_accvgpr_read_b32 v46, a59
  v_mul_f32 v43, v43, v42
  v_mul_f32 v44, v44, v42
  v_mul_f32 v45, v45, v42
  v_mul_f32 v46, v46, v42
  v_accvgpr_write_b32 a56, v43
  v_accvgpr_write_b32 a57, v44
  v_accvgpr_write_b32 a58, v45
  v_accvgpr_write_b32 a59, v46
  v_accvgpr_read_b32 v43, a60
  v_accvgpr_read_b32 v44, a61
  v_accvgpr_read_b32 v45, a62
  v_accvgpr_read_b32 v46, a63
  v_mul_f32 v43, v43, v42
  v_mul_f32 v44, v44, v42
  v_mul_f32 v45, v45, v42
  v_mul_f32 v46, v46, v42
  v_accvgpr_write_b32 a60, v43
  v_accvgpr_write_b32 a61, v44
  v_accvgpr_write_b32 a62, v45
  v_accvgpr_write_b32 a63, v46
  v_accvgpr_read_b32 v43, a64
  v_accvgpr_read_b32 v44, a65
  v_accvgpr_read_b32 v45, a66
  v_accvgpr_read_b32 v46, a67
  v_mul_f32 v43, v43, v41
  v_mul_f32 v44, v44, v41
  v_mul_f32 v45, v45, v41
  v_mul_f32 v46, v46, v41
  v_accvgpr_write_b32 a64, v43
  v_accvgpr_write_b32 a65, v44
  v_accvgpr_write_b32 a66, v45
  v_accvgpr_write_b32 a67, v46
  v_accvgpr_read_b32 v43, a68
  v_accvgpr_read_b32 v44, a69
  v_accvgpr_read_b32 v45, a70
  v_accvgpr_read_b32 v46, a71
  v_mul_f32 v43, v43, v41
  v_mul_f32 v44, v44, v41
  v_mul_f32 v45, v45, v41
  v_mul_f32 v46, v46, v41
  v_accvgpr_write_b32 a68, v43
  v_accvgpr_write_b32 a69, v44
  v_accvgpr_write_b32 a70, v45
  v_accvgpr_write_b32 a71, v46
  v_accvgpr_read_b32 v43, a72
  v_accvgpr_read_b32 v44, a73
  v_accvgpr_read_b32 v45, a74
  v_accvgpr_read_b32 v46, a75
  v_mul_f32 v43, v43, v41
  v_mul_f32 v44, v44, v41
  v_mul_f32 v45, v45, v41
  v_mul_f32 v46, v46, v41
  v_accvgpr_write_b32 a72, v43
  v_accvgpr_write_b32 a73, v44
  v_accvgpr_write_b32 a74, v45
  v_accvgpr_write_b32 a75, v46
  v_accvgpr_read_b32 v43, a76
  v_accvgpr_read_b32 v44, a77
  v_accvgpr_read_b32 v45, a78
  v_accvgpr_read_b32 v46, a79
  v_mul_f32 v43, v43, v41
  v_mul_f32 v44, v44, v41
  v_mul_f32 v45, v45, v41
  v_mul_f32 v46, v46, v41
  v_accvgpr_write_b32 a76, v43
  v_accvgpr_write_b32 a77, v44
  v_accvgpr_write_b32 a78, v45
  v_accvgpr_write_b32 a79, v46
  v_accvgpr_read_b32 v43, a80
  v_accvgpr_read_b32 v44, a81
  v_accvgpr_read_b32 v45, a82
  v_accvgpr_read_b32 v46, a83
  v_mul_f32 v43, v43, v42
  v_mul_f32 v44, v44, v42
  v_mul_f32 v45, v45, v42
  v_mul_f32 v46, v46, v42
  v_accvgpr_write_b32 a80, v43
  v_accvgpr_write_b32 a81, v44
  v_accvgpr_write_b32 a82, v45
  v_accvgpr_write_b32 a83, v46
  v_accvgpr_read_b32 v43, a84
  v_accvgpr_read_b32 v44, a85
  v_accvgpr_read_b32 v45, a86
  v_accvgpr_read_b32 v46, a87
  v_mul_f32 v43, v43, v42
  v_mul_f32 v44, v44, v42
  v_mul_f32 v45, v45, v42
  v_mul_f32 v46, v46, v42
  v_accvgpr_write_b32 a84, v43
  v_accvgpr_write_b32 a85, v44
  v_accvgpr_write_b32 a86, v45
  v_accvgpr_write_b32 a87, v46
  v_accvgpr_read_b32 v43, a88
  v_accvgpr_read_b32 v44, a89
  v_accvgpr_read_b32 v45, a90
  v_accvgpr_read_b32 v46, a91
  v_mul_f32 v43, v43, v42
  v_mul_f32 v44, v44, v42
  v_mul_f32 v45, v45, v42
  v_mul_f32 v46, v46, v42
  v_accvgpr_write_b32 a88, v43
  v_accvgpr_write_b32 a89, v44
  v_accvgpr_write_b32 a90, v45
  v_accvgpr_write_b32 a91, v46
  v_accvgpr_read_b32 v43, a92
  v_accvgpr_read_b32 v44, a93
  v_accvgpr_read_b32 v45, a94
  v_accvgpr_read_b32 v46, a95
  v_mul_f32 v43, v43, v42
  v_mul_f32 v44, v44, v42
  v_mul_f32 v45, v45, v42
  v_mul_f32 v46, v46, v42
  v_accvgpr_write_b32 a92, v43
  v_accvgpr_write_b32 a93, v44
  v_accvgpr_write_b32 a94, v45
  v_accvgpr_write_b32 a95, v46
  v_accvgpr_read_b32 v43, a96
  v_accvgpr_read_b32 v44, a97
  v_accvgpr_read_b32 v45, a98
  v_accvgpr_read_b32 v46, a99
  v_mul_f32 v43, v43, v41
  v_mul_f32 v44, v44, v41
  v_mul_f32 v45, v45, v41
  v_mul_f32 v46, v46, v41
  v_accvgpr_write_b32 a96, v43
  v_accvgpr_write_b32 a97, v44
  v_accvgpr_write_b32 a98, v45
  v_accvgpr_write_b32 a99, v46
  v_accvgpr_read_b32 v43, a100
  v_accvgpr_read_b32 v44, a101
  v_accvgpr_read_b32 v45, a102
  v_accvgpr_read_b32 v46, a103
  v_mul_f32 v43, v43, v41
  v_mul_f32 v44, v44, v41
  v_mul_f32 v45, v45, v41
  v_mul_f32 v46, v46, v41
  v_accvgpr_write_b32 a100, v43
  v_accvgpr_write_b32 a101, v44
  v_accvgpr_write_b32 a102, v45
  v_accvgpr_write_b32 a103, v46
  v_accvgpr_read_b32 v43, a104
  v_accvgpr_read_b32 v44, a105
  v_accvgpr_read_b32 v45, a106
  v_accvgpr_read_b32 v46, a107
  v_mul_f32 v43, v43, v41
  v_mul_f32 v44, v44, v41
  v_mul_f32 v45, v45, v41
  v_mul_f32 v46, v46, v41
  v_accvgpr_write_b32 a104, v43
  v_accvgpr_write_b32 a105, v44
  v_accvgpr_write_b32 a106, v45
  v_accvgpr_write_b32 a107, v46
  v_accvgpr_read_b32 v43, a108
  v_accvgpr_read_b32 v44, a109
  v_accvgpr_read_b32 v45, a110
  v_accvgpr_read_b32 v46, a111
  v_mul_f32 v43, v43, v41
  v_mul_f32 v44, v44, v41
  v_mul_f32 v45, v45, v41
  v_mul_f32 v46, v46, v41
  v_accvgpr_write_b32 a108, v43
  v_accvgpr_write_b32 a109, v44
  v_accvgpr_write_b32 a110, v45
  v_accvgpr_write_b32 a111, v46
  v_accvgpr_read_b32 v43, a112
  v_accvgpr_read_b32 v44, a113
  v_accvgpr_read_b32 v45, a114
  v_accvgpr_read_b32 v46, a115
  v_mul_f32 v43, v43, v42
  v_mul_f32 v44, v44, v42
  v_mul_f32 v45, v45, v42
  v_mul_f32 v46, v46, v42
  v_accvgpr_write_b32 a112, v43
  v_accvgpr_write_b32 a113, v44
  v_accvgpr_write_b32 a114, v45
  v_accvgpr_write_b32 a115, v46
  v_accvgpr_read_b32 v43, a116
  v_accvgpr_read_b32 v44, a117
  v_accvgpr_read_b32 v45, a118
  v_accvgpr_read_b32 v46, a119
  v_mul_f32 v43, v43, v42
  v_mul_f32 v44, v44, v42
  v_mul_f32 v45, v45, v42
  v_mul_f32 v46, v46, v42
  v_accvgpr_write_b32 a116, v43
  v_accvgpr_write_b32 a117, v44
  v_accvgpr_write_b32 a118, v45
  v_accvgpr_write_b32 a119, v46
  v_accvgpr_read_b32 v43, a120
  v_accvgpr_read_b32 v44, a121
  v_accvgpr_read_b32 v45, a122
  v_accvgpr_read_b32 v46, a123
  v_mul_f32 v43, v43, v42
  v_mul_f32 v44, v44, v42
  v_mul_f32 v45, v45, v42
  v_mul_f32 v46, v46, v42
  v_accvgpr_write_b32 a120, v43
  v_accvgpr_write_b32 a121, v44
  v_accvgpr_write_b32 a122, v45
  v_accvgpr_write_b32 a123, v46
  v_accvgpr_read_b32 v43, a124
  v_accvgpr_read_b32 v44, a125
  v_accvgpr_read_b32 v45, a126
  v_accvgpr_read_b32 v46, a127
  v_mul_f32 v43, v43, v42
  v_mul_f32 v44, v44, v42
  v_mul_f32 v45, v45, v42
  v_mul_f32 v46, v46, v42
  v_accvgpr_write_b32 a124, v43
  v_accvgpr_write_b32 a125, v44
  v_accvgpr_write_b32 a126, v45
  v_accvgpr_write_b32 a127, v46
  v_accvgpr_read_b32 v43, a128
  v_accvgpr_read_b32 v44, a129
  v_accvgpr_read_b32 v45, a130
  v_accvgpr_read_b32 v46, a131
  v_mul_f32 v43, v43, v41
  v_mul_f32 v44, v44, v41
  v_mul_f32 v45, v45, v41
  v_mul_f32 v46, v46, v41
  v_accvgpr_write_b32 a128, v43
  v_accvgpr_write_b32 a129, v44
  v_accvgpr_write_b32 a130, v45
  v_accvgpr_write_b32 a131, v46
  v_accvgpr_read_b32 v43, a132
  v_accvgpr_read_b32 v44, a133
  v_accvgpr_read_b32 v45, a134
  v_accvgpr_read_b32 v46, a135
  v_mul_f32 v43, v43, v41
  v_mul_f32 v44, v44, v41
  v_mul_f32 v45, v45, v41
  v_mul_f32 v46, v46, v41
  v_accvgpr_write_b32 a132, v43
  v_accvgpr_write_b32 a133, v44
  v_accvgpr_write_b32 a134, v45
  v_accvgpr_write_b32 a135, v46
  v_accvgpr_read_b32 v43, a136
  v_accvgpr_read_b32 v44, a137
  v_accvgpr_read_b32 v45, a138
  v_accvgpr_read_b32 v46, a139
  v_mul_f32 v43, v43, v41
  v_mul_f32 v44, v44, v41
  v_mul_f32 v45, v45, v41
  v_mul_f32 v46, v46, v41
  v_accvgpr_write_b32 a136, v43
  v_accvgpr_write_b32 a137, v44
  v_accvgpr_write_b32 a138, v45
  v_accvgpr_write_b32 a139, v46
  v_accvgpr_read_b32 v43, a140
  v_accvgpr_read_b32 v44, a141
  v_accvgpr_read_b32 v45, a142
  v_accvgpr_read_b32 v46, a143
  v_mul_f32 v43, v43, v41
  v_mul_f32 v44, v44, v41
  v_mul_f32 v45, v45, v41
  v_mul_f32 v46, v46, v41
  v_accvgpr_write_b32 a140, v43
  v_accvgpr_write_b32 a141, v44
  v_accvgpr_write_b32 a142, v45
  v_accvgpr_write_b32 a143, v46
  v_accvgpr_read_b32 v43, a144
  v_accvgpr_read_b32 v44, a145
  v_accvgpr_read_b32 v45, a146
  v_accvgpr_read_b32 v46, a147
  v_mul_f32 v43, v43, v42
  v_mul_f32 v44, v44, v42
  v_mul_f32 v45, v45, v42
  v_mul_f32 v46, v46, v42
  v_accvgpr_write_b32 a144, v43
  v_accvgpr_write_b32 a145, v44
  v_accvgpr_write_b32 a146, v45
  v_accvgpr_write_b32 a147, v46
  v_accvgpr_read_b32 v43, a148
  v_accvgpr_read_b32 v44, a149
  v_accvgpr_read_b32 v45, a150
  v_accvgpr_read_b32 v46, a151
  v_mul_f32 v43, v43, v42
  v_mul_f32 v44, v44, v42
  v_mul_f32 v45, v45, v42
  v_mul_f32 v46, v46, v42
  v_accvgpr_write_b32 a148, v43
  v_accvgpr_write_b32 a149, v44
  v_accvgpr_write_b32 a150, v45
  v_accvgpr_write_b32 a151, v46
  v_accvgpr_read_b32 v43, a152
  v_accvgpr_read_b32 v44, a153
  v_accvgpr_read_b32 v45, a154
  v_accvgpr_read_b32 v46, a155
  v_mul_f32 v43, v43, v42
  v_mul_f32 v44, v44, v42
  v_mul_f32 v45, v45, v42
  v_mul_f32 v46, v46, v42
  v_accvgpr_write_b32 a152, v43
  v_accvgpr_write_b32 a153, v44
  v_accvgpr_write_b32 a154, v45
  v_accvgpr_write_b32 a155, v46
  v_accvgpr_read_b32 v43, a156
  v_accvgpr_read_b32 v44, a157
  v_accvgpr_read_b32 v45, a158
  v_accvgpr_read_b32 v46, a159
  v_mul_f32 v43, v43, v42
  v_mul_f32 v44, v44, v42
  v_mul_f32 v45, v45, v42
  v_mul_f32 v46, v46, v42
  v_accvgpr_write_b32 a156, v43
  v_accvgpr_write_b32 a157, v44
  v_accvgpr_write_b32 a158, v45
  v_accvgpr_write_b32 a159, v46
  v_accvgpr_read_b32 v43, a160
  v_accvgpr_read_b32 v44, a161
  v_accvgpr_read_b32 v45, a162
  v_accvgpr_read_b32 v46, a163
  v_mul_f32 v43, v43, v41
  v_mul_f32 v44, v44, v41
  v_mul_f32 v45, v45, v41
  v_mul_f32 v46, v46, v41
  v_accvgpr_write_b32 a160, v43
  v_accvgpr_write_b32 a161, v44
  v_accvgpr_write_b32 a162, v45
  v_accvgpr_write_b32 a163, v46
  v_accvgpr_read_b32 v43, a164
  v_accvgpr_read_b32 v44, a165
  v_accvgpr_read_b32 v45, a166
  v_accvgpr_read_b32 v46, a167
  v_mul_f32 v43, v43, v41
  v_mul_f32 v44, v44, v41
  v_mul_f32 v45, v45, v41
  v_mul_f32 v46, v46, v41
  v_accvgpr_write_b32 a164, v43
  v_accvgpr_write_b32 a165, v44
  v_accvgpr_write_b32 a166, v45
  v_accvgpr_write_b32 a167, v46
  v_accvgpr_read_b32 v43, a168
  v_accvgpr_read_b32 v44, a169
  v_accvgpr_read_b32 v45, a170
  v_accvgpr_read_b32 v46, a171
  v_mul_f32 v43, v43, v41
  v_mul_f32 v44, v44, v41
  v_mul_f32 v45, v45, v41
  v_mul_f32 v46, v46, v41
  v_accvgpr_write_b32 a168, v43
  v_accvgpr_write_b32 a169, v44
  v_accvgpr_write_b32 a170, v45
  v_accvgpr_write_b32 a171, v46
  v_accvgpr_read_b32 v43, a172
  v_accvgpr_read_b32 v44, a173
  v_accvgpr_read_b32 v45, a174
  v_accvgpr_read_b32 v46, a175
  v_mul_f32 v43, v43, v41
  v_mul_f32 v44, v44, v41
  v_mul_f32 v45, v45, v41
  v_mul_f32 v46, v46, v41
  v_accvgpr_write_b32 a172, v43
  v_accvgpr_write_b32 a173, v44
  v_accvgpr_write_b32 a174, v45
  v_accvgpr_write_b32 a175, v46
  v_accvgpr_read_b32 v43, a176
  v_accvgpr_read_b32 v44, a177
  v_accvgpr_read_b32 v45, a178
  v_accvgpr_read_b32 v46, a179
  v_mul_f32 v43, v43, v42
  v_mul_f32 v44, v44, v42
  v_mul_f32 v45, v45, v42
  v_mul_f32 v46, v46, v42
  v_accvgpr_write_b32 a176, v43
  v_accvgpr_write_b32 a177, v44
  v_accvgpr_write_b32 a178, v45
  v_accvgpr_write_b32 a179, v46
  v_accvgpr_read_b32 v43, a180
  v_accvgpr_read_b32 v44, a181
  v_accvgpr_read_b32 v45, a182
  v_accvgpr_read_b32 v46, a183
  v_mul_f32 v43, v43, v42
  v_mul_f32 v44, v44, v42
  v_mul_f32 v45, v45, v42
  v_mul_f32 v46, v46, v42
  v_accvgpr_write_b32 a180, v43
  v_accvgpr_write_b32 a181, v44
  v_accvgpr_write_b32 a182, v45
  v_accvgpr_write_b32 a183, v46
  v_accvgpr_read_b32 v43, a184
  v_accvgpr_read_b32 v44, a185
  v_accvgpr_read_b32 v45, a186
  v_accvgpr_read_b32 v46, a187
  v_mul_f32 v43, v43, v42
  v_mul_f32 v44, v44, v42
  v_mul_f32 v45, v45, v42
  v_mul_f32 v46, v46, v42
  v_accvgpr_write_b32 a184, v43
  v_accvgpr_write_b32 a185, v44
  v_accvgpr_write_b32 a186, v45
  v_accvgpr_write_b32 a187, v46
  v_accvgpr_read_b32 v43, a188
  v_accvgpr_read_b32 v44, a189
  v_accvgpr_read_b32 v45, a190
  v_accvgpr_read_b32 v46, a191
  v_mul_f32 v43, v43, v42
  v_mul_f32 v44, v44, v42
  v_mul_f32 v45, v45, v42
  v_mul_f32 v46, v46, v42
  v_accvgpr_write_b32 a188, v43
  v_accvgpr_write_b32 a189, v44
  v_accvgpr_write_b32 a190, v45
  v_accvgpr_write_b32 a191, v46
  s_nop 3
  s_setpc_b64 s[70:71]
L_end:
  s_endpgm
.section .rodata,"a"
.p2align 6
.amdhsa_kernel adaLN_cond__sliding_block_cached__glu_gated_swiglu__prompt_kernel
  .amdhsa_next_free_vgpr 512
  .amdhsa_next_free_sgpr 102
  .amdhsa_accum_offset 256
  .amdhsa_group_segment_fixed_size 0
  .amdhsa_kernarg_size 112
  .amdhsa_user_sgpr_count 2
  .amdhsa_user_sgpr_kernarg_segment_ptr 1
  .amdhsa_system_sgpr_workgroup_id_x 1
.end_amdhsa_kernel
```
